```python
import torch

def _softmax(x, axis=-1):
    return torch.softmax(x, dim=axis)

def _gelu(x):
    return torch.nn.functional.gelu(x, approximate='tanh')

def _silu(x):
    return torch.nn.functional.silu(x)

def _sigmoid(x):
    return torch.sigmoid(x)

def _layernorm(x, axis=-1, eps=1e-05):
    m = x.mean(dim=axis, keepdim=True)
    v = x.var(dim=axis, keepdim=True, unbiased=False)
    return (x - m) / torch.sqrt(v + eps)

def _scatter_add(tgt, idx, src, axis=0):
    return tgt.clone().index_add_(axis, idx, src)

def _segment_sum(src, seg, n):
    out = torch.zeros((n,) + src.shape[1:], dtype=src.dtype)
    return out.index_add_(0, seg, src)

def _pad(x, pw):
    flat = tuple((v for pair in reversed(pw) for v in pair))
    return torch.nn.functional.pad(x, flat)
kernel_name = 'gated_mix__linear_kernel_hedgehog__mixer_gmlp__prompt'

def setup_inputs():

    _w = lambda a: (lambda t: t.to(torch.bfloat16) if t.is_floating_point() else t)(torch.as_tensor(a))

    def _A_setup():
        B, S, D, H = (1, 2048, 1024, 32)
        Dh = D // H
        return {'x': _w((lambda *s: torch.randn(*s, dtype=torch.bfloat16) * 0.05)(B, S, D)), 'wqkv': _w((lambda *s: torch.randn(*s, dtype=torch.bfloat16) * 1.6)(D, 3 * D)), 'w_phi': _w((lambda *s: torch.randn(*s, dtype=torch.bfloat16) * 1.6)(H, Dh, Dh) * Dh ** (-0.5)), 'wo': _w((lambda *s: torch.randn(*s, dtype=torch.bfloat16) * 0.1)(D, D))}
    _A_in = _A_setup()

    def _B_setup():
        B, S, D, F = (1, 2048, 1024, 3584)
        Fh = F // 2
        return {'x': _w((lambda *s: torch.randn(*s, dtype=torch.bfloat16) * 0.05)(B, S, D)), 'w_in': _w((lambda *s: torch.randn(*s, dtype=torch.bfloat16) * 0.4)(D, 2 * Fh)), 'w_sp': _w(0.01 * (lambda *s: torch.randn(*s, dtype=torch.bfloat16) * 0.4)(S, S)), 'b_sp': _w(1.0 + 0.01 * (lambda *s: torch.randn(*s, dtype=torch.bfloat16) * 0.05)(S)), 'w_out': _w((lambda *s: torch.randn(*s, dtype=torch.bfloat16) * 0.05)(Fh, D))}
    _B_in = _B_setup()
    return {'A_x': _A_in['x'], 'A_wqkv': _A_in['wqkv'], 'A_w_phi': _A_in['w_phi'], 'A_wo': _A_in['wo'], 'B_x': _B_in['x'], 'B_w_in': _B_in['w_in'], 'B_w_sp': _B_in['w_sp'], 'B_b_sp': _B_in['b_sp'], 'B_w_out': _B_in['w_out'], 'gate_w': _w((lambda *s: torch.randn(*s, dtype=torch.bfloat16) * 0.05)(1024) * 16.0)}

def reference(A_x, A_wqkv, A_w_phi, A_wo, B_x, B_w_in, B_w_sp, B_b_sp, B_w_out, gate_w):

    def _A_ref(x, wqkv, w_phi, wo):
        B, S, D = x.shape
        H = 32
        Dh = D // H
        qkv = (lambda x, *d: x.permute(*d))((x @ wqkv).reshape(B, S, 3, H, Dh), 2, 0, 3, 1, 4)
        q, k, v = (qkv[0], qkv[1], qkv[2])
        pq = torch.einsum('bhsd,hdf->bhsf', q, w_phi)
        pk = torch.einsum('bhsd,hdf->bhsf', k, w_phi)
        phi_q = torch.concatenate([_softmax(pq, axis=-1), _softmax(-pq, axis=-1)], axis=-1)
        phi_k = torch.concatenate([_softmax(pk, axis=-1), _softmax(-pk, axis=-1)], axis=-1)
        kv = torch.einsum('bhsf,bhsd->bhfd', phi_k, v)
        z = torch.einsum('bhsf->bhf', phi_k)
        num = torch.einsum('bhqf,bhfd->bhqd', phi_q, kv)
        den = torch.einsum('bhqf,bhf->bhq', phi_q, z)[..., None] + 1e-06
        o = num / den
        return (lambda x, *d: x.permute(*d))(o, 0, 2, 1, 3).reshape(B, S, D) @ wo

    def _B_ref(x, w_in, w_sp, b_sp, w_out):
        B, S, D = x.shape
        F = w_in.shape[-1]
        Fh = F // 2
        z = _gelu(torch.einsum('bsd,df->bsf', x, w_in))
        z1 = z[..., :Fh].clone()
        z2 = _layernorm(z[..., Fh:], axis=-1)
        g = torch.einsum('ts,bsf->btf', w_sp, z2) + b_sp[None, :, None]
        return torch.einsum('bsf,fd->bsd', z1 * g, w_out)
    x = A_x
    g = _sigmoid((x * gate_w).sum(-1, keepdims=True))
    a = _A_ref(x, A_wqkv, A_w_phi, A_wo)
    b = _B_ref(x, B_w_in, B_w_sp, B_b_sp, B_w_out)
    return g * a + (1 - g) * b
```

```asm
; @launch grid=(256,1,1) block=(512,1,1) lds=163840
.amdgcn_target "amdgcn-amd-amdhsa--gfx950"
.text
.globl gated_mix__linear_kernel_hedgehog__mixer_gmlp__prompt_kernel
.p2align 8
.type gated_mix__linear_kernel_hedgehog__mixer_gmlp__prompt_kernel,@function
gated_mix__linear_kernel_hedgehog__mixer_gmlp__prompt_kernel:

  s_cmp_ge_u32 s2, 256
  s_cbranch_scc1 L_end
  s_load_dwordx16 s[48:63], s[0:1], 0
  s_load_dwordx8 s[64:71], s[0:1], 64
  s_load_dwordx2 s[72:73], s[0:1], 96
  v_lshrrev_b32 v2, 6, v0
  v_and_b32 v1, 63, v0
  v_readfirstlane_b32 s3, v2
  v_mov_b32 v13, v0
  s_and_b32 s4, s2, 1
  s_lshl_b32 s40, s4, 3
  s_bfe_u32 s4, s2, 0x30003
  s_add_u32 s40, s40, s4
  s_bfe_u32 s4, s2, 0x20001
  s_lshl_b32 s41, s4, 2
  s_lshr_b32 s4, s2, 6
  s_add_u32 s41, s41, s4
  s_and_b32 s42, s2, 3
  s_lshl_b32 s42, s42, 2
  s_bfe_u32 s4, s2, 0x20003
  s_add_u32 s42, s42, s4
  s_bfe_u32 s43, s2, 0x10002
  s_lshl_b32 s43, s43, 3
  s_lshr_b32 s4, s2, 5
  s_add_u32 s43, s43, s4
  s_mov_b32 s46, 0x3fb8aa3b
  s_mov_b32 s80, 0xc0135761
  s_and_b32 s44, s3, 1
  s_lshr_b32 s45, s3, 1
  s_bfe_u32 s82, s3, 0x10001
  s_lshr_b32 s83, s3, 2
  v_lshrrev_b32 v0, 3, v1
  v_lshrrev_b32 v3, 4, v1
  v_xor_b32 v38, v3, v1
  v_and_b32 v38, 7, v38
  v_lshlrev_b32 v38, 4, v38
  s_cmp_eq_u32 s41, 15
  s_cbranch_scc1 L_aux
  s_lshl_b32 s77, s40, 7
  s_lshl_b32 s32, s3, 11
  s_mul_i32 s34, s3, 4096
  s_add_u32 s34, s34, 49152
  s_lshl_b32 s4, s3, 4
  s_add_u32 s4, s4, s77
  s_mul_i32 s33, s4, 2048
  v_mul_u32_u24 v2, 2048, v0
  v_add_u32 v14, v2, v38
  v_xor_b32 v15, 64, v38
  v_add_u32 v2, 15360, v2
  v_add_u32 v15, v15, v2
  s_cmp_ge_u32 s41, 8
  s_cbranch_scc1 L_z2a
  s_mov_b32 s74, 0
  s_lshl_b32 s78, s41, 2
  s_mul_i32 s35, s3, 49152
  s_and_b32 s4, s3, 1
  s_lshl_b32 s4, s4, 2
  v_lshrrev_b32 v2, 5, v1
  v_bfe_u32 v4, v1, 1, 4
  v_and_b32 v5, 3, v2
  v_or_b32 v5, s4, v5
  v_xor_b32 v4, v4, v5
  v_lshrrev_b32 v5, 2, v4
  v_add_u32 v5, s78, v5
  v_lshlrev_b32 v5, 6, v5
  v_and_b32 v7, 1, v4
  v_lshl_add_u32 v5, v7, 5, v5
  v_bfe_u32 v7, v4, 1, 1
  v_lshl_add_u32 v5, v7, 11, v5
  v_add_u32 v5, 2048, v5
  v_and_b32 v3, 1, v1
  v_lshl_add_u32 v5, v3, 4, v5
  v_mul_u32_u24 v2, 6144, v2
  v_add_u32 v16, v2, v5
  v_lshrrev_b32 v2, 5, v1
  v_add_u32 v2, 2, v2
  v_bfe_u32 v4, v1, 1, 4
  v_and_b32 v5, 3, v2
  v_or_b32 v5, s4, v5
  v_xor_b32 v4, v4, v5
  v_lshrrev_b32 v5, 2, v4
  v_add_u32 v5, s78, v5
  v_lshlrev_b32 v5, 6, v5
  v_and_b32 v7, 1, v4
  v_lshl_add_u32 v5, v7, 5, v5
  v_bfe_u32 v7, v4, 1, 1
  v_lshl_add_u32 v5, v7, 11, v5
  v_add_u32 v5, 2048, v5
  v_and_b32 v3, 1, v1
  v_lshl_add_u32 v5, v3, 4, v5
  v_mul_u32_u24 v2, 6144, v2
  v_add_u32 v2, v2, v5
  v_subrev_u32 v17, 1024, v2
  v_lshrrev_b32 v2, 5, v1
  v_add_u32 v2, 4, v2
  v_bfe_u32 v4, v1, 1, 4
  v_and_b32 v5, 3, v2
  v_or_b32 v5, s4, v5
  v_xor_b32 v4, v4, v5
  v_lshrrev_b32 v5, 2, v4
  v_add_u32 v5, s78, v5
  v_lshlrev_b32 v5, 6, v5
  v_and_b32 v7, 1, v4
  v_lshl_add_u32 v5, v7, 5, v5
  v_bfe_u32 v7, v4, 1, 1
  v_lshl_add_u32 v5, v7, 11, v5
  v_add_u32 v5, 2048, v5
  v_and_b32 v3, 1, v1
  v_lshl_add_u32 v5, v3, 4, v5
  v_mul_u32_u24 v2, 6144, v2
  v_add_u32 v2, v2, v5
  v_subrev_u32 v18, 2048, v2
  v_lshrrev_b32 v2, 5, v1
  v_add_u32 v2, 6, v2
  v_bfe_u32 v4, v1, 1, 4
  v_and_b32 v5, 3, v2
  v_or_b32 v5, s4, v5
  v_xor_b32 v4, v4, v5
  v_lshrrev_b32 v5, 2, v4
  v_add_u32 v5, s78, v5
  v_lshlrev_b32 v5, 6, v5
  v_and_b32 v7, 1, v4
  v_lshl_add_u32 v5, v7, 5, v5
  v_bfe_u32 v7, v4, 1, 1
  v_lshl_add_u32 v5, v7, 11, v5
  v_add_u32 v5, 2048, v5
  v_and_b32 v3, 1, v1
  v_lshl_add_u32 v5, v3, 4, v5
  v_mul_u32_u24 v2, 6144, v2
  v_add_u32 v2, v2, v5
  v_subrev_u32 v19, 3072, v2
  s_waitcnt lgkmcnt(0)
  s_mov_b32 s8, s72
  s_and_b32 s9, s73, 0xffff
  s_mov_b32 s10, 41943040
  s_mov_b32 s11, 0x20000
  s_mov_b32 s12, s48
  s_and_b32 s13, s49, 0xffff
  s_mov_b32 s14, 4194304
  s_mov_b32 s15, 0x20000
  s_mov_b32 s28, s52
  s_and_b32 s29, s53, 0xffff
  s_mov_b32 s30, 65536
  s_mov_b32 s31, 0x20000
  s_mov_b32 s16, s50
  s_and_b32 s17, s51, 0xffff
  s_mov_b32 s18, 6291456
  s_mov_b32 s19, 0x20000
  s_mov_b32 s79, 393216
  s_branch L_t1go
L_z2a:
  s_mov_b32 s74, 1
  s_sub_u32 s5, s41, 8
  s_lshl_b32 s78, s5, 9
  s_add_u32 s78, s78, 3584
  s_mul_i32 s35, s3, 57344
  s_and_b32 s4, s3, 1
  s_lshl_b32 s4, s4, 2
  v_lshrrev_b32 v2, 5, v1
  v_bfe_u32 v4, v1, 1, 4
  v_and_b32 v5, 3, v2
  v_or_b32 v5, s4, v5
  v_xor_b32 v4, v4, v5
  v_lshlrev_b32 v5, 5, v4
  v_add_u32 v5, s78, v5
  v_and_b32 v3, 1, v1
  v_lshl_add_u32 v5, v3, 4, v5
  v_mul_u32_u24 v2, 7168, v2
  v_add_u32 v16, v2, v5
  v_lshrrev_b32 v2, 5, v1
  v_add_u32 v2, 2, v2
  v_bfe_u32 v4, v1, 1, 4
  v_and_b32 v5, 3, v2
  v_or_b32 v5, s4, v5
  v_xor_b32 v4, v4, v5
  v_lshlrev_b32 v5, 5, v4
  v_add_u32 v5, s78, v5
  v_and_b32 v3, 1, v1
  v_lshl_add_u32 v5, v3, 4, v5
  v_mul_u32_u24 v2, 7168, v2
  v_add_u32 v2, v2, v5
  v_subrev_u32 v17, 1024, v2
  v_lshrrev_b32 v2, 5, v1
  v_add_u32 v2, 4, v2
  v_bfe_u32 v4, v1, 1, 4
  v_and_b32 v5, 3, v2
  v_or_b32 v5, s4, v5
  v_xor_b32 v4, v4, v5
  v_lshlrev_b32 v5, 5, v4
  v_add_u32 v5, s78, v5
  v_and_b32 v3, 1, v1
  v_lshl_add_u32 v5, v3, 4, v5
  v_mul_u32_u24 v2, 7168, v2
  v_add_u32 v2, v2, v5
  v_subrev_u32 v18, 2048, v2
  v_lshrrev_b32 v2, 5, v1
  v_add_u32 v2, 6, v2
  v_bfe_u32 v4, v1, 1, 4
  v_and_b32 v5, 3, v2
  v_or_b32 v5, s4, v5
  v_xor_b32 v4, v4, v5
  v_lshlrev_b32 v5, 5, v4
  v_add_u32 v5, s78, v5
  v_and_b32 v3, 1, v1
  v_lshl_add_u32 v5, v3, 4, v5
  v_mul_u32_u24 v2, 7168, v2
  v_add_u32 v2, v2, v5
  v_subrev_u32 v19, 3072, v2
  s_waitcnt lgkmcnt(0)
  s_mov_b32 s8, s72
  s_and_b32 s9, s73, 0xffff
  s_mov_b32 s10, 41943040
  s_mov_b32 s11, 0x20000
  s_mov_b32 s12, s48
  s_and_b32 s13, s49, 0xffff
  s_mov_b32 s14, 4194304
  s_mov_b32 s15, 0x20000
  s_mov_b32 s28, s52
  s_and_b32 s29, s53, 0xffff
  s_mov_b32 s30, 65536
  s_mov_b32 s31, 0x20000
  s_mov_b32 s16, s58
  s_and_b32 s17, s59, 0xffff
  s_mov_b32 s18, 7340032
  s_mov_b32 s19, 0x20000
  s_mov_b32 s79, 458752
L_t1go:
  s_add_u32 m0, s32, 0
  s_nop 0
  buffer_load_dwordx4 v14, s[12:15], s33 offen lds
  buffer_load_dwordx4 v15, s[12:15], s33 offen offset:1024 lds
  s_add_u32 s33, s33, 128
  s_add_u32 m0, s34, 0
  s_nop 0
  buffer_load_dwordx4 v16, s[16:19], s35 offen lds
  buffer_load_dwordx4 v17, s[16:19], s35 offen offset:1024 lds
  buffer_load_dwordx4 v18, s[16:19], s35 offen offset:2048 lds
  buffer_load_dwordx4 v19, s[16:19], s35 offen offset:3072 lds
  s_add_u32 s35, s35, s79
  s_and_b32 s4, s3, 1
  s_lshl_b32 s5, s4, 2
  v_lshrrev_b32 v2, 4, v1
  v_or_b32 v2, s5, v2
  v_bfe_u32 v3, v1, 1, 3
  v_xor_b32 v2, v2, v3
  s_add_u32 m0, s32, 16384
  s_nop 0
  buffer_load_dwordx4 v14, s[12:15], s33 offen lds
  v_and_b32 v3, 1, v1
  v_lshlrev_b32 v3, 4, v3
  v_lshl_add_u32 v39, v2, 5, v3
  v_cmp_eq_u32 vcc, 7, v2
  v_mov_b32 v4, 2146435072
  s_nop 0
  v_cndmask_b32 v39, v39, v4, vcc
  v_and_b32 v2, 15, v1
  s_mul_i32 s4, s44, 8192
  s_mul_i32 s5, s82, 4096
  s_add_u32 s4, s4, s5
  v_lshlrev_b32 v2, 7, v2
  v_add_u32 v2, s4, v2
  v_bfe_u32 v3, v1, 1, 3
  buffer_load_dwordx4 v15, s[12:15], s33 offen offset:1024 lds
  s_add_u32 s33, s33, 128
  v_lshrrev_b32 v4, 4, v1
  v_xor_b32 v4, v4, v3
  v_lshl_add_u32 v30, v4, 4, v2
  v_xor_b32 v31, 64, v30
  s_lshl_b32 s5, s83, 2
  v_lshrrev_b32 v2, 4, v1
  v_lshlrev_b32 v2, 3, v2
  v_bfe_u32 v3, v1, 2, 2
  v_add_u32 v2, v2, v3
  v_lshlrev_b32 v2, 8, v2
  v_add_u32 v2, 49152, v2
  v_and_b32 v4, 3, v1
  v_lshl_add_u32 v2, v4, 3, v2
  s_add_u32 m0, s34, 32768
  s_nop 0
  buffer_load_dwordx4 v16, s[16:19], s35 offen lds
  v_bfe_u32 v4, v1, 4, 1
  v_lshl_or_b32 v3, v4, 2, v3
  v_xor_b32 v3, s5, v3
  v_lshl_add_u32 v32, v3, 5, v2
  v_xor_b32 v33, 32, v32
  v_xor_b32 v34, 64, v32
  v_xor_b32 v35, 96, v32
  s_lshl_b32 s5, s83, 1
  v_lshrrev_b32 v2, 4, v1
  v_lshlrev_b32 v2, 3, v2
  v_bfe_u32 v3, v1, 2, 2
  v_add_u32 v2, v2, v3
  v_lshlrev_b32 v2, 7, v2
  buffer_load_dwordx4 v17, s[16:19], s35 offen offset:1024 lds
  v_add_u32 v2, 98304, v2
  v_and_b32 v4, 3, v1
  v_lshl_add_u32 v2, v4, 3, v2
  v_bfe_u32 v4, v1, 4, 1
  v_lshrrev_b32 v3, 1, v3
  v_lshl_or_b32 v3, v4, 1, v3
  v_xor_b32 v3, s5, v3
  v_lshl_add_u32 v36, v3, 5, v2
  v_xor_b32 v37, 32, v36
  s_mov_b32 s24, s48
  s_cmp_eq_u32 s3, 1
  s_cselect_b32 s24, s50, s24
  s_cmp_eq_u32 s3, 2
  s_cselect_b32 s24, s58, s24
  s_cmp_eq_u32 s3, 3
  s_cselect_b32 s24, s58, s24
  buffer_load_dwordx4 v18, s[16:19], s35 offen offset:2048 lds
  s_cmp_eq_u32 s3, 4
  s_cselect_b32 s24, s50, s24
  s_mov_b32 s25, s49
  s_cmp_eq_u32 s3, 1
  s_cselect_b32 s25, s51, s25
  s_cmp_eq_u32 s3, 2
  s_cselect_b32 s25, s59, s25
  s_cmp_eq_u32 s3, 3
  s_cselect_b32 s25, s59, s25
  s_cmp_eq_u32 s3, 4
  s_cselect_b32 s25, s51, s25
  s_and_b32 s25, s25, 0xffff
  s_mov_b32 s26, 4194304
  s_cmp_eq_u32 s3, 1
  s_cselect_b32 s26, 6291456, s26
  s_cmp_eq_u32 s3, 2
  s_cselect_b32 s26, 7340032, s26
  s_cmp_eq_u32 s3, 3
  s_cselect_b32 s26, 0, s26
  s_cmp_eq_u32 s3, 4
  s_cselect_b32 s26, 0, s26
  s_cmp_eq_u32 s3, 5
  s_cselect_b32 s26, 0, s26
  buffer_load_dwordx4 v19, s[16:19], s35 offen offset:3072 lds
  s_add_u32 s35, s35, s79
  s_cmp_eq_u32 s3, 6
  s_cselect_b32 s26, 0, s26
  s_cmp_eq_u32 s3, 7
  s_cselect_b32 s26, 0, s26
  s_mov_b32 s27, 0x20000
  s_mov_b32 s39, 128
  s_cmp_eq_u32 s3, 1
  s_cselect_b32 s39, 393216, s39
  s_cmp_eq_u32 s3, 2
  s_cselect_b32 s39, 458752, s39
  s_cmp_eq_u32 s3, 3
  s_cselect_b32 s39, 458752, s39
  s_cmp_eq_u32 s3, 4
  s_cselect_b32 s39, 393216, s39
  s_cmp_eq_u32 s3, 5
  s_cselect_b32 s39, 0, s39
  s_cmp_eq_u32 s3, 6
  s_cselect_b32 s39, 0, s39
  s_cmp_eq_u32 s3, 7
  s_cselect_b32 s39, 0, s39
  v_lshrrev_b32 v2, 3, v1
  s_add_u32 m0, s32, 32768
  s_nop 0
  buffer_load_dwordx4 v14, s[12:15], s33 offen lds
  s_mov_b32 s4, 7
  s_cmp_eq_u32 s3, 2
  s_cselect_b32 s4, 6, s4
  s_cmp_eq_u32 s3, 3
  s_cselect_b32 s4, 6, s4
  s_cmp_eq_u32 s3, 4
  s_cselect_b32 s4, 3, s4
  s_cmp_eq_u32 s3, 5
  s_cselect_b32 s4, 0, s4
  s_cmp_eq_u32 s3, 6
  s_cselect_b32 s4, 0, s4
  s_cmp_eq_u32 s3, 7
  s_cselect_b32 s4, 0, s4
  v_min_u32 v2, s4, v2
  s_mov_b32 s4, 2048
  s_cmp_eq_u32 s3, 1
  s_cselect_b32 s4, 128, s4
  s_cmp_eq_u32 s3, 2
  s_cselect_b32 s4, 128, s4
  s_cmp_eq_u32 s3, 3
  s_cselect_b32 s4, 128, s4
  s_cmp_eq_u32 s3, 4
  s_cselect_b32 s4, 128, s4
  buffer_load_dwordx4 v15, s[12:15], s33 offen offset:1024 lds
  s_add_u32 s33, s33, 128
  s_cmp_eq_u32 s3, 5
  s_cselect_b32 s4, 0, s4
  s_cmp_eq_u32 s3, 6
  s_cselect_b32 s4, 0, s4
  s_cmp_eq_u32 s3, 7
  s_cselect_b32 s4, 0, s4
  v_mul_lo_u32 v11, v2, s4
  s_lshr_b32 s5, s2, 2
  s_and_b32 s6, s2, 3
  s_mul_i32 s38, s2, 16384
  s_mul_i32 s75, s5, 6144
  s_mul_i32 s76, s6, 1024
  s_add_u32 s75, s75, s76
  s_add_u32 s75, s75, 2048
  s_cmp_eq_u32 s3, 1
  s_cselect_b32 s38, s75, s38
  s_mul_i32 s75, s5, 7168
  s_add_u32 m0, s34, 65536
  s_nop 0
  buffer_load_dwordx4 v16, s[16:19], s35 offen lds
  s_mul_i32 s76, s6, 896
  s_add_u32 s75, s75, s76
  s_add_u32 s75, s75, 3584
  s_cmp_eq_u32 s3, 2
  s_cselect_b32 s38, s75, s38
  s_mul_i32 s75, s5, 7168
  s_mul_i32 s76, s6, 896
  s_add_u32 s75, s75, s76
  s_cmp_eq_u32 s3, 3
  s_cselect_b32 s38, s75, s38
  s_mul_i32 s75, s5, 6144
  s_mul_i32 s76, s6, 512
  s_add_u32 s75, s75, s76
  s_cmp_eq_u32 s3, 4
  s_cselect_b32 s38, s75, s38
  s_mul_i32 s84, s39, 15
  buffer_load_dwordx4 v17, s[16:19], s35 offen offset:1024 lds
  s_add_u32 s84, s84, s38
  s_mul_i32 s75, s39, 3
  s_cmp_lt_u32 s3, 3
  s_cselect_b32 s75, s75, 0
  s_add_u32 s38, s38, s75
  v_and_b32 v2, 15, v1
  s_mul_i32 s4, s44, 8192
  v_lshlrev_b32 v2, 7, v2
  v_add_u32 v2, s4, v2
  v_bfe_u32 v3, v1, 1, 3
  v_lshrrev_b32 v4, 4, v1
  v_xor_b32 v4, v4, v3
  v_lshl_add_u32 v20, v4, 4, v2
  v_xor_b32 v21, 64, v20
  buffer_load_dwordx4 v18, s[16:19], s35 offen offset:2048 lds
  s_lshl_b32 s5, s45, 2
  v_lshrrev_b32 v2, 4, v1
  v_lshlrev_b32 v2, 3, v2
  v_bfe_u32 v3, v1, 2, 2
  v_add_u32 v2, v2, v3
  v_lshlrev_b32 v2, 9, v2
  v_add_u32 v2, 49152, v2
  v_and_b32 v4, 3, v1
  v_lshl_add_u32 v2, v4, 3, v2
  v_bfe_u32 v4, v1, 4, 1
  v_lshl_or_b32 v3, v4, 2, v3
  v_xor_b32 v3, s5, v3
  v_lshl_add_u32 v22, v3, 5, v2
  buffer_load_dwordx4 v19, s[16:19], s35 offen offset:3072 lds
  s_add_u32 s35, s35, s79
  v_xor_b32 v24, 32, v22
  v_xor_b32 v26, 64, v22
  v_xor_b32 v28, 96, v22
  v_add_u32 v23, 65536, v22
  v_add_u32 v25, 65536, v24
  v_add_u32 v27, 65536, v26
  v_add_u32 v29, 65536, v28
  s_and_b32 s4, s3, 3
  s_lshl_b32 s4, s4, 10
  s_add_u32 m0, s4, 155648
  s_lshl_b32 s5, s43, 12
  s_add_u32 s4, s4, s5
  v_lshlrev_b32 v2, 4, v1
  buffer_load_dwordx4 v2, s[28:31], s4 offen lds
  s_lshl_b32 s4, s3, 10
  s_add_u32 m0, s4, 147456
  s_and_b32 s5, s41, 7
  s_lshl_b32 s5, s5, 13
  s_add_u32 s4, s4, s5
  buffer_load_dwordx4 v2, s[28:31], s4 offen lds
  buffer_load_dword v10, v11, s[24:27], s38 offen
  s_add_u32 s38, s38, s39
  s_min_u32 s38, s38, s84
  buffer_load_dword v10, v11, s[24:27], s38 offen
  s_add_u32 s38, s38, s39
  s_min_u32 s38, s38, s84
  buffer_load_dword v10, v11, s[24:27], s38 offen
  s_add_u32 s38, s38, s39
  s_min_u32 s38, s38, s84
  s_cmp_eq_u32 s74, 0
  s_cbranch_scc0 L_z2loop
  s_waitcnt vmcnt(17)
  s_barrier
  ds_read_b128 v[104:107], v20 offset:0
  ds_read_b64_tr_b16 v[136:137], v22 offset:0
  ds_read_b64_tr_b16 v[138:139], v22 offset:2048
  ds_read_b64_tr_b16 v[140:141], v24 offset:0
  ds_read_b64_tr_b16 v[142:143], v24 offset:2048
  ds_read_b64_tr_b16 v[144:145], v26 offset:0
  ds_read_b64_tr_b16 v[146:147], v26 offset:2048
  ds_read_b64_tr_b16 v[148:149], v28 offset:0
  ds_read_b64_tr_b16 v[150:151], v28 offset:2048
  ds_read_b128 v[108:111], v20 offset:2048
  ds_read_b128 v[112:115], v20 offset:4096
  ds_read_b128 v[116:119], v20 offset:6144
  s_waitcnt lgkmcnt(0)
  v_mfma_f32_16x16x32_bf16 v[40:43], v[136:139], v[104:107], 0
  ds_read_b128 v[120:123], v21 offset:0
  v_mfma_f32_16x16x32_bf16 v[44:47], v[140:143], v[104:107], 0
  ds_read_b64_tr_b16 v[152:153], v22 offset:16384
  v_mfma_f32_16x16x32_bf16 v[48:51], v[104:107], v[144:147], 0
  ds_read_b64_tr_b16 v[154:155], v22 offset:18432
  v_mfma_f32_16x16x32_bf16 v[52:55], v[104:107], v[148:151], 0
  ds_read_b64_tr_b16 v[156:157], v24 offset:16384
  v_mfma_f32_16x16x32_bf16 v[68:71], v[108:111], v[148:151], 0
  ds_read_b64_tr_b16 v[158:159], v24 offset:18432
  v_mfma_f32_16x16x32_bf16 v[64:67], v[108:111], v[144:147], 0
  ds_read_b64_tr_b16 v[160:161], v26 offset:16384
  v_mfma_f32_16x16x32_bf16 v[60:63], v[140:143], v[108:111], 0
  ds_read_b64_tr_b16 v[162:163], v26 offset:18432
  v_mfma_f32_16x16x32_bf16 v[56:59], v[136:139], v[108:111], 0
  ds_read_b64_tr_b16 v[164:165], v28 offset:16384
  v_mfma_f32_16x16x32_bf16 v[72:75], v[136:139], v[112:115], 0
  ds_read_b64_tr_b16 v[166:167], v28 offset:18432
  v_mfma_f32_16x16x32_bf16 v[76:79], v[140:143], v[112:115], 0
  ds_read_b128 v[124:127], v21 offset:2048
  v_mfma_f32_16x16x32_bf16 v[80:83], v[112:115], v[144:147], 0
  ds_read_b128 v[128:131], v21 offset:4096
  v_mfma_f32_16x16x32_bf16 v[84:87], v[112:115], v[148:151], 0
  ds_read_b128 v[132:135], v21 offset:6144
  v_mfma_f32_16x16x32_bf16 v[100:103], v[116:119], v[148:151], 0
  v_mfma_f32_16x16x32_bf16 v[96:99], v[116:119], v[144:147], 0
  v_mfma_f32_16x16x32_bf16 v[92:95], v[140:143], v[116:119], 0
  v_mfma_f32_16x16x32_bf16 v[88:91], v[136:139], v[116:119], 0
  s_waitcnt vmcnt(11) lgkmcnt(0)
  s_barrier
  v_mfma_f32_16x16x32_bf16 v[40:43], v[152:155], v[120:123], v[40:43]
  ds_read_b128 v[104:107], v20 offset:16384
  v_mfma_f32_16x16x32_bf16 v[44:47], v[156:159], v[120:123], v[44:47]
  ds_read_b64_tr_b16 v[136:137], v22 offset:32768
  v_mfma_f32_16x16x32_bf16 v[48:51], v[120:123], v[160:163], v[48:51]
  ds_read_b64_tr_b16 v[138:139], v22 offset:34816
  s_add_u32 m0, s32, 0
  s_nop 0
  buffer_load_dwordx4 v14, s[12:15], s33 offen lds
  v_mfma_f32_16x16x32_bf16 v[52:55], v[120:123], v[164:167], v[52:55]
  ds_read_b64_tr_b16 v[140:141], v24 offset:32768
  v_mfma_f32_16x16x32_bf16 v[68:71], v[124:127], v[164:167], v[68:71]
  ds_read_b64_tr_b16 v[142:143], v24 offset:34816
  v_mfma_f32_16x16x32_bf16 v[64:67], v[124:127], v[160:163], v[64:67]
  ds_read_b64_tr_b16 v[144:145], v26 offset:32768
  v_mfma_f32_16x16x32_bf16 v[60:63], v[156:159], v[124:127], v[60:63]
  ds_read_b64_tr_b16 v[146:147], v26 offset:34816
  v_mfma_f32_16x16x32_bf16 v[56:59], v[152:155], v[124:127], v[56:59]
  ds_read_b64_tr_b16 v[148:149], v28 offset:32768
  v_mfma_f32_16x16x32_bf16 v[72:75], v[152:155], v[128:131], v[72:75]
  ds_read_b64_tr_b16 v[150:151], v28 offset:34816
  buffer_load_dwordx4 v15, s[12:15], s33 offen offset:1024 lds
  s_add_u32 s33, s33, 128
  v_mfma_f32_16x16x32_bf16 v[76:79], v[156:159], v[128:131], v[76:79]
  ds_read_b128 v[108:111], v20 offset:18432
  v_mfma_f32_16x16x32_bf16 v[80:83], v[128:131], v[160:163], v[80:83]
  ds_read_b128 v[112:115], v20 offset:20480
  v_mfma_f32_16x16x32_bf16 v[84:87], v[128:131], v[164:167], v[84:87]
  ds_read_b128 v[116:119], v20 offset:22528
  v_mfma_f32_16x16x32_bf16 v[100:103], v[132:135], v[164:167], v[100:103]
  v_mfma_f32_16x16x32_bf16 v[96:99], v[132:135], v[160:163], v[96:99]
  s_add_u32 m0, s34, 0
  s_nop 0
  buffer_load_dwordx4 v16, s[16:19], s35 offen lds
  v_mfma_f32_16x16x32_bf16 v[92:95], v[156:159], v[132:135], v[92:95]
  v_mfma_f32_16x16x32_bf16 v[88:91], v[152:155], v[132:135], v[88:91]
  s_waitcnt lgkmcnt(0)
  v_mfma_f32_16x16x32_bf16 v[40:43], v[136:139], v[104:107], v[40:43]
  ds_read_b128 v[120:123], v21 offset:16384
  v_mfma_f32_16x16x32_bf16 v[44:47], v[140:143], v[104:107], v[44:47]
  ds_read_b64_tr_b16 v[152:153], v22 offset:49152
  v_mfma_f32_16x16x32_bf16 v[48:51], v[104:107], v[144:147], v[48:51]
  ds_read_b64_tr_b16 v[154:155], v22 offset:51200
  buffer_load_dwordx4 v17, s[16:19], s35 offen offset:1024 lds
  v_mfma_f32_16x16x32_bf16 v[52:55], v[104:107], v[148:151], v[52:55]
  ds_read_b64_tr_b16 v[156:157], v24 offset:49152
  v_mfma_f32_16x16x32_bf16 v[68:71], v[108:111], v[148:151], v[68:71]
  ds_read_b64_tr_b16 v[158:159], v24 offset:51200
  v_mfma_f32_16x16x32_bf16 v[64:67], v[108:111], v[144:147], v[64:67]
  ds_read_b64_tr_b16 v[160:161], v26 offset:49152
  v_mfma_f32_16x16x32_bf16 v[60:63], v[140:143], v[108:111], v[60:63]
  ds_read_b64_tr_b16 v[162:163], v26 offset:51200
  buffer_load_dwordx4 v18, s[16:19], s35 offen offset:2048 lds
  v_mfma_f32_16x16x32_bf16 v[56:59], v[136:139], v[108:111], v[56:59]
  ds_read_b64_tr_b16 v[164:165], v28 offset:49152
  v_mfma_f32_16x16x32_bf16 v[72:75], v[136:139], v[112:115], v[72:75]
  ds_read_b64_tr_b16 v[166:167], v28 offset:51200
  v_mfma_f32_16x16x32_bf16 v[76:79], v[140:143], v[112:115], v[76:79]
  ds_read_b128 v[124:127], v21 offset:18432
  v_mfma_f32_16x16x32_bf16 v[80:83], v[112:115], v[144:147], v[80:83]
  ds_read_b128 v[128:131], v21 offset:20480
  buffer_load_dwordx4 v19, s[16:19], s35 offen offset:3072 lds
  s_add_u32 s35, s35, s79
  v_mfma_f32_16x16x32_bf16 v[84:87], v[112:115], v[148:151], v[84:87]
  ds_read_b128 v[132:135], v21 offset:22528
  v_mfma_f32_16x16x32_bf16 v[100:103], v[116:119], v[148:151], v[100:103]
  v_mfma_f32_16x16x32_bf16 v[96:99], v[116:119], v[144:147], v[96:99]
  v_mfma_f32_16x16x32_bf16 v[92:95], v[140:143], v[116:119], v[92:95]
  buffer_load_dword v10, v11, s[24:27], s38 offen
  s_add_u32 s38, s38, s39
  s_min_u32 s38, s38, s84
  v_mfma_f32_16x16x32_bf16 v[88:91], v[136:139], v[116:119], v[88:91]
  s_waitcnt vmcnt(12) lgkmcnt(0)
  s_barrier
  v_mfma_f32_16x16x32_bf16 v[40:43], v[152:155], v[120:123], v[40:43]
  ds_read_b128 v[104:107], v20 offset:32768
  v_mfma_f32_16x16x32_bf16 v[44:47], v[156:159], v[120:123], v[44:47]
  ds_read_b64_tr_b16 v[136:137], v23 offset:0
  v_mfma_f32_16x16x32_bf16 v[48:51], v[120:123], v[160:163], v[48:51]
  ds_read_b64_tr_b16 v[138:139], v23 offset:2048
  s_add_u32 m0, s32, 16384
  s_nop 0
  buffer_load_dwordx4 v14, s[12:15], s33 offen lds
  v_mfma_f32_16x16x32_bf16 v[52:55], v[120:123], v[164:167], v[52:55]
  ds_read_b64_tr_b16 v[140:141], v25 offset:0
  v_mfma_f32_16x16x32_bf16 v[68:71], v[124:127], v[164:167], v[68:71]
  ds_read_b64_tr_b16 v[142:143], v25 offset:2048
  v_mfma_f32_16x16x32_bf16 v[64:67], v[124:127], v[160:163], v[64:67]
  ds_read_b64_tr_b16 v[144:145], v27 offset:0
  v_mfma_f32_16x16x32_bf16 v[60:63], v[156:159], v[124:127], v[60:63]
  ds_read_b64_tr_b16 v[146:147], v27 offset:2048
  v_mfma_f32_16x16x32_bf16 v[56:59], v[152:155], v[124:127], v[56:59]
  ds_read_b64_tr_b16 v[148:149], v29 offset:0
  v_mfma_f32_16x16x32_bf16 v[72:75], v[152:155], v[128:131], v[72:75]
  ds_read_b64_tr_b16 v[150:151], v29 offset:2048
  buffer_load_dwordx4 v15, s[12:15], s33 offen offset:1024 lds
  s_add_u32 s33, s33, 128
  v_mfma_f32_16x16x32_bf16 v[76:79], v[156:159], v[128:131], v[76:79]
  ds_read_b128 v[108:111], v20 offset:34816
  v_mfma_f32_16x16x32_bf16 v[80:83], v[128:131], v[160:163], v[80:83]
  ds_read_b128 v[112:115], v20 offset:36864
  v_mfma_f32_16x16x32_bf16 v[84:87], v[128:131], v[164:167], v[84:87]
  ds_read_b128 v[116:119], v20 offset:38912
  v_mfma_f32_16x16x32_bf16 v[100:103], v[132:135], v[164:167], v[100:103]
  v_mfma_f32_16x16x32_bf16 v[96:99], v[132:135], v[160:163], v[96:99]
  s_add_u32 m0, s34, 32768
  s_nop 0
  buffer_load_dwordx4 v16, s[16:19], s35 offen lds
  v_mfma_f32_16x16x32_bf16 v[92:95], v[156:159], v[132:135], v[92:95]
  v_mfma_f32_16x16x32_bf16 v[88:91], v[152:155], v[132:135], v[88:91]
  s_waitcnt lgkmcnt(0)
  v_mfma_f32_16x16x32_bf16 v[40:43], v[136:139], v[104:107], v[40:43]
  ds_read_b128 v[120:123], v21 offset:32768
  v_mfma_f32_16x16x32_bf16 v[44:47], v[140:143], v[104:107], v[44:47]
  ds_read_b64_tr_b16 v[152:153], v23 offset:16384
  v_mfma_f32_16x16x32_bf16 v[48:51], v[104:107], v[144:147], v[48:51]
  ds_read_b64_tr_b16 v[154:155], v23 offset:18432
  buffer_load_dwordx4 v17, s[16:19], s35 offen offset:1024 lds
  v_mfma_f32_16x16x32_bf16 v[52:55], v[104:107], v[148:151], v[52:55]
  ds_read_b64_tr_b16 v[156:157], v25 offset:16384
  v_mfma_f32_16x16x32_bf16 v[68:71], v[108:111], v[148:151], v[68:71]
  ds_read_b64_tr_b16 v[158:159], v25 offset:18432
  v_mfma_f32_16x16x32_bf16 v[64:67], v[108:111], v[144:147], v[64:67]
  ds_read_b64_tr_b16 v[160:161], v27 offset:16384
  v_mfma_f32_16x16x32_bf16 v[60:63], v[140:143], v[108:111], v[60:63]
  ds_read_b64_tr_b16 v[162:163], v27 offset:18432
  buffer_load_dwordx4 v18, s[16:19], s35 offen offset:2048 lds
  v_mfma_f32_16x16x32_bf16 v[56:59], v[136:139], v[108:111], v[56:59]
  ds_read_b64_tr_b16 v[164:165], v29 offset:16384
  v_mfma_f32_16x16x32_bf16 v[72:75], v[136:139], v[112:115], v[72:75]
  ds_read_b64_tr_b16 v[166:167], v29 offset:18432
  v_mfma_f32_16x16x32_bf16 v[76:79], v[140:143], v[112:115], v[76:79]
  ds_read_b128 v[124:127], v21 offset:34816
  v_mfma_f32_16x16x32_bf16 v[80:83], v[112:115], v[144:147], v[80:83]
  ds_read_b128 v[128:131], v21 offset:36864
  buffer_load_dwordx4 v19, s[16:19], s35 offen offset:3072 lds
  s_add_u32 s35, s35, s79
  v_mfma_f32_16x16x32_bf16 v[84:87], v[112:115], v[148:151], v[84:87]
  ds_read_b128 v[132:135], v21 offset:38912
  v_mfma_f32_16x16x32_bf16 v[100:103], v[116:119], v[148:151], v[100:103]
  v_mfma_f32_16x16x32_bf16 v[96:99], v[116:119], v[144:147], v[96:99]
  v_mfma_f32_16x16x32_bf16 v[92:95], v[140:143], v[116:119], v[92:95]
  buffer_load_dword v10, v11, s[24:27], s38 offen
  s_add_u32 s38, s38, s39
  s_min_u32 s38, s38, s84
  v_mfma_f32_16x16x32_bf16 v[88:91], v[136:139], v[116:119], v[88:91]
  s_waitcnt vmcnt(8) lgkmcnt(0)
  s_barrier
  v_mfma_f32_16x16x32_bf16 v[40:43], v[152:155], v[120:123], v[40:43]
  ds_read_b128 v[104:107], v20 offset:0
  v_mfma_f32_16x16x32_bf16 v[44:47], v[156:159], v[120:123], v[44:47]
  ds_read_b64_tr_b16 v[136:137], v22 offset:0
  v_mfma_f32_16x16x32_bf16 v[48:51], v[120:123], v[160:163], v[48:51]
  ds_read_b64_tr_b16 v[138:139], v22 offset:2048
  s_add_u32 m0, s32, 32768
  s_nop 0
  buffer_load_dwordx4 v14, s[12:15], s33 offen lds
  v_mfma_f32_16x16x32_bf16 v[52:55], v[120:123], v[164:167], v[52:55]
  ds_read_b64_tr_b16 v[140:141], v24 offset:0
  v_mfma_f32_16x16x32_bf16 v[68:71], v[124:127], v[164:167], v[68:71]
  ds_read_b64_tr_b16 v[142:143], v24 offset:2048
  v_mfma_f32_16x16x32_bf16 v[64:67], v[124:127], v[160:163], v[64:67]
  ds_read_b64_tr_b16 v[144:145], v26 offset:0
  v_mfma_f32_16x16x32_bf16 v[60:63], v[156:159], v[124:127], v[60:63]
  ds_read_b64_tr_b16 v[146:147], v26 offset:2048
  v_mfma_f32_16x16x32_bf16 v[56:59], v[152:155], v[124:127], v[56:59]
  ds_read_b64_tr_b16 v[148:149], v28 offset:0
  v_mfma_f32_16x16x32_bf16 v[72:75], v[152:155], v[128:131], v[72:75]
  ds_read_b64_tr_b16 v[150:151], v28 offset:2048
  buffer_load_dwordx4 v15, s[12:15], s33 offen offset:1024 lds
  s_add_u32 s33, s33, 128
  v_mfma_f32_16x16x32_bf16 v[76:79], v[156:159], v[128:131], v[76:79]
  ds_read_b128 v[108:111], v20 offset:2048
  v_mfma_f32_16x16x32_bf16 v[80:83], v[128:131], v[160:163], v[80:83]
  ds_read_b128 v[112:115], v20 offset:4096
  v_mfma_f32_16x16x32_bf16 v[84:87], v[128:131], v[164:167], v[84:87]
  ds_read_b128 v[116:119], v20 offset:6144
  v_mfma_f32_16x16x32_bf16 v[100:103], v[132:135], v[164:167], v[100:103]
  v_mfma_f32_16x16x32_bf16 v[96:99], v[132:135], v[160:163], v[96:99]
  s_add_u32 m0, s34, 65536
  s_nop 0
  buffer_load_dwordx4 v16, s[16:19], s35 offen lds
  v_mfma_f32_16x16x32_bf16 v[92:95], v[156:159], v[132:135], v[92:95]
  v_mfma_f32_16x16x32_bf16 v[88:91], v[152:155], v[132:135], v[88:91]
  s_waitcnt lgkmcnt(0)
  v_mfma_f32_16x16x32_bf16 v[40:43], v[136:139], v[104:107], v[40:43]
  ds_read_b128 v[120:123], v21 offset:0
  v_mfma_f32_16x16x32_bf16 v[44:47], v[140:143], v[104:107], v[44:47]
  ds_read_b64_tr_b16 v[152:153], v22 offset:16384
  v_mfma_f32_16x16x32_bf16 v[48:51], v[104:107], v[144:147], v[48:51]
  ds_read_b64_tr_b16 v[154:155], v22 offset:18432
  buffer_load_dwordx4 v17, s[16:19], s35 offen offset:1024 lds
  v_mfma_f32_16x16x32_bf16 v[52:55], v[104:107], v[148:151], v[52:55]
  ds_read_b64_tr_b16 v[156:157], v24 offset:16384
  v_mfma_f32_16x16x32_bf16 v[68:71], v[108:111], v[148:151], v[68:71]
  ds_read_b64_tr_b16 v[158:159], v24 offset:18432
  v_mfma_f32_16x16x32_bf16 v[64:67], v[108:111], v[144:147], v[64:67]
  ds_read_b64_tr_b16 v[160:161], v26 offset:16384
  v_mfma_f32_16x16x32_bf16 v[60:63], v[140:143], v[108:111], v[60:63]
  ds_read_b64_tr_b16 v[162:163], v26 offset:18432
  buffer_load_dwordx4 v18, s[16:19], s35 offen offset:2048 lds
  v_mfma_f32_16x16x32_bf16 v[56:59], v[136:139], v[108:111], v[56:59]
  ds_read_b64_tr_b16 v[164:165], v28 offset:16384
  v_mfma_f32_16x16x32_bf16 v[72:75], v[136:139], v[112:115], v[72:75]
  ds_read_b64_tr_b16 v[166:167], v28 offset:18432
  v_mfma_f32_16x16x32_bf16 v[76:79], v[140:143], v[112:115], v[76:79]
  ds_read_b128 v[124:127], v21 offset:2048
  v_mfma_f32_16x16x32_bf16 v[80:83], v[112:115], v[144:147], v[80:83]
  ds_read_b128 v[128:131], v21 offset:4096
  buffer_load_dwordx4 v19, s[16:19], s35 offen offset:3072 lds
  s_add_u32 s35, s35, s79
  v_mfma_f32_16x16x32_bf16 v[84:87], v[112:115], v[148:151], v[84:87]
  ds_read_b128 v[132:135], v21 offset:6144
  v_mfma_f32_16x16x32_bf16 v[100:103], v[116:119], v[148:151], v[100:103]
  v_mfma_f32_16x16x32_bf16 v[96:99], v[116:119], v[144:147], v[96:99]
  v_mfma_f32_16x16x32_bf16 v[92:95], v[140:143], v[116:119], v[92:95]
  buffer_load_dword v10, v11, s[24:27], s38 offen
  s_add_u32 s38, s38, s39
  s_min_u32 s38, s38, s84
  v_mfma_f32_16x16x32_bf16 v[88:91], v[136:139], v[116:119], v[88:91]
  s_waitcnt vmcnt(8) lgkmcnt(0)
  s_barrier
  v_mfma_f32_16x16x32_bf16 v[40:43], v[152:155], v[120:123], v[40:43]
  ds_read_b128 v[104:107], v20 offset:16384
  v_mfma_f32_16x16x32_bf16 v[44:47], v[156:159], v[120:123], v[44:47]
  ds_read_b64_tr_b16 v[136:137], v22 offset:32768
  v_mfma_f32_16x16x32_bf16 v[48:51], v[120:123], v[160:163], v[48:51]
  ds_read_b64_tr_b16 v[138:139], v22 offset:34816
  s_add_u32 m0, s32, 0
  s_nop 0
  buffer_load_dwordx4 v14, s[12:15], s33 offen lds
  v_mfma_f32_16x16x32_bf16 v[52:55], v[120:123], v[164:167], v[52:55]
  ds_read_b64_tr_b16 v[140:141], v24 offset:32768
  v_mfma_f32_16x16x32_bf16 v[68:71], v[124:127], v[164:167], v[68:71]
  ds_read_b64_tr_b16 v[142:143], v24 offset:34816
  v_mfma_f32_16x16x32_bf16 v[64:67], v[124:127], v[160:163], v[64:67]
  ds_read_b64_tr_b16 v[144:145], v26 offset:32768
  v_mfma_f32_16x16x32_bf16 v[60:63], v[156:159], v[124:127], v[60:63]
  ds_read_b64_tr_b16 v[146:147], v26 offset:34816
  v_mfma_f32_16x16x32_bf16 v[56:59], v[152:155], v[124:127], v[56:59]
  ds_read_b64_tr_b16 v[148:149], v28 offset:32768
  v_mfma_f32_16x16x32_bf16 v[72:75], v[152:155], v[128:131], v[72:75]
  ds_read_b64_tr_b16 v[150:151], v28 offset:34816
  buffer_load_dwordx4 v15, s[12:15], s33 offen offset:1024 lds
  s_add_u32 s33, s33, 128
  v_mfma_f32_16x16x32_bf16 v[76:79], v[156:159], v[128:131], v[76:79]
  ds_read_b128 v[108:111], v20 offset:18432
  v_mfma_f32_16x16x32_bf16 v[80:83], v[128:131], v[160:163], v[80:83]
  ds_read_b128 v[112:115], v20 offset:20480
  v_mfma_f32_16x16x32_bf16 v[84:87], v[128:131], v[164:167], v[84:87]
  ds_read_b128 v[116:119], v20 offset:22528
  v_mfma_f32_16x16x32_bf16 v[100:103], v[132:135], v[164:167], v[100:103]
  v_mfma_f32_16x16x32_bf16 v[96:99], v[132:135], v[160:163], v[96:99]
  s_add_u32 m0, s34, 0
  s_nop 0
  buffer_load_dwordx4 v16, s[16:19], s35 offen lds
  v_mfma_f32_16x16x32_bf16 v[92:95], v[156:159], v[132:135], v[92:95]
  v_mfma_f32_16x16x32_bf16 v[88:91], v[152:155], v[132:135], v[88:91]
  s_waitcnt lgkmcnt(0)
  v_mfma_f32_16x16x32_bf16 v[40:43], v[136:139], v[104:107], v[40:43]
  ds_read_b128 v[120:123], v21 offset:16384
  v_mfma_f32_16x16x32_bf16 v[44:47], v[140:143], v[104:107], v[44:47]
  ds_read_b64_tr_b16 v[152:153], v22 offset:49152
  v_mfma_f32_16x16x32_bf16 v[48:51], v[104:107], v[144:147], v[48:51]
  ds_read_b64_tr_b16 v[154:155], v22 offset:51200
  buffer_load_dwordx4 v17, s[16:19], s35 offen offset:1024 lds
  v_mfma_f32_16x16x32_bf16 v[52:55], v[104:107], v[148:151], v[52:55]
  ds_read_b64_tr_b16 v[156:157], v24 offset:49152
  v_mfma_f32_16x16x32_bf16 v[68:71], v[108:111], v[148:151], v[68:71]
  ds_read_b64_tr_b16 v[158:159], v24 offset:51200
  v_mfma_f32_16x16x32_bf16 v[64:67], v[108:111], v[144:147], v[64:67]
  ds_read_b64_tr_b16 v[160:161], v26 offset:49152
  v_mfma_f32_16x16x32_bf16 v[60:63], v[140:143], v[108:111], v[60:63]
  ds_read_b64_tr_b16 v[162:163], v26 offset:51200
  buffer_load_dwordx4 v18, s[16:19], s35 offen offset:2048 lds
  v_mfma_f32_16x16x32_bf16 v[56:59], v[136:139], v[108:111], v[56:59]
  ds_read_b64_tr_b16 v[164:165], v28 offset:49152
  v_mfma_f32_16x16x32_bf16 v[72:75], v[136:139], v[112:115], v[72:75]
  ds_read_b64_tr_b16 v[166:167], v28 offset:51200
  v_mfma_f32_16x16x32_bf16 v[76:79], v[140:143], v[112:115], v[76:79]
  ds_read_b128 v[124:127], v21 offset:18432
  v_mfma_f32_16x16x32_bf16 v[80:83], v[112:115], v[144:147], v[80:83]
  ds_read_b128 v[128:131], v21 offset:20480
  buffer_load_dwordx4 v19, s[16:19], s35 offen offset:3072 lds
  s_add_u32 s35, s35, s79
  v_mfma_f32_16x16x32_bf16 v[84:87], v[112:115], v[148:151], v[84:87]
  ds_read_b128 v[132:135], v21 offset:22528
  v_mfma_f32_16x16x32_bf16 v[100:103], v[116:119], v[148:151], v[100:103]
  v_mfma_f32_16x16x32_bf16 v[96:99], v[116:119], v[144:147], v[96:99]
  v_mfma_f32_16x16x32_bf16 v[92:95], v[140:143], v[116:119], v[92:95]
  buffer_load_dword v10, v11, s[24:27], s38 offen
  s_add_u32 s38, s38, s39
  s_min_u32 s38, s38, s84
  v_mfma_f32_16x16x32_bf16 v[88:91], v[136:139], v[116:119], v[88:91]
  s_waitcnt vmcnt(8) lgkmcnt(0)
  s_barrier
  s_mov_b32 s28, s58
  s_cmp_eq_u32 s3, 5
  s_cselect_b32 s28, s50, s28
  s_mov_b32 s29, s59
  s_cmp_eq_u32 s3, 5
  s_cselect_b32 s29, s51, s29
  s_and_b32 s29, s29, 0xffff
  s_mov_b32 s30, 0
  s_cmp_eq_u32 s3, 3
  s_cselect_b32 s30, 7340032, s30
  s_cmp_eq_u32 s3, 4
  s_cselect_b32 s30, 7340032, s30
  s_cmp_eq_u32 s3, 5
  s_cselect_b32 s30, 6291456, s30
  s_mov_b32 s31, 0x20000
  s_cmp_eq_u32 s3, 4
  s_cselect_b32 s4, 64, 0
  v_add_u32 v2, s4, v1
  v_min_u32 v2, 111, v2
  v_mul_u32_u24 v3, 2341, v2
  v_lshrrev_b32 v3, 16, v3
  v_mul_u32_u24 v4, 28, v3
  v_sub_u32 v2, v2, v4
  v_mul_u32_u24 v3, 7168, v3
  v_lshl_add_u32 v2, v2, 7, v3
  v_lshrrev_b32 v3, 4, v1
  v_mul_u32_u24 v3, 6144, v3
  v_and_b32 v4, 15, v1
  v_lshl_add_u32 v3, v4, 7, v3
  s_cmp_eq_u32 s3, 5
  s_cselect_b64 vcc, -1, 0
  v_cndmask_b32 v2, v2, v3, vcc
  s_mov_b32 s5, 28672
  s_cselect_b32 s4, 24576, s5
  s_mul_i32 s4, s4, s2
  buffer_load_dword v10, v2, s[28:31], s4 offen
  v_mfma_f32_16x16x32_bf16 v[40:43], v[152:155], v[120:123], v[40:43]
  ds_read_b128 v[104:107], v20 offset:32768
  v_mfma_f32_16x16x32_bf16 v[44:47], v[156:159], v[120:123], v[44:47]
  ds_read_b64_tr_b16 v[136:137], v23 offset:0
  v_mfma_f32_16x16x32_bf16 v[48:51], v[120:123], v[160:163], v[48:51]
  ds_read_b64_tr_b16 v[138:139], v23 offset:2048
  s_add_u32 m0, s32, 16384
  s_nop 0
  buffer_load_dwordx4 v14, s[12:15], s33 offen lds
  v_mfma_f32_16x16x32_bf16 v[52:55], v[120:123], v[164:167], v[52:55]
  ds_read_b64_tr_b16 v[140:141], v25 offset:0
  v_mfma_f32_16x16x32_bf16 v[68:71], v[124:127], v[164:167], v[68:71]
  ds_read_b64_tr_b16 v[142:143], v25 offset:2048
  v_mfma_f32_16x16x32_bf16 v[64:67], v[124:127], v[160:163], v[64:67]
  ds_read_b64_tr_b16 v[144:145], v27 offset:0
  v_mfma_f32_16x16x32_bf16 v[60:63], v[156:159], v[124:127], v[60:63]
  ds_read_b64_tr_b16 v[146:147], v27 offset:2048
  v_mfma_f32_16x16x32_bf16 v[56:59], v[152:155], v[124:127], v[56:59]
  ds_read_b64_tr_b16 v[148:149], v29 offset:0
  v_mfma_f32_16x16x32_bf16 v[72:75], v[152:155], v[128:131], v[72:75]
  ds_read_b64_tr_b16 v[150:151], v29 offset:2048
  buffer_load_dwordx4 v15, s[12:15], s33 offen offset:1024 lds
  s_add_u32 s33, s33, 128
  v_mfma_f32_16x16x32_bf16 v[76:79], v[156:159], v[128:131], v[76:79]
  ds_read_b128 v[108:111], v20 offset:34816
  v_mfma_f32_16x16x32_bf16 v[80:83], v[128:131], v[160:163], v[80:83]
  ds_read_b128 v[112:115], v20 offset:36864
  v_mfma_f32_16x16x32_bf16 v[84:87], v[128:131], v[164:167], v[84:87]
  ds_read_b128 v[116:119], v20 offset:38912
  v_mfma_f32_16x16x32_bf16 v[100:103], v[132:135], v[164:167], v[100:103]
  v_mfma_f32_16x16x32_bf16 v[96:99], v[132:135], v[160:163], v[96:99]
  s_add_u32 m0, s34, 32768
  s_nop 0
  buffer_load_dwordx4 v16, s[16:19], s35 offen lds
  v_mfma_f32_16x16x32_bf16 v[92:95], v[156:159], v[132:135], v[92:95]
  v_mfma_f32_16x16x32_bf16 v[88:91], v[152:155], v[132:135], v[88:91]
  s_waitcnt lgkmcnt(0)
  v_mfma_f32_16x16x32_bf16 v[40:43], v[136:139], v[104:107], v[40:43]
  ds_read_b128 v[120:123], v21 offset:32768
  v_mfma_f32_16x16x32_bf16 v[44:47], v[140:143], v[104:107], v[44:47]
  ds_read_b64_tr_b16 v[152:153], v23 offset:16384
  v_mfma_f32_16x16x32_bf16 v[48:51], v[104:107], v[144:147], v[48:51]
  ds_read_b64_tr_b16 v[154:155], v23 offset:18432
  buffer_load_dwordx4 v17, s[16:19], s35 offen offset:1024 lds
  v_mfma_f32_16x16x32_bf16 v[52:55], v[104:107], v[148:151], v[52:55]
  ds_read_b64_tr_b16 v[156:157], v25 offset:16384
  v_mfma_f32_16x16x32_bf16 v[68:71], v[108:111], v[148:151], v[68:71]
  ds_read_b64_tr_b16 v[158:159], v25 offset:18432
  v_mfma_f32_16x16x32_bf16 v[64:67], v[108:111], v[144:147], v[64:67]
  ds_read_b64_tr_b16 v[160:161], v27 offset:16384
  v_mfma_f32_16x16x32_bf16 v[60:63], v[140:143], v[108:111], v[60:63]
  ds_read_b64_tr_b16 v[162:163], v27 offset:18432
  buffer_load_dwordx4 v18, s[16:19], s35 offen offset:2048 lds
  v_mfma_f32_16x16x32_bf16 v[56:59], v[136:139], v[108:111], v[56:59]
  ds_read_b64_tr_b16 v[164:165], v29 offset:16384
  v_mfma_f32_16x16x32_bf16 v[72:75], v[136:139], v[112:115], v[72:75]
  ds_read_b64_tr_b16 v[166:167], v29 offset:18432
  v_mfma_f32_16x16x32_bf16 v[76:79], v[140:143], v[112:115], v[76:79]
  ds_read_b128 v[124:127], v21 offset:34816
  v_mfma_f32_16x16x32_bf16 v[80:83], v[112:115], v[144:147], v[80:83]
  ds_read_b128 v[128:131], v21 offset:36864
  buffer_load_dwordx4 v19, s[16:19], s35 offen offset:3072 lds
  s_add_u32 s35, s35, s79
  v_mfma_f32_16x16x32_bf16 v[84:87], v[112:115], v[148:151], v[84:87]
  ds_read_b128 v[132:135], v21 offset:38912
  v_mfma_f32_16x16x32_bf16 v[100:103], v[116:119], v[148:151], v[100:103]
  v_mfma_f32_16x16x32_bf16 v[96:99], v[116:119], v[144:147], v[96:99]
  v_mfma_f32_16x16x32_bf16 v[92:95], v[140:143], v[116:119], v[92:95]
  buffer_load_dword v10, v11, s[24:27], s38 offen
  s_add_u32 s38, s38, s39
  s_min_u32 s38, s38, s84
  v_mfma_f32_16x16x32_bf16 v[88:91], v[136:139], v[116:119], v[88:91]
  s_waitcnt vmcnt(9) lgkmcnt(0)
  s_barrier
  v_mfma_f32_16x16x32_bf16 v[40:43], v[152:155], v[120:123], v[40:43]
  ds_read_b128 v[104:107], v20 offset:0
  v_mfma_f32_16x16x32_bf16 v[44:47], v[156:159], v[120:123], v[44:47]
  ds_read_b64_tr_b16 v[136:137], v22 offset:0
  v_mfma_f32_16x16x32_bf16 v[48:51], v[120:123], v[160:163], v[48:51]
  ds_read_b64_tr_b16 v[138:139], v22 offset:2048
  s_add_u32 m0, s32, 32768
  s_nop 0
  buffer_load_dwordx4 v14, s[12:15], s33 offen lds
  v_mfma_f32_16x16x32_bf16 v[52:55], v[120:123], v[164:167], v[52:55]
  ds_read_b64_tr_b16 v[140:141], v24 offset:0
  v_mfma_f32_16x16x32_bf16 v[68:71], v[124:127], v[164:167], v[68:71]
  ds_read_b64_tr_b16 v[142:143], v24 offset:2048
  v_mfma_f32_16x16x32_bf16 v[64:67], v[124:127], v[160:163], v[64:67]
  ds_read_b64_tr_b16 v[144:145], v26 offset:0
  v_mfma_f32_16x16x32_bf16 v[60:63], v[156:159], v[124:127], v[60:63]
  ds_read_b64_tr_b16 v[146:147], v26 offset:2048
  v_mfma_f32_16x16x32_bf16 v[56:59], v[152:155], v[124:127], v[56:59]
  ds_read_b64_tr_b16 v[148:149], v28 offset:0
  v_mfma_f32_16x16x32_bf16 v[72:75], v[152:155], v[128:131], v[72:75]
  ds_read_b64_tr_b16 v[150:151], v28 offset:2048
  buffer_load_dwordx4 v15, s[12:15], s33 offen offset:1024 lds
  s_add_u32 s33, s33, 128
  v_mfma_f32_16x16x32_bf16 v[76:79], v[156:159], v[128:131], v[76:79]
  ds_read_b128 v[108:111], v20 offset:2048
  v_mfma_f32_16x16x32_bf16 v[80:83], v[128:131], v[160:163], v[80:83]
  ds_read_b128 v[112:115], v20 offset:4096
  v_mfma_f32_16x16x32_bf16 v[84:87], v[128:131], v[164:167], v[84:87]
  ds_read_b128 v[116:119], v20 offset:6144
  v_mfma_f32_16x16x32_bf16 v[100:103], v[132:135], v[164:167], v[100:103]
  v_mfma_f32_16x16x32_bf16 v[96:99], v[132:135], v[160:163], v[96:99]
  s_add_u32 m0, s34, 65536
  s_nop 0
  buffer_load_dwordx4 v16, s[16:19], s35 offen lds
  v_mfma_f32_16x16x32_bf16 v[92:95], v[156:159], v[132:135], v[92:95]
  v_mfma_f32_16x16x32_bf16 v[88:91], v[152:155], v[132:135], v[88:91]
  s_waitcnt lgkmcnt(0)
  v_mfma_f32_16x16x32_bf16 v[40:43], v[136:139], v[104:107], v[40:43]
  ds_read_b128 v[120:123], v21 offset:0
  v_mfma_f32_16x16x32_bf16 v[44:47], v[140:143], v[104:107], v[44:47]
  ds_read_b64_tr_b16 v[152:153], v22 offset:16384
  v_mfma_f32_16x16x32_bf16 v[48:51], v[104:107], v[144:147], v[48:51]
  ds_read_b64_tr_b16 v[154:155], v22 offset:18432
  buffer_load_dwordx4 v17, s[16:19], s35 offen offset:1024 lds
  v_mfma_f32_16x16x32_bf16 v[52:55], v[104:107], v[148:151], v[52:55]
  ds_read_b64_tr_b16 v[156:157], v24 offset:16384
  v_mfma_f32_16x16x32_bf16 v[68:71], v[108:111], v[148:151], v[68:71]
  ds_read_b64_tr_b16 v[158:159], v24 offset:18432
  v_mfma_f32_16x16x32_bf16 v[64:67], v[108:111], v[144:147], v[64:67]
  ds_read_b64_tr_b16 v[160:161], v26 offset:16384
  v_mfma_f32_16x16x32_bf16 v[60:63], v[140:143], v[108:111], v[60:63]
  ds_read_b64_tr_b16 v[162:163], v26 offset:18432
  buffer_load_dwordx4 v18, s[16:19], s35 offen offset:2048 lds
  v_mfma_f32_16x16x32_bf16 v[56:59], v[136:139], v[108:111], v[56:59]
  ds_read_b64_tr_b16 v[164:165], v28 offset:16384
  v_mfma_f32_16x16x32_bf16 v[72:75], v[136:139], v[112:115], v[72:75]
  ds_read_b64_tr_b16 v[166:167], v28 offset:18432
  v_mfma_f32_16x16x32_bf16 v[76:79], v[140:143], v[112:115], v[76:79]
  ds_read_b128 v[124:127], v21 offset:2048
  v_mfma_f32_16x16x32_bf16 v[80:83], v[112:115], v[144:147], v[80:83]
  ds_read_b128 v[128:131], v21 offset:4096
  buffer_load_dwordx4 v19, s[16:19], s35 offen offset:3072 lds
  s_add_u32 s35, s35, s79
  v_mfma_f32_16x16x32_bf16 v[84:87], v[112:115], v[148:151], v[84:87]
  ds_read_b128 v[132:135], v21 offset:6144
  v_mfma_f32_16x16x32_bf16 v[100:103], v[116:119], v[148:151], v[100:103]
  v_mfma_f32_16x16x32_bf16 v[96:99], v[116:119], v[144:147], v[96:99]
  v_mfma_f32_16x16x32_bf16 v[92:95], v[140:143], v[116:119], v[92:95]
  buffer_load_dword v10, v11, s[24:27], s38 offen
  s_add_u32 s38, s38, s39
  s_min_u32 s38, s38, s84
  v_mfma_f32_16x16x32_bf16 v[88:91], v[136:139], v[116:119], v[88:91]
  s_waitcnt vmcnt(8) lgkmcnt(0)
  s_barrier
  v_mfma_f32_16x16x32_bf16 v[40:43], v[152:155], v[120:123], v[40:43]
  ds_read_b128 v[104:107], v20 offset:16384
  v_mfma_f32_16x16x32_bf16 v[44:47], v[156:159], v[120:123], v[44:47]
  ds_read_b64_tr_b16 v[136:137], v22 offset:32768
  v_mfma_f32_16x16x32_bf16 v[48:51], v[120:123], v[160:163], v[48:51]
  ds_read_b64_tr_b16 v[138:139], v22 offset:34816
  s_add_u32 m0, s32, 0
  s_nop 0
  buffer_load_dwordx4 v14, s[12:15], s33 offen lds
  v_mfma_f32_16x16x32_bf16 v[52:55], v[120:123], v[164:167], v[52:55]
  ds_read_b64_tr_b16 v[140:141], v24 offset:32768
  v_mfma_f32_16x16x32_bf16 v[68:71], v[124:127], v[164:167], v[68:71]
  ds_read_b64_tr_b16 v[142:143], v24 offset:34816
  v_mfma_f32_16x16x32_bf16 v[64:67], v[124:127], v[160:163], v[64:67]
  ds_read_b64_tr_b16 v[144:145], v26 offset:32768
  v_mfma_f32_16x16x32_bf16 v[60:63], v[156:159], v[124:127], v[60:63]
  ds_read_b64_tr_b16 v[146:147], v26 offset:34816
  v_mfma_f32_16x16x32_bf16 v[56:59], v[152:155], v[124:127], v[56:59]
  ds_read_b64_tr_b16 v[148:149], v28 offset:32768
  v_mfma_f32_16x16x32_bf16 v[72:75], v[152:155], v[128:131], v[72:75]
  ds_read_b64_tr_b16 v[150:151], v28 offset:34816
  buffer_load_dwordx4 v15, s[12:15], s33 offen offset:1024 lds
  s_add_u32 s33, s33, 128
  v_mfma_f32_16x16x32_bf16 v[76:79], v[156:159], v[128:131], v[76:79]
  ds_read_b128 v[108:111], v20 offset:18432
  v_mfma_f32_16x16x32_bf16 v[80:83], v[128:131], v[160:163], v[80:83]
  ds_read_b128 v[112:115], v20 offset:20480
  v_mfma_f32_16x16x32_bf16 v[84:87], v[128:131], v[164:167], v[84:87]
  ds_read_b128 v[116:119], v20 offset:22528
  v_mfma_f32_16x16x32_bf16 v[100:103], v[132:135], v[164:167], v[100:103]
  v_mfma_f32_16x16x32_bf16 v[96:99], v[132:135], v[160:163], v[96:99]
  s_add_u32 m0, s34, 0
  s_nop 0
  buffer_load_dwordx4 v16, s[16:19], s35 offen lds
  v_mfma_f32_16x16x32_bf16 v[92:95], v[156:159], v[132:135], v[92:95]
  v_mfma_f32_16x16x32_bf16 v[88:91], v[152:155], v[132:135], v[88:91]
  s_waitcnt lgkmcnt(0)
  v_mfma_f32_16x16x32_bf16 v[40:43], v[136:139], v[104:107], v[40:43]
  ds_read_b128 v[120:123], v21 offset:16384
  v_mfma_f32_16x16x32_bf16 v[44:47], v[140:143], v[104:107], v[44:47]
  ds_read_b64_tr_b16 v[152:153], v22 offset:49152
  v_mfma_f32_16x16x32_bf16 v[48:51], v[104:107], v[144:147], v[48:51]
  ds_read_b64_tr_b16 v[154:155], v22 offset:51200
  buffer_load_dwordx4 v17, s[16:19], s35 offen offset:1024 lds
  v_mfma_f32_16x16x32_bf16 v[52:55], v[104:107], v[148:151], v[52:55]
  ds_read_b64_tr_b16 v[156:157], v24 offset:49152
  v_mfma_f32_16x16x32_bf16 v[68:71], v[108:111], v[148:151], v[68:71]
  ds_read_b64_tr_b16 v[158:159], v24 offset:51200
  v_mfma_f32_16x16x32_bf16 v[64:67], v[108:111], v[144:147], v[64:67]
  ds_read_b64_tr_b16 v[160:161], v26 offset:49152
  v_mfma_f32_16x16x32_bf16 v[60:63], v[140:143], v[108:111], v[60:63]
  ds_read_b64_tr_b16 v[162:163], v26 offset:51200
  buffer_load_dwordx4 v18, s[16:19], s35 offen offset:2048 lds
  v_mfma_f32_16x16x32_bf16 v[56:59], v[136:139], v[108:111], v[56:59]
  ds_read_b64_tr_b16 v[164:165], v28 offset:49152
  v_mfma_f32_16x16x32_bf16 v[72:75], v[136:139], v[112:115], v[72:75]
  ds_read_b64_tr_b16 v[166:167], v28 offset:51200
  v_mfma_f32_16x16x32_bf16 v[76:79], v[140:143], v[112:115], v[76:79]
  ds_read_b128 v[124:127], v21 offset:18432
  v_mfma_f32_16x16x32_bf16 v[80:83], v[112:115], v[144:147], v[80:83]
  ds_read_b128 v[128:131], v21 offset:20480
  buffer_load_dwordx4 v19, s[16:19], s35 offen offset:3072 lds
  s_add_u32 s35, s35, s79
  v_mfma_f32_16x16x32_bf16 v[84:87], v[112:115], v[148:151], v[84:87]
  ds_read_b128 v[132:135], v21 offset:22528
  v_mfma_f32_16x16x32_bf16 v[100:103], v[116:119], v[148:151], v[100:103]
  v_mfma_f32_16x16x32_bf16 v[96:99], v[116:119], v[144:147], v[96:99]
  v_mfma_f32_16x16x32_bf16 v[92:95], v[140:143], v[116:119], v[92:95]
  buffer_load_dword v10, v11, s[24:27], s38 offen
  s_add_u32 s38, s38, s39
  s_min_u32 s38, s38, s84
  v_mfma_f32_16x16x32_bf16 v[88:91], v[136:139], v[116:119], v[88:91]
  s_waitcnt vmcnt(8) lgkmcnt(0)
  s_barrier
  v_mfma_f32_16x16x32_bf16 v[40:43], v[152:155], v[120:123], v[40:43]
  ds_read_b128 v[104:107], v20 offset:32768
  v_mfma_f32_16x16x32_bf16 v[44:47], v[156:159], v[120:123], v[44:47]
  ds_read_b64_tr_b16 v[136:137], v23 offset:0
  v_mfma_f32_16x16x32_bf16 v[48:51], v[120:123], v[160:163], v[48:51]
  ds_read_b64_tr_b16 v[138:139], v23 offset:2048
  s_add_u32 m0, s32, 16384
  s_nop 0
  buffer_load_dwordx4 v14, s[12:15], s33 offen lds
  v_mfma_f32_16x16x32_bf16 v[52:55], v[120:123], v[164:167], v[52:55]
  ds_read_b64_tr_b16 v[140:141], v25 offset:0
  v_mfma_f32_16x16x32_bf16 v[68:71], v[124:127], v[164:167], v[68:71]
  ds_read_b64_tr_b16 v[142:143], v25 offset:2048
  v_mfma_f32_16x16x32_bf16 v[64:67], v[124:127], v[160:163], v[64:67]
  ds_read_b64_tr_b16 v[144:145], v27 offset:0
  v_mfma_f32_16x16x32_bf16 v[60:63], v[156:159], v[124:127], v[60:63]
  ds_read_b64_tr_b16 v[146:147], v27 offset:2048
  v_mfma_f32_16x16x32_bf16 v[56:59], v[152:155], v[124:127], v[56:59]
  ds_read_b64_tr_b16 v[148:149], v29 offset:0
  v_mfma_f32_16x16x32_bf16 v[72:75], v[152:155], v[128:131], v[72:75]
  ds_read_b64_tr_b16 v[150:151], v29 offset:2048
  buffer_load_dwordx4 v15, s[12:15], s33 offen offset:1024 lds
  s_add_u32 s33, s33, 128
  v_mfma_f32_16x16x32_bf16 v[76:79], v[156:159], v[128:131], v[76:79]
  ds_read_b128 v[108:111], v20 offset:34816
  v_mfma_f32_16x16x32_bf16 v[80:83], v[128:131], v[160:163], v[80:83]
  ds_read_b128 v[112:115], v20 offset:36864
  v_mfma_f32_16x16x32_bf16 v[84:87], v[128:131], v[164:167], v[84:87]
  ds_read_b128 v[116:119], v20 offset:38912
  v_mfma_f32_16x16x32_bf16 v[100:103], v[132:135], v[164:167], v[100:103]
  v_mfma_f32_16x16x32_bf16 v[96:99], v[132:135], v[160:163], v[96:99]
  s_add_u32 m0, s34, 32768
  s_nop 0
  buffer_load_dwordx4 v16, s[16:19], s35 offen lds
  v_mfma_f32_16x16x32_bf16 v[92:95], v[156:159], v[132:135], v[92:95]
  v_mfma_f32_16x16x32_bf16 v[88:91], v[152:155], v[132:135], v[88:91]
  s_waitcnt lgkmcnt(0)
  v_mfma_f32_16x16x32_bf16 v[40:43], v[136:139], v[104:107], v[40:43]
  ds_read_b128 v[120:123], v21 offset:32768
  v_mfma_f32_16x16x32_bf16 v[44:47], v[140:143], v[104:107], v[44:47]
  ds_read_b64_tr_b16 v[152:153], v23 offset:16384
  v_mfma_f32_16x16x32_bf16 v[48:51], v[104:107], v[144:147], v[48:51]
  ds_read_b64_tr_b16 v[154:155], v23 offset:18432
  buffer_load_dwordx4 v17, s[16:19], s35 offen offset:1024 lds
  v_mfma_f32_16x16x32_bf16 v[52:55], v[104:107], v[148:151], v[52:55]
  ds_read_b64_tr_b16 v[156:157], v25 offset:16384
  v_mfma_f32_16x16x32_bf16 v[68:71], v[108:111], v[148:151], v[68:71]
  ds_read_b64_tr_b16 v[158:159], v25 offset:18432
  v_mfma_f32_16x16x32_bf16 v[64:67], v[108:111], v[144:147], v[64:67]
  ds_read_b64_tr_b16 v[160:161], v27 offset:16384
  v_mfma_f32_16x16x32_bf16 v[60:63], v[140:143], v[108:111], v[60:63]
  ds_read_b64_tr_b16 v[162:163], v27 offset:18432
  buffer_load_dwordx4 v18, s[16:19], s35 offen offset:2048 lds
  v_mfma_f32_16x16x32_bf16 v[56:59], v[136:139], v[108:111], v[56:59]
  ds_read_b64_tr_b16 v[164:165], v29 offset:16384
  v_mfma_f32_16x16x32_bf16 v[72:75], v[136:139], v[112:115], v[72:75]
  ds_read_b64_tr_b16 v[166:167], v29 offset:18432
  v_mfma_f32_16x16x32_bf16 v[76:79], v[140:143], v[112:115], v[76:79]
  ds_read_b128 v[124:127], v21 offset:34816
  v_mfma_f32_16x16x32_bf16 v[80:83], v[112:115], v[144:147], v[80:83]
  ds_read_b128 v[128:131], v21 offset:36864
  buffer_load_dwordx4 v19, s[16:19], s35 offen offset:3072 lds
  s_add_u32 s35, s35, s79
  v_mfma_f32_16x16x32_bf16 v[84:87], v[112:115], v[148:151], v[84:87]
  ds_read_b128 v[132:135], v21 offset:38912
  v_mfma_f32_16x16x32_bf16 v[100:103], v[116:119], v[148:151], v[100:103]
  v_mfma_f32_16x16x32_bf16 v[96:99], v[116:119], v[144:147], v[96:99]
  v_mfma_f32_16x16x32_bf16 v[92:95], v[140:143], v[116:119], v[92:95]
  buffer_load_dword v10, v11, s[24:27], s38 offen
  s_add_u32 s38, s38, s39
  s_min_u32 s38, s38, s84
  v_mfma_f32_16x16x32_bf16 v[88:91], v[136:139], v[116:119], v[88:91]
  s_waitcnt vmcnt(8) lgkmcnt(0)
  s_barrier
  v_mfma_f32_16x16x32_bf16 v[40:43], v[152:155], v[120:123], v[40:43]
  ds_read_b128 v[104:107], v20 offset:0
  v_mfma_f32_16x16x32_bf16 v[44:47], v[156:159], v[120:123], v[44:47]
  ds_read_b64_tr_b16 v[136:137], v22 offset:0
  v_mfma_f32_16x16x32_bf16 v[48:51], v[120:123], v[160:163], v[48:51]
  ds_read_b64_tr_b16 v[138:139], v22 offset:2048
  s_add_u32 m0, s32, 32768
  s_nop 0
  buffer_load_dwordx4 v14, s[12:15], s33 offen lds
  v_mfma_f32_16x16x32_bf16 v[52:55], v[120:123], v[164:167], v[52:55]
  ds_read_b64_tr_b16 v[140:141], v24 offset:0
  v_mfma_f32_16x16x32_bf16 v[68:71], v[124:127], v[164:167], v[68:71]
  ds_read_b64_tr_b16 v[142:143], v24 offset:2048
  v_mfma_f32_16x16x32_bf16 v[64:67], v[124:127], v[160:163], v[64:67]
  ds_read_b64_tr_b16 v[144:145], v26 offset:0
  v_mfma_f32_16x16x32_bf16 v[60:63], v[156:159], v[124:127], v[60:63]
  ds_read_b64_tr_b16 v[146:147], v26 offset:2048
  v_mfma_f32_16x16x32_bf16 v[56:59], v[152:155], v[124:127], v[56:59]
  ds_read_b64_tr_b16 v[148:149], v28 offset:0
  v_mfma_f32_16x16x32_bf16 v[72:75], v[152:155], v[128:131], v[72:75]
  ds_read_b64_tr_b16 v[150:151], v28 offset:2048
  buffer_load_dwordx4 v15, s[12:15], s33 offen offset:1024 lds
  s_add_u32 s33, s33, 128
  v_mfma_f32_16x16x32_bf16 v[76:79], v[156:159], v[128:131], v[76:79]
  ds_read_b128 v[108:111], v20 offset:2048
  v_mfma_f32_16x16x32_bf16 v[80:83], v[128:131], v[160:163], v[80:83]
  ds_read_b128 v[112:115], v20 offset:4096
  v_mfma_f32_16x16x32_bf16 v[84:87], v[128:131], v[164:167], v[84:87]
  ds_read_b128 v[116:119], v20 offset:6144
  v_mfma_f32_16x16x32_bf16 v[100:103], v[132:135], v[164:167], v[100:103]
  v_mfma_f32_16x16x32_bf16 v[96:99], v[132:135], v[160:163], v[96:99]
  s_add_u32 m0, s34, 65536
  s_nop 0
  buffer_load_dwordx4 v16, s[16:19], s35 offen lds
  v_mfma_f32_16x16x32_bf16 v[92:95], v[156:159], v[132:135], v[92:95]
  v_mfma_f32_16x16x32_bf16 v[88:91], v[152:155], v[132:135], v[88:91]
  s_waitcnt lgkmcnt(0)
  v_mfma_f32_16x16x32_bf16 v[40:43], v[136:139], v[104:107], v[40:43]
  ds_read_b128 v[120:123], v21 offset:0
  s_lshl_b32 s77, s42, 7
  v_mfma_f32_16x16x32_bf16 v[44:47], v[140:143], v[104:107], v[44:47]
  ds_read_b64_tr_b16 v[152:153], v22 offset:16384
  v_mfma_f32_16x16x32_bf16 v[48:51], v[104:107], v[144:147], v[48:51]
  ds_read_b64_tr_b16 v[154:155], v22 offset:18432
  buffer_load_dwordx4 v17, s[16:19], s35 offen offset:1024 lds
  s_mov_b32 s20, s58
  v_mfma_f32_16x16x32_bf16 v[52:55], v[104:107], v[148:151], v[52:55]
  ds_read_b64_tr_b16 v[156:157], v24 offset:16384
  v_mfma_f32_16x16x32_bf16 v[68:71], v[108:111], v[148:151], v[68:71]
  ds_read_b64_tr_b16 v[158:159], v24 offset:18432
  v_mfma_f32_16x16x32_bf16 v[64:67], v[108:111], v[144:147], v[64:67]
  ds_read_b64_tr_b16 v[160:161], v26 offset:16384
  s_and_b32 s21, s59, 0xffff
  v_mfma_f32_16x16x32_bf16 v[60:63], v[140:143], v[108:111], v[60:63]
  ds_read_b64_tr_b16 v[162:163], v26 offset:18432
  buffer_load_dwordx4 v18, s[16:19], s35 offen offset:2048 lds
  v_mfma_f32_16x16x32_bf16 v[56:59], v[136:139], v[108:111], v[56:59]
  ds_read_b64_tr_b16 v[164:165], v28 offset:16384
  v_mfma_f32_16x16x32_bf16 v[72:75], v[136:139], v[112:115], v[72:75]
  ds_read_b64_tr_b16 v[166:167], v28 offset:18432
  s_mov_b32 s22, 7340032
  v_mfma_f32_16x16x32_bf16 v[76:79], v[140:143], v[112:115], v[76:79]
  ds_read_b128 v[124:127], v21 offset:2048
  v_mfma_f32_16x16x32_bf16 v[80:83], v[112:115], v[144:147], v[80:83]
  ds_read_b128 v[128:131], v21 offset:4096
  buffer_load_dwordx4 v19, s[16:19], s35 offen offset:3072 lds
  s_add_u32 s35, s35, s79
  s_mov_b32 s23, 0x20000
  v_mfma_f32_16x16x32_bf16 v[84:87], v[112:115], v[148:151], v[84:87]
  ds_read_b128 v[132:135], v21 offset:6144
  v_mfma_f32_16x16x32_bf16 v[100:103], v[116:119], v[148:151], v[100:103]
  v_mfma_f32_16x16x32_bf16 v[96:99], v[116:119], v[144:147], v[96:99]
  s_mul_i32 s94, s3, 2048
  v_mfma_f32_16x16x32_bf16 v[92:95], v[140:143], v[116:119], v[92:95]
  buffer_load_dword v10, v11, s[24:27], s38 offen
  s_add_u32 s38, s38, s39
  s_min_u32 s38, s38, s84
  v_mfma_f32_16x16x32_bf16 v[88:91], v[136:139], v[116:119], v[88:91]
  s_waitcnt vmcnt(8) lgkmcnt(0)
  s_barrier
  v_mfma_f32_16x16x32_bf16 v[40:43], v[152:155], v[120:123], v[40:43]
  ds_read_b128 v[104:107], v20 offset:16384
  s_add_u32 s94, s94, 49152
  v_mfma_f32_16x16x32_bf16 v[44:47], v[156:159], v[120:123], v[44:47]
  ds_read_b64_tr_b16 v[136:137], v22 offset:32768
  v_mfma_f32_16x16x32_bf16 v[48:51], v[120:123], v[160:163], v[48:51]
  ds_read_b64_tr_b16 v[138:139], v22 offset:34816
  s_add_u32 m0, s32, 0
  s_nop 0
  buffer_load_dwordx4 v14, s[12:15], s33 offen lds
  s_mul_i32 s36, s3, 1024
  v_mfma_f32_16x16x32_bf16 v[52:55], v[120:123], v[164:167], v[52:55]
  ds_read_b64_tr_b16 v[140:141], v24 offset:32768
  v_mfma_f32_16x16x32_bf16 v[68:71], v[124:127], v[164:167], v[68:71]
  ds_read_b64_tr_b16 v[142:143], v24 offset:34816
  s_add_u32 s36, s36, 98304
  v_mfma_f32_16x16x32_bf16 v[64:67], v[124:127], v[160:163], v[64:67]
  ds_read_b64_tr_b16 v[144:145], v26 offset:32768
  v_mfma_f32_16x16x32_bf16 v[60:63], v[156:159], v[124:127], v[60:63]
  ds_read_b64_tr_b16 v[146:147], v26 offset:34816
  s_lshl_b32 s4, s3, 4
  v_mfma_f32_16x16x32_bf16 v[56:59], v[152:155], v[124:127], v[56:59]
  ds_read_b64_tr_b16 v[148:149], v28 offset:32768
  v_mfma_f32_16x16x32_bf16 v[72:75], v[152:155], v[128:131], v[72:75]
  ds_read_b64_tr_b16 v[150:151], v28 offset:34816
  buffer_load_dwordx4 v15, s[12:15], s33 offen offset:1024 lds
  s_add_u32 s33, s33, 128
  v_mfma_f32_16x16x32_bf16 v[76:79], v[156:159], v[128:131], v[76:79]
  ds_read_b128 v[108:111], v20 offset:18432
  s_add_u32 s4, s4, s77
  v_mfma_f32_16x16x32_bf16 v[80:83], v[128:131], v[160:163], v[80:83]
  ds_read_b128 v[112:115], v20 offset:20480
  v_mfma_f32_16x16x32_bf16 v[84:87], v[128:131], v[164:167], v[84:87]
  ds_read_b128 v[116:119], v20 offset:22528
  s_mul_i32 s93, s4, 2048
  v_mfma_f32_16x16x32_bf16 v[100:103], v[132:135], v[164:167], v[100:103]
  v_mfma_f32_16x16x32_bf16 v[96:99], v[132:135], v[160:163], v[96:99]
  s_add_u32 m0, s34, 0
  s_nop 0
  buffer_load_dwordx4 v16, s[16:19], s35 offen lds
  v_mul_u32_u24 v2, 2048, v0
  v_mfma_f32_16x16x32_bf16 v[92:95], v[156:159], v[132:135], v[92:95]
  v_mfma_f32_16x16x32_bf16 v[88:91], v[152:155], v[132:135], v[88:91]
  s_waitcnt lgkmcnt(0)
  v_mfma_f32_16x16x32_bf16 v[40:43], v[136:139], v[104:107], v[40:43]
  ds_read_b128 v[120:123], v21 offset:16384
  v_add_u32 v168, v2, v38
  v_mfma_f32_16x16x32_bf16 v[44:47], v[140:143], v[104:107], v[44:47]
  ds_read_b64_tr_b16 v[152:153], v22 offset:49152
  v_mfma_f32_16x16x32_bf16 v[48:51], v[104:107], v[144:147], v[48:51]
  ds_read_b64_tr_b16 v[154:155], v22 offset:51200
  buffer_load_dwordx4 v17, s[16:19], s35 offen offset:1024 lds
  v_xor_b32 v169, 64, v38
  v_mfma_f32_16x16x32_bf16 v[52:55], v[104:107], v[148:151], v[52:55]
  ds_read_b64_tr_b16 v[156:157], v24 offset:49152
  v_mfma_f32_16x16x32_bf16 v[68:71], v[108:111], v[148:151], v[68:71]
  ds_read_b64_tr_b16 v[158:159], v24 offset:51200
  v_mfma_f32_16x16x32_bf16 v[64:67], v[108:111], v[144:147], v[64:67]
  ds_read_b64_tr_b16 v[160:161], v26 offset:49152
  v_add_u32 v2, 15360, v2
  v_mfma_f32_16x16x32_bf16 v[60:63], v[140:143], v[108:111], v[60:63]
  ds_read_b64_tr_b16 v[162:163], v26 offset:51200
  buffer_load_dwordx4 v18, s[16:19], s35 offen offset:2048 lds
  v_mfma_f32_16x16x32_bf16 v[56:59], v[136:139], v[108:111], v[56:59]
  ds_read_b64_tr_b16 v[164:165], v28 offset:49152
  v_mfma_f32_16x16x32_bf16 v[72:75], v[136:139], v[112:115], v[72:75]
  ds_read_b64_tr_b16 v[166:167], v28 offset:51200
  v_add_u32 v169, v169, v2
  v_mfma_f32_16x16x32_bf16 v[76:79], v[140:143], v[112:115], v[76:79]
  ds_read_b128 v[124:127], v21 offset:18432
  v_mfma_f32_16x16x32_bf16 v[80:83], v[112:115], v[144:147], v[80:83]
  ds_read_b128 v[128:131], v21 offset:20480
  buffer_load_dwordx4 v19, s[16:19], s35 offen offset:3072 lds
  s_add_u32 s35, s35, s79
  s_mul_i32 s78, s43, 224
  v_mfma_f32_16x16x32_bf16 v[84:87], v[112:115], v[148:151], v[84:87]
  ds_read_b128 v[132:135], v21 offset:22528
  v_mfma_f32_16x16x32_bf16 v[100:103], v[116:119], v[148:151], v[100:103]
  v_mfma_f32_16x16x32_bf16 v[96:99], v[116:119], v[144:147], v[96:99]
  s_mul_i32 s95, s3, 57344
  v_mfma_f32_16x16x32_bf16 v[92:95], v[140:143], v[116:119], v[92:95]
  buffer_load_dword v10, v11, s[24:27], s38 offen
  s_add_u32 s38, s38, s39
  s_min_u32 s38, s38, s84
  v_mfma_f32_16x16x32_bf16 v[88:91], v[136:139], v[116:119], v[88:91]
  s_waitcnt vmcnt(8) lgkmcnt(0)
  s_barrier
  v_mfma_f32_16x16x32_bf16 v[40:43], v[152:155], v[120:123], v[40:43]
  ds_read_b128 v[104:107], v20 offset:32768
  s_add_u32 s95, s95, s78
  v_mfma_f32_16x16x32_bf16 v[44:47], v[156:159], v[120:123], v[44:47]
  ds_read_b64_tr_b16 v[136:137], v23 offset:0
  v_mfma_f32_16x16x32_bf16 v[48:51], v[120:123], v[160:163], v[48:51]
  ds_read_b64_tr_b16 v[138:139], v23 offset:2048
  s_add_u32 m0, s32, 16384
  s_nop 0
  buffer_load_dwordx4 v14, s[12:15], s33 offen lds
  v_lshrrev_b32 v2, 4, v1
  v_mfma_f32_16x16x32_bf16 v[52:55], v[120:123], v[164:167], v[52:55]
  ds_read_b64_tr_b16 v[140:141], v25 offset:0
  v_mfma_f32_16x16x32_bf16 v[68:71], v[124:127], v[164:167], v[68:71]
  ds_read_b64_tr_b16 v[142:143], v25 offset:2048
  v_mul_u32_u24 v2, 7168, v2
  v_mfma_f32_16x16x32_bf16 v[64:67], v[124:127], v[160:163], v[64:67]
  ds_read_b64_tr_b16 v[144:145], v27 offset:0
  v_mfma_f32_16x16x32_bf16 v[60:63], v[156:159], v[124:127], v[60:63]
  ds_read_b64_tr_b16 v[146:147], v27 offset:2048
  v_add_u32 v170, v2, v39
  v_mfma_f32_16x16x32_bf16 v[56:59], v[152:155], v[124:127], v[56:59]
  ds_read_b64_tr_b16 v[148:149], v29 offset:0
  v_mfma_f32_16x16x32_bf16 v[72:75], v[152:155], v[128:131], v[72:75]
  ds_read_b64_tr_b16 v[150:151], v29 offset:2048
  buffer_load_dwordx4 v15, s[12:15], s33 offen offset:1024 lds
  s_add_u32 s33, s33, 128
  v_mfma_f32_16x16x32_bf16 v[76:79], v[156:159], v[128:131], v[76:79]
  ds_read_b128 v[108:111], v20 offset:34816
  v_add_u32 v171, 27648, v170
  v_mfma_f32_16x16x32_bf16 v[80:83], v[128:131], v[160:163], v[80:83]
  ds_read_b128 v[112:115], v20 offset:36864
  v_mfma_f32_16x16x32_bf16 v[84:87], v[128:131], v[164:167], v[84:87]
  ds_read_b128 v[116:119], v20 offset:38912
  s_lshl_b32 s78, s43, 7
  v_mfma_f32_16x16x32_bf16 v[100:103], v[132:135], v[164:167], v[100:103]
  v_mfma_f32_16x16x32_bf16 v[96:99], v[132:135], v[160:163], v[96:99]
  s_add_u32 m0, s34, 32768
  s_nop 0
  buffer_load_dwordx4 v16, s[16:19], s35 offen lds
  s_mov_b32 s5, 6144
  v_mfma_f32_16x16x32_bf16 v[92:95], v[156:159], v[132:135], v[92:95]
  v_mfma_f32_16x16x32_bf16 v[88:91], v[152:155], v[132:135], v[88:91]
  s_waitcnt lgkmcnt(0)
  v_mfma_f32_16x16x32_bf16 v[40:43], v[136:139], v[104:107], v[40:43]
  ds_read_b128 v[120:123], v21 offset:32768
  s_mul_i32 s37, s3, 49152
  v_mfma_f32_16x16x32_bf16 v[44:47], v[140:143], v[104:107], v[44:47]
  ds_read_b64_tr_b16 v[152:153], v23 offset:16384
  v_mfma_f32_16x16x32_bf16 v[48:51], v[104:107], v[144:147], v[48:51]
  ds_read_b64_tr_b16 v[154:155], v23 offset:18432
  buffer_load_dwordx4 v17, s[16:19], s35 offen offset:1024 lds
  v_mfma_f32_16x16x32_bf16 v[52:55], v[104:107], v[148:151], v[52:55]
  ds_read_b64_tr_b16 v[156:157], v25 offset:16384
  s_add_u32 s37, s37, s78
  v_mfma_f32_16x16x32_bf16 v[68:71], v[108:111], v[148:151], v[68:71]
  ds_read_b64_tr_b16 v[158:159], v25 offset:18432
  v_mfma_f32_16x16x32_bf16 v[64:67], v[108:111], v[144:147], v[64:67]
  ds_read_b64_tr_b16 v[160:161], v27 offset:16384
  v_mfma_f32_16x16x32_bf16 v[60:63], v[140:143], v[108:111], v[60:63]
  ds_read_b64_tr_b16 v[162:163], v27 offset:18432
  buffer_load_dwordx4 v18, s[16:19], s35 offen offset:2048 lds
  s_lshl_b32 s4, s44, 1
  v_mfma_f32_16x16x32_bf16 v[56:59], v[136:139], v[108:111], v[56:59]
  ds_read_b64_tr_b16 v[164:165], v29 offset:16384
  v_mfma_f32_16x16x32_bf16 v[72:75], v[136:139], v[112:115], v[72:75]
  ds_read_b64_tr_b16 v[166:167], v29 offset:18432
  v_mfma_f32_16x16x32_bf16 v[76:79], v[140:143], v[112:115], v[76:79]
  ds_read_b128 v[124:127], v21 offset:34816
  v_bfe_u32 v3, v1, 4, 1
  v_mfma_f32_16x16x32_bf16 v[80:83], v[112:115], v[144:147], v[80:83]
  ds_read_b128 v[128:131], v21 offset:36864
  buffer_load_dwordx4 v19, s[16:19], s35 offen offset:3072 lds
  s_add_u32 s35, s35, s79
  v_mfma_f32_16x16x32_bf16 v[84:87], v[112:115], v[148:151], v[84:87]
  ds_read_b128 v[132:135], v21 offset:38912
  v_mfma_f32_16x16x32_bf16 v[100:103], v[116:119], v[148:151], v[100:103]
  v_or_b32 v3, s4, v3
  v_mfma_f32_16x16x32_bf16 v[96:99], v[116:119], v[144:147], v[96:99]
  v_mfma_f32_16x16x32_bf16 v[92:95], v[140:143], v[116:119], v[92:95]
  buffer_load_dword v10, v11, s[24:27], s38 offen
  s_add_u32 s38, s38, s39
  s_min_u32 s38, s38, s84
  v_mfma_f32_16x16x32_bf16 v[88:91], v[136:139], v[116:119], v[88:91]
  s_waitcnt vmcnt(8) lgkmcnt(0)
  s_barrier
  v_mfma_f32_16x16x32_bf16 v[40:43], v[152:155], v[120:123], v[40:43]
  ds_read_b128 v[104:107], v20 offset:0
  v_bfe_u32 v4, v1, 1, 2
  v_mfma_f32_16x16x32_bf16 v[44:47], v[156:159], v[120:123], v[44:47]
  ds_read_b64_tr_b16 v[136:137], v22 offset:0
  v_mfma_f32_16x16x32_bf16 v[48:51], v[120:123], v[160:163], v[48:51]
  ds_read_b64_tr_b16 v[138:139], v22 offset:2048
  s_add_u32 m0, s32, 32768
  s_nop 0
  buffer_load_dwordx4 v14, s[12:15], s33 offen lds
  v_xor_b32 v3, v3, v4
  v_mfma_f32_16x16x32_bf16 v[52:55], v[120:123], v[164:167], v[52:55]
  ds_read_b64_tr_b16 v[140:141], v24 offset:0
  v_mfma_f32_16x16x32_bf16 v[68:71], v[124:127], v[164:167], v[68:71]
  ds_read_b64_tr_b16 v[142:143], v24 offset:2048
  v_mfma_f32_16x16x32_bf16 v[64:67], v[124:127], v[160:163], v[64:67]
  ds_read_b64_tr_b16 v[144:145], v26 offset:0
  v_and_b32 v4, 1, v1
  v_mfma_f32_16x16x32_bf16 v[60:63], v[156:159], v[124:127], v[60:63]
  ds_read_b64_tr_b16 v[146:147], v26 offset:2048
  v_mfma_f32_16x16x32_bf16 v[56:59], v[152:155], v[124:127], v[56:59]
  ds_read_b64_tr_b16 v[148:149], v28 offset:0
  v_mfma_f32_16x16x32_bf16 v[72:75], v[152:155], v[128:131], v[72:75]
  ds_read_b64_tr_b16 v[150:151], v28 offset:2048
  buffer_load_dwordx4 v15, s[12:15], s33 offen offset:1024 lds
  s_add_u32 s33, s33, 128
  v_lshlrev_b32 v4, 4, v4
  v_mfma_f32_16x16x32_bf16 v[76:79], v[156:159], v[128:131], v[76:79]
  ds_read_b128 v[108:111], v20 offset:2048
  v_mfma_f32_16x16x32_bf16 v[80:83], v[128:131], v[160:163], v[80:83]
  ds_read_b128 v[112:115], v20 offset:4096
  v_lshl_add_u32 v3, v3, 5, v4
  v_mfma_f32_16x16x32_bf16 v[84:87], v[128:131], v[164:167], v[84:87]
  ds_read_b128 v[116:119], v20 offset:6144
  v_mfma_f32_16x16x32_bf16 v[100:103], v[132:135], v[164:167], v[100:103]
  v_mfma_f32_16x16x32_bf16 v[96:99], v[132:135], v[160:163], v[96:99]
  s_add_u32 m0, s34, 65536
  s_nop 0
  buffer_load_dwordx4 v16, s[16:19], s35 offen lds
  v_mad_u32_u24 v172, v0, s5, v3
  v_mfma_f32_16x16x32_bf16 v[92:95], v[156:159], v[132:135], v[92:95]
  v_mfma_f32_16x16x32_bf16 v[88:91], v[152:155], v[132:135], v[88:91]
  s_waitcnt lgkmcnt(0)
  v_mfma_f32_16x16x32_bf16 v[40:43], v[136:139], v[104:107], v[40:43]
  ds_read_b128 v[120:123], v21 offset:0
  s_mul_i32 s4, s43, 112
  v_mfma_f32_16x16x32_bf16 v[44:47], v[140:143], v[104:107], v[44:47]
  ds_read_b64_tr_b16 v[152:153], v22 offset:16384
  s_lshr_b32 s5, s4, 8
  v_mfma_f32_16x16x32_bf16 v[48:51], v[104:107], v[144:147], v[48:51]
  ds_read_b64_tr_b16 v[154:155], v22 offset:18432
  buffer_load_dwordx4 v17, s[16:19], s35 offen offset:1024 lds
  v_mfma_f32_16x16x32_bf16 v[52:55], v[104:107], v[148:151], v[52:55]
  ds_read_b64_tr_b16 v[156:157], v24 offset:16384
  s_add_u32 s4, s4, 111
  v_mfma_f32_16x16x32_bf16 v[68:71], v[108:111], v[148:151], v[68:71]
  ds_read_b64_tr_b16 v[158:159], v24 offset:18432
  s_lshr_b32 s4, s4, 8
  v_mfma_f32_16x16x32_bf16 v[64:67], v[108:111], v[144:147], v[64:67]
  ds_read_b64_tr_b16 v[160:161], v26 offset:16384
  v_mfma_f32_16x16x32_bf16 v[60:63], v[140:143], v[108:111], v[60:63]
  ds_read_b64_tr_b16 v[162:163], v26 offset:18432
  buffer_load_dwordx4 v18, s[16:19], s35 offen offset:2048 lds
  v_mov_b32 v2, s5
  v_mfma_f32_16x16x32_bf16 v[56:59], v[136:139], v[108:111], v[56:59]
  ds_read_b64_tr_b16 v[164:165], v28 offset:16384
  v_mfma_f32_16x16x32_bf16 v[72:75], v[136:139], v[112:115], v[72:75]
  ds_read_b64_tr_b16 v[166:167], v28 offset:18432
  v_mov_b32 v3, s4
  v_mfma_f32_16x16x32_bf16 v[76:79], v[140:143], v[112:115], v[76:79]
  ds_read_b128 v[124:127], v21 offset:2048
  v_cmp_gt_u32 vcc, 16, v1
  s_nop 1
  v_cndmask_b32 v2, v3, v2, vcc
  v_mfma_f32_16x16x32_bf16 v[80:83], v[112:115], v[144:147], v[80:83]
  ds_read_b128 v[128:131], v21 offset:4096
  buffer_load_dwordx4 v19, s[16:19], s35 offen offset:3072 lds
  s_add_u32 s35, s35, s79
  v_mfma_f32_16x16x32_bf16 v[84:87], v[112:115], v[148:151], v[84:87]
  ds_read_b128 v[132:135], v21 offset:6144
  v_and_b32 v3, 15, v1
  v_mfma_f32_16x16x32_bf16 v[100:103], v[116:119], v[148:151], v[100:103]
  v_lshl_add_u32 v2, v2, 4, v3
  v_mfma_f32_16x16x32_bf16 v[96:99], v[116:119], v[144:147], v[96:99]
  v_mfma_f32_16x16x32_bf16 v[92:95], v[140:143], v[116:119], v[92:95]
  buffer_load_dword v10, v11, s[24:27], s38 offen
  s_add_u32 s38, s38, s39
  s_min_u32 s38, s38, s84
  v_lshlrev_b32 v2, 2, v2
  v_mfma_f32_16x16x32_bf16 v[88:91], v[136:139], v[116:119], v[88:91]
  s_waitcnt vmcnt(8) lgkmcnt(0)
  s_barrier
  v_mfma_f32_16x16x32_bf16 v[40:43], v[152:155], v[120:123], v[40:43]
  ds_read_b128 v[104:107], v20 offset:16384
  v_add_u32 v13, 15728640, v2
  v_mfma_f32_16x16x32_bf16 v[44:47], v[156:159], v[120:123], v[44:47]
  ds_read_b64_tr_b16 v[136:137], v22 offset:32768
  s_lshr_b32 s4, s2, 5
  v_mfma_f32_16x16x32_bf16 v[48:51], v[120:123], v[160:163], v[48:51]
  ds_read_b64_tr_b16 v[138:139], v22 offset:34816
  s_add_u32 m0, s32, 0
  s_nop 0
  buffer_load_dwordx4 v14, s[12:15], s33 offen lds
  v_mfma_f32_16x16x32_bf16 v[52:55], v[120:123], v[164:167], v[52:55]
  ds_read_b64_tr_b16 v[140:141], v24 offset:32768
  s_lshl_b32 s4, s4, 6
  v_mfma_f32_16x16x32_bf16 v[68:71], v[124:127], v[164:167], v[68:71]
  ds_read_b64_tr_b16 v[142:143], v24 offset:34816
  s_add_u32 s4, s4, 15729152
  v_mfma_f32_16x16x32_bf16 v[64:67], v[124:127], v[160:163], v[64:67]
  ds_read_b64_tr_b16 v[144:145], v26 offset:32768
  v_mfma_f32_16x16x32_bf16 v[60:63], v[156:159], v[124:127], v[60:63]
  ds_read_b64_tr_b16 v[146:147], v26 offset:34816
  v_lshl_add_u32 v2, v3, 2, s4
  v_mfma_f32_16x16x32_bf16 v[56:59], v[152:155], v[124:127], v[56:59]
  ds_read_b64_tr_b16 v[148:149], v28 offset:32768
  v_mfma_f32_16x16x32_bf16 v[72:75], v[152:155], v[128:131], v[72:75]
  ds_read_b64_tr_b16 v[150:151], v28 offset:34816
  buffer_load_dwordx4 v15, s[12:15], s33 offen offset:1024 lds
  s_add_u32 s33, s33, 128
  v_cmp_le_u32 vcc, 32, v1
  s_nop 1
  v_cndmask_b32 v13, v13, v2, vcc
  v_mfma_f32_16x16x32_bf16 v[76:79], v[156:159], v[128:131], v[76:79]
  ds_read_b128 v[108:111], v20 offset:18432
  s_lshl_b32 s4, s42, 2
  v_mfma_f32_16x16x32_bf16 v[80:83], v[128:131], v[160:163], v[80:83]
  ds_read_b128 v[112:115], v20 offset:20480
  v_mfma_f32_16x16x32_bf16 v[84:87], v[128:131], v[164:167], v[84:87]
  ds_read_b128 v[116:119], v20 offset:22528
  s_add_u32 s4, s4, 15730688
  v_mfma_f32_16x16x32_bf16 v[100:103], v[132:135], v[164:167], v[100:103]
  v_mov_b32 v2, s4
  v_mfma_f32_16x16x32_bf16 v[96:99], v[132:135], v[160:163], v[96:99]
  s_add_u32 m0, s34, 0
  s_nop 0
  buffer_load_dwordx4 v16, s[16:19], s35 offen lds
  v_mfma_f32_16x16x32_bf16 v[92:95], v[156:159], v[132:135], v[92:95]
  v_cmp_le_u32 vcc, 48, v1
  s_nop 1
  v_cndmask_b32 v13, v13, v2, vcc
  v_mfma_f32_16x16x32_bf16 v[88:91], v[152:155], v[132:135], v[88:91]
  s_waitcnt lgkmcnt(0)
  v_mfma_f32_16x16x32_bf16 v[40:43], v[136:139], v[104:107], v[40:43]
  ds_read_b128 v[120:123], v21 offset:16384
  v_mfma_f32_16x16x32_bf16 v[44:47], v[140:143], v[104:107], v[44:47]
  ds_read_b64_tr_b16 v[152:153], v22 offset:49152
  v_mfma_f32_16x16x32_bf16 v[48:51], v[104:107], v[144:147], v[48:51]
  ds_read_b64_tr_b16 v[154:155], v22 offset:51200
  buffer_load_dwordx4 v17, s[16:19], s35 offen offset:1024 lds
  v_mfma_f32_16x16x32_bf16 v[52:55], v[104:107], v[148:151], v[52:55]
  ds_read_b64_tr_b16 v[156:157], v24 offset:49152
  v_mfma_f32_16x16x32_bf16 v[68:71], v[108:111], v[148:151], v[68:71]
  ds_read_b64_tr_b16 v[158:159], v24 offset:51200
  v_mfma_f32_16x16x32_bf16 v[64:67], v[108:111], v[144:147], v[64:67]
  ds_read_b64_tr_b16 v[160:161], v26 offset:49152
  v_mfma_f32_16x16x32_bf16 v[60:63], v[140:143], v[108:111], v[60:63]
  ds_read_b64_tr_b16 v[162:163], v26 offset:51200
  buffer_load_dwordx4 v18, s[16:19], s35 offen offset:2048 lds
  v_mfma_f32_16x16x32_bf16 v[56:59], v[136:139], v[108:111], v[56:59]
  ds_read_b64_tr_b16 v[164:165], v28 offset:49152
  v_mfma_f32_16x16x32_bf16 v[72:75], v[136:139], v[112:115], v[72:75]
  ds_read_b64_tr_b16 v[166:167], v28 offset:51200
  v_mfma_f32_16x16x32_bf16 v[76:79], v[140:143], v[112:115], v[76:79]
  ds_read_b128 v[124:127], v21 offset:18432
  v_mfma_f32_16x16x32_bf16 v[80:83], v[112:115], v[144:147], v[80:83]
  ds_read_b128 v[128:131], v21 offset:20480
  buffer_load_dwordx4 v19, s[16:19], s35 offen offset:3072 lds
  s_add_u32 s35, s35, s79
  v_mfma_f32_16x16x32_bf16 v[84:87], v[112:115], v[148:151], v[84:87]
  ds_read_b128 v[132:135], v21 offset:22528
  v_mfma_f32_16x16x32_bf16 v[100:103], v[116:119], v[148:151], v[100:103]
  v_mfma_f32_16x16x32_bf16 v[96:99], v[116:119], v[144:147], v[96:99]
  v_mfma_f32_16x16x32_bf16 v[92:95], v[140:143], v[116:119], v[92:95]
  buffer_load_dword v10, v11, s[24:27], s38 offen
  s_add_u32 s38, s38, s39
  s_min_u32 s38, s38, s84
  v_mfma_f32_16x16x32_bf16 v[88:91], v[136:139], v[116:119], v[88:91]
  s_waitcnt vmcnt(8) lgkmcnt(0)
  s_barrier
  v_mov_b32 v14, v168
  v_mov_b32 v15, v169
  v_mov_b32 v16, v170
  v_mov_b32 v17, v171
  v_mov_b32 v18, v172
  s_mov_b32 s24, s50
  s_and_b32 s25, s51, 0xffff
  s_mov_b32 s26, 6291456
  s_mov_b32 s27, 0x20000
  v_mfma_f32_16x16x32_bf16 v[40:43], v[152:155], v[120:123], v[40:43]
  ds_read_b128 v[104:107], v20 offset:32768
  v_mfma_f32_16x16x32_bf16 v[44:47], v[156:159], v[120:123], v[44:47]
  ds_read_b64_tr_b16 v[136:137], v23 offset:0
  v_mfma_f32_16x16x32_bf16 v[48:51], v[120:123], v[160:163], v[48:51]
  ds_read_b64_tr_b16 v[138:139], v23 offset:2048
  s_add_u32 m0, s32, 16384
  s_nop 0
  buffer_load_dwordx4 v14, s[12:15], s93 offen lds
  v_mfma_f32_16x16x32_bf16 v[52:55], v[120:123], v[164:167], v[52:55]
  ds_read_b64_tr_b16 v[140:141], v25 offset:0
  v_mfma_f32_16x16x32_bf16 v[68:71], v[124:127], v[164:167], v[68:71]
  ds_read_b64_tr_b16 v[142:143], v25 offset:2048
  v_mfma_f32_16x16x32_bf16 v[64:67], v[124:127], v[160:163], v[64:67]
  ds_read_b64_tr_b16 v[144:145], v27 offset:0
  v_mfma_f32_16x16x32_bf16 v[60:63], v[156:159], v[124:127], v[60:63]
  ds_read_b64_tr_b16 v[146:147], v27 offset:2048
  v_mfma_f32_16x16x32_bf16 v[56:59], v[152:155], v[124:127], v[56:59]
  ds_read_b64_tr_b16 v[148:149], v29 offset:0
  v_mfma_f32_16x16x32_bf16 v[72:75], v[152:155], v[128:131], v[72:75]
  ds_read_b64_tr_b16 v[150:151], v29 offset:2048
  buffer_load_dwordx4 v15, s[12:15], s93 offen offset:1024 lds
  s_add_u32 s93, s93, 128
  v_mfma_f32_16x16x32_bf16 v[76:79], v[156:159], v[128:131], v[76:79]
  ds_read_b128 v[108:111], v20 offset:34816
  v_mfma_f32_16x16x32_bf16 v[80:83], v[128:131], v[160:163], v[80:83]
  ds_read_b128 v[112:115], v20 offset:36864
  v_mfma_f32_16x16x32_bf16 v[84:87], v[128:131], v[164:167], v[84:87]
  ds_read_b128 v[116:119], v20 offset:38912
  v_mfma_f32_16x16x32_bf16 v[100:103], v[132:135], v[164:167], v[100:103]
  v_mfma_f32_16x16x32_bf16 v[96:99], v[132:135], v[160:163], v[96:99]
  s_add_u32 m0, s94, 32768
  s_nop 0
  buffer_load_dwordx4 v16, s[20:23], s95 offen lds
  v_mfma_f32_16x16x32_bf16 v[92:95], v[156:159], v[132:135], v[92:95]
  v_mfma_f32_16x16x32_bf16 v[88:91], v[152:155], v[132:135], v[88:91]
  s_waitcnt lgkmcnt(0)
  v_mfma_f32_16x16x32_bf16 v[40:43], v[136:139], v[104:107], v[40:43]
  ds_read_b128 v[120:123], v21 offset:32768
  v_mfma_f32_16x16x32_bf16 v[44:47], v[140:143], v[104:107], v[44:47]
  ds_read_b64_tr_b16 v[152:153], v23 offset:16384
  v_mfma_f32_16x16x32_bf16 v[48:51], v[104:107], v[144:147], v[48:51]
  ds_read_b64_tr_b16 v[154:155], v23 offset:18432
  v_mfma_f32_16x16x32_bf16 v[52:55], v[104:107], v[148:151], v[52:55]
  ds_read_b64_tr_b16 v[156:157], v25 offset:16384
  v_mfma_f32_16x16x32_bf16 v[68:71], v[108:111], v[148:151], v[68:71]
  ds_read_b64_tr_b16 v[158:159], v25 offset:18432
  buffer_load_dwordx4 v17, s[20:23], s95 offen offset:1024 lds
  s_add_u32 s95, s95, 458752
  v_mfma_f32_16x16x32_bf16 v[64:67], v[108:111], v[144:147], v[64:67]
  ds_read_b64_tr_b16 v[160:161], v27 offset:16384
  v_mfma_f32_16x16x32_bf16 v[60:63], v[140:143], v[108:111], v[60:63]
  ds_read_b64_tr_b16 v[162:163], v27 offset:18432
  v_mfma_f32_16x16x32_bf16 v[56:59], v[136:139], v[108:111], v[56:59]
  ds_read_b64_tr_b16 v[164:165], v29 offset:16384
  v_mfma_f32_16x16x32_bf16 v[72:75], v[136:139], v[112:115], v[72:75]
  ds_read_b64_tr_b16 v[166:167], v29 offset:18432
  v_mfma_f32_16x16x32_bf16 v[76:79], v[140:143], v[112:115], v[76:79]
  ds_read_b128 v[124:127], v21 offset:34816
  v_mfma_f32_16x16x32_bf16 v[80:83], v[112:115], v[144:147], v[80:83]
  ds_read_b128 v[128:131], v21 offset:36864
  v_mfma_f32_16x16x32_bf16 v[84:87], v[112:115], v[148:151], v[84:87]
  ds_read_b128 v[132:135], v21 offset:38912
  v_mfma_f32_16x16x32_bf16 v[100:103], v[116:119], v[148:151], v[100:103]
  s_add_u32 m0, s36, 0
  s_nop 0
  buffer_load_dwordx4 v18, s[24:27], s37 offen lds
  s_add_u32 s37, s37, 393216
  v_mfma_f32_16x16x32_bf16 v[96:99], v[116:119], v[144:147], v[96:99]
  v_mfma_f32_16x16x32_bf16 v[92:95], v[140:143], v[116:119], v[92:95]
  v_mfma_f32_16x16x32_bf16 v[88:91], v[136:139], v[116:119], v[88:91]
  s_waitcnt vmcnt(6) lgkmcnt(0)
  s_barrier
  v_mfma_f32_16x16x32_bf16 v[40:43], v[152:155], v[120:123], v[40:43]
  ds_read_b128 v[104:107], v20 offset:0
  v_mfma_f32_16x16x32_bf16 v[44:47], v[156:159], v[120:123], v[44:47]
  ds_read_b64_tr_b16 v[136:137], v22 offset:0
  v_mfma_f32_16x16x32_bf16 v[48:51], v[120:123], v[160:163], v[48:51]
  ds_read_b64_tr_b16 v[138:139], v22 offset:2048
  v_mfma_f32_16x16x32_bf16 v[52:55], v[120:123], v[164:167], v[52:55]
  ds_read_b64_tr_b16 v[140:141], v24 offset:0
  v_mfma_f32_16x16x32_bf16 v[68:71], v[124:127], v[164:167], v[68:71]
  ds_read_b64_tr_b16 v[142:143], v24 offset:2048
  s_add_u32 m0, s32, 32768
  s_nop 0
  buffer_load_dwordx4 v14, s[12:15], s93 offen lds
  v_mfma_f32_16x16x32_bf16 v[64:67], v[124:127], v[160:163], v[64:67]
  ds_read_b64_tr_b16 v[144:145], v26 offset:0
  v_mfma_f32_16x16x32_bf16 v[60:63], v[156:159], v[124:127], v[60:63]
  ds_read_b64_tr_b16 v[146:147], v26 offset:2048
  v_mfma_f32_16x16x32_bf16 v[56:59], v[152:155], v[124:127], v[56:59]
  ds_read_b64_tr_b16 v[148:149], v28 offset:0
  v_mfma_f32_16x16x32_bf16 v[72:75], v[152:155], v[128:131], v[72:75]
  ds_read_b64_tr_b16 v[150:151], v28 offset:2048
  v_mfma_f32_16x16x32_bf16 v[76:79], v[156:159], v[128:131], v[76:79]
  ds_read_b128 v[108:111], v20 offset:2048
  v_mfma_f32_16x16x32_bf16 v[80:83], v[128:131], v[160:163], v[80:83]
  ds_read_b128 v[112:115], v20 offset:4096
  v_mfma_f32_16x16x32_bf16 v[84:87], v[128:131], v[164:167], v[84:87]
  ds_read_b128 v[116:119], v20 offset:6144
  v_mfma_f32_16x16x32_bf16 v[100:103], v[132:135], v[164:167], v[100:103]
  buffer_load_dwordx4 v15, s[12:15], s93 offen offset:1024 lds
  s_add_u32 s93, s93, 128
  v_mfma_f32_16x16x32_bf16 v[96:99], v[132:135], v[160:163], v[96:99]
  v_mfma_f32_16x16x32_bf16 v[92:95], v[156:159], v[132:135], v[92:95]
  v_mfma_f32_16x16x32_bf16 v[88:91], v[152:155], v[132:135], v[88:91]
  s_waitcnt lgkmcnt(0)
  v_mfma_f32_16x16x32_bf16 v[40:43], v[136:139], v[104:107], v[40:43]
  ds_read_b128 v[120:123], v21 offset:0
  s_mov_b32 s28, s70
  v_mfma_f32_16x16x32_bf16 v[44:47], v[140:143], v[104:107], v[44:47]
  ds_read_b64_tr_b16 v[152:153], v22 offset:16384
  v_mfma_f32_16x16x32_bf16 v[48:51], v[104:107], v[144:147], v[48:51]
  ds_read_b64_tr_b16 v[154:155], v22 offset:18432
  s_and_b32 s29, s71, 0xffff
  v_mfma_f32_16x16x32_bf16 v[52:55], v[104:107], v[148:151], v[52:55]
  ds_read_b64_tr_b16 v[156:157], v24 offset:16384
  v_mfma_f32_16x16x32_bf16 v[68:71], v[108:111], v[148:151], v[68:71]
  ds_read_b64_tr_b16 v[158:159], v24 offset:18432
  v_mfma_f32_16x16x32_bf16 v[64:67], v[108:111], v[144:147], v[64:67]
  ds_read_b64_tr_b16 v[160:161], v26 offset:16384
  s_mov_b32 s30, 256
  v_mfma_f32_16x16x32_bf16 v[60:63], v[140:143], v[108:111], v[60:63]
  ds_read_b64_tr_b16 v[162:163], v26 offset:18432
  v_mfma_f32_16x16x32_bf16 v[56:59], v[136:139], v[108:111], v[56:59]
  ds_read_b64_tr_b16 v[164:165], v28 offset:16384
  v_mfma_f32_16x16x32_bf16 v[72:75], v[136:139], v[112:115], v[72:75]
  ds_read_b64_tr_b16 v[166:167], v28 offset:18432
  s_add_u32 m0, s36, 8192
  s_nop 0
  buffer_load_dwordx4 v18, s[24:27], s37 offen lds
  s_add_u32 s37, s37, 393216
  s_mov_b32 s31, 0x20000
  v_mfma_f32_16x16x32_bf16 v[76:79], v[140:143], v[112:115], v[76:79]
  ds_read_b128 v[124:127], v21 offset:2048
  v_mfma_f32_16x16x32_bf16 v[80:83], v[112:115], v[144:147], v[80:83]
  ds_read_b128 v[128:131], v21 offset:4096
  s_mov_b32 s16, s60
  v_mfma_f32_16x16x32_bf16 v[84:87], v[112:115], v[148:151], v[84:87]
  ds_read_b128 v[132:135], v21 offset:6144
  v_mfma_f32_16x16x32_bf16 v[100:103], v[116:119], v[148:151], v[100:103]
  v_mfma_f32_16x16x32_bf16 v[96:99], v[116:119], v[144:147], v[96:99]
  s_and_b32 s17, s61, 0xffff
  v_mfma_f32_16x16x32_bf16 v[92:95], v[140:143], v[116:119], v[92:95]
  v_mfma_f32_16x16x32_bf16 v[88:91], v[136:139], v[116:119], v[88:91]
  s_waitcnt lgkmcnt(0)
  v_mfma_f32_16x16x32_bf16 v[40:43], v[152:155], v[120:123], v[40:43]
  s_cmp_lt_u32 s3, 4
  s_cselect_b32 s18, 8388608, 0
  v_mfma_f32_16x16x32_bf16 v[44:47], v[156:159], v[120:123], v[44:47]
  v_mfma_f32_16x16x32_bf16 v[48:51], v[120:123], v[160:163], v[48:51]
  s_mov_b32 s19, 0x20000
  v_mfma_f32_16x16x32_bf16 v[52:55], v[120:123], v[164:167], v[52:55]
  v_mfma_f32_16x16x32_bf16 v[68:71], v[124:127], v[164:167], v[68:71]
  v_mfma_f32_16x16x32_bf16 v[64:67], v[124:127], v[160:163], v[64:67]
  s_lshl_b32 s38, s2, 15
  v_mfma_f32_16x16x32_bf16 v[60:63], v[156:159], v[124:127], v[60:63]
  v_mfma_f32_16x16x32_bf16 v[56:59], v[152:155], v[124:127], v[56:59]
  v_mfma_f32_16x16x32_bf16 v[72:75], v[152:155], v[128:131], v[72:75]
  s_lshl_b32 s4, s3, 13
  v_mfma_f32_16x16x32_bf16 v[76:79], v[156:159], v[128:131], v[76:79]
  v_mfma_f32_16x16x32_bf16 v[80:83], v[128:131], v[160:163], v[80:83]
  s_add_u32 s38, s38, s4
  v_mfma_f32_16x16x32_bf16 v[84:87], v[128:131], v[164:167], v[84:87]
  v_mfma_f32_16x16x32_bf16 v[100:103], v[132:135], v[164:167], v[100:103]
  v_mfma_f32_16x16x32_bf16 v[96:99], v[132:135], v[160:163], v[96:99]
  v_lshlrev_b32 v11, 7, v1
  v_mfma_f32_16x16x32_bf16 v[92:95], v[156:159], v[132:135], v[92:95]
  v_mfma_f32_16x16x32_bf16 v[88:91], v[152:155], v[132:135], v[88:91]
  s_branch L_t1done
L_z2loop:
  s_waitcnt vmcnt(17)
  s_barrier
  ds_read_b128 v[104:107], v20 offset:0
  ds_read_b64_tr_b16 v[136:137], v22 offset:0
  ds_read_b64_tr_b16 v[138:139], v22 offset:2048
  ds_read_b64_tr_b16 v[140:141], v24 offset:0
  ds_read_b64_tr_b16 v[142:143], v24 offset:2048
  ds_read_b64_tr_b16 v[144:145], v26 offset:0
  ds_read_b64_tr_b16 v[146:147], v26 offset:2048
  ds_read_b64_tr_b16 v[148:149], v28 offset:0
  ds_read_b64_tr_b16 v[150:151], v28 offset:2048
  ds_read_b128 v[108:111], v20 offset:2048
  ds_read_b128 v[112:115], v20 offset:4096
  ds_read_b128 v[116:119], v20 offset:6144
  s_waitcnt lgkmcnt(0)
  v_mfma_f32_16x16x32_bf16 v[40:43], v[136:139], v[104:107], 0
  ds_read_b128 v[120:123], v21 offset:0
  v_mfma_f32_16x16x32_bf16 v[44:47], v[140:143], v[104:107], 0
  ds_read_b64_tr_b16 v[152:153], v22 offset:16384
  v_mfma_f32_16x16x32_bf16 v[48:51], v[144:147], v[104:107], 0
  ds_read_b64_tr_b16 v[154:155], v22 offset:18432
  v_mfma_f32_16x16x32_bf16 v[52:55], v[148:151], v[104:107], 0
  ds_read_b64_tr_b16 v[156:157], v24 offset:16384
  v_mfma_f32_16x16x32_bf16 v[68:71], v[148:151], v[108:111], 0
  ds_read_b64_tr_b16 v[158:159], v24 offset:18432
  v_mfma_f32_16x16x32_bf16 v[64:67], v[144:147], v[108:111], 0
  ds_read_b64_tr_b16 v[160:161], v26 offset:16384
  v_mfma_f32_16x16x32_bf16 v[60:63], v[140:143], v[108:111], 0
  ds_read_b64_tr_b16 v[162:163], v26 offset:18432
  v_mfma_f32_16x16x32_bf16 v[56:59], v[136:139], v[108:111], 0
  ds_read_b64_tr_b16 v[164:165], v28 offset:16384
  v_mfma_f32_16x16x32_bf16 v[72:75], v[136:139], v[112:115], 0
  ds_read_b64_tr_b16 v[166:167], v28 offset:18432
  v_mfma_f32_16x16x32_bf16 v[76:79], v[140:143], v[112:115], 0
  ds_read_b128 v[124:127], v21 offset:2048
  v_mfma_f32_16x16x32_bf16 v[80:83], v[144:147], v[112:115], 0
  ds_read_b128 v[128:131], v21 offset:4096
  v_mfma_f32_16x16x32_bf16 v[84:87], v[148:151], v[112:115], 0
  ds_read_b128 v[132:135], v21 offset:6144
  v_mfma_f32_16x16x32_bf16 v[100:103], v[148:151], v[116:119], 0
  v_mfma_f32_16x16x32_bf16 v[96:99], v[144:147], v[116:119], 0
  v_mfma_f32_16x16x32_bf16 v[92:95], v[140:143], v[116:119], 0
  v_mfma_f32_16x16x32_bf16 v[88:91], v[136:139], v[116:119], 0
  s_waitcnt vmcnt(11) lgkmcnt(0)
  s_barrier
  v_mfma_f32_16x16x32_bf16 v[40:43], v[152:155], v[120:123], v[40:43]
  ds_read_b128 v[104:107], v20 offset:16384
  v_mfma_f32_16x16x32_bf16 v[44:47], v[156:159], v[120:123], v[44:47]
  ds_read_b64_tr_b16 v[136:137], v22 offset:32768
  v_mfma_f32_16x16x32_bf16 v[48:51], v[160:163], v[120:123], v[48:51]
  ds_read_b64_tr_b16 v[138:139], v22 offset:34816
  s_add_u32 m0, s32, 0
  s_nop 0
  buffer_load_dwordx4 v14, s[12:15], s33 offen lds
  v_mfma_f32_16x16x32_bf16 v[52:55], v[164:167], v[120:123], v[52:55]
  ds_read_b64_tr_b16 v[140:141], v24 offset:32768
  v_mfma_f32_16x16x32_bf16 v[68:71], v[164:167], v[124:127], v[68:71]
  ds_read_b64_tr_b16 v[142:143], v24 offset:34816
  v_mfma_f32_16x16x32_bf16 v[64:67], v[160:163], v[124:127], v[64:67]
  ds_read_b64_tr_b16 v[144:145], v26 offset:32768
  v_mfma_f32_16x16x32_bf16 v[60:63], v[156:159], v[124:127], v[60:63]
  ds_read_b64_tr_b16 v[146:147], v26 offset:34816
  v_mfma_f32_16x16x32_bf16 v[56:59], v[152:155], v[124:127], v[56:59]
  ds_read_b64_tr_b16 v[148:149], v28 offset:32768
  v_mfma_f32_16x16x32_bf16 v[72:75], v[152:155], v[128:131], v[72:75]
  ds_read_b64_tr_b16 v[150:151], v28 offset:34816
  buffer_load_dwordx4 v15, s[12:15], s33 offen offset:1024 lds
  s_add_u32 s33, s33, 128
  v_mfma_f32_16x16x32_bf16 v[76:79], v[156:159], v[128:131], v[76:79]
  ds_read_b128 v[108:111], v20 offset:18432
  v_mfma_f32_16x16x32_bf16 v[80:83], v[160:163], v[128:131], v[80:83]
  ds_read_b128 v[112:115], v20 offset:20480
  v_mfma_f32_16x16x32_bf16 v[84:87], v[164:167], v[128:131], v[84:87]
  ds_read_b128 v[116:119], v20 offset:22528
  v_mfma_f32_16x16x32_bf16 v[100:103], v[164:167], v[132:135], v[100:103]
  v_mfma_f32_16x16x32_bf16 v[96:99], v[160:163], v[132:135], v[96:99]
  s_add_u32 m0, s34, 0
  s_nop 0
  buffer_load_dwordx4 v16, s[16:19], s35 offen lds
  v_mfma_f32_16x16x32_bf16 v[92:95], v[156:159], v[132:135], v[92:95]
  v_mfma_f32_16x16x32_bf16 v[88:91], v[152:155], v[132:135], v[88:91]
  s_waitcnt lgkmcnt(0)
  v_mfma_f32_16x16x32_bf16 v[40:43], v[136:139], v[104:107], v[40:43]
  ds_read_b128 v[120:123], v21 offset:16384
  v_mfma_f32_16x16x32_bf16 v[44:47], v[140:143], v[104:107], v[44:47]
  ds_read_b64_tr_b16 v[152:153], v22 offset:49152
  v_mfma_f32_16x16x32_bf16 v[48:51], v[144:147], v[104:107], v[48:51]
  ds_read_b64_tr_b16 v[154:155], v22 offset:51200
  buffer_load_dwordx4 v17, s[16:19], s35 offen offset:1024 lds
  v_mfma_f32_16x16x32_bf16 v[52:55], v[148:151], v[104:107], v[52:55]
  ds_read_b64_tr_b16 v[156:157], v24 offset:49152
  v_mfma_f32_16x16x32_bf16 v[68:71], v[148:151], v[108:111], v[68:71]
  ds_read_b64_tr_b16 v[158:159], v24 offset:51200
  v_mfma_f32_16x16x32_bf16 v[64:67], v[144:147], v[108:111], v[64:67]
  ds_read_b64_tr_b16 v[160:161], v26 offset:49152
  v_mfma_f32_16x16x32_bf16 v[60:63], v[140:143], v[108:111], v[60:63]
  ds_read_b64_tr_b16 v[162:163], v26 offset:51200
  buffer_load_dwordx4 v18, s[16:19], s35 offen offset:2048 lds
  v_mfma_f32_16x16x32_bf16 v[56:59], v[136:139], v[108:111], v[56:59]
  ds_read_b64_tr_b16 v[164:165], v28 offset:49152
  v_mfma_f32_16x16x32_bf16 v[72:75], v[136:139], v[112:115], v[72:75]
  ds_read_b64_tr_b16 v[166:167], v28 offset:51200
  v_mfma_f32_16x16x32_bf16 v[76:79], v[140:143], v[112:115], v[76:79]
  ds_read_b128 v[124:127], v21 offset:18432
  v_mfma_f32_16x16x32_bf16 v[80:83], v[144:147], v[112:115], v[80:83]
  ds_read_b128 v[128:131], v21 offset:20480
  buffer_load_dwordx4 v19, s[16:19], s35 offen offset:3072 lds
  s_add_u32 s35, s35, s79
  v_mfma_f32_16x16x32_bf16 v[84:87], v[148:151], v[112:115], v[84:87]
  ds_read_b128 v[132:135], v21 offset:22528
  v_mfma_f32_16x16x32_bf16 v[100:103], v[148:151], v[116:119], v[100:103]
  v_mfma_f32_16x16x32_bf16 v[96:99], v[144:147], v[116:119], v[96:99]
  v_mfma_f32_16x16x32_bf16 v[92:95], v[140:143], v[116:119], v[92:95]
  buffer_load_dword v10, v11, s[24:27], s38 offen
  s_add_u32 s38, s38, s39
  s_min_u32 s38, s38, s84
  v_mfma_f32_16x16x32_bf16 v[88:91], v[136:139], v[116:119], v[88:91]
  s_waitcnt vmcnt(12) lgkmcnt(0)
  s_barrier
  v_mfma_f32_16x16x32_bf16 v[40:43], v[152:155], v[120:123], v[40:43]
  ds_read_b128 v[104:107], v20 offset:32768
  v_mfma_f32_16x16x32_bf16 v[44:47], v[156:159], v[120:123], v[44:47]
  ds_read_b64_tr_b16 v[136:137], v23 offset:0
  v_mfma_f32_16x16x32_bf16 v[48:51], v[160:163], v[120:123], v[48:51]
  ds_read_b64_tr_b16 v[138:139], v23 offset:2048
  s_add_u32 m0, s32, 16384
  s_nop 0
  buffer_load_dwordx4 v14, s[12:15], s33 offen lds
  v_mfma_f32_16x16x32_bf16 v[52:55], v[164:167], v[120:123], v[52:55]
  ds_read_b64_tr_b16 v[140:141], v25 offset:0
  v_mfma_f32_16x16x32_bf16 v[68:71], v[164:167], v[124:127], v[68:71]
  ds_read_b64_tr_b16 v[142:143], v25 offset:2048
  v_mfma_f32_16x16x32_bf16 v[64:67], v[160:163], v[124:127], v[64:67]
  ds_read_b64_tr_b16 v[144:145], v27 offset:0
  v_mfma_f32_16x16x32_bf16 v[60:63], v[156:159], v[124:127], v[60:63]
  ds_read_b64_tr_b16 v[146:147], v27 offset:2048
  v_mfma_f32_16x16x32_bf16 v[56:59], v[152:155], v[124:127], v[56:59]
  ds_read_b64_tr_b16 v[148:149], v29 offset:0
  v_mfma_f32_16x16x32_bf16 v[72:75], v[152:155], v[128:131], v[72:75]
  ds_read_b64_tr_b16 v[150:151], v29 offset:2048
  buffer_load_dwordx4 v15, s[12:15], s33 offen offset:1024 lds
  s_add_u32 s33, s33, 128
  v_mfma_f32_16x16x32_bf16 v[76:79], v[156:159], v[128:131], v[76:79]
  ds_read_b128 v[108:111], v20 offset:34816
  v_mfma_f32_16x16x32_bf16 v[80:83], v[160:163], v[128:131], v[80:83]
  ds_read_b128 v[112:115], v20 offset:36864
  v_mfma_f32_16x16x32_bf16 v[84:87], v[164:167], v[128:131], v[84:87]
  ds_read_b128 v[116:119], v20 offset:38912
  v_mfma_f32_16x16x32_bf16 v[100:103], v[164:167], v[132:135], v[100:103]
  v_mfma_f32_16x16x32_bf16 v[96:99], v[160:163], v[132:135], v[96:99]
  s_add_u32 m0, s34, 32768
  s_nop 0
  buffer_load_dwordx4 v16, s[16:19], s35 offen lds
  v_mfma_f32_16x16x32_bf16 v[92:95], v[156:159], v[132:135], v[92:95]
  v_mfma_f32_16x16x32_bf16 v[88:91], v[152:155], v[132:135], v[88:91]
  s_waitcnt lgkmcnt(0)
  v_mfma_f32_16x16x32_bf16 v[40:43], v[136:139], v[104:107], v[40:43]
  ds_read_b128 v[120:123], v21 offset:32768
  v_mfma_f32_16x16x32_bf16 v[44:47], v[140:143], v[104:107], v[44:47]
  ds_read_b64_tr_b16 v[152:153], v23 offset:16384
  v_mfma_f32_16x16x32_bf16 v[48:51], v[144:147], v[104:107], v[48:51]
  ds_read_b64_tr_b16 v[154:155], v23 offset:18432
  buffer_load_dwordx4 v17, s[16:19], s35 offen offset:1024 lds
  v_mfma_f32_16x16x32_bf16 v[52:55], v[148:151], v[104:107], v[52:55]
  ds_read_b64_tr_b16 v[156:157], v25 offset:16384
  v_mfma_f32_16x16x32_bf16 v[68:71], v[148:151], v[108:111], v[68:71]
  ds_read_b64_tr_b16 v[158:159], v25 offset:18432
  v_mfma_f32_16x16x32_bf16 v[64:67], v[144:147], v[108:111], v[64:67]
  ds_read_b64_tr_b16 v[160:161], v27 offset:16384
  v_mfma_f32_16x16x32_bf16 v[60:63], v[140:143], v[108:111], v[60:63]
  ds_read_b64_tr_b16 v[162:163], v27 offset:18432
  buffer_load_dwordx4 v18, s[16:19], s35 offen offset:2048 lds
  v_mfma_f32_16x16x32_bf16 v[56:59], v[136:139], v[108:111], v[56:59]
  ds_read_b64_tr_b16 v[164:165], v29 offset:16384
  v_mfma_f32_16x16x32_bf16 v[72:75], v[136:139], v[112:115], v[72:75]
  ds_read_b64_tr_b16 v[166:167], v29 offset:18432
  v_mfma_f32_16x16x32_bf16 v[76:79], v[140:143], v[112:115], v[76:79]
  ds_read_b128 v[124:127], v21 offset:34816
  v_mfma_f32_16x16x32_bf16 v[80:83], v[144:147], v[112:115], v[80:83]
  ds_read_b128 v[128:131], v21 offset:36864
  buffer_load_dwordx4 v19, s[16:19], s35 offen offset:3072 lds
  s_add_u32 s35, s35, s79
  v_mfma_f32_16x16x32_bf16 v[84:87], v[148:151], v[112:115], v[84:87]
  ds_read_b128 v[132:135], v21 offset:38912
  v_mfma_f32_16x16x32_bf16 v[100:103], v[148:151], v[116:119], v[100:103]
  v_mfma_f32_16x16x32_bf16 v[96:99], v[144:147], v[116:119], v[96:99]
  v_mfma_f32_16x16x32_bf16 v[92:95], v[140:143], v[116:119], v[92:95]
  buffer_load_dword v10, v11, s[24:27], s38 offen
  s_add_u32 s38, s38, s39
  s_min_u32 s38, s38, s84
  v_mfma_f32_16x16x32_bf16 v[88:91], v[136:139], v[116:119], v[88:91]
  s_waitcnt vmcnt(8) lgkmcnt(0)
  s_barrier
  v_mfma_f32_16x16x32_bf16 v[40:43], v[152:155], v[120:123], v[40:43]
  ds_read_b128 v[104:107], v20 offset:0
  v_mfma_f32_16x16x32_bf16 v[44:47], v[156:159], v[120:123], v[44:47]
  ds_read_b64_tr_b16 v[136:137], v22 offset:0
  v_mfma_f32_16x16x32_bf16 v[48:51], v[160:163], v[120:123], v[48:51]
  ds_read_b64_tr_b16 v[138:139], v22 offset:2048
  s_add_u32 m0, s32, 32768
  s_nop 0
  buffer_load_dwordx4 v14, s[12:15], s33 offen lds
  v_mfma_f32_16x16x32_bf16 v[52:55], v[164:167], v[120:123], v[52:55]
  ds_read_b64_tr_b16 v[140:141], v24 offset:0
  v_mfma_f32_16x16x32_bf16 v[68:71], v[164:167], v[124:127], v[68:71]
  ds_read_b64_tr_b16 v[142:143], v24 offset:2048
  v_mfma_f32_16x16x32_bf16 v[64:67], v[160:163], v[124:127], v[64:67]
  ds_read_b64_tr_b16 v[144:145], v26 offset:0
  v_mfma_f32_16x16x32_bf16 v[60:63], v[156:159], v[124:127], v[60:63]
  ds_read_b64_tr_b16 v[146:147], v26 offset:2048
  v_mfma_f32_16x16x32_bf16 v[56:59], v[152:155], v[124:127], v[56:59]
  ds_read_b64_tr_b16 v[148:149], v28 offset:0
  v_mfma_f32_16x16x32_bf16 v[72:75], v[152:155], v[128:131], v[72:75]
  ds_read_b64_tr_b16 v[150:151], v28 offset:2048
  buffer_load_dwordx4 v15, s[12:15], s33 offen offset:1024 lds
  s_add_u32 s33, s33, 128
  v_mfma_f32_16x16x32_bf16 v[76:79], v[156:159], v[128:131], v[76:79]
  ds_read_b128 v[108:111], v20 offset:2048
  v_mfma_f32_16x16x32_bf16 v[80:83], v[160:163], v[128:131], v[80:83]
  ds_read_b128 v[112:115], v20 offset:4096
  v_mfma_f32_16x16x32_bf16 v[84:87], v[164:167], v[128:131], v[84:87]
  ds_read_b128 v[116:119], v20 offset:6144
  v_mfma_f32_16x16x32_bf16 v[100:103], v[164:167], v[132:135], v[100:103]
  v_mfma_f32_16x16x32_bf16 v[96:99], v[160:163], v[132:135], v[96:99]
  s_add_u32 m0, s34, 65536
  s_nop 0
  buffer_load_dwordx4 v16, s[16:19], s35 offen lds
  v_mfma_f32_16x16x32_bf16 v[92:95], v[156:159], v[132:135], v[92:95]
  v_mfma_f32_16x16x32_bf16 v[88:91], v[152:155], v[132:135], v[88:91]
  s_waitcnt lgkmcnt(0)
  v_mfma_f32_16x16x32_bf16 v[40:43], v[136:139], v[104:107], v[40:43]
  ds_read_b128 v[120:123], v21 offset:0
  v_mfma_f32_16x16x32_bf16 v[44:47], v[140:143], v[104:107], v[44:47]
  ds_read_b64_tr_b16 v[152:153], v22 offset:16384
  v_mfma_f32_16x16x32_bf16 v[48:51], v[144:147], v[104:107], v[48:51]
  ds_read_b64_tr_b16 v[154:155], v22 offset:18432
  buffer_load_dwordx4 v17, s[16:19], s35 offen offset:1024 lds
  v_mfma_f32_16x16x32_bf16 v[52:55], v[148:151], v[104:107], v[52:55]
  ds_read_b64_tr_b16 v[156:157], v24 offset:16384
  v_mfma_f32_16x16x32_bf16 v[68:71], v[148:151], v[108:111], v[68:71]
  ds_read_b64_tr_b16 v[158:159], v24 offset:18432
  v_mfma_f32_16x16x32_bf16 v[64:67], v[144:147], v[108:111], v[64:67]
  ds_read_b64_tr_b16 v[160:161], v26 offset:16384
  v_mfma_f32_16x16x32_bf16 v[60:63], v[140:143], v[108:111], v[60:63]
  ds_read_b64_tr_b16 v[162:163], v26 offset:18432
  buffer_load_dwordx4 v18, s[16:19], s35 offen offset:2048 lds
  v_mfma_f32_16x16x32_bf16 v[56:59], v[136:139], v[108:111], v[56:59]
  ds_read_b64_tr_b16 v[164:165], v28 offset:16384
  v_mfma_f32_16x16x32_bf16 v[72:75], v[136:139], v[112:115], v[72:75]
  ds_read_b64_tr_b16 v[166:167], v28 offset:18432
  v_mfma_f32_16x16x32_bf16 v[76:79], v[140:143], v[112:115], v[76:79]
  ds_read_b128 v[124:127], v21 offset:2048
  v_mfma_f32_16x16x32_bf16 v[80:83], v[144:147], v[112:115], v[80:83]
  ds_read_b128 v[128:131], v21 offset:4096
  buffer_load_dwordx4 v19, s[16:19], s35 offen offset:3072 lds
  s_add_u32 s35, s35, s79
  v_mfma_f32_16x16x32_bf16 v[84:87], v[148:151], v[112:115], v[84:87]
  ds_read_b128 v[132:135], v21 offset:6144
  v_mfma_f32_16x16x32_bf16 v[100:103], v[148:151], v[116:119], v[100:103]
  v_mfma_f32_16x16x32_bf16 v[96:99], v[144:147], v[116:119], v[96:99]
  v_mfma_f32_16x16x32_bf16 v[92:95], v[140:143], v[116:119], v[92:95]
  buffer_load_dword v10, v11, s[24:27], s38 offen
  s_add_u32 s38, s38, s39
  s_min_u32 s38, s38, s84
  v_mfma_f32_16x16x32_bf16 v[88:91], v[136:139], v[116:119], v[88:91]
  s_waitcnt vmcnt(8) lgkmcnt(0)
  s_barrier
  v_mfma_f32_16x16x32_bf16 v[40:43], v[152:155], v[120:123], v[40:43]
  ds_read_b128 v[104:107], v20 offset:16384
  v_mfma_f32_16x16x32_bf16 v[44:47], v[156:159], v[120:123], v[44:47]
  ds_read_b64_tr_b16 v[136:137], v22 offset:32768
  v_mfma_f32_16x16x32_bf16 v[48:51], v[160:163], v[120:123], v[48:51]
  ds_read_b64_tr_b16 v[138:139], v22 offset:34816
  s_add_u32 m0, s32, 0
  s_nop 0
  buffer_load_dwordx4 v14, s[12:15], s33 offen lds
  v_mfma_f32_16x16x32_bf16 v[52:55], v[164:167], v[120:123], v[52:55]
  ds_read_b64_tr_b16 v[140:141], v24 offset:32768
  v_mfma_f32_16x16x32_bf16 v[68:71], v[164:167], v[124:127], v[68:71]
  ds_read_b64_tr_b16 v[142:143], v24 offset:34816
  v_mfma_f32_16x16x32_bf16 v[64:67], v[160:163], v[124:127], v[64:67]
  ds_read_b64_tr_b16 v[144:145], v26 offset:32768
  v_mfma_f32_16x16x32_bf16 v[60:63], v[156:159], v[124:127], v[60:63]
  ds_read_b64_tr_b16 v[146:147], v26 offset:34816
  v_mfma_f32_16x16x32_bf16 v[56:59], v[152:155], v[124:127], v[56:59]
  ds_read_b64_tr_b16 v[148:149], v28 offset:32768
  v_mfma_f32_16x16x32_bf16 v[72:75], v[152:155], v[128:131], v[72:75]
  ds_read_b64_tr_b16 v[150:151], v28 offset:34816
  buffer_load_dwordx4 v15, s[12:15], s33 offen offset:1024 lds
  s_add_u32 s33, s33, 128
  v_mfma_f32_16x16x32_bf16 v[76:79], v[156:159], v[128:131], v[76:79]
  ds_read_b128 v[108:111], v20 offset:18432
  v_mfma_f32_16x16x32_bf16 v[80:83], v[160:163], v[128:131], v[80:83]
  ds_read_b128 v[112:115], v20 offset:20480
  v_mfma_f32_16x16x32_bf16 v[84:87], v[164:167], v[128:131], v[84:87]
  ds_read_b128 v[116:119], v20 offset:22528
  v_mfma_f32_16x16x32_bf16 v[100:103], v[164:167], v[132:135], v[100:103]
  v_mfma_f32_16x16x32_bf16 v[96:99], v[160:163], v[132:135], v[96:99]
  s_add_u32 m0, s34, 0
  s_nop 0
  buffer_load_dwordx4 v16, s[16:19], s35 offen lds
  v_mfma_f32_16x16x32_bf16 v[92:95], v[156:159], v[132:135], v[92:95]
  v_mfma_f32_16x16x32_bf16 v[88:91], v[152:155], v[132:135], v[88:91]
  s_waitcnt lgkmcnt(0)
  v_mfma_f32_16x16x32_bf16 v[40:43], v[136:139], v[104:107], v[40:43]
  ds_read_b128 v[120:123], v21 offset:16384
  v_mfma_f32_16x16x32_bf16 v[44:47], v[140:143], v[104:107], v[44:47]
  ds_read_b64_tr_b16 v[152:153], v22 offset:49152
  v_mfma_f32_16x16x32_bf16 v[48:51], v[144:147], v[104:107], v[48:51]
  ds_read_b64_tr_b16 v[154:155], v22 offset:51200
  buffer_load_dwordx4 v17, s[16:19], s35 offen offset:1024 lds
  v_mfma_f32_16x16x32_bf16 v[52:55], v[148:151], v[104:107], v[52:55]
  ds_read_b64_tr_b16 v[156:157], v24 offset:49152
  v_mfma_f32_16x16x32_bf16 v[68:71], v[148:151], v[108:111], v[68:71]
  ds_read_b64_tr_b16 v[158:159], v24 offset:51200
  v_mfma_f32_16x16x32_bf16 v[64:67], v[144:147], v[108:111], v[64:67]
  ds_read_b64_tr_b16 v[160:161], v26 offset:49152
  v_mfma_f32_16x16x32_bf16 v[60:63], v[140:143], v[108:111], v[60:63]
  ds_read_b64_tr_b16 v[162:163], v26 offset:51200
  buffer_load_dwordx4 v18, s[16:19], s35 offen offset:2048 lds
  v_mfma_f32_16x16x32_bf16 v[56:59], v[136:139], v[108:111], v[56:59]
  ds_read_b64_tr_b16 v[164:165], v28 offset:49152
  v_mfma_f32_16x16x32_bf16 v[72:75], v[136:139], v[112:115], v[72:75]
  ds_read_b64_tr_b16 v[166:167], v28 offset:51200
  v_mfma_f32_16x16x32_bf16 v[76:79], v[140:143], v[112:115], v[76:79]
  ds_read_b128 v[124:127], v21 offset:18432
  v_mfma_f32_16x16x32_bf16 v[80:83], v[144:147], v[112:115], v[80:83]
  ds_read_b128 v[128:131], v21 offset:20480
  buffer_load_dwordx4 v19, s[16:19], s35 offen offset:3072 lds
  s_add_u32 s35, s35, s79
  v_mfma_f32_16x16x32_bf16 v[84:87], v[148:151], v[112:115], v[84:87]
  ds_read_b128 v[132:135], v21 offset:22528
  v_mfma_f32_16x16x32_bf16 v[100:103], v[148:151], v[116:119], v[100:103]
  v_mfma_f32_16x16x32_bf16 v[96:99], v[144:147], v[116:119], v[96:99]
  v_mfma_f32_16x16x32_bf16 v[92:95], v[140:143], v[116:119], v[92:95]
  buffer_load_dword v10, v11, s[24:27], s38 offen
  s_add_u32 s38, s38, s39
  s_min_u32 s38, s38, s84
  v_mfma_f32_16x16x32_bf16 v[88:91], v[136:139], v[116:119], v[88:91]
  s_waitcnt vmcnt(8) lgkmcnt(0)
  s_barrier
  s_mov_b32 s28, s58
  s_cmp_eq_u32 s3, 5
  s_cselect_b32 s28, s50, s28
  s_mov_b32 s29, s59
  s_cmp_eq_u32 s3, 5
  s_cselect_b32 s29, s51, s29
  s_and_b32 s29, s29, 0xffff
  s_mov_b32 s30, 0
  s_cmp_eq_u32 s3, 3
  s_cselect_b32 s30, 7340032, s30
  s_cmp_eq_u32 s3, 4
  s_cselect_b32 s30, 7340032, s30
  s_cmp_eq_u32 s3, 5
  s_cselect_b32 s30, 6291456, s30
  s_mov_b32 s31, 0x20000
  s_cmp_eq_u32 s3, 4
  s_cselect_b32 s4, 64, 0
  v_add_u32 v2, s4, v1
  v_min_u32 v2, 111, v2
  v_mul_u32_u24 v3, 2341, v2
  v_lshrrev_b32 v3, 16, v3
  v_mul_u32_u24 v4, 28, v3
  v_sub_u32 v2, v2, v4
  v_mul_u32_u24 v3, 7168, v3
  v_lshl_add_u32 v2, v2, 7, v3
  v_lshrrev_b32 v3, 4, v1
  v_mul_u32_u24 v3, 6144, v3
  v_and_b32 v4, 15, v1
  v_lshl_add_u32 v3, v4, 7, v3
  s_cmp_eq_u32 s3, 5
  s_cselect_b64 vcc, -1, 0
  v_cndmask_b32 v2, v2, v3, vcc
  s_mov_b32 s5, 28672
  s_cselect_b32 s4, 24576, s5
  s_mul_i32 s4, s4, s2
  buffer_load_dword v10, v2, s[28:31], s4 offen
  v_mfma_f32_16x16x32_bf16 v[40:43], v[152:155], v[120:123], v[40:43]
  ds_read_b128 v[104:107], v20 offset:32768
  v_mfma_f32_16x16x32_bf16 v[44:47], v[156:159], v[120:123], v[44:47]
  ds_read_b64_tr_b16 v[136:137], v23 offset:0
  v_mfma_f32_16x16x32_bf16 v[48:51], v[160:163], v[120:123], v[48:51]
  ds_read_b64_tr_b16 v[138:139], v23 offset:2048
  s_add_u32 m0, s32, 16384
  s_nop 0
  buffer_load_dwordx4 v14, s[12:15], s33 offen lds
  v_mfma_f32_16x16x32_bf16 v[52:55], v[164:167], v[120:123], v[52:55]
  ds_read_b64_tr_b16 v[140:141], v25 offset:0
  v_mfma_f32_16x16x32_bf16 v[68:71], v[164:167], v[124:127], v[68:71]
  ds_read_b64_tr_b16 v[142:143], v25 offset:2048
  v_mfma_f32_16x16x32_bf16 v[64:67], v[160:163], v[124:127], v[64:67]
  ds_read_b64_tr_b16 v[144:145], v27 offset:0
  v_mfma_f32_16x16x32_bf16 v[60:63], v[156:159], v[124:127], v[60:63]
  ds_read_b64_tr_b16 v[146:147], v27 offset:2048
  v_mfma_f32_16x16x32_bf16 v[56:59], v[152:155], v[124:127], v[56:59]
  ds_read_b64_tr_b16 v[148:149], v29 offset:0
  v_mfma_f32_16x16x32_bf16 v[72:75], v[152:155], v[128:131], v[72:75]
  ds_read_b64_tr_b16 v[150:151], v29 offset:2048
  buffer_load_dwordx4 v15, s[12:15], s33 offen offset:1024 lds
  s_add_u32 s33, s33, 128
  v_mfma_f32_16x16x32_bf16 v[76:79], v[156:159], v[128:131], v[76:79]
  ds_read_b128 v[108:111], v20 offset:34816
  v_mfma_f32_16x16x32_bf16 v[80:83], v[160:163], v[128:131], v[80:83]
  ds_read_b128 v[112:115], v20 offset:36864
  v_mfma_f32_16x16x32_bf16 v[84:87], v[164:167], v[128:131], v[84:87]
  ds_read_b128 v[116:119], v20 offset:38912
  v_mfma_f32_16x16x32_bf16 v[100:103], v[164:167], v[132:135], v[100:103]
  v_mfma_f32_16x16x32_bf16 v[96:99], v[160:163], v[132:135], v[96:99]
  s_add_u32 m0, s34, 32768
  s_nop 0
  buffer_load_dwordx4 v16, s[16:19], s35 offen lds
  v_mfma_f32_16x16x32_bf16 v[92:95], v[156:159], v[132:135], v[92:95]
  v_mfma_f32_16x16x32_bf16 v[88:91], v[152:155], v[132:135], v[88:91]
  s_waitcnt lgkmcnt(0)
  v_mfma_f32_16x16x32_bf16 v[40:43], v[136:139], v[104:107], v[40:43]
  ds_read_b128 v[120:123], v21 offset:32768
  v_mfma_f32_16x16x32_bf16 v[44:47], v[140:143], v[104:107], v[44:47]
  ds_read_b64_tr_b16 v[152:153], v23 offset:16384
  v_mfma_f32_16x16x32_bf16 v[48:51], v[144:147], v[104:107], v[48:51]
  ds_read_b64_tr_b16 v[154:155], v23 offset:18432
  buffer_load_dwordx4 v17, s[16:19], s35 offen offset:1024 lds
  v_mfma_f32_16x16x32_bf16 v[52:55], v[148:151], v[104:107], v[52:55]
  ds_read_b64_tr_b16 v[156:157], v25 offset:16384
  v_mfma_f32_16x16x32_bf16 v[68:71], v[148:151], v[108:111], v[68:71]
  ds_read_b64_tr_b16 v[158:159], v25 offset:18432
  v_mfma_f32_16x16x32_bf16 v[64:67], v[144:147], v[108:111], v[64:67]
  ds_read_b64_tr_b16 v[160:161], v27 offset:16384
  v_mfma_f32_16x16x32_bf16 v[60:63], v[140:143], v[108:111], v[60:63]
  ds_read_b64_tr_b16 v[162:163], v27 offset:18432
  buffer_load_dwordx4 v18, s[16:19], s35 offen offset:2048 lds
  v_mfma_f32_16x16x32_bf16 v[56:59], v[136:139], v[108:111], v[56:59]
  ds_read_b64_tr_b16 v[164:165], v29 offset:16384
  v_mfma_f32_16x16x32_bf16 v[72:75], v[136:139], v[112:115], v[72:75]
  ds_read_b64_tr_b16 v[166:167], v29 offset:18432
  v_mfma_f32_16x16x32_bf16 v[76:79], v[140:143], v[112:115], v[76:79]
  ds_read_b128 v[124:127], v21 offset:34816
  v_mfma_f32_16x16x32_bf16 v[80:83], v[144:147], v[112:115], v[80:83]
  ds_read_b128 v[128:131], v21 offset:36864
  buffer_load_dwordx4 v19, s[16:19], s35 offen offset:3072 lds
  s_add_u32 s35, s35, s79
  v_mfma_f32_16x16x32_bf16 v[84:87], v[148:151], v[112:115], v[84:87]
  ds_read_b128 v[132:135], v21 offset:38912
  v_mfma_f32_16x16x32_bf16 v[100:103], v[148:151], v[116:119], v[100:103]
  v_mfma_f32_16x16x32_bf16 v[96:99], v[144:147], v[116:119], v[96:99]
  v_mfma_f32_16x16x32_bf16 v[92:95], v[140:143], v[116:119], v[92:95]
  buffer_load_dword v10, v11, s[24:27], s38 offen
  s_add_u32 s38, s38, s39
  s_min_u32 s38, s38, s84
  v_mfma_f32_16x16x32_bf16 v[88:91], v[136:139], v[116:119], v[88:91]
  s_waitcnt vmcnt(9) lgkmcnt(0)
  s_barrier
  v_mfma_f32_16x16x32_bf16 v[40:43], v[152:155], v[120:123], v[40:43]
  ds_read_b128 v[104:107], v20 offset:0
  v_mfma_f32_16x16x32_bf16 v[44:47], v[156:159], v[120:123], v[44:47]
  ds_read_b64_tr_b16 v[136:137], v22 offset:0
  v_mfma_f32_16x16x32_bf16 v[48:51], v[160:163], v[120:123], v[48:51]
  ds_read_b64_tr_b16 v[138:139], v22 offset:2048
  s_add_u32 m0, s32, 32768
  s_nop 0
  buffer_load_dwordx4 v14, s[12:15], s33 offen lds
  v_mfma_f32_16x16x32_bf16 v[52:55], v[164:167], v[120:123], v[52:55]
  ds_read_b64_tr_b16 v[140:141], v24 offset:0
  v_mfma_f32_16x16x32_bf16 v[68:71], v[164:167], v[124:127], v[68:71]
  ds_read_b64_tr_b16 v[142:143], v24 offset:2048
  v_mfma_f32_16x16x32_bf16 v[64:67], v[160:163], v[124:127], v[64:67]
  ds_read_b64_tr_b16 v[144:145], v26 offset:0
  v_mfma_f32_16x16x32_bf16 v[60:63], v[156:159], v[124:127], v[60:63]
  ds_read_b64_tr_b16 v[146:147], v26 offset:2048
  v_mfma_f32_16x16x32_bf16 v[56:59], v[152:155], v[124:127], v[56:59]
  ds_read_b64_tr_b16 v[148:149], v28 offset:0
  v_mfma_f32_16x16x32_bf16 v[72:75], v[152:155], v[128:131], v[72:75]
  ds_read_b64_tr_b16 v[150:151], v28 offset:2048
  buffer_load_dwordx4 v15, s[12:15], s33 offen offset:1024 lds
  s_add_u32 s33, s33, 128
  v_mfma_f32_16x16x32_bf16 v[76:79], v[156:159], v[128:131], v[76:79]
  ds_read_b128 v[108:111], v20 offset:2048
  v_mfma_f32_16x16x32_bf16 v[80:83], v[160:163], v[128:131], v[80:83]
  ds_read_b128 v[112:115], v20 offset:4096
  v_mfma_f32_16x16x32_bf16 v[84:87], v[164:167], v[128:131], v[84:87]
  ds_read_b128 v[116:119], v20 offset:6144
  v_mfma_f32_16x16x32_bf16 v[100:103], v[164:167], v[132:135], v[100:103]
  v_mfma_f32_16x16x32_bf16 v[96:99], v[160:163], v[132:135], v[96:99]
  s_add_u32 m0, s34, 65536
  s_nop 0
  buffer_load_dwordx4 v16, s[16:19], s35 offen lds
  v_mfma_f32_16x16x32_bf16 v[92:95], v[156:159], v[132:135], v[92:95]
  v_mfma_f32_16x16x32_bf16 v[88:91], v[152:155], v[132:135], v[88:91]
  s_waitcnt lgkmcnt(0)
  v_mfma_f32_16x16x32_bf16 v[40:43], v[136:139], v[104:107], v[40:43]
  ds_read_b128 v[120:123], v21 offset:0
  v_mfma_f32_16x16x32_bf16 v[44:47], v[140:143], v[104:107], v[44:47]
  ds_read_b64_tr_b16 v[152:153], v22 offset:16384
  v_mfma_f32_16x16x32_bf16 v[48:51], v[144:147], v[104:107], v[48:51]
  ds_read_b64_tr_b16 v[154:155], v22 offset:18432
  buffer_load_dwordx4 v17, s[16:19], s35 offen offset:1024 lds
  v_mfma_f32_16x16x32_bf16 v[52:55], v[148:151], v[104:107], v[52:55]
  ds_read_b64_tr_b16 v[156:157], v24 offset:16384
  v_mfma_f32_16x16x32_bf16 v[68:71], v[148:151], v[108:111], v[68:71]
  ds_read_b64_tr_b16 v[158:159], v24 offset:18432
  v_mfma_f32_16x16x32_bf16 v[64:67], v[144:147], v[108:111], v[64:67]
  ds_read_b64_tr_b16 v[160:161], v26 offset:16384
  v_mfma_f32_16x16x32_bf16 v[60:63], v[140:143], v[108:111], v[60:63]
  ds_read_b64_tr_b16 v[162:163], v26 offset:18432
  buffer_load_dwordx4 v18, s[16:19], s35 offen offset:2048 lds
  v_mfma_f32_16x16x32_bf16 v[56:59], v[136:139], v[108:111], v[56:59]
  ds_read_b64_tr_b16 v[164:165], v28 offset:16384
  v_mfma_f32_16x16x32_bf16 v[72:75], v[136:139], v[112:115], v[72:75]
  ds_read_b64_tr_b16 v[166:167], v28 offset:18432
  v_mfma_f32_16x16x32_bf16 v[76:79], v[140:143], v[112:115], v[76:79]
  ds_read_b128 v[124:127], v21 offset:2048
  v_mfma_f32_16x16x32_bf16 v[80:83], v[144:147], v[112:115], v[80:83]
  ds_read_b128 v[128:131], v21 offset:4096
  buffer_load_dwordx4 v19, s[16:19], s35 offen offset:3072 lds
  s_add_u32 s35, s35, s79
  v_mfma_f32_16x16x32_bf16 v[84:87], v[148:151], v[112:115], v[84:87]
  ds_read_b128 v[132:135], v21 offset:6144
  v_mfma_f32_16x16x32_bf16 v[100:103], v[148:151], v[116:119], v[100:103]
  v_mfma_f32_16x16x32_bf16 v[96:99], v[144:147], v[116:119], v[96:99]
  v_mfma_f32_16x16x32_bf16 v[92:95], v[140:143], v[116:119], v[92:95]
  buffer_load_dword v10, v11, s[24:27], s38 offen
  s_add_u32 s38, s38, s39
  s_min_u32 s38, s38, s84
  v_mfma_f32_16x16x32_bf16 v[88:91], v[136:139], v[116:119], v[88:91]
  s_waitcnt vmcnt(8) lgkmcnt(0)
  s_barrier
  v_mfma_f32_16x16x32_bf16 v[40:43], v[152:155], v[120:123], v[40:43]
  ds_read_b128 v[104:107], v20 offset:16384
  v_mfma_f32_16x16x32_bf16 v[44:47], v[156:159], v[120:123], v[44:47]
  ds_read_b64_tr_b16 v[136:137], v22 offset:32768
  v_mfma_f32_16x16x32_bf16 v[48:51], v[160:163], v[120:123], v[48:51]
  ds_read_b64_tr_b16 v[138:139], v22 offset:34816
  s_add_u32 m0, s32, 0
  s_nop 0
  buffer_load_dwordx4 v14, s[12:15], s33 offen lds
  v_mfma_f32_16x16x32_bf16 v[52:55], v[164:167], v[120:123], v[52:55]
  ds_read_b64_tr_b16 v[140:141], v24 offset:32768
  v_mfma_f32_16x16x32_bf16 v[68:71], v[164:167], v[124:127], v[68:71]
  ds_read_b64_tr_b16 v[142:143], v24 offset:34816
  v_mfma_f32_16x16x32_bf16 v[64:67], v[160:163], v[124:127], v[64:67]
  ds_read_b64_tr_b16 v[144:145], v26 offset:32768
  v_mfma_f32_16x16x32_bf16 v[60:63], v[156:159], v[124:127], v[60:63]
  ds_read_b64_tr_b16 v[146:147], v26 offset:34816
  v_mfma_f32_16x16x32_bf16 v[56:59], v[152:155], v[124:127], v[56:59]
  ds_read_b64_tr_b16 v[148:149], v28 offset:32768
  v_mfma_f32_16x16x32_bf16 v[72:75], v[152:155], v[128:131], v[72:75]
  ds_read_b64_tr_b16 v[150:151], v28 offset:34816
  buffer_load_dwordx4 v15, s[12:15], s33 offen offset:1024 lds
  s_add_u32 s33, s33, 128
  v_mfma_f32_16x16x32_bf16 v[76:79], v[156:159], v[128:131], v[76:79]
  ds_read_b128 v[108:111], v20 offset:18432
  v_mfma_f32_16x16x32_bf16 v[80:83], v[160:163], v[128:131], v[80:83]
  ds_read_b128 v[112:115], v20 offset:20480
  v_mfma_f32_16x16x32_bf16 v[84:87], v[164:167], v[128:131], v[84:87]
  ds_read_b128 v[116:119], v20 offset:22528
  v_mfma_f32_16x16x32_bf16 v[100:103], v[164:167], v[132:135], v[100:103]
  v_mfma_f32_16x16x32_bf16 v[96:99], v[160:163], v[132:135], v[96:99]
  s_add_u32 m0, s34, 0
  s_nop 0
  buffer_load_dwordx4 v16, s[16:19], s35 offen lds
  v_mfma_f32_16x16x32_bf16 v[92:95], v[156:159], v[132:135], v[92:95]
  v_mfma_f32_16x16x32_bf16 v[88:91], v[152:155], v[132:135], v[88:91]
  s_waitcnt lgkmcnt(0)
  v_mfma_f32_16x16x32_bf16 v[40:43], v[136:139], v[104:107], v[40:43]
  ds_read_b128 v[120:123], v21 offset:16384
  s_sub_u32 s75, s41, 8
  v_mfma_f32_16x16x32_bf16 v[44:47], v[140:143], v[104:107], v[44:47]
  ds_read_b64_tr_b16 v[152:153], v22 offset:49152
  s_lshl_b32 s4, s75, 5
  v_mfma_f32_16x16x32_bf16 v[48:51], v[144:147], v[104:107], v[48:51]
  ds_read_b64_tr_b16 v[154:155], v22 offset:51200
  buffer_load_dwordx4 v17, s[16:19], s35 offen offset:1024 lds
  s_lshl_b32 s5, s45, 3
  v_mfma_f32_16x16x32_bf16 v[52:55], v[148:151], v[104:107], v[52:55]
  ds_read_b64_tr_b16 v[156:157], v24 offset:49152
  v_mfma_f32_16x16x32_bf16 v[68:71], v[148:151], v[108:111], v[68:71]
  ds_read_b64_tr_b16 v[158:159], v24 offset:51200
  s_add_u32 s4, s4, s5
  v_mfma_f32_16x16x32_bf16 v[64:67], v[144:147], v[108:111], v[64:67]
  ds_read_b64_tr_b16 v[160:161], v26 offset:49152
  v_bfe_u32 v2, v1, 4, 1
  v_mfma_f32_16x16x32_bf16 v[60:63], v[140:143], v[108:111], v[60:63]
  ds_read_b64_tr_b16 v[162:163], v26 offset:51200
  buffer_load_dwordx4 v18, s[16:19], s35 offen offset:2048 lds
  v_lshrrev_b32 v3, 5, v1
  v_mfma_f32_16x16x32_bf16 v[56:59], v[136:139], v[108:111], v[56:59]
  ds_read_b64_tr_b16 v[164:165], v28 offset:49152
  v_mfma_f32_16x16x32_bf16 v[72:75], v[136:139], v[112:115], v[72:75]
  ds_read_b64_tr_b16 v[166:167], v28 offset:51200
  v_lshl_add_u32 v2, v2, 1, v3
  v_mfma_f32_16x16x32_bf16 v[76:79], v[140:143], v[112:115], v[76:79]
  ds_read_b128 v[124:127], v21 offset:18432
  v_add_u32 v2, s4, v2
  v_mfma_f32_16x16x32_bf16 v[80:83], v[144:147], v[112:115], v[80:83]
  ds_read_b128 v[128:131], v21 offset:20480
  buffer_load_dwordx4 v19, s[16:19], s35 offen offset:3072 lds
  s_add_u32 s35, s35, s79
  v_mul_u32_u24 v3, 4682, v2
  v_mfma_f32_16x16x32_bf16 v[84:87], v[148:151], v[112:115], v[84:87]
  ds_read_b128 v[132:135], v21 offset:22528
  v_mfma_f32_16x16x32_bf16 v[100:103], v[148:151], v[116:119], v[100:103]
  v_lshrrev_b32 v3, 16, v3
  v_mfma_f32_16x16x32_bf16 v[96:99], v[144:147], v[116:119], v[96:99]
  v_mul_u32_u24 v4, 14, v3
  v_mfma_f32_16x16x32_bf16 v[92:95], v[140:143], v[116:119], v[92:95]
  buffer_load_dword v10, v11, s[24:27], s38 offen
  s_add_u32 s38, s38, s39
  s_min_u32 s38, s38, s84
  v_sub_u32 v2, v2, v4
  v_mfma_f32_16x16x32_bf16 v[88:91], v[136:139], v[116:119], v[88:91]
  s_waitcnt vmcnt(8) lgkmcnt(0)
  s_barrier
  v_mfma_f32_16x16x32_bf16 v[40:43], v[152:155], v[120:123], v[40:43]
  ds_read_b128 v[104:107], v20 offset:32768
  v_mul_u32_u24 v3, 448, v3
  v_mfma_f32_16x16x32_bf16 v[44:47], v[156:159], v[120:123], v[44:47]
  ds_read_b64_tr_b16 v[136:137], v23 offset:0
  v_add_u32 v2, v2, v3
  v_mfma_f32_16x16x32_bf16 v[48:51], v[160:163], v[120:123], v[48:51]
  ds_read_b64_tr_b16 v[138:139], v23 offset:2048
  s_add_u32 m0, s32, 16384
  s_nop 0
  buffer_load_dwordx4 v14, s[12:15], s33 offen lds
  s_lshl_b32 s4, s40, 1
  v_mfma_f32_16x16x32_bf16 v[52:55], v[164:167], v[120:123], v[52:55]
  ds_read_b64_tr_b16 v[140:141], v25 offset:0
  v_mfma_f32_16x16x32_bf16 v[68:71], v[164:167], v[124:127], v[68:71]
  ds_read_b64_tr_b16 v[142:143], v25 offset:2048
  s_add_u32 s4, s4, s44
  v_mfma_f32_16x16x32_bf16 v[64:67], v[160:163], v[124:127], v[64:67]
  ds_read_b64_tr_b16 v[144:145], v27 offset:0
  s_mul_i32 s4, s4, 14
  v_mfma_f32_16x16x32_bf16 v[60:63], v[156:159], v[124:127], v[60:63]
  ds_read_b64_tr_b16 v[146:147], v27 offset:2048
  v_add_u32 v2, s4, v2
  v_mfma_f32_16x16x32_bf16 v[56:59], v[152:155], v[124:127], v[56:59]
  ds_read_b64_tr_b16 v[148:149], v29 offset:0
  v_mfma_f32_16x16x32_bf16 v[72:75], v[152:155], v[128:131], v[72:75]
  ds_read_b64_tr_b16 v[150:151], v29 offset:2048
  buffer_load_dwordx4 v15, s[12:15], s33 offen offset:1024 lds
  s_add_u32 s33, s33, 128
  v_and_b32 v3, 15, v1
  v_mfma_f32_16x16x32_bf16 v[76:79], v[156:159], v[128:131], v[76:79]
  ds_read_b128 v[108:111], v20 offset:34816
  v_lshlrev_b32 v3, 4, v3
  v_mfma_f32_16x16x32_bf16 v[80:83], v[160:163], v[128:131], v[80:83]
  ds_read_b128 v[112:115], v20 offset:36864
  v_lshl_add_u32 v248, v2, 10, v3
  v_mfma_f32_16x16x32_bf16 v[84:87], v[164:167], v[128:131], v[84:87]
  ds_read_b128 v[116:119], v20 offset:38912
  v_mfma_f32_16x16x32_bf16 v[100:103], v[164:167], v[132:135], v[100:103]
  v_add_u32 v250, 256, v248
  v_mfma_f32_16x16x32_bf16 v[96:99], v[160:163], v[132:135], v[96:99]
  s_add_u32 m0, s34, 32768
  s_nop 0
  buffer_load_dwordx4 v16, s[16:19], s35 offen lds
  v_add_u32 v252, 512, v248
  v_mfma_f32_16x16x32_bf16 v[92:95], v[156:159], v[132:135], v[92:95]
  v_add_u32 v254, 768, v248
  v_mfma_f32_16x16x32_bf16 v[88:91], v[152:155], v[132:135], v[88:91]
  s_waitcnt lgkmcnt(0)
  v_mfma_f32_16x16x32_bf16 v[40:43], v[136:139], v[104:107], v[40:43]
  ds_read_b128 v[120:123], v21 offset:32768
  s_lshl_b32 s4, s75, 5
  v_mfma_f32_16x16x32_bf16 v[44:47], v[140:143], v[104:107], v[44:47]
  ds_read_b64_tr_b16 v[152:153], v23 offset:16384
  s_lshl_b32 s5, s45, 3
  v_mfma_f32_16x16x32_bf16 v[48:51], v[144:147], v[104:107], v[48:51]
  ds_read_b64_tr_b16 v[154:155], v23 offset:18432
  buffer_load_dwordx4 v17, s[16:19], s35 offen offset:1024 lds
  s_add_u32 s4, s4, s5
  v_mfma_f32_16x16x32_bf16 v[52:55], v[148:151], v[104:107], v[52:55]
  ds_read_b64_tr_b16 v[156:157], v25 offset:16384
  v_mfma_f32_16x16x32_bf16 v[68:71], v[148:151], v[108:111], v[68:71]
  ds_read_b64_tr_b16 v[158:159], v25 offset:18432
  s_add_u32 s4, s4, 4
  v_mfma_f32_16x16x32_bf16 v[64:67], v[144:147], v[108:111], v[64:67]
  ds_read_b64_tr_b16 v[160:161], v27 offset:16384
  v_bfe_u32 v2, v1, 4, 1
  v_mfma_f32_16x16x32_bf16 v[60:63], v[140:143], v[108:111], v[60:63]
  ds_read_b64_tr_b16 v[162:163], v27 offset:18432
  buffer_load_dwordx4 v18, s[16:19], s35 offen offset:2048 lds
  v_lshrrev_b32 v3, 5, v1
  v_mfma_f32_16x16x32_bf16 v[56:59], v[136:139], v[108:111], v[56:59]
  ds_read_b64_tr_b16 v[164:165], v29 offset:16384
  v_mfma_f32_16x16x32_bf16 v[72:75], v[136:139], v[112:115], v[72:75]
  ds_read_b64_tr_b16 v[166:167], v29 offset:18432
  v_lshl_add_u32 v2, v2, 1, v3
  v_mfma_f32_16x16x32_bf16 v[76:79], v[140:143], v[112:115], v[76:79]
  ds_read_b128 v[124:127], v21 offset:34816
  v_add_u32 v2, s4, v2
  v_mfma_f32_16x16x32_bf16 v[80:83], v[144:147], v[112:115], v[80:83]
  ds_read_b128 v[128:131], v21 offset:36864
  buffer_load_dwordx4 v19, s[16:19], s35 offen offset:3072 lds
  s_add_u32 s35, s35, s79
  v_mul_u32_u24 v3, 4682, v2
  v_mfma_f32_16x16x32_bf16 v[84:87], v[148:151], v[112:115], v[84:87]
  ds_read_b128 v[132:135], v21 offset:38912
  v_mfma_f32_16x16x32_bf16 v[100:103], v[148:151], v[116:119], v[100:103]
  v_lshrrev_b32 v3, 16, v3
  v_mfma_f32_16x16x32_bf16 v[96:99], v[144:147], v[116:119], v[96:99]
  v_mul_u32_u24 v4, 14, v3
  v_mfma_f32_16x16x32_bf16 v[92:95], v[140:143], v[116:119], v[92:95]
  buffer_load_dword v10, v11, s[24:27], s38 offen
  s_add_u32 s38, s38, s39
  s_min_u32 s38, s38, s84
  v_sub_u32 v2, v2, v4
  v_mfma_f32_16x16x32_bf16 v[88:91], v[136:139], v[116:119], v[88:91]
  s_waitcnt vmcnt(8) lgkmcnt(0)
  s_barrier
  v_mfma_f32_16x16x32_bf16 v[40:43], v[152:155], v[120:123], v[40:43]
  ds_read_b128 v[104:107], v20 offset:0
  v_mul_u32_u24 v3, 448, v3
  v_mfma_f32_16x16x32_bf16 v[44:47], v[156:159], v[120:123], v[44:47]
  ds_read_b64_tr_b16 v[136:137], v22 offset:0
  v_add_u32 v2, v2, v3
  v_mfma_f32_16x16x32_bf16 v[48:51], v[160:163], v[120:123], v[48:51]
  ds_read_b64_tr_b16 v[138:139], v22 offset:2048
  s_add_u32 m0, s32, 32768
  s_nop 0
  buffer_load_dwordx4 v14, s[12:15], s33 offen lds
  s_lshl_b32 s4, s40, 1
  v_mfma_f32_16x16x32_bf16 v[52:55], v[164:167], v[120:123], v[52:55]
  ds_read_b64_tr_b16 v[140:141], v24 offset:0
  v_mfma_f32_16x16x32_bf16 v[68:71], v[164:167], v[124:127], v[68:71]
  ds_read_b64_tr_b16 v[142:143], v24 offset:2048
  s_add_u32 s4, s4, s44
  v_mfma_f32_16x16x32_bf16 v[64:67], v[160:163], v[124:127], v[64:67]
  ds_read_b64_tr_b16 v[144:145], v26 offset:0
  s_mul_i32 s4, s4, 14
  v_mfma_f32_16x16x32_bf16 v[60:63], v[156:159], v[124:127], v[60:63]
  ds_read_b64_tr_b16 v[146:147], v26 offset:2048
  v_add_u32 v2, s4, v2
  v_mfma_f32_16x16x32_bf16 v[56:59], v[152:155], v[124:127], v[56:59]
  ds_read_b64_tr_b16 v[148:149], v28 offset:0
  v_mfma_f32_16x16x32_bf16 v[72:75], v[152:155], v[128:131], v[72:75]
  ds_read_b64_tr_b16 v[150:151], v28 offset:2048
  buffer_load_dwordx4 v15, s[12:15], s33 offen offset:1024 lds
  s_add_u32 s33, s33, 128
  v_and_b32 v3, 15, v1
  v_mfma_f32_16x16x32_bf16 v[76:79], v[156:159], v[128:131], v[76:79]
  ds_read_b128 v[108:111], v20 offset:2048
  v_lshlrev_b32 v3, 4, v3
  v_mfma_f32_16x16x32_bf16 v[80:83], v[160:163], v[128:131], v[80:83]
  ds_read_b128 v[112:115], v20 offset:4096
  v_lshl_add_u32 v249, v2, 10, v3
  v_mfma_f32_16x16x32_bf16 v[84:87], v[164:167], v[128:131], v[84:87]
  ds_read_b128 v[116:119], v20 offset:6144
  v_mfma_f32_16x16x32_bf16 v[100:103], v[164:167], v[132:135], v[100:103]
  v_add_u32 v251, 256, v249
  v_mfma_f32_16x16x32_bf16 v[96:99], v[160:163], v[132:135], v[96:99]
  s_add_u32 m0, s34, 65536
  s_nop 0
  buffer_load_dwordx4 v16, s[16:19], s35 offen lds
  v_add_u32 v253, 512, v249
  v_mfma_f32_16x16x32_bf16 v[92:95], v[156:159], v[132:135], v[92:95]
  v_add_u32 v255, 768, v249
  v_mfma_f32_16x16x32_bf16 v[88:91], v[152:155], v[132:135], v[88:91]
  s_waitcnt lgkmcnt(0)
  v_mfma_f32_16x16x32_bf16 v[40:43], v[136:139], v[104:107], v[40:43]
  ds_read_b128 v[120:123], v21 offset:0
  s_lshl_b32 s77, s42, 7
  v_mfma_f32_16x16x32_bf16 v[44:47], v[140:143], v[104:107], v[44:47]
  ds_read_b64_tr_b16 v[152:153], v22 offset:16384
  v_mfma_f32_16x16x32_bf16 v[48:51], v[144:147], v[104:107], v[48:51]
  ds_read_b64_tr_b16 v[154:155], v22 offset:18432
  buffer_load_dwordx4 v17, s[16:19], s35 offen offset:1024 lds
  s_mov_b32 s20, s58
  v_mfma_f32_16x16x32_bf16 v[52:55], v[148:151], v[104:107], v[52:55]
  ds_read_b64_tr_b16 v[156:157], v24 offset:16384
  v_mfma_f32_16x16x32_bf16 v[68:71], v[148:151], v[108:111], v[68:71]
  ds_read_b64_tr_b16 v[158:159], v24 offset:18432
  v_mfma_f32_16x16x32_bf16 v[64:67], v[144:147], v[108:111], v[64:67]
  ds_read_b64_tr_b16 v[160:161], v26 offset:16384
  s_and_b32 s21, s59, 0xffff
  v_mfma_f32_16x16x32_bf16 v[60:63], v[140:143], v[108:111], v[60:63]
  ds_read_b64_tr_b16 v[162:163], v26 offset:18432
  buffer_load_dwordx4 v18, s[16:19], s35 offen offset:2048 lds
  v_mfma_f32_16x16x32_bf16 v[56:59], v[136:139], v[108:111], v[56:59]
  ds_read_b64_tr_b16 v[164:165], v28 offset:16384
  v_mfma_f32_16x16x32_bf16 v[72:75], v[136:139], v[112:115], v[72:75]
  ds_read_b64_tr_b16 v[166:167], v28 offset:18432
  s_mov_b32 s22, 7340032
  v_mfma_f32_16x16x32_bf16 v[76:79], v[140:143], v[112:115], v[76:79]
  ds_read_b128 v[124:127], v21 offset:2048
  v_mfma_f32_16x16x32_bf16 v[80:83], v[144:147], v[112:115], v[80:83]
  ds_read_b128 v[128:131], v21 offset:4096
  buffer_load_dwordx4 v19, s[16:19], s35 offen offset:3072 lds
  s_add_u32 s35, s35, s79
  s_mov_b32 s23, 0x20000
  v_mfma_f32_16x16x32_bf16 v[84:87], v[148:151], v[112:115], v[84:87]
  ds_read_b128 v[132:135], v21 offset:6144
  v_mfma_f32_16x16x32_bf16 v[100:103], v[148:151], v[116:119], v[100:103]
  v_mfma_f32_16x16x32_bf16 v[96:99], v[144:147], v[116:119], v[96:99]
  s_mul_i32 s94, s3, 2048
  v_mfma_f32_16x16x32_bf16 v[92:95], v[140:143], v[116:119], v[92:95]
  buffer_load_dword v10, v11, s[24:27], s38 offen
  s_add_u32 s38, s38, s39
  s_min_u32 s38, s38, s84
  v_mfma_f32_16x16x32_bf16 v[88:91], v[136:139], v[116:119], v[88:91]
  s_waitcnt vmcnt(8) lgkmcnt(0)
  s_barrier
  v_mfma_f32_16x16x32_bf16 v[40:43], v[152:155], v[120:123], v[40:43]
  ds_read_b128 v[104:107], v20 offset:16384
  s_add_u32 s94, s94, 49152
  v_mfma_f32_16x16x32_bf16 v[44:47], v[156:159], v[120:123], v[44:47]
  ds_read_b64_tr_b16 v[136:137], v22 offset:32768
  v_mfma_f32_16x16x32_bf16 v[48:51], v[160:163], v[120:123], v[48:51]
  ds_read_b64_tr_b16 v[138:139], v22 offset:34816
  s_add_u32 m0, s32, 0
  s_nop 0
  buffer_load_dwordx4 v14, s[12:15], s33 offen lds
  s_mul_i32 s36, s3, 1024
  v_mfma_f32_16x16x32_bf16 v[52:55], v[164:167], v[120:123], v[52:55]
  ds_read_b64_tr_b16 v[140:141], v24 offset:32768
  v_mfma_f32_16x16x32_bf16 v[68:71], v[164:167], v[124:127], v[68:71]
  ds_read_b64_tr_b16 v[142:143], v24 offset:34816
  s_add_u32 s36, s36, 98304
  v_mfma_f32_16x16x32_bf16 v[64:67], v[160:163], v[124:127], v[64:67]
  ds_read_b64_tr_b16 v[144:145], v26 offset:32768
  v_mfma_f32_16x16x32_bf16 v[60:63], v[156:159], v[124:127], v[60:63]
  ds_read_b64_tr_b16 v[146:147], v26 offset:34816
  s_lshl_b32 s4, s3, 4
  v_mfma_f32_16x16x32_bf16 v[56:59], v[152:155], v[124:127], v[56:59]
  ds_read_b64_tr_b16 v[148:149], v28 offset:32768
  v_mfma_f32_16x16x32_bf16 v[72:75], v[152:155], v[128:131], v[72:75]
  ds_read_b64_tr_b16 v[150:151], v28 offset:34816
  buffer_load_dwordx4 v15, s[12:15], s33 offen offset:1024 lds
  s_add_u32 s33, s33, 128
  v_mfma_f32_16x16x32_bf16 v[76:79], v[156:159], v[128:131], v[76:79]
  ds_read_b128 v[108:111], v20 offset:18432
  s_add_u32 s4, s4, s77
  v_mfma_f32_16x16x32_bf16 v[80:83], v[160:163], v[128:131], v[80:83]
  ds_read_b128 v[112:115], v20 offset:20480
  v_mfma_f32_16x16x32_bf16 v[84:87], v[164:167], v[128:131], v[84:87]
  ds_read_b128 v[116:119], v20 offset:22528
  s_mul_i32 s93, s4, 2048
  v_mfma_f32_16x16x32_bf16 v[100:103], v[164:167], v[132:135], v[100:103]
  v_mfma_f32_16x16x32_bf16 v[96:99], v[160:163], v[132:135], v[96:99]
  s_add_u32 m0, s34, 0
  s_nop 0
  buffer_load_dwordx4 v16, s[16:19], s35 offen lds
  v_mul_u32_u24 v2, 2048, v0
  v_mfma_f32_16x16x32_bf16 v[92:95], v[156:159], v[132:135], v[92:95]
  v_mfma_f32_16x16x32_bf16 v[88:91], v[152:155], v[132:135], v[88:91]
  s_waitcnt lgkmcnt(0)
  v_mfma_f32_16x16x32_bf16 v[40:43], v[136:139], v[104:107], v[40:43]
  ds_read_b128 v[120:123], v21 offset:16384
  v_add_u32 v168, v2, v38
  v_mfma_f32_16x16x32_bf16 v[44:47], v[140:143], v[104:107], v[44:47]
  ds_read_b64_tr_b16 v[152:153], v22 offset:49152
  v_mfma_f32_16x16x32_bf16 v[48:51], v[144:147], v[104:107], v[48:51]
  ds_read_b64_tr_b16 v[154:155], v22 offset:51200
  buffer_load_dwordx4 v17, s[16:19], s35 offen offset:1024 lds
  v_xor_b32 v169, 64, v38
  v_mfma_f32_16x16x32_bf16 v[52:55], v[148:151], v[104:107], v[52:55]
  ds_read_b64_tr_b16 v[156:157], v24 offset:49152
  v_mfma_f32_16x16x32_bf16 v[68:71], v[148:151], v[108:111], v[68:71]
  ds_read_b64_tr_b16 v[158:159], v24 offset:51200
  v_mfma_f32_16x16x32_bf16 v[64:67], v[144:147], v[108:111], v[64:67]
  ds_read_b64_tr_b16 v[160:161], v26 offset:49152
  v_add_u32 v2, 15360, v2
  v_mfma_f32_16x16x32_bf16 v[60:63], v[140:143], v[108:111], v[60:63]
  ds_read_b64_tr_b16 v[162:163], v26 offset:51200
  buffer_load_dwordx4 v18, s[16:19], s35 offen offset:2048 lds
  v_mfma_f32_16x16x32_bf16 v[56:59], v[136:139], v[108:111], v[56:59]
  ds_read_b64_tr_b16 v[164:165], v28 offset:49152
  v_mfma_f32_16x16x32_bf16 v[72:75], v[136:139], v[112:115], v[72:75]
  ds_read_b64_tr_b16 v[166:167], v28 offset:51200
  v_add_u32 v169, v169, v2
  v_mfma_f32_16x16x32_bf16 v[76:79], v[140:143], v[112:115], v[76:79]
  ds_read_b128 v[124:127], v21 offset:18432
  v_mfma_f32_16x16x32_bf16 v[80:83], v[144:147], v[112:115], v[80:83]
  ds_read_b128 v[128:131], v21 offset:20480
  buffer_load_dwordx4 v19, s[16:19], s35 offen offset:3072 lds
  s_add_u32 s35, s35, s79
  s_mul_i32 s78, s43, 224
  v_mfma_f32_16x16x32_bf16 v[84:87], v[148:151], v[112:115], v[84:87]
  ds_read_b128 v[132:135], v21 offset:22528
  v_mfma_f32_16x16x32_bf16 v[100:103], v[148:151], v[116:119], v[100:103]
  v_mfma_f32_16x16x32_bf16 v[96:99], v[144:147], v[116:119], v[96:99]
  s_mul_i32 s95, s3, 57344
  v_mfma_f32_16x16x32_bf16 v[92:95], v[140:143], v[116:119], v[92:95]
  buffer_load_dword v10, v11, s[24:27], s38 offen
  s_add_u32 s38, s38, s39
  s_min_u32 s38, s38, s84
  v_mfma_f32_16x16x32_bf16 v[88:91], v[136:139], v[116:119], v[88:91]
  s_waitcnt vmcnt(8) lgkmcnt(0)
  s_barrier
  v_mfma_f32_16x16x32_bf16 v[40:43], v[152:155], v[120:123], v[40:43]
  ds_read_b128 v[104:107], v20 offset:32768
  s_add_u32 s95, s95, s78
  v_mfma_f32_16x16x32_bf16 v[44:47], v[156:159], v[120:123], v[44:47]
  ds_read_b64_tr_b16 v[136:137], v23 offset:0
  v_mfma_f32_16x16x32_bf16 v[48:51], v[160:163], v[120:123], v[48:51]
  ds_read_b64_tr_b16 v[138:139], v23 offset:2048
  s_add_u32 m0, s32, 16384
  s_nop 0
  buffer_load_dwordx4 v14, s[12:15], s33 offen lds
  v_lshrrev_b32 v2, 4, v1
  v_mfma_f32_16x16x32_bf16 v[52:55], v[164:167], v[120:123], v[52:55]
  ds_read_b64_tr_b16 v[140:141], v25 offset:0
  v_mfma_f32_16x16x32_bf16 v[68:71], v[164:167], v[124:127], v[68:71]
  ds_read_b64_tr_b16 v[142:143], v25 offset:2048
  v_mul_u32_u24 v2, 7168, v2
  v_mfma_f32_16x16x32_bf16 v[64:67], v[160:163], v[124:127], v[64:67]
  ds_read_b64_tr_b16 v[144:145], v27 offset:0
  v_mfma_f32_16x16x32_bf16 v[60:63], v[156:159], v[124:127], v[60:63]
  ds_read_b64_tr_b16 v[146:147], v27 offset:2048
  v_add_u32 v170, v2, v39
  v_mfma_f32_16x16x32_bf16 v[56:59], v[152:155], v[124:127], v[56:59]
  ds_read_b64_tr_b16 v[148:149], v29 offset:0
  v_mfma_f32_16x16x32_bf16 v[72:75], v[152:155], v[128:131], v[72:75]
  ds_read_b64_tr_b16 v[150:151], v29 offset:2048
  buffer_load_dwordx4 v15, s[12:15], s33 offen offset:1024 lds
  s_add_u32 s33, s33, 128
  v_mfma_f32_16x16x32_bf16 v[76:79], v[156:159], v[128:131], v[76:79]
  ds_read_b128 v[108:111], v20 offset:34816
  v_add_u32 v171, 27648, v170
  v_mfma_f32_16x16x32_bf16 v[80:83], v[160:163], v[128:131], v[80:83]
  ds_read_b128 v[112:115], v20 offset:36864
  v_mfma_f32_16x16x32_bf16 v[84:87], v[164:167], v[128:131], v[84:87]
  ds_read_b128 v[116:119], v20 offset:38912
  s_lshl_b32 s78, s43, 7
  v_mfma_f32_16x16x32_bf16 v[100:103], v[164:167], v[132:135], v[100:103]
  v_mfma_f32_16x16x32_bf16 v[96:99], v[160:163], v[132:135], v[96:99]
  s_add_u32 m0, s34, 32768
  s_nop 0
  buffer_load_dwordx4 v16, s[16:19], s35 offen lds
  s_mov_b32 s5, 6144
  v_mfma_f32_16x16x32_bf16 v[92:95], v[156:159], v[132:135], v[92:95]
  v_mfma_f32_16x16x32_bf16 v[88:91], v[152:155], v[132:135], v[88:91]
  s_waitcnt lgkmcnt(0)
  v_mfma_f32_16x16x32_bf16 v[40:43], v[136:139], v[104:107], v[40:43]
  ds_read_b128 v[120:123], v21 offset:32768
  s_mul_i32 s37, s3, 49152
  v_mfma_f32_16x16x32_bf16 v[44:47], v[140:143], v[104:107], v[44:47]
  ds_read_b64_tr_b16 v[152:153], v23 offset:16384
  v_mfma_f32_16x16x32_bf16 v[48:51], v[144:147], v[104:107], v[48:51]
  ds_read_b64_tr_b16 v[154:155], v23 offset:18432
  buffer_load_dwordx4 v17, s[16:19], s35 offen offset:1024 lds
  v_mfma_f32_16x16x32_bf16 v[52:55], v[148:151], v[104:107], v[52:55]
  ds_read_b64_tr_b16 v[156:157], v25 offset:16384
  s_add_u32 s37, s37, s78
  v_mfma_f32_16x16x32_bf16 v[68:71], v[148:151], v[108:111], v[68:71]
  ds_read_b64_tr_b16 v[158:159], v25 offset:18432
  v_mfma_f32_16x16x32_bf16 v[64:67], v[144:147], v[108:111], v[64:67]
  ds_read_b64_tr_b16 v[160:161], v27 offset:16384
  v_mfma_f32_16x16x32_bf16 v[60:63], v[140:143], v[108:111], v[60:63]
  ds_read_b64_tr_b16 v[162:163], v27 offset:18432
  buffer_load_dwordx4 v18, s[16:19], s35 offen offset:2048 lds
  s_lshl_b32 s4, s44, 1
  v_mfma_f32_16x16x32_bf16 v[56:59], v[136:139], v[108:111], v[56:59]
  ds_read_b64_tr_b16 v[164:165], v29 offset:16384
  v_mfma_f32_16x16x32_bf16 v[72:75], v[136:139], v[112:115], v[72:75]
  ds_read_b64_tr_b16 v[166:167], v29 offset:18432
  v_mfma_f32_16x16x32_bf16 v[76:79], v[140:143], v[112:115], v[76:79]
  ds_read_b128 v[124:127], v21 offset:34816
  v_bfe_u32 v3, v1, 4, 1
  v_mfma_f32_16x16x32_bf16 v[80:83], v[144:147], v[112:115], v[80:83]
  ds_read_b128 v[128:131], v21 offset:36864
  buffer_load_dwordx4 v19, s[16:19], s35 offen offset:3072 lds
  s_add_u32 s35, s35, s79
  v_mfma_f32_16x16x32_bf16 v[84:87], v[148:151], v[112:115], v[84:87]
  ds_read_b128 v[132:135], v21 offset:38912
  v_mfma_f32_16x16x32_bf16 v[100:103], v[148:151], v[116:119], v[100:103]
  v_or_b32 v3, s4, v3
  v_mfma_f32_16x16x32_bf16 v[96:99], v[144:147], v[116:119], v[96:99]
  v_mfma_f32_16x16x32_bf16 v[92:95], v[140:143], v[116:119], v[92:95]
  buffer_load_dword v10, v11, s[24:27], s38 offen
  s_add_u32 s38, s38, s39
  s_min_u32 s38, s38, s84
  v_mfma_f32_16x16x32_bf16 v[88:91], v[136:139], v[116:119], v[88:91]
  s_waitcnt vmcnt(8) lgkmcnt(0)
  s_barrier
  v_mfma_f32_16x16x32_bf16 v[40:43], v[152:155], v[120:123], v[40:43]
  ds_read_b128 v[104:107], v20 offset:0
  v_bfe_u32 v4, v1, 1, 2
  v_mfma_f32_16x16x32_bf16 v[44:47], v[156:159], v[120:123], v[44:47]
  ds_read_b64_tr_b16 v[136:137], v22 offset:0
  v_mfma_f32_16x16x32_bf16 v[48:51], v[160:163], v[120:123], v[48:51]
  ds_read_b64_tr_b16 v[138:139], v22 offset:2048
  s_add_u32 m0, s32, 32768
  s_nop 0
  buffer_load_dwordx4 v14, s[12:15], s33 offen lds
  v_xor_b32 v3, v3, v4
  v_mfma_f32_16x16x32_bf16 v[52:55], v[164:167], v[120:123], v[52:55]
  ds_read_b64_tr_b16 v[140:141], v24 offset:0
  v_mfma_f32_16x16x32_bf16 v[68:71], v[164:167], v[124:127], v[68:71]
  ds_read_b64_tr_b16 v[142:143], v24 offset:2048
  v_mfma_f32_16x16x32_bf16 v[64:67], v[160:163], v[124:127], v[64:67]
  ds_read_b64_tr_b16 v[144:145], v26 offset:0
  v_and_b32 v4, 1, v1
  v_mfma_f32_16x16x32_bf16 v[60:63], v[156:159], v[124:127], v[60:63]
  ds_read_b64_tr_b16 v[146:147], v26 offset:2048
  v_mfma_f32_16x16x32_bf16 v[56:59], v[152:155], v[124:127], v[56:59]
  ds_read_b64_tr_b16 v[148:149], v28 offset:0
  v_mfma_f32_16x16x32_bf16 v[72:75], v[152:155], v[128:131], v[72:75]
  ds_read_b64_tr_b16 v[150:151], v28 offset:2048
  buffer_load_dwordx4 v15, s[12:15], s33 offen offset:1024 lds
  s_add_u32 s33, s33, 128
  v_lshlrev_b32 v4, 4, v4
  v_mfma_f32_16x16x32_bf16 v[76:79], v[156:159], v[128:131], v[76:79]
  ds_read_b128 v[108:111], v20 offset:2048
  v_mfma_f32_16x16x32_bf16 v[80:83], v[160:163], v[128:131], v[80:83]
  ds_read_b128 v[112:115], v20 offset:4096
  v_lshl_add_u32 v3, v3, 5, v4
  v_mfma_f32_16x16x32_bf16 v[84:87], v[164:167], v[128:131], v[84:87]
  ds_read_b128 v[116:119], v20 offset:6144
  v_mfma_f32_16x16x32_bf16 v[100:103], v[164:167], v[132:135], v[100:103]
  v_mfma_f32_16x16x32_bf16 v[96:99], v[160:163], v[132:135], v[96:99]
  s_add_u32 m0, s34, 65536
  s_nop 0
  buffer_load_dwordx4 v16, s[16:19], s35 offen lds
  v_mad_u32_u24 v172, v0, s5, v3
  v_mfma_f32_16x16x32_bf16 v[92:95], v[156:159], v[132:135], v[92:95]
  v_mfma_f32_16x16x32_bf16 v[88:91], v[152:155], v[132:135], v[88:91]
  s_waitcnt lgkmcnt(0)
  v_mfma_f32_16x16x32_bf16 v[40:43], v[136:139], v[104:107], v[40:43]
  ds_read_b128 v[120:123], v21 offset:0
  s_mul_i32 s4, s43, 112
  v_mfma_f32_16x16x32_bf16 v[44:47], v[140:143], v[104:107], v[44:47]
  ds_read_b64_tr_b16 v[152:153], v22 offset:16384
  s_lshr_b32 s5, s4, 8
  v_mfma_f32_16x16x32_bf16 v[48:51], v[144:147], v[104:107], v[48:51]
  ds_read_b64_tr_b16 v[154:155], v22 offset:18432
  buffer_load_dwordx4 v17, s[16:19], s35 offen offset:1024 lds
  v_mfma_f32_16x16x32_bf16 v[52:55], v[148:151], v[104:107], v[52:55]
  ds_read_b64_tr_b16 v[156:157], v24 offset:16384
  s_add_u32 s4, s4, 111
  v_mfma_f32_16x16x32_bf16 v[68:71], v[148:151], v[108:111], v[68:71]
  ds_read_b64_tr_b16 v[158:159], v24 offset:18432
  s_lshr_b32 s4, s4, 8
  v_mfma_f32_16x16x32_bf16 v[64:67], v[144:147], v[108:111], v[64:67]
  ds_read_b64_tr_b16 v[160:161], v26 offset:16384
  v_mfma_f32_16x16x32_bf16 v[60:63], v[140:143], v[108:111], v[60:63]
  ds_read_b64_tr_b16 v[162:163], v26 offset:18432
  buffer_load_dwordx4 v18, s[16:19], s35 offen offset:2048 lds
  v_mov_b32 v2, s5
  v_mfma_f32_16x16x32_bf16 v[56:59], v[136:139], v[108:111], v[56:59]
  ds_read_b64_tr_b16 v[164:165], v28 offset:16384
  v_mfma_f32_16x16x32_bf16 v[72:75], v[136:139], v[112:115], v[72:75]
  ds_read_b64_tr_b16 v[166:167], v28 offset:18432
  v_mov_b32 v3, s4
  v_mfma_f32_16x16x32_bf16 v[76:79], v[140:143], v[112:115], v[76:79]
  ds_read_b128 v[124:127], v21 offset:2048
  v_cmp_gt_u32 vcc, 16, v1
  s_nop 1
  v_cndmask_b32 v2, v3, v2, vcc
  v_mfma_f32_16x16x32_bf16 v[80:83], v[144:147], v[112:115], v[80:83]
  ds_read_b128 v[128:131], v21 offset:4096
  buffer_load_dwordx4 v19, s[16:19], s35 offen offset:3072 lds
  s_add_u32 s35, s35, s79
  v_mfma_f32_16x16x32_bf16 v[84:87], v[148:151], v[112:115], v[84:87]
  ds_read_b128 v[132:135], v21 offset:6144
  v_and_b32 v3, 15, v1
  v_mfma_f32_16x16x32_bf16 v[100:103], v[148:151], v[116:119], v[100:103]
  v_lshl_add_u32 v2, v2, 4, v3
  v_mfma_f32_16x16x32_bf16 v[96:99], v[144:147], v[116:119], v[96:99]
  v_mfma_f32_16x16x32_bf16 v[92:95], v[140:143], v[116:119], v[92:95]
  buffer_load_dword v10, v11, s[24:27], s38 offen
  s_add_u32 s38, s38, s39
  s_min_u32 s38, s38, s84
  v_lshlrev_b32 v2, 2, v2
  v_mfma_f32_16x16x32_bf16 v[88:91], v[136:139], v[116:119], v[88:91]
  s_waitcnt vmcnt(8) lgkmcnt(0)
  s_barrier
  v_mfma_f32_16x16x32_bf16 v[40:43], v[152:155], v[120:123], v[40:43]
  ds_read_b128 v[104:107], v20 offset:16384
  v_add_u32 v13, 15728640, v2
  v_mfma_f32_16x16x32_bf16 v[44:47], v[156:159], v[120:123], v[44:47]
  ds_read_b64_tr_b16 v[136:137], v22 offset:32768
  s_lshr_b32 s4, s2, 5
  v_mfma_f32_16x16x32_bf16 v[48:51], v[160:163], v[120:123], v[48:51]
  ds_read_b64_tr_b16 v[138:139], v22 offset:34816
  s_add_u32 m0, s32, 0
  s_nop 0
  buffer_load_dwordx4 v14, s[12:15], s33 offen lds
  v_mfma_f32_16x16x32_bf16 v[52:55], v[164:167], v[120:123], v[52:55]
  ds_read_b64_tr_b16 v[140:141], v24 offset:32768
  s_lshl_b32 s4, s4, 6
  v_mfma_f32_16x16x32_bf16 v[68:71], v[164:167], v[124:127], v[68:71]
  ds_read_b64_tr_b16 v[142:143], v24 offset:34816
  s_add_u32 s4, s4, 15729152
  v_mfma_f32_16x16x32_bf16 v[64:67], v[160:163], v[124:127], v[64:67]
  ds_read_b64_tr_b16 v[144:145], v26 offset:32768
  v_mfma_f32_16x16x32_bf16 v[60:63], v[156:159], v[124:127], v[60:63]
  ds_read_b64_tr_b16 v[146:147], v26 offset:34816
  v_lshl_add_u32 v2, v3, 2, s4
  v_mfma_f32_16x16x32_bf16 v[56:59], v[152:155], v[124:127], v[56:59]
  ds_read_b64_tr_b16 v[148:149], v28 offset:32768
  v_mfma_f32_16x16x32_bf16 v[72:75], v[152:155], v[128:131], v[72:75]
  ds_read_b64_tr_b16 v[150:151], v28 offset:34816
  buffer_load_dwordx4 v15, s[12:15], s33 offen offset:1024 lds
  s_add_u32 s33, s33, 128
  v_cmp_le_u32 vcc, 32, v1
  s_nop 1
  v_cndmask_b32 v13, v13, v2, vcc
  v_mfma_f32_16x16x32_bf16 v[76:79], v[156:159], v[128:131], v[76:79]
  ds_read_b128 v[108:111], v20 offset:18432
  s_lshl_b32 s4, s42, 2
  v_mfma_f32_16x16x32_bf16 v[80:83], v[160:163], v[128:131], v[80:83]
  ds_read_b128 v[112:115], v20 offset:20480
  v_mfma_f32_16x16x32_bf16 v[84:87], v[164:167], v[128:131], v[84:87]
  ds_read_b128 v[116:119], v20 offset:22528
  s_add_u32 s4, s4, 15730688
  v_mfma_f32_16x16x32_bf16 v[100:103], v[164:167], v[132:135], v[100:103]
  v_mov_b32 v2, s4
  v_mfma_f32_16x16x32_bf16 v[96:99], v[160:163], v[132:135], v[96:99]
  s_add_u32 m0, s34, 0
  s_nop 0
  buffer_load_dwordx4 v16, s[16:19], s35 offen lds
  v_mfma_f32_16x16x32_bf16 v[92:95], v[156:159], v[132:135], v[92:95]
  v_cmp_le_u32 vcc, 48, v1
  s_nop 1
  v_cndmask_b32 v13, v13, v2, vcc
  v_mfma_f32_16x16x32_bf16 v[88:91], v[152:155], v[132:135], v[88:91]
  s_waitcnt lgkmcnt(0)
  v_mfma_f32_16x16x32_bf16 v[40:43], v[136:139], v[104:107], v[40:43]
  ds_read_b128 v[120:123], v21 offset:16384
  v_mfma_f32_16x16x32_bf16 v[44:47], v[140:143], v[104:107], v[44:47]
  ds_read_b64_tr_b16 v[152:153], v22 offset:49152
  v_mfma_f32_16x16x32_bf16 v[48:51], v[144:147], v[104:107], v[48:51]
  ds_read_b64_tr_b16 v[154:155], v22 offset:51200
  buffer_load_dwordx4 v17, s[16:19], s35 offen offset:1024 lds
  v_mfma_f32_16x16x32_bf16 v[52:55], v[148:151], v[104:107], v[52:55]
  ds_read_b64_tr_b16 v[156:157], v24 offset:49152
  v_mfma_f32_16x16x32_bf16 v[68:71], v[148:151], v[108:111], v[68:71]
  ds_read_b64_tr_b16 v[158:159], v24 offset:51200
  v_mfma_f32_16x16x32_bf16 v[64:67], v[144:147], v[108:111], v[64:67]
  ds_read_b64_tr_b16 v[160:161], v26 offset:49152
  v_mfma_f32_16x16x32_bf16 v[60:63], v[140:143], v[108:111], v[60:63]
  ds_read_b64_tr_b16 v[162:163], v26 offset:51200
  buffer_load_dwordx4 v18, s[16:19], s35 offen offset:2048 lds
  v_mfma_f32_16x16x32_bf16 v[56:59], v[136:139], v[108:111], v[56:59]
  ds_read_b64_tr_b16 v[164:165], v28 offset:49152
  v_mfma_f32_16x16x32_bf16 v[72:75], v[136:139], v[112:115], v[72:75]
  ds_read_b64_tr_b16 v[166:167], v28 offset:51200
  v_mfma_f32_16x16x32_bf16 v[76:79], v[140:143], v[112:115], v[76:79]
  ds_read_b128 v[124:127], v21 offset:18432
  v_mfma_f32_16x16x32_bf16 v[80:83], v[144:147], v[112:115], v[80:83]
  ds_read_b128 v[128:131], v21 offset:20480
  buffer_load_dwordx4 v19, s[16:19], s35 offen offset:3072 lds
  s_add_u32 s35, s35, s79
  v_mfma_f32_16x16x32_bf16 v[84:87], v[148:151], v[112:115], v[84:87]
  ds_read_b128 v[132:135], v21 offset:22528
  v_mfma_f32_16x16x32_bf16 v[100:103], v[148:151], v[116:119], v[100:103]
  v_mfma_f32_16x16x32_bf16 v[96:99], v[144:147], v[116:119], v[96:99]
  v_mfma_f32_16x16x32_bf16 v[92:95], v[140:143], v[116:119], v[92:95]
  buffer_load_dword v10, v11, s[24:27], s38 offen
  s_add_u32 s38, s38, s39
  s_min_u32 s38, s38, s84
  v_mfma_f32_16x16x32_bf16 v[88:91], v[136:139], v[116:119], v[88:91]
  s_waitcnt vmcnt(8) lgkmcnt(0)
  s_barrier
  v_mov_b32 v14, v168
  v_mov_b32 v15, v169
  v_mov_b32 v16, v170
  v_mov_b32 v17, v171
  v_mov_b32 v18, v172
  s_mov_b32 s24, s50
  s_and_b32 s25, s51, 0xffff
  s_mov_b32 s26, 6291456
  s_mov_b32 s27, 0x20000
  v_mfma_f32_16x16x32_bf16 v[40:43], v[152:155], v[120:123], v[40:43]
  ds_read_b128 v[104:107], v20 offset:32768
  v_mfma_f32_16x16x32_bf16 v[44:47], v[156:159], v[120:123], v[44:47]
  ds_read_b64_tr_b16 v[136:137], v23 offset:0
  v_mfma_f32_16x16x32_bf16 v[48:51], v[160:163], v[120:123], v[48:51]
  ds_read_b64_tr_b16 v[138:139], v23 offset:2048
  s_add_u32 m0, s32, 16384
  s_nop 0
  buffer_load_dwordx4 v14, s[12:15], s93 offen lds
  v_mfma_f32_16x16x32_bf16 v[52:55], v[164:167], v[120:123], v[52:55]
  ds_read_b64_tr_b16 v[140:141], v25 offset:0
  v_mfma_f32_16x16x32_bf16 v[68:71], v[164:167], v[124:127], v[68:71]
  ds_read_b64_tr_b16 v[142:143], v25 offset:2048
  v_mfma_f32_16x16x32_bf16 v[64:67], v[160:163], v[124:127], v[64:67]
  ds_read_b64_tr_b16 v[144:145], v27 offset:0
  v_mfma_f32_16x16x32_bf16 v[60:63], v[156:159], v[124:127], v[60:63]
  ds_read_b64_tr_b16 v[146:147], v27 offset:2048
  v_mfma_f32_16x16x32_bf16 v[56:59], v[152:155], v[124:127], v[56:59]
  ds_read_b64_tr_b16 v[148:149], v29 offset:0
  v_mfma_f32_16x16x32_bf16 v[72:75], v[152:155], v[128:131], v[72:75]
  ds_read_b64_tr_b16 v[150:151], v29 offset:2048
  buffer_load_dwordx4 v15, s[12:15], s93 offen offset:1024 lds
  s_add_u32 s93, s93, 128
  v_mfma_f32_16x16x32_bf16 v[76:79], v[156:159], v[128:131], v[76:79]
  ds_read_b128 v[108:111], v20 offset:34816
  v_mfma_f32_16x16x32_bf16 v[80:83], v[160:163], v[128:131], v[80:83]
  ds_read_b128 v[112:115], v20 offset:36864
  v_mfma_f32_16x16x32_bf16 v[84:87], v[164:167], v[128:131], v[84:87]
  ds_read_b128 v[116:119], v20 offset:38912
  v_mfma_f32_16x16x32_bf16 v[100:103], v[164:167], v[132:135], v[100:103]
  v_mfma_f32_16x16x32_bf16 v[96:99], v[160:163], v[132:135], v[96:99]
  s_add_u32 m0, s94, 32768
  s_nop 0
  buffer_load_dwordx4 v16, s[20:23], s95 offen lds
  v_mfma_f32_16x16x32_bf16 v[92:95], v[156:159], v[132:135], v[92:95]
  v_mfma_f32_16x16x32_bf16 v[88:91], v[152:155], v[132:135], v[88:91]
  s_waitcnt lgkmcnt(0)
  v_mfma_f32_16x16x32_bf16 v[40:43], v[136:139], v[104:107], v[40:43]
  ds_read_b128 v[120:123], v21 offset:32768
  v_mfma_f32_16x16x32_bf16 v[44:47], v[140:143], v[104:107], v[44:47]
  ds_read_b64_tr_b16 v[152:153], v23 offset:16384
  v_mfma_f32_16x16x32_bf16 v[48:51], v[144:147], v[104:107], v[48:51]
  ds_read_b64_tr_b16 v[154:155], v23 offset:18432
  v_mfma_f32_16x16x32_bf16 v[52:55], v[148:151], v[104:107], v[52:55]
  ds_read_b64_tr_b16 v[156:157], v25 offset:16384
  v_mfma_f32_16x16x32_bf16 v[68:71], v[148:151], v[108:111], v[68:71]
  ds_read_b64_tr_b16 v[158:159], v25 offset:18432
  buffer_load_dwordx4 v17, s[20:23], s95 offen offset:1024 lds
  s_add_u32 s95, s95, 458752
  v_mfma_f32_16x16x32_bf16 v[64:67], v[144:147], v[108:111], v[64:67]
  ds_read_b64_tr_b16 v[160:161], v27 offset:16384
  v_mfma_f32_16x16x32_bf16 v[60:63], v[140:143], v[108:111], v[60:63]
  ds_read_b64_tr_b16 v[162:163], v27 offset:18432
  v_mfma_f32_16x16x32_bf16 v[56:59], v[136:139], v[108:111], v[56:59]
  ds_read_b64_tr_b16 v[164:165], v29 offset:16384
  v_mfma_f32_16x16x32_bf16 v[72:75], v[136:139], v[112:115], v[72:75]
  ds_read_b64_tr_b16 v[166:167], v29 offset:18432
  v_mfma_f32_16x16x32_bf16 v[76:79], v[140:143], v[112:115], v[76:79]
  ds_read_b128 v[124:127], v21 offset:34816
  v_mfma_f32_16x16x32_bf16 v[80:83], v[144:147], v[112:115], v[80:83]
  ds_read_b128 v[128:131], v21 offset:36864
  v_mfma_f32_16x16x32_bf16 v[84:87], v[148:151], v[112:115], v[84:87]
  ds_read_b128 v[132:135], v21 offset:38912
  v_mfma_f32_16x16x32_bf16 v[100:103], v[148:151], v[116:119], v[100:103]
  s_add_u32 m0, s36, 0
  s_nop 0
  buffer_load_dwordx4 v18, s[24:27], s37 offen lds
  s_add_u32 s37, s37, 393216
  v_mfma_f32_16x16x32_bf16 v[96:99], v[144:147], v[116:119], v[96:99]
  v_mfma_f32_16x16x32_bf16 v[92:95], v[140:143], v[116:119], v[92:95]
  v_mfma_f32_16x16x32_bf16 v[88:91], v[136:139], v[116:119], v[88:91]
  s_waitcnt vmcnt(6) lgkmcnt(0)
  s_barrier
  v_mfma_f32_16x16x32_bf16 v[40:43], v[152:155], v[120:123], v[40:43]
  ds_read_b128 v[104:107], v20 offset:0
  v_mfma_f32_16x16x32_bf16 v[44:47], v[156:159], v[120:123], v[44:47]
  ds_read_b64_tr_b16 v[136:137], v22 offset:0
  v_mfma_f32_16x16x32_bf16 v[48:51], v[160:163], v[120:123], v[48:51]
  ds_read_b64_tr_b16 v[138:139], v22 offset:2048
  v_mfma_f32_16x16x32_bf16 v[52:55], v[164:167], v[120:123], v[52:55]
  ds_read_b64_tr_b16 v[140:141], v24 offset:0
  v_mfma_f32_16x16x32_bf16 v[68:71], v[164:167], v[124:127], v[68:71]
  ds_read_b64_tr_b16 v[142:143], v24 offset:2048
  s_add_u32 m0, s32, 32768
  s_nop 0
  buffer_load_dwordx4 v14, s[12:15], s93 offen lds
  v_mfma_f32_16x16x32_bf16 v[64:67], v[160:163], v[124:127], v[64:67]
  ds_read_b64_tr_b16 v[144:145], v26 offset:0
  v_mfma_f32_16x16x32_bf16 v[60:63], v[156:159], v[124:127], v[60:63]
  ds_read_b64_tr_b16 v[146:147], v26 offset:2048
  v_mfma_f32_16x16x32_bf16 v[56:59], v[152:155], v[124:127], v[56:59]
  ds_read_b64_tr_b16 v[148:149], v28 offset:0
  v_mfma_f32_16x16x32_bf16 v[72:75], v[152:155], v[128:131], v[72:75]
  ds_read_b64_tr_b16 v[150:151], v28 offset:2048
  v_mfma_f32_16x16x32_bf16 v[76:79], v[156:159], v[128:131], v[76:79]
  ds_read_b128 v[108:111], v20 offset:2048
  v_mfma_f32_16x16x32_bf16 v[80:83], v[160:163], v[128:131], v[80:83]
  ds_read_b128 v[112:115], v20 offset:4096
  v_mfma_f32_16x16x32_bf16 v[84:87], v[164:167], v[128:131], v[84:87]
  ds_read_b128 v[116:119], v20 offset:6144
  v_mfma_f32_16x16x32_bf16 v[100:103], v[164:167], v[132:135], v[100:103]
  buffer_load_dwordx4 v15, s[12:15], s93 offen offset:1024 lds
  s_add_u32 s93, s93, 128
  v_mfma_f32_16x16x32_bf16 v[96:99], v[160:163], v[132:135], v[96:99]
  v_mfma_f32_16x16x32_bf16 v[92:95], v[156:159], v[132:135], v[92:95]
  v_mfma_f32_16x16x32_bf16 v[88:91], v[152:155], v[132:135], v[88:91]
  s_waitcnt lgkmcnt(0)
  v_mfma_f32_16x16x32_bf16 v[40:43], v[136:139], v[104:107], v[40:43]
  ds_read_b128 v[120:123], v21 offset:0
  s_mov_b32 s28, s70
  v_mfma_f32_16x16x32_bf16 v[44:47], v[140:143], v[104:107], v[44:47]
  ds_read_b64_tr_b16 v[152:153], v22 offset:16384
  v_mfma_f32_16x16x32_bf16 v[48:51], v[144:147], v[104:107], v[48:51]
  ds_read_b64_tr_b16 v[154:155], v22 offset:18432
  s_and_b32 s29, s71, 0xffff
  v_mfma_f32_16x16x32_bf16 v[52:55], v[148:151], v[104:107], v[52:55]
  ds_read_b64_tr_b16 v[156:157], v24 offset:16384
  v_mfma_f32_16x16x32_bf16 v[68:71], v[148:151], v[108:111], v[68:71]
  ds_read_b64_tr_b16 v[158:159], v24 offset:18432
  v_mfma_f32_16x16x32_bf16 v[64:67], v[144:147], v[108:111], v[64:67]
  ds_read_b64_tr_b16 v[160:161], v26 offset:16384
  s_mov_b32 s30, 256
  v_mfma_f32_16x16x32_bf16 v[60:63], v[140:143], v[108:111], v[60:63]
  ds_read_b64_tr_b16 v[162:163], v26 offset:18432
  v_mfma_f32_16x16x32_bf16 v[56:59], v[136:139], v[108:111], v[56:59]
  ds_read_b64_tr_b16 v[164:165], v28 offset:16384
  v_mfma_f32_16x16x32_bf16 v[72:75], v[136:139], v[112:115], v[72:75]
  ds_read_b64_tr_b16 v[166:167], v28 offset:18432
  s_add_u32 m0, s36, 8192
  s_nop 0
  buffer_load_dwordx4 v18, s[24:27], s37 offen lds
  s_add_u32 s37, s37, 393216
  s_mov_b32 s31, 0x20000
  v_mfma_f32_16x16x32_bf16 v[76:79], v[140:143], v[112:115], v[76:79]
  ds_read_b128 v[124:127], v21 offset:2048
  v_mfma_f32_16x16x32_bf16 v[80:83], v[144:147], v[112:115], v[80:83]
  ds_read_b128 v[128:131], v21 offset:4096
  s_mov_b32 s16, s60
  v_mfma_f32_16x16x32_bf16 v[84:87], v[148:151], v[112:115], v[84:87]
  ds_read_b128 v[132:135], v21 offset:6144
  v_mfma_f32_16x16x32_bf16 v[100:103], v[148:151], v[116:119], v[100:103]
  v_mfma_f32_16x16x32_bf16 v[96:99], v[144:147], v[116:119], v[96:99]
  s_and_b32 s17, s61, 0xffff
  v_mfma_f32_16x16x32_bf16 v[92:95], v[140:143], v[116:119], v[92:95]
  v_mfma_f32_16x16x32_bf16 v[88:91], v[136:139], v[116:119], v[88:91]
  s_waitcnt lgkmcnt(0)
  v_mfma_f32_16x16x32_bf16 v[40:43], v[152:155], v[120:123], v[40:43]
  s_cmp_lt_u32 s3, 4
  s_cselect_b32 s18, 8388608, 0
  v_mfma_f32_16x16x32_bf16 v[44:47], v[156:159], v[120:123], v[44:47]
  v_mfma_f32_16x16x32_bf16 v[48:51], v[160:163], v[120:123], v[48:51]
  s_mov_b32 s19, 0x20000
  v_mfma_f32_16x16x32_bf16 v[52:55], v[164:167], v[120:123], v[52:55]
  v_mfma_f32_16x16x32_bf16 v[68:71], v[164:167], v[124:127], v[68:71]
  v_mfma_f32_16x16x32_bf16 v[64:67], v[160:163], v[124:127], v[64:67]
  s_lshl_b32 s38, s2, 15
  v_mfma_f32_16x16x32_bf16 v[60:63], v[156:159], v[124:127], v[60:63]
  v_mfma_f32_16x16x32_bf16 v[56:59], v[152:155], v[124:127], v[56:59]
  v_mfma_f32_16x16x32_bf16 v[72:75], v[152:155], v[128:131], v[72:75]
  s_lshl_b32 s4, s3, 13
  v_mfma_f32_16x16x32_bf16 v[76:79], v[156:159], v[128:131], v[76:79]
  v_mfma_f32_16x16x32_bf16 v[80:83], v[160:163], v[128:131], v[80:83]
  s_add_u32 s38, s38, s4
  v_mfma_f32_16x16x32_bf16 v[84:87], v[164:167], v[128:131], v[84:87]
  v_mfma_f32_16x16x32_bf16 v[100:103], v[164:167], v[132:135], v[100:103]
  v_mfma_f32_16x16x32_bf16 v[96:99], v[160:163], v[132:135], v[96:99]
  v_lshlrev_b32 v11, 7, v1
  v_mfma_f32_16x16x32_bf16 v[92:95], v[156:159], v[132:135], v[92:95]
  v_mfma_f32_16x16x32_bf16 v[88:91], v[152:155], v[132:135], v[88:91]
L_t1done:
  s_barrier
L_t23pro:
  s_sub_u32 s75, s3, 0
  s_cmp_ge_u32 s75, 4
  s_cbranch_scc1 ow_1
  v_mov_b32 v9, 0
  buffer_load_dword v12, v9, s[28:31], 0 offen sc1
ow_1:
  buffer_load_dword v10, v11, s[16:19], s38 offen
  s_cmp_eq_u32 s74, 1
  s_cbranch_scc1 L_z2epi
  s_cmp_eq_u32 s74, 2
  s_cbranch_scc1 L_auxepi
  s_lshl_b32 s4, s45, 11
  s_add_u32 s4, s4, 147456
  v_lshrrev_b32 v2, 4, v1
  v_lshlrev_b32 v2, 2, v2
  v_bfe_u32 v3, v1, 2, 2
  v_add_u32 v2, v2, v3
  v_lshlrev_b32 v2, 6, v2
  v_and_b32 v3, 3, v1
  v_lshl_add_u32 v2, v3, 3, v2
  v_add_u32 v2, s4, v2
  ds_read_b64_tr_b16 v[168:169], v2 offset:0
  ds_read_b64_tr_b16 v[170:171], v2 offset:1024
  ds_read_b64_tr_b16 v[172:173], v2 offset:32
  ds_read_b64_tr_b16 v[174:175], v2 offset:1056
  v_and_b32 v2, 15, v1
  v_lshrrev_b32 v3, 4, v1
  v_lshlrev_b32 v3, 2, v3
  v_sub_u32 v2, v2, v3
  v_mov_b32 v4, 0x3f80
  v_mov_b32 v5, 0x3f800000
  v_mov_b32 v248, 0
  v_mov_b32 v249, 0
  v_mov_b32 v252, 0
  v_mov_b32 v253, 0
  v_cmp_eq_u32 vcc, 0, v2
  s_nop 1
  v_cndmask_b32 v250, 0, v4, vcc
  v_cmp_eq_u32 vcc, 1, v2
  s_nop 1
  v_cndmask_b32 v250, v250, v5, vcc
  v_cmp_eq_u32 vcc, 2, v2
  s_nop 1
  v_cndmask_b32 v251, 0, v4, vcc
  v_cmp_eq_u32 vcc, 3, v2
  s_nop 1
  v_cndmask_b32 v251, v251, v5, vcc
  v_mov_b32 v4, 0x3f803f80
  v_mov_b32 v5, 0x3f803f80
  v_mov_b32 v6, 0x3f803f80
  v_mov_b32 v7, 0x3f803f80
  s_waitcnt lgkmcnt(0)
  v_cvt_pk_bf16_f32 v104, v40, v41
  v_cvt_pk_bf16_f32 v136, v56, v57
  v_cvt_pk_bf16_f32 v105, v42, v43
  v_cvt_pk_bf16_f32 v137, v58, v59
  v_cvt_pk_bf16_f32 v106, v44, v45
  v_cvt_pk_bf16_f32 v138, v60, v61
  v_cvt_pk_bf16_f32 v107, v46, v47
  v_cvt_pk_bf16_f32 v139, v62, v63
  v_cvt_pk_bf16_f32 v208, v48, v49
  v_cvt_pk_bf16_f32 v210, v64, v65
  v_cvt_pk_bf16_f32 v209, v50, v51
  v_cvt_pk_bf16_f32 v211, v66, v67
  v_cvt_pk_bf16_f32 v212, v52, v53
  v_cvt_pk_bf16_f32 v214, v68, v69
  v_cvt_pk_bf16_f32 v213, v54, v55
  v_cvt_pk_bf16_f32 v215, v70, v71
  v_mfma_f32_16x16x32_bf16 v[108:111], v[168:171], v[104:107], 0
  v_mfma_f32_16x16x32_bf16 v[140:143], v[168:171], v[136:139], 0
  v_mfma_f32_16x16x32_bf16 v[112:115], v[172:175], v[104:107], 0
  v_mfma_f32_16x16x32_bf16 v[144:147], v[172:175], v[136:139], 0
  s_nop 4
  v_max3_f32 v132, v108, v109, v110
  v_max3_f32 v164, v140, v141, v142
  v_max3_f32 v134, -v108, -v109, -v110
  v_max3_f32 v166, -v140, -v141, -v142
  s_add_u32 m0, s94, 0
  s_nop 0
  buffer_load_dwordx4 v16, s[20:23], s95 offen lds
  v_max3_f32 v132, v132, v111, v112
  v_max3_f32 v164, v164, v143, v144
  v_max3_f32 v134, v134, -v111, -v112
  v_max3_f32 v166, v166, -v143, -v144
  v_max3_f32 v132, v132, v113, v114
  v_max3_f32 v164, v164, v145, v146
  v_max3_f32 v134, v134, -v113, -v114
  v_max3_f32 v166, v166, -v145, -v146
  v_max_f32 v132, v132, v115
  v_max_f32 v164, v164, v147
  v_max_f32 v134, v134, -v115
  v_max_f32 v166, v166, -v147
  s_nop 0
  v_permlane16_swap_b32 v132, v134
  v_permlane16_swap_b32 v164, v166
  v_max_f32 v132, v132, v134
  v_max_f32 v164, v164, v166
  v_mov_b32 v134, v132
  v_mov_b32 v166, v164
  s_nop 0
  v_permlane32_swap_b32 v132, v134
  v_permlane32_swap_b32 v164, v166
  v_max_f32 v132, v132, v134
  v_max_f32 v164, v164, v166
  v_mov_b32 v134, v132
  v_mov_b32 v166, v164
  s_nop 0
  v_permlane16_swap_b32 v132, v134
  v_permlane16_swap_b32 v164, v166
  v_mul_f32 v132, s46, v132
  v_mul_f32 v164, s46, v164
  v_mul_f32 v134, s46, v134
  v_mul_f32 v166, s46, v166
  v_pk_fma_f32 v[116:117], v[108:109], s[46:47], v[132:133] op_sel_hi:[1,0,0] neg_lo:[0,0,1] neg_hi:[0,0,1]
  v_pk_fma_f32 v[148:149], v[140:141], s[46:47], v[164:165] op_sel_hi:[1,0,0] neg_lo:[0,0,1] neg_hi:[0,0,1]
  v_pk_fma_f32 v[124:125], v[108:109], s[46:47], v[134:135] op_sel_hi:[1,0,0] neg_lo:[1,0,1] neg_hi:[1,0,1]
  v_pk_fma_f32 v[156:157], v[140:141], s[46:47], v[166:167] op_sel_hi:[1,0,0] neg_lo:[1,0,1] neg_hi:[1,0,1]
  v_pk_fma_f32 v[118:119], v[110:111], s[46:47], v[132:133] op_sel_hi:[1,0,0] neg_lo:[0,0,1] neg_hi:[0,0,1]
  v_pk_fma_f32 v[150:151], v[142:143], s[46:47], v[164:165] op_sel_hi:[1,0,0] neg_lo:[0,0,1] neg_hi:[0,0,1]
  v_pk_fma_f32 v[126:127], v[110:111], s[46:47], v[134:135] op_sel_hi:[1,0,0] neg_lo:[1,0,1] neg_hi:[1,0,1]
  v_pk_fma_f32 v[158:159], v[142:143], s[46:47], v[166:167] op_sel_hi:[1,0,0] neg_lo:[1,0,1] neg_hi:[1,0,1]
  v_pk_fma_f32 v[120:121], v[112:113], s[46:47], v[132:133] op_sel_hi:[1,0,0] neg_lo:[0,0,1] neg_hi:[0,0,1]
  v_pk_fma_f32 v[152:153], v[144:145], s[46:47], v[164:165] op_sel_hi:[1,0,0] neg_lo:[0,0,1] neg_hi:[0,0,1]
  v_pk_fma_f32 v[128:129], v[112:113], s[46:47], v[134:135] op_sel_hi:[1,0,0] neg_lo:[1,0,1] neg_hi:[1,0,1]
  v_pk_fma_f32 v[160:161], v[144:145], s[46:47], v[166:167] op_sel_hi:[1,0,0] neg_lo:[1,0,1] neg_hi:[1,0,1]
  v_pk_fma_f32 v[122:123], v[114:115], s[46:47], v[132:133] op_sel_hi:[1,0,0] neg_lo:[0,0,1] neg_hi:[0,0,1]
  v_pk_fma_f32 v[154:155], v[146:147], s[46:47], v[164:165] op_sel_hi:[1,0,0] neg_lo:[0,0,1] neg_hi:[0,0,1]
  v_pk_fma_f32 v[130:131], v[114:115], s[46:47], v[134:135] op_sel_hi:[1,0,0] neg_lo:[1,0,1] neg_hi:[1,0,1]
  v_pk_fma_f32 v[162:163], v[146:147], s[46:47], v[166:167] op_sel_hi:[1,0,0] neg_lo:[1,0,1] neg_hi:[1,0,1]
  v_exp_f32 v116, v116
  v_exp_f32 v148, v148
  buffer_load_dwordx4 v17, s[20:23], s95 offen offset:1024 lds
  s_add_u32 s95, s95, 458752
  v_exp_f32 v117, v117
  v_exp_f32 v149, v149
  v_exp_f32 v118, v118
  v_exp_f32 v150, v150
  v_exp_f32 v119, v119
  v_exp_f32 v151, v151
  v_exp_f32 v120, v120
  v_exp_f32 v152, v152
  v_exp_f32 v121, v121
  v_exp_f32 v153, v153
  v_exp_f32 v122, v122
  v_exp_f32 v154, v154
  v_exp_f32 v123, v123
  v_exp_f32 v155, v155
  v_exp_f32 v124, v124
  v_exp_f32 v156, v156
  v_exp_f32 v125, v125
  v_exp_f32 v157, v157
  v_exp_f32 v126, v126
  v_exp_f32 v158, v158
  v_exp_f32 v127, v127
  v_exp_f32 v159, v159
  v_exp_f32 v128, v128
  v_exp_f32 v160, v160
  v_exp_f32 v129, v129
  v_exp_f32 v161, v161
  v_exp_f32 v130, v130
  v_exp_f32 v162, v162
  v_exp_f32 v131, v131
  v_exp_f32 v163, v163
  v_pk_add_f32 v[108:109], v[116:117], v[118:119]
  v_pk_add_f32 v[140:141], v[148:149], v[150:151]
  v_pk_add_f32 v[110:111], v[124:125], v[126:127]
  v_pk_add_f32 v[142:143], v[156:157], v[158:159]
  v_pk_add_f32 v[112:113], v[120:121], v[122:123]
  v_pk_add_f32 v[144:145], v[152:153], v[154:155]
  v_pk_add_f32 v[114:115], v[128:129], v[130:131]
  v_pk_add_f32 v[146:147], v[160:161], v[162:163]
  v_pk_add_f32 v[108:109], v[108:109], v[112:113]
  v_pk_add_f32 v[140:141], v[140:141], v[144:145]
  v_pk_add_f32 v[110:111], v[110:111], v[114:115]
  v_pk_add_f32 v[142:143], v[142:143], v[146:147]
  v_add_f32 v132, v108, v109
  v_add_f32 v164, v140, v141
  v_add_f32 v134, v110, v111
  v_add_f32 v166, v142, v143
  s_nop 0
  v_permlane16_swap_b32 v132, v134
  v_permlane16_swap_b32 v164, v166
  s_add_u32 m0, s32, 0
  s_nop 0
  buffer_load_dwordx4 v14, s[12:15], s93 offen lds
  v_add_f32 v132, v132, v134
  v_add_f32 v164, v164, v166
  v_mov_b32 v134, v132
  v_mov_b32 v166, v164
  s_nop 0
  v_permlane32_swap_b32 v132, v134
  v_permlane32_swap_b32 v164, v166
  v_add_f32 v132, v132, v134
  v_add_f32 v164, v164, v166
  v_mov_b32 v134, v132
  v_mov_b32 v166, v164
  s_nop 0
  v_permlane16_swap_b32 v132, v134
  v_permlane16_swap_b32 v164, v166
  v_rcp_f32 v132, v132
  v_rcp_f32 v164, v164
  v_rcp_f32 v134, v134
  v_rcp_f32 v166, v166
  v_pk_mul_f32 v[116:117], v[116:117], v[132:133] op_sel_hi:[1,0]
  v_pk_mul_f32 v[148:149], v[148:149], v[164:165] op_sel_hi:[1,0]
  v_pk_mul_f32 v[124:125], v[124:125], v[134:135] op_sel_hi:[1,0]
  v_pk_mul_f32 v[156:157], v[156:157], v[166:167] op_sel_hi:[1,0]
  v_pk_mul_f32 v[118:119], v[118:119], v[132:133] op_sel_hi:[1,0]
  v_pk_mul_f32 v[150:151], v[150:151], v[164:165] op_sel_hi:[1,0]
  v_pk_mul_f32 v[126:127], v[126:127], v[134:135] op_sel_hi:[1,0]
  v_pk_mul_f32 v[158:159], v[158:159], v[166:167] op_sel_hi:[1,0]
  v_pk_mul_f32 v[120:121], v[120:121], v[132:133] op_sel_hi:[1,0]
  v_pk_mul_f32 v[152:153], v[152:153], v[164:165] op_sel_hi:[1,0]
  v_pk_mul_f32 v[128:129], v[128:129], v[134:135] op_sel_hi:[1,0]
  v_pk_mul_f32 v[160:161], v[160:161], v[166:167] op_sel_hi:[1,0]
  v_pk_mul_f32 v[122:123], v[122:123], v[132:133] op_sel_hi:[1,0]
  v_pk_mul_f32 v[154:155], v[154:155], v[164:165] op_sel_hi:[1,0]
  v_pk_mul_f32 v[130:131], v[130:131], v[134:135] op_sel_hi:[1,0]
  v_pk_mul_f32 v[162:163], v[162:163], v[166:167] op_sel_hi:[1,0]
  v_cvt_pk_bf16_f32 v108, v116, v117
  v_cvt_pk_bf16_f32 v140, v148, v149
  v_cvt_pk_bf16_f32 v112, v124, v125
  v_cvt_pk_bf16_f32 v144, v156, v157
  v_cvt_pk_bf16_f32 v109, v118, v119
  v_cvt_pk_bf16_f32 v141, v150, v151
  v_cvt_pk_bf16_f32 v113, v126, v127
  v_cvt_pk_bf16_f32 v145, v158, v159
  v_cvt_pk_bf16_f32 v110, v120, v121
  v_cvt_pk_bf16_f32 v142, v152, v153
  v_cvt_pk_bf16_f32 v114, v128, v129
  v_cvt_pk_bf16_f32 v146, v160, v161
  v_cvt_pk_bf16_f32 v111, v122, v123
  v_cvt_pk_bf16_f32 v143, v154, v155
  v_cvt_pk_bf16_f32 v115, v130, v131
  v_cvt_pk_bf16_f32 v147, v162, v163
  buffer_load_dwordx4 v15, s[12:15], s93 offen offset:1024 lds
  s_add_u32 s93, s93, 128
  v_mfma_f32_16x16x32_bf16 v[116:119], v[108:111], v[250:253], 0
  v_mfma_f32_16x16x32_bf16 v[148:151], v[140:143], v[250:253], 0
  v_mfma_f32_16x16x32_bf16 v[120:123], v[108:111], v[248:251], 0
  v_mfma_f32_16x16x32_bf16 v[152:155], v[140:143], v[248:251], 0
  v_mfma_f32_16x16x32_bf16 v[124:127], v[112:115], v[250:253], 0
  v_mfma_f32_16x16x32_bf16 v[156:159], v[144:147], v[250:253], 0
  v_mfma_f32_16x16x32_bf16 v[128:131], v[112:115], v[248:251], 0
  v_mfma_f32_16x16x32_bf16 v[160:163], v[144:147], v[248:251], 0
  s_nop 0
  v_cvt_pk_bf16_f32 v192, v116, v117
  v_cvt_pk_bf16_f32 v194, v148, v149
  v_cvt_pk_bf16_f32 v193, v118, v119
  v_cvt_pk_bf16_f32 v195, v150, v151
  v_cvt_pk_bf16_f32 v196, v120, v121
  v_cvt_pk_bf16_f32 v198, v152, v153
  v_cvt_pk_bf16_f32 v197, v122, v123
  v_cvt_pk_bf16_f32 v199, v154, v155
  v_cvt_pk_bf16_f32 v200, v124, v125
  v_cvt_pk_bf16_f32 v202, v156, v157
  v_cvt_pk_bf16_f32 v201, v126, v127
  v_cvt_pk_bf16_f32 v203, v158, v159
  v_cvt_pk_bf16_f32 v204, v128, v129
  v_cvt_pk_bf16_f32 v206, v160, v161
  v_cvt_pk_bf16_f32 v205, v130, v131
  v_cvt_pk_bf16_f32 v207, v162, v163
  v_mfma_f32_16x16x32_bf16 v[216:219], v[192:195], v[208:211], 0
  v_mfma_f32_16x16x32_bf16 v[220:223], v[192:195], v[212:215], 0
  v_mfma_f32_16x16x32_bf16 v[176:179], v[192:195], v[4:7], 0
  v_mfma_f32_16x16x32_bf16 v[224:227], v[196:199], v[208:211], 0
  v_mfma_f32_16x16x32_bf16 v[228:231], v[196:199], v[212:215], 0
  v_mfma_f32_16x16x32_bf16 v[180:183], v[196:199], v[4:7], 0
  v_mfma_f32_16x16x32_bf16 v[232:235], v[200:203], v[208:211], 0
  v_mfma_f32_16x16x32_bf16 v[236:239], v[200:203], v[212:215], 0
  v_mfma_f32_16x16x32_bf16 v[184:187], v[200:203], v[4:7], 0
  v_mfma_f32_16x16x32_bf16 v[240:243], v[204:207], v[208:211], 0
  v_mfma_f32_16x16x32_bf16 v[244:247], v[204:207], v[212:215], 0
  v_mfma_f32_16x16x32_bf16 v[188:191], v[204:207], v[4:7], 0
  v_cvt_pk_bf16_f32 v104, v72, v73
  v_cvt_pk_bf16_f32 v136, v88, v89
  v_cvt_pk_bf16_f32 v105, v74, v75
  v_cvt_pk_bf16_f32 v137, v90, v91
  v_cvt_pk_bf16_f32 v106, v76, v77
  v_cvt_pk_bf16_f32 v138, v92, v93
  v_cvt_pk_bf16_f32 v107, v78, v79
  v_cvt_pk_bf16_f32 v139, v94, v95
  v_cvt_pk_bf16_f32 v208, v80, v81
  v_cvt_pk_bf16_f32 v210, v96, v97
  v_cvt_pk_bf16_f32 v209, v82, v83
  v_cvt_pk_bf16_f32 v211, v98, v99
  v_cvt_pk_bf16_f32 v212, v84, v85
  v_cvt_pk_bf16_f32 v214, v100, v101
  v_cvt_pk_bf16_f32 v213, v86, v87
  v_cvt_pk_bf16_f32 v215, v102, v103
  v_mfma_f32_16x16x32_bf16 v[108:111], v[168:171], v[104:107], 0
  v_mfma_f32_16x16x32_bf16 v[140:143], v[168:171], v[136:139], 0
  v_mfma_f32_16x16x32_bf16 v[112:115], v[172:175], v[104:107], 0
  v_mfma_f32_16x16x32_bf16 v[144:147], v[172:175], v[136:139], 0
  s_nop 4
  v_max3_f32 v132, v108, v109, v110
  v_max3_f32 v164, v140, v141, v142
  v_max3_f32 v134, -v108, -v109, -v110
  v_max3_f32 v166, -v140, -v141, -v142
  v_max3_f32 v132, v132, v111, v112
  v_max3_f32 v164, v164, v143, v144
  v_max3_f32 v134, v134, -v111, -v112
  v_max3_f32 v166, v166, -v143, -v144
  v_max3_f32 v132, v132, v113, v114
  v_max3_f32 v164, v164, v145, v146
  v_max3_f32 v134, v134, -v113, -v114
  v_max3_f32 v166, v166, -v145, -v146
  s_add_u32 m0, s94, 16384
  s_nop 0
  buffer_load_dwordx4 v16, s[20:23], s95 offen lds
  v_max_f32 v132, v132, v115
  v_max_f32 v164, v164, v147
  v_max_f32 v134, v134, -v115
  v_max_f32 v166, v166, -v147
  s_nop 0
  v_permlane16_swap_b32 v132, v134
  v_permlane16_swap_b32 v164, v166
  v_max_f32 v132, v132, v134
  v_max_f32 v164, v164, v166
  v_mov_b32 v134, v132
  v_mov_b32 v166, v164
  s_nop 0
  v_permlane32_swap_b32 v132, v134
  v_permlane32_swap_b32 v164, v166
  v_max_f32 v132, v132, v134
  v_max_f32 v164, v164, v166
  v_mov_b32 v134, v132
  v_mov_b32 v166, v164
  s_nop 0
  v_permlane16_swap_b32 v132, v134
  v_permlane16_swap_b32 v164, v166
  v_mul_f32 v132, s46, v132
  v_mul_f32 v164, s46, v164
  v_mul_f32 v134, s46, v134
  v_mul_f32 v166, s46, v166
  v_pk_fma_f32 v[116:117], v[108:109], s[46:47], v[132:133] op_sel_hi:[1,0,0] neg_lo:[0,0,1] neg_hi:[0,0,1]
  v_pk_fma_f32 v[148:149], v[140:141], s[46:47], v[164:165] op_sel_hi:[1,0,0] neg_lo:[0,0,1] neg_hi:[0,0,1]
  v_pk_fma_f32 v[124:125], v[108:109], s[46:47], v[134:135] op_sel_hi:[1,0,0] neg_lo:[1,0,1] neg_hi:[1,0,1]
  v_pk_fma_f32 v[156:157], v[140:141], s[46:47], v[166:167] op_sel_hi:[1,0,0] neg_lo:[1,0,1] neg_hi:[1,0,1]
  v_pk_fma_f32 v[118:119], v[110:111], s[46:47], v[132:133] op_sel_hi:[1,0,0] neg_lo:[0,0,1] neg_hi:[0,0,1]
  v_pk_fma_f32 v[150:151], v[142:143], s[46:47], v[164:165] op_sel_hi:[1,0,0] neg_lo:[0,0,1] neg_hi:[0,0,1]
  v_pk_fma_f32 v[126:127], v[110:111], s[46:47], v[134:135] op_sel_hi:[1,0,0] neg_lo:[1,0,1] neg_hi:[1,0,1]
  v_pk_fma_f32 v[158:159], v[142:143], s[46:47], v[166:167] op_sel_hi:[1,0,0] neg_lo:[1,0,1] neg_hi:[1,0,1]
  v_pk_fma_f32 v[120:121], v[112:113], s[46:47], v[132:133] op_sel_hi:[1,0,0] neg_lo:[0,0,1] neg_hi:[0,0,1]
  v_pk_fma_f32 v[152:153], v[144:145], s[46:47], v[164:165] op_sel_hi:[1,0,0] neg_lo:[0,0,1] neg_hi:[0,0,1]
  v_pk_fma_f32 v[128:129], v[112:113], s[46:47], v[134:135] op_sel_hi:[1,0,0] neg_lo:[1,0,1] neg_hi:[1,0,1]
  v_pk_fma_f32 v[160:161], v[144:145], s[46:47], v[166:167] op_sel_hi:[1,0,0] neg_lo:[1,0,1] neg_hi:[1,0,1]
  v_pk_fma_f32 v[122:123], v[114:115], s[46:47], v[132:133] op_sel_hi:[1,0,0] neg_lo:[0,0,1] neg_hi:[0,0,1]
  v_pk_fma_f32 v[154:155], v[146:147], s[46:47], v[164:165] op_sel_hi:[1,0,0] neg_lo:[0,0,1] neg_hi:[0,0,1]
  v_pk_fma_f32 v[130:131], v[114:115], s[46:47], v[134:135] op_sel_hi:[1,0,0] neg_lo:[1,0,1] neg_hi:[1,0,1]
  v_pk_fma_f32 v[162:163], v[146:147], s[46:47], v[166:167] op_sel_hi:[1,0,0] neg_lo:[1,0,1] neg_hi:[1,0,1]
  v_exp_f32 v116, v116
  v_exp_f32 v148, v148
  v_exp_f32 v117, v117
  v_exp_f32 v149, v149
  v_exp_f32 v118, v118
  v_exp_f32 v150, v150
  v_exp_f32 v119, v119
  v_exp_f32 v151, v151
  v_exp_f32 v120, v120
  v_exp_f32 v152, v152
  v_exp_f32 v121, v121
  v_exp_f32 v153, v153
  v_exp_f32 v122, v122
  v_exp_f32 v154, v154
  v_exp_f32 v123, v123
  v_exp_f32 v155, v155
  v_exp_f32 v124, v124
  v_exp_f32 v156, v156
  v_exp_f32 v125, v125
  v_exp_f32 v157, v157
  v_exp_f32 v126, v126
  v_exp_f32 v158, v158
  v_exp_f32 v127, v127
  v_exp_f32 v159, v159
  v_exp_f32 v128, v128
  v_exp_f32 v160, v160
  buffer_load_dwordx4 v17, s[20:23], s95 offen offset:1024 lds
  s_add_u32 s95, s95, 458752
  v_exp_f32 v129, v129
  v_exp_f32 v161, v161
  v_exp_f32 v130, v130
  v_exp_f32 v162, v162
  v_exp_f32 v131, v131
  v_exp_f32 v163, v163
  v_pk_add_f32 v[108:109], v[116:117], v[118:119]
  v_pk_add_f32 v[140:141], v[148:149], v[150:151]
  v_pk_add_f32 v[110:111], v[124:125], v[126:127]
  v_pk_add_f32 v[142:143], v[156:157], v[158:159]
  v_pk_add_f32 v[112:113], v[120:121], v[122:123]
  v_pk_add_f32 v[144:145], v[152:153], v[154:155]
  v_pk_add_f32 v[114:115], v[128:129], v[130:131]
  v_pk_add_f32 v[146:147], v[160:161], v[162:163]
  v_pk_add_f32 v[108:109], v[108:109], v[112:113]
  v_pk_add_f32 v[140:141], v[140:141], v[144:145]
  v_pk_add_f32 v[110:111], v[110:111], v[114:115]
  v_pk_add_f32 v[142:143], v[142:143], v[146:147]
  v_add_f32 v132, v108, v109
  v_add_f32 v164, v140, v141
  v_add_f32 v134, v110, v111
  v_add_f32 v166, v142, v143
  s_nop 0
  v_permlane16_swap_b32 v132, v134
  v_permlane16_swap_b32 v164, v166
  v_add_f32 v132, v132, v134
  v_add_f32 v164, v164, v166
  v_mov_b32 v134, v132
  v_mov_b32 v166, v164
  s_nop 0
  v_permlane32_swap_b32 v132, v134
  v_permlane32_swap_b32 v164, v166
  v_add_f32 v132, v132, v134
  v_add_f32 v164, v164, v166
  v_mov_b32 v134, v132
  v_mov_b32 v166, v164
  s_nop 0
  v_permlane16_swap_b32 v132, v134
  v_permlane16_swap_b32 v164, v166
  v_rcp_f32 v132, v132
  v_rcp_f32 v164, v164
  v_rcp_f32 v134, v134
  v_rcp_f32 v166, v166
  v_pk_mul_f32 v[116:117], v[116:117], v[132:133] op_sel_hi:[1,0]
  v_pk_mul_f32 v[148:149], v[148:149], v[164:165] op_sel_hi:[1,0]
  v_pk_mul_f32 v[124:125], v[124:125], v[134:135] op_sel_hi:[1,0]
  v_pk_mul_f32 v[156:157], v[156:157], v[166:167] op_sel_hi:[1,0]
  v_pk_mul_f32 v[118:119], v[118:119], v[132:133] op_sel_hi:[1,0]
  v_pk_mul_f32 v[150:151], v[150:151], v[164:165] op_sel_hi:[1,0]
  v_pk_mul_f32 v[126:127], v[126:127], v[134:135] op_sel_hi:[1,0]
  v_pk_mul_f32 v[158:159], v[158:159], v[166:167] op_sel_hi:[1,0]
  v_pk_mul_f32 v[120:121], v[120:121], v[132:133] op_sel_hi:[1,0]
  v_pk_mul_f32 v[152:153], v[152:153], v[164:165] op_sel_hi:[1,0]
  v_pk_mul_f32 v[128:129], v[128:129], v[134:135] op_sel_hi:[1,0]
  v_pk_mul_f32 v[160:161], v[160:161], v[166:167] op_sel_hi:[1,0]
  v_pk_mul_f32 v[122:123], v[122:123], v[132:133] op_sel_hi:[1,0]
  v_pk_mul_f32 v[154:155], v[154:155], v[164:165] op_sel_hi:[1,0]
  v_pk_mul_f32 v[130:131], v[130:131], v[134:135] op_sel_hi:[1,0]
  v_pk_mul_f32 v[162:163], v[162:163], v[166:167] op_sel_hi:[1,0]
  v_cvt_pk_bf16_f32 v108, v116, v117
  v_cvt_pk_bf16_f32 v140, v148, v149
  v_cvt_pk_bf16_f32 v112, v124, v125
  v_cvt_pk_bf16_f32 v144, v156, v157
  v_cvt_pk_bf16_f32 v109, v118, v119
  v_cvt_pk_bf16_f32 v141, v150, v151
  v_cvt_pk_bf16_f32 v113, v126, v127
  v_cvt_pk_bf16_f32 v145, v158, v159
  s_add_u32 m0, s36, 16384
  s_nop 0
  buffer_load_dwordx4 v18, s[24:27], s37 offen lds
  s_add_u32 s37, s37, 393216
  v_cvt_pk_bf16_f32 v110, v120, v121
  v_cvt_pk_bf16_f32 v142, v152, v153
  v_cvt_pk_bf16_f32 v114, v128, v129
  v_cvt_pk_bf16_f32 v146, v160, v161
  v_cvt_pk_bf16_f32 v111, v122, v123
  v_cvt_pk_bf16_f32 v143, v154, v155
  v_cvt_pk_bf16_f32 v115, v130, v131
  v_cvt_pk_bf16_f32 v147, v162, v163
  v_mfma_f32_16x16x32_bf16 v[116:119], v[108:111], v[250:253], 0
  v_mfma_f32_16x16x32_bf16 v[148:151], v[140:143], v[250:253], 0
  v_mfma_f32_16x16x32_bf16 v[120:123], v[108:111], v[248:251], 0
  v_mfma_f32_16x16x32_bf16 v[152:155], v[140:143], v[248:251], 0
  v_mfma_f32_16x16x32_bf16 v[124:127], v[112:115], v[250:253], 0
  v_mfma_f32_16x16x32_bf16 v[156:159], v[144:147], v[250:253], 0
  v_mfma_f32_16x16x32_bf16 v[128:131], v[112:115], v[248:251], 0
  v_mfma_f32_16x16x32_bf16 v[160:163], v[144:147], v[248:251], 0
  s_nop 0
  v_cvt_pk_bf16_f32 v192, v116, v117
  v_cvt_pk_bf16_f32 v194, v148, v149
  v_cvt_pk_bf16_f32 v193, v118, v119
  v_cvt_pk_bf16_f32 v195, v150, v151
  v_cvt_pk_bf16_f32 v196, v120, v121
  v_cvt_pk_bf16_f32 v198, v152, v153
  v_cvt_pk_bf16_f32 v197, v122, v123
  v_cvt_pk_bf16_f32 v199, v154, v155
  v_cvt_pk_bf16_f32 v200, v124, v125
  v_cvt_pk_bf16_f32 v202, v156, v157
  v_cvt_pk_bf16_f32 v201, v126, v127
  v_cvt_pk_bf16_f32 v203, v158, v159
  v_cvt_pk_bf16_f32 v204, v128, v129
  v_cvt_pk_bf16_f32 v206, v160, v161
  v_cvt_pk_bf16_f32 v205, v130, v131
  v_cvt_pk_bf16_f32 v207, v162, v163
  v_mfma_f32_16x16x32_bf16 v[216:219], v[192:195], v[208:211], v[216:219]
  v_mfma_f32_16x16x32_bf16 v[220:223], v[192:195], v[212:215], v[220:223]
  v_mfma_f32_16x16x32_bf16 v[176:179], v[192:195], v[4:7], v[176:179]
  v_mfma_f32_16x16x32_bf16 v[224:227], v[196:199], v[208:211], v[224:227]
  v_mfma_f32_16x16x32_bf16 v[228:231], v[196:199], v[212:215], v[228:231]
  v_mfma_f32_16x16x32_bf16 v[180:183], v[196:199], v[4:7], v[180:183]
  v_mfma_f32_16x16x32_bf16 v[232:235], v[200:203], v[208:211], v[232:235]
  v_mfma_f32_16x16x32_bf16 v[236:239], v[200:203], v[212:215], v[236:239]
  v_mfma_f32_16x16x32_bf16 v[184:187], v[200:203], v[4:7], v[184:187]
  v_mfma_f32_16x16x32_bf16 v[240:243], v[204:207], v[208:211], v[240:243]
  v_mfma_f32_16x16x32_bf16 v[244:247], v[204:207], v[212:215], v[244:247]
  v_mfma_f32_16x16x32_bf16 v[188:191], v[204:207], v[4:7], v[188:191]
  s_lshl_b32 s6, s41, 2
  s_add_u32 s6, s6, s45
  s_lshl_b32 s6, s6, 4
  s_add_u32 s6, s6, s40
  s_lshl_b32 s6, s6, 1
  s_add_u32 s6, s6, s44
  s_lshl_b32 s4, s6, 12
  s_add_u32 s4, s4, 33554432
  v_lshlrev_b32 v2, 4, v1
  v_and_b32 v3, 15, v1
  v_cmp_eq_u32 vcc, 1, v3
  s_nop 1
  v_cndmask_b32 v176, v176, v180, vcc
  v_cndmask_b32 v177, v177, v181, vcc
  v_cndmask_b32 v178, v178, v182, vcc
  v_cndmask_b32 v179, v179, v183, vcc
  v_cmp_eq_u32 vcc, 2, v3
  s_nop 1
  v_cndmask_b32 v176, v176, v184, vcc
  v_cndmask_b32 v177, v177, v185, vcc
  v_cndmask_b32 v178, v178, v186, vcc
  v_cndmask_b32 v179, v179, v187, vcc
  v_cmp_eq_u32 vcc, 3, v3
  s_nop 1
  v_cndmask_b32 v176, v176, v188, vcc
  v_cndmask_b32 v177, v177, v189, vcc
  v_cndmask_b32 v178, v178, v190, vcc
  v_cndmask_b32 v179, v179, v191, vcc
  v_cvt_pk_bf16_f32 v192, v216, v217
  v_cvt_pk_bf16_f32 v193, v218, v219
  v_cvt_pk_bf16_f32 v194, v220, v221
  v_cvt_pk_bf16_f32 v195, v222, v223
  v_cvt_pk_bf16_f32 v196, v224, v225
  v_cvt_pk_bf16_f32 v197, v226, v227
  v_cvt_pk_bf16_f32 v198, v228, v229
  v_cvt_pk_bf16_f32 v199, v230, v231
  v_cvt_pk_bf16_f32 v200, v232, v233
  v_cvt_pk_bf16_f32 v201, v234, v235
  v_cvt_pk_bf16_f32 v202, v236, v237
  v_cvt_pk_bf16_f32 v203, v238, v239
  v_cvt_pk_bf16_f32 v204, v240, v241
  v_cvt_pk_bf16_f32 v205, v242, v243
  v_cvt_pk_bf16_f32 v206, v244, v245
  v_cvt_pk_bf16_f32 v207, v246, v247
  buffer_store_dwordx4 v[192:195], v2, s[8:11], s4 offen offset:0 sc1
  buffer_store_dwordx4 v[196:199], v2, s[8:11], s4 offen offset:1024 sc1
  buffer_store_dwordx4 v[200:203], v2, s[8:11], s4 offen offset:2048 sc1
  buffer_store_dwordx4 v[204:207], v2, s[8:11], s4 offen offset:3072 sc1
  v_lshrrev_b32 v4, 4, v1
  v_lshl_add_u32 v4, v3, 2, v4
  v_lshlrev_b32 v4, 4, v4
  v_cmp_gt_u32 vcc, 4, v3
  v_mov_b32 v5, 2146435072
  s_nop 0
  v_cndmask_b32 v4, v5, v4, vcc
  s_lshl_b32 s4, s6, 8
  s_add_u32 s4, s4, 13631488
  buffer_store_dwordx4 v[176:179], v4, s[8:11], s4 offen sc1
  v_mov_b32 v248, 2146435072
  v_mov_b32 v249, 2146435072
  v_mov_b32 v250, 2146435072
  v_mov_b32 v251, 2146435072
  v_mov_b32 v252, 2146435072
  v_mov_b32 v253, 2146435072
  v_mov_b32 v254, 2146435072
  v_mov_b32 v255, 2146435072
  s_lshl_b32 s76, s41, 4
  s_add_u32 s76, s76, s40
  s_lshl_b32 s76, s76, 2
  s_add_u32 s76, s76, 15729152
  s_branch L_t23
L_z2epi:
  s_sub_u32 s79, s41, 8
  v_mov_b32 v26, 0xbdd2d3e8
  v_mov_b32 v27, 1.0
  s_lshl_b32 s4, s45, 7
  s_lshl_b32 s5, s44, 6
  s_add_u32 s4, s4, s5
  v_and_b32 v2, 15, v1
  v_add_u32 v2, s4, v2
  v_lshlrev_b32 v2, 1, v2
  v_bfe_u32 v3, v1, 4, 1
  v_add_u32 v2, v2, v3
  v_lshlrev_b32 v2, 2, v2
  v_add_u32 v172, 147456, v2
  v_pk_mul_f32 v[104:105], v[40:41], v[40:41]
  v_pk_mul_f32 v[120:121], v[56:57], v[56:57]
  v_pk_mul_f32 v[106:107], v[42:43], v[42:43]
  v_pk_mul_f32 v[122:123], v[58:59], v[58:59]
  v_pk_mul_f32 v[108:109], v[44:45], v[44:45]
  v_pk_mul_f32 v[124:125], v[60:61], v[60:61]
  v_pk_mul_f32 v[110:111], v[46:47], v[46:47]
  v_pk_mul_f32 v[126:127], v[62:63], v[62:63]
  v_pk_mul_f32 v[112:113], v[48:49], v[48:49]
  v_pk_mul_f32 v[128:129], v[64:65], v[64:65]
  v_pk_mul_f32 v[114:115], v[50:51], v[50:51]
  v_pk_mul_f32 v[130:131], v[66:67], v[66:67]
  v_pk_mul_f32 v[116:117], v[52:53], v[52:53]
  v_pk_mul_f32 v[132:133], v[68:69], v[68:69]
  v_pk_mul_f32 v[118:119], v[54:55], v[54:55]
  v_pk_mul_f32 v[134:135], v[70:71], v[70:71]
  v_pk_fma_f32 v[104:105], v[104:105], v[26:27], s[80:81] op_sel_hi:[1,0,0]
  v_pk_fma_f32 v[120:121], v[120:121], v[26:27], s[80:81] op_sel_hi:[1,0,0]
  v_pk_fma_f32 v[106:107], v[106:107], v[26:27], s[80:81] op_sel_hi:[1,0,0]
  v_pk_fma_f32 v[122:123], v[122:123], v[26:27], s[80:81] op_sel_hi:[1,0,0]
  v_pk_fma_f32 v[108:109], v[108:109], v[26:27], s[80:81] op_sel_hi:[1,0,0]
  v_pk_fma_f32 v[124:125], v[124:125], v[26:27], s[80:81] op_sel_hi:[1,0,0]
  v_pk_fma_f32 v[110:111], v[110:111], v[26:27], s[80:81] op_sel_hi:[1,0,0]
  s_add_u32 m0, s94, 0
  s_nop 0
  buffer_load_dwordx4 v16, s[20:23], s95 offen lds
  v_pk_fma_f32 v[126:127], v[126:127], v[26:27], s[80:81] op_sel_hi:[1,0,0]
  v_pk_fma_f32 v[112:113], v[112:113], v[26:27], s[80:81] op_sel_hi:[1,0,0]
  v_pk_fma_f32 v[128:129], v[128:129], v[26:27], s[80:81] op_sel_hi:[1,0,0]
  v_pk_fma_f32 v[114:115], v[114:115], v[26:27], s[80:81] op_sel_hi:[1,0,0]
  v_pk_fma_f32 v[130:131], v[130:131], v[26:27], s[80:81] op_sel_hi:[1,0,0]
  v_pk_fma_f32 v[116:117], v[116:117], v[26:27], s[80:81] op_sel_hi:[1,0,0]
  v_pk_fma_f32 v[132:133], v[132:133], v[26:27], s[80:81] op_sel_hi:[1,0,0]
  v_pk_fma_f32 v[118:119], v[118:119], v[26:27], s[80:81] op_sel_hi:[1,0,0]
  v_pk_fma_f32 v[134:135], v[134:135], v[26:27], s[80:81] op_sel_hi:[1,0,0]
  v_pk_mul_f32 v[104:105], v[40:41], v[104:105]
  v_pk_mul_f32 v[120:121], v[56:57], v[120:121]
  v_pk_mul_f32 v[106:107], v[42:43], v[106:107]
  v_pk_mul_f32 v[122:123], v[58:59], v[122:123]
  v_pk_mul_f32 v[108:109], v[44:45], v[108:109]
  v_pk_mul_f32 v[124:125], v[60:61], v[124:125]
  v_pk_mul_f32 v[110:111], v[46:47], v[110:111]
  v_pk_mul_f32 v[126:127], v[62:63], v[126:127]
  v_pk_mul_f32 v[112:113], v[48:49], v[112:113]
  v_pk_mul_f32 v[128:129], v[64:65], v[128:129]
  v_pk_mul_f32 v[114:115], v[50:51], v[114:115]
  v_pk_mul_f32 v[130:131], v[66:67], v[130:131]
  v_pk_mul_f32 v[116:117], v[52:53], v[116:117]
  v_pk_mul_f32 v[132:133], v[68:69], v[132:133]
  v_pk_mul_f32 v[118:119], v[54:55], v[118:119]
  v_pk_mul_f32 v[134:135], v[70:71], v[134:135]
  v_exp_f32 v104, v104
  v_exp_f32 v120, v120
  v_exp_f32 v105, v105
  v_exp_f32 v121, v121
  v_exp_f32 v106, v106
  v_exp_f32 v122, v122
  v_exp_f32 v107, v107
  v_exp_f32 v123, v123
  v_exp_f32 v108, v108
  v_exp_f32 v124, v124
  v_exp_f32 v109, v109
  v_exp_f32 v125, v125
  v_exp_f32 v110, v110
  v_exp_f32 v126, v126
  v_exp_f32 v111, v111
  v_exp_f32 v127, v127
  v_exp_f32 v112, v112
  v_exp_f32 v128, v128
  v_exp_f32 v113, v113
  v_exp_f32 v129, v129
  v_exp_f32 v114, v114
  v_exp_f32 v130, v130
  v_exp_f32 v115, v115
  buffer_load_dwordx4 v17, s[20:23], s95 offen offset:1024 lds
  s_add_u32 s95, s95, 458752
  v_exp_f32 v131, v131
  v_exp_f32 v116, v116
  v_exp_f32 v132, v132
  v_exp_f32 v117, v117
  v_exp_f32 v133, v133
  v_exp_f32 v118, v118
  v_exp_f32 v134, v134
  v_exp_f32 v119, v119
  v_exp_f32 v135, v135
  v_pk_add_f32 v[104:105], v[104:105], v[26:27] op_sel:[0,1] op_sel_hi:[1,1]
  v_pk_add_f32 v[120:121], v[120:121], v[26:27] op_sel:[0,1] op_sel_hi:[1,1]
  v_pk_add_f32 v[106:107], v[106:107], v[26:27] op_sel:[0,1] op_sel_hi:[1,1]
  v_pk_add_f32 v[122:123], v[122:123], v[26:27] op_sel:[0,1] op_sel_hi:[1,1]
  v_pk_add_f32 v[108:109], v[108:109], v[26:27] op_sel:[0,1] op_sel_hi:[1,1]
  v_pk_add_f32 v[124:125], v[124:125], v[26:27] op_sel:[0,1] op_sel_hi:[1,1]
  v_pk_add_f32 v[110:111], v[110:111], v[26:27] op_sel:[0,1] op_sel_hi:[1,1]
  v_pk_add_f32 v[126:127], v[126:127], v[26:27] op_sel:[0,1] op_sel_hi:[1,1]
  v_pk_add_f32 v[112:113], v[112:113], v[26:27] op_sel:[0,1] op_sel_hi:[1,1]
  v_pk_add_f32 v[128:129], v[128:129], v[26:27] op_sel:[0,1] op_sel_hi:[1,1]
  v_pk_add_f32 v[114:115], v[114:115], v[26:27] op_sel:[0,1] op_sel_hi:[1,1]
  v_pk_add_f32 v[130:131], v[130:131], v[26:27] op_sel:[0,1] op_sel_hi:[1,1]
  v_pk_add_f32 v[116:117], v[116:117], v[26:27] op_sel:[0,1] op_sel_hi:[1,1]
  v_pk_add_f32 v[132:133], v[132:133], v[26:27] op_sel:[0,1] op_sel_hi:[1,1]
  v_pk_add_f32 v[118:119], v[118:119], v[26:27] op_sel:[0,1] op_sel_hi:[1,1]
  v_pk_add_f32 v[134:135], v[134:135], v[26:27] op_sel:[0,1] op_sel_hi:[1,1]
  v_rcp_f32 v104, v104
  v_rcp_f32 v120, v120
  v_rcp_f32 v105, v105
  v_rcp_f32 v121, v121
  v_rcp_f32 v106, v106
  v_rcp_f32 v122, v122
  v_rcp_f32 v107, v107
  v_rcp_f32 v123, v123
  v_rcp_f32 v108, v108
  v_rcp_f32 v124, v124
  v_rcp_f32 v109, v109
  v_rcp_f32 v125, v125
  v_rcp_f32 v110, v110
  v_rcp_f32 v126, v126
  v_rcp_f32 v111, v111
  v_rcp_f32 v127, v127
  v_rcp_f32 v112, v112
  v_rcp_f32 v128, v128
  v_rcp_f32 v113, v113
  v_rcp_f32 v129, v129
  v_rcp_f32 v114, v114
  v_rcp_f32 v130, v130
  s_add_u32 m0, s32, 0
  s_nop 0
  buffer_load_dwordx4 v14, s[12:15], s93 offen lds
  v_rcp_f32 v115, v115
  v_rcp_f32 v131, v131
  v_rcp_f32 v116, v116
  v_rcp_f32 v132, v132
  v_rcp_f32 v117, v117
  v_rcp_f32 v133, v133
  v_rcp_f32 v118, v118
  v_rcp_f32 v134, v134
  v_rcp_f32 v119, v119
  v_rcp_f32 v135, v135
  v_pk_mul_f32 v[40:41], v[40:41], v[104:105]
  v_pk_mul_f32 v[56:57], v[56:57], v[120:121]
  v_pk_mul_f32 v[42:43], v[42:43], v[106:107]
  v_pk_mul_f32 v[58:59], v[58:59], v[122:123]
  v_pk_mul_f32 v[44:45], v[44:45], v[108:109]
  v_pk_mul_f32 v[60:61], v[60:61], v[124:125]
  v_pk_mul_f32 v[46:47], v[46:47], v[110:111]
  v_pk_mul_f32 v[62:63], v[62:63], v[126:127]
  v_pk_mul_f32 v[48:49], v[48:49], v[112:113]
  v_pk_mul_f32 v[64:65], v[64:65], v[128:129]
  v_pk_mul_f32 v[50:51], v[50:51], v[114:115]
  v_pk_mul_f32 v[66:67], v[66:67], v[130:131]
  v_pk_mul_f32 v[52:53], v[52:53], v[116:117]
  v_pk_mul_f32 v[68:69], v[68:69], v[132:133]
  v_pk_mul_f32 v[54:55], v[54:55], v[118:119]
  v_pk_mul_f32 v[70:71], v[70:71], v[134:135]
  v_pk_add_f32 v[168:169], v[40:41], v[42:43]
  v_pk_add_f32 v[176:177], v[56:57], v[58:59]
  v_pk_mul_f32 v[170:171], v[40:41], v[40:41]
  v_pk_mul_f32 v[178:179], v[56:57], v[56:57]
  v_pk_fma_f32 v[170:171], v[42:43], v[42:43], v[170:171]
  v_pk_fma_f32 v[178:179], v[58:59], v[58:59], v[178:179]
  v_pk_add_f32 v[168:169], v[168:169], v[44:45]
  v_pk_add_f32 v[176:177], v[176:177], v[60:61]
  v_pk_fma_f32 v[170:171], v[44:45], v[44:45], v[170:171]
  v_pk_fma_f32 v[178:179], v[60:61], v[60:61], v[178:179]
  v_pk_add_f32 v[168:169], v[168:169], v[46:47]
  v_pk_add_f32 v[176:177], v[176:177], v[62:63]
  v_pk_fma_f32 v[170:171], v[46:47], v[46:47], v[170:171]
  v_pk_fma_f32 v[178:179], v[62:63], v[62:63], v[178:179]
  v_pk_add_f32 v[168:169], v[168:169], v[48:49]
  v_pk_add_f32 v[176:177], v[176:177], v[64:65]
  v_pk_fma_f32 v[170:171], v[48:49], v[48:49], v[170:171]
  v_pk_fma_f32 v[178:179], v[64:65], v[64:65], v[178:179]
  v_pk_add_f32 v[168:169], v[168:169], v[50:51]
  v_pk_add_f32 v[176:177], v[176:177], v[66:67]
  v_pk_fma_f32 v[170:171], v[50:51], v[50:51], v[170:171]
  v_pk_fma_f32 v[178:179], v[66:67], v[66:67], v[178:179]
  buffer_load_dwordx4 v15, s[12:15], s93 offen offset:1024 lds
  s_add_u32 s93, s93, 128
  v_pk_add_f32 v[168:169], v[168:169], v[52:53]
  v_pk_add_f32 v[176:177], v[176:177], v[68:69]
  v_pk_fma_f32 v[170:171], v[52:53], v[52:53], v[170:171]
  v_pk_fma_f32 v[178:179], v[68:69], v[68:69], v[178:179]
  v_pk_add_f32 v[168:169], v[168:169], v[54:55]
  v_pk_add_f32 v[176:177], v[176:177], v[70:71]
  v_pk_fma_f32 v[170:171], v[54:55], v[54:55], v[170:171]
  v_pk_fma_f32 v[178:179], v[70:71], v[70:71], v[178:179]
  v_add_f32 v168, v168, v169
  v_add_f32 v176, v176, v177
  v_add_f32 v170, v170, v171
  v_add_f32 v178, v178, v179
  s_nop 0
  v_permlane16_swap_b32 v168, v170
  v_permlane16_swap_b32 v176, v178
  v_add_f32 v168, v168, v170
  v_add_f32 v176, v176, v178
  v_mov_b32 v170, v168
  v_mov_b32 v178, v176
  s_nop 0
  v_permlane32_swap_b32 v168, v170
  v_permlane32_swap_b32 v176, v178
  v_add_f32 v168, v168, v170
  v_add_f32 v176, v176, v178
  ds_write_b32 v172, v168 offset:0
  ds_write_b32 v172, v176 offset:128
  v_pk_mul_f32 v[104:105], v[72:73], v[72:73]
  v_pk_mul_f32 v[120:121], v[88:89], v[88:89]
  v_pk_mul_f32 v[106:107], v[74:75], v[74:75]
  v_pk_mul_f32 v[122:123], v[90:91], v[90:91]
  v_pk_mul_f32 v[108:109], v[76:77], v[76:77]
  v_pk_mul_f32 v[124:125], v[92:93], v[92:93]
  v_pk_mul_f32 v[110:111], v[78:79], v[78:79]
  v_pk_mul_f32 v[126:127], v[94:95], v[94:95]
  v_pk_mul_f32 v[112:113], v[80:81], v[80:81]
  v_pk_mul_f32 v[128:129], v[96:97], v[96:97]
  v_pk_mul_f32 v[114:115], v[82:83], v[82:83]
  v_pk_mul_f32 v[130:131], v[98:99], v[98:99]
  v_pk_mul_f32 v[116:117], v[84:85], v[84:85]
  v_pk_mul_f32 v[132:133], v[100:101], v[100:101]
  v_pk_mul_f32 v[118:119], v[86:87], v[86:87]
  v_pk_mul_f32 v[134:135], v[102:103], v[102:103]
  v_pk_fma_f32 v[104:105], v[104:105], v[26:27], s[80:81] op_sel_hi:[1,0,0]
  v_pk_fma_f32 v[120:121], v[120:121], v[26:27], s[80:81] op_sel_hi:[1,0,0]
  v_pk_fma_f32 v[106:107], v[106:107], v[26:27], s[80:81] op_sel_hi:[1,0,0]
  v_pk_fma_f32 v[122:123], v[122:123], v[26:27], s[80:81] op_sel_hi:[1,0,0]
  v_pk_fma_f32 v[108:109], v[108:109], v[26:27], s[80:81] op_sel_hi:[1,0,0]
  v_pk_fma_f32 v[124:125], v[124:125], v[26:27], s[80:81] op_sel_hi:[1,0,0]
  v_pk_fma_f32 v[110:111], v[110:111], v[26:27], s[80:81] op_sel_hi:[1,0,0]
  v_pk_fma_f32 v[126:127], v[126:127], v[26:27], s[80:81] op_sel_hi:[1,0,0]
  v_pk_fma_f32 v[112:113], v[112:113], v[26:27], s[80:81] op_sel_hi:[1,0,0]
  v_pk_fma_f32 v[128:129], v[128:129], v[26:27], s[80:81] op_sel_hi:[1,0,0]
  v_pk_fma_f32 v[114:115], v[114:115], v[26:27], s[80:81] op_sel_hi:[1,0,0]
  v_pk_fma_f32 v[130:131], v[130:131], v[26:27], s[80:81] op_sel_hi:[1,0,0]
  v_pk_fma_f32 v[116:117], v[116:117], v[26:27], s[80:81] op_sel_hi:[1,0,0]
  v_pk_fma_f32 v[132:133], v[132:133], v[26:27], s[80:81] op_sel_hi:[1,0,0]
  v_pk_fma_f32 v[118:119], v[118:119], v[26:27], s[80:81] op_sel_hi:[1,0,0]
  s_add_u32 m0, s94, 16384
  s_nop 0
  buffer_load_dwordx4 v16, s[20:23], s95 offen lds
  v_pk_fma_f32 v[134:135], v[134:135], v[26:27], s[80:81] op_sel_hi:[1,0,0]
  v_pk_mul_f32 v[104:105], v[72:73], v[104:105]
  v_pk_mul_f32 v[120:121], v[88:89], v[120:121]
  v_pk_mul_f32 v[106:107], v[74:75], v[106:107]
  v_pk_mul_f32 v[122:123], v[90:91], v[122:123]
  v_pk_mul_f32 v[108:109], v[76:77], v[108:109]
  v_pk_mul_f32 v[124:125], v[92:93], v[124:125]
  v_pk_mul_f32 v[110:111], v[78:79], v[110:111]
  v_pk_mul_f32 v[126:127], v[94:95], v[126:127]
  v_pk_mul_f32 v[112:113], v[80:81], v[112:113]
  v_pk_mul_f32 v[128:129], v[96:97], v[128:129]
  v_pk_mul_f32 v[114:115], v[82:83], v[114:115]
  v_pk_mul_f32 v[130:131], v[98:99], v[130:131]
  v_pk_mul_f32 v[116:117], v[84:85], v[116:117]
  v_pk_mul_f32 v[132:133], v[100:101], v[132:133]
  v_pk_mul_f32 v[118:119], v[86:87], v[118:119]
  v_pk_mul_f32 v[134:135], v[102:103], v[134:135]
  v_exp_f32 v104, v104
  v_exp_f32 v120, v120
  v_exp_f32 v105, v105
  v_exp_f32 v121, v121
  v_exp_f32 v106, v106
  v_exp_f32 v122, v122
  v_exp_f32 v107, v107
  v_exp_f32 v123, v123
  v_exp_f32 v108, v108
  v_exp_f32 v124, v124
  v_exp_f32 v109, v109
  v_exp_f32 v125, v125
  v_exp_f32 v110, v110
  v_exp_f32 v126, v126
  v_exp_f32 v111, v111
  v_exp_f32 v127, v127
  v_exp_f32 v112, v112
  v_exp_f32 v128, v128
  v_exp_f32 v113, v113
  v_exp_f32 v129, v129
  v_exp_f32 v114, v114
  v_exp_f32 v130, v130
  v_exp_f32 v115, v115
  v_exp_f32 v131, v131
  v_exp_f32 v116, v116
  v_exp_f32 v132, v132
  v_exp_f32 v117, v117
  v_exp_f32 v133, v133
  v_exp_f32 v118, v118
  v_exp_f32 v134, v134
  v_exp_f32 v119, v119
  v_exp_f32 v135, v135
  v_pk_add_f32 v[104:105], v[104:105], v[26:27] op_sel:[0,1] op_sel_hi:[1,1]
  v_pk_add_f32 v[120:121], v[120:121], v[26:27] op_sel:[0,1] op_sel_hi:[1,1]
  v_pk_add_f32 v[106:107], v[106:107], v[26:27] op_sel:[0,1] op_sel_hi:[1,1]
  v_pk_add_f32 v[122:123], v[122:123], v[26:27] op_sel:[0,1] op_sel_hi:[1,1]
  v_pk_add_f32 v[108:109], v[108:109], v[26:27] op_sel:[0,1] op_sel_hi:[1,1]
  v_pk_add_f32 v[124:125], v[124:125], v[26:27] op_sel:[0,1] op_sel_hi:[1,1]
  v_pk_add_f32 v[110:111], v[110:111], v[26:27] op_sel:[0,1] op_sel_hi:[1,1]
  v_pk_add_f32 v[126:127], v[126:127], v[26:27] op_sel:[0,1] op_sel_hi:[1,1]
  v_pk_add_f32 v[112:113], v[112:113], v[26:27] op_sel:[0,1] op_sel_hi:[1,1]
  v_pk_add_f32 v[128:129], v[128:129], v[26:27] op_sel:[0,1] op_sel_hi:[1,1]
  v_pk_add_f32 v[114:115], v[114:115], v[26:27] op_sel:[0,1] op_sel_hi:[1,1]
  v_pk_add_f32 v[130:131], v[130:131], v[26:27] op_sel:[0,1] op_sel_hi:[1,1]
  v_pk_add_f32 v[116:117], v[116:117], v[26:27] op_sel:[0,1] op_sel_hi:[1,1]
  v_pk_add_f32 v[132:133], v[132:133], v[26:27] op_sel:[0,1] op_sel_hi:[1,1]
  v_pk_add_f32 v[118:119], v[118:119], v[26:27] op_sel:[0,1] op_sel_hi:[1,1]
  buffer_load_dwordx4 v17, s[20:23], s95 offen offset:1024 lds
  s_add_u32 s95, s95, 458752
  v_pk_add_f32 v[134:135], v[134:135], v[26:27] op_sel:[0,1] op_sel_hi:[1,1]
  v_rcp_f32 v104, v104
  v_rcp_f32 v120, v120
  v_rcp_f32 v105, v105
  v_rcp_f32 v121, v121
  v_rcp_f32 v106, v106
  v_rcp_f32 v122, v122
  v_rcp_f32 v107, v107
  v_rcp_f32 v123, v123
  v_rcp_f32 v108, v108
  v_rcp_f32 v124, v124
  v_rcp_f32 v109, v109
  v_rcp_f32 v125, v125
  v_rcp_f32 v110, v110
  v_rcp_f32 v126, v126
  v_rcp_f32 v111, v111
  v_rcp_f32 v127, v127
  v_rcp_f32 v112, v112
  v_rcp_f32 v128, v128
  v_rcp_f32 v113, v113
  v_rcp_f32 v129, v129
  v_rcp_f32 v114, v114
  v_rcp_f32 v130, v130
  v_rcp_f32 v115, v115
  v_rcp_f32 v131, v131
  v_rcp_f32 v116, v116
  v_rcp_f32 v132, v132
  v_rcp_f32 v117, v117
  v_rcp_f32 v133, v133
  v_rcp_f32 v118, v118
  v_rcp_f32 v134, v134
  v_rcp_f32 v119, v119
  v_rcp_f32 v135, v135
  v_pk_mul_f32 v[72:73], v[72:73], v[104:105]
  v_pk_mul_f32 v[88:89], v[88:89], v[120:121]
  v_pk_mul_f32 v[74:75], v[74:75], v[106:107]
  v_pk_mul_f32 v[90:91], v[90:91], v[122:123]
  v_pk_mul_f32 v[76:77], v[76:77], v[108:109]
  v_pk_mul_f32 v[92:93], v[92:93], v[124:125]
  v_pk_mul_f32 v[78:79], v[78:79], v[110:111]
  v_pk_mul_f32 v[94:95], v[94:95], v[126:127]
  v_pk_mul_f32 v[80:81], v[80:81], v[112:113]
  v_pk_mul_f32 v[96:97], v[96:97], v[128:129]
  v_pk_mul_f32 v[82:83], v[82:83], v[114:115]
  v_pk_mul_f32 v[98:99], v[98:99], v[130:131]
  v_pk_mul_f32 v[84:85], v[84:85], v[116:117]
  v_pk_mul_f32 v[100:101], v[100:101], v[132:133]
  v_pk_mul_f32 v[86:87], v[86:87], v[118:119]
  v_pk_mul_f32 v[102:103], v[102:103], v[134:135]
  v_pk_add_f32 v[168:169], v[72:73], v[74:75]
  v_pk_add_f32 v[176:177], v[88:89], v[90:91]
  v_pk_mul_f32 v[170:171], v[72:73], v[72:73]
  v_pk_mul_f32 v[178:179], v[88:89], v[88:89]
  v_pk_fma_f32 v[170:171], v[74:75], v[74:75], v[170:171]
  v_pk_fma_f32 v[178:179], v[90:91], v[90:91], v[178:179]
  v_pk_add_f32 v[168:169], v[168:169], v[76:77]
  v_pk_add_f32 v[176:177], v[176:177], v[92:93]
  v_pk_fma_f32 v[170:171], v[76:77], v[76:77], v[170:171]
  v_pk_fma_f32 v[178:179], v[92:93], v[92:93], v[178:179]
  v_pk_add_f32 v[168:169], v[168:169], v[78:79]
  v_pk_add_f32 v[176:177], v[176:177], v[94:95]
  v_pk_fma_f32 v[170:171], v[78:79], v[78:79], v[170:171]
  v_pk_fma_f32 v[178:179], v[94:95], v[94:95], v[178:179]
  s_add_u32 m0, s36, 16384
  s_nop 0
  buffer_load_dwordx4 v18, s[24:27], s37 offen lds
  s_add_u32 s37, s37, 393216
  v_pk_add_f32 v[168:169], v[168:169], v[80:81]
  v_pk_add_f32 v[176:177], v[176:177], v[96:97]
  v_pk_fma_f32 v[170:171], v[80:81], v[80:81], v[170:171]
  v_pk_fma_f32 v[178:179], v[96:97], v[96:97], v[178:179]
  v_pk_add_f32 v[168:169], v[168:169], v[82:83]
  v_pk_add_f32 v[176:177], v[176:177], v[98:99]
  v_pk_fma_f32 v[170:171], v[82:83], v[82:83], v[170:171]
  v_pk_fma_f32 v[178:179], v[98:99], v[98:99], v[178:179]
  v_pk_add_f32 v[168:169], v[168:169], v[84:85]
  v_pk_add_f32 v[176:177], v[176:177], v[100:101]
  v_pk_fma_f32 v[170:171], v[84:85], v[84:85], v[170:171]
  v_pk_fma_f32 v[178:179], v[100:101], v[100:101], v[178:179]
  v_pk_add_f32 v[168:169], v[168:169], v[86:87]
  v_pk_add_f32 v[176:177], v[176:177], v[102:103]
  v_pk_fma_f32 v[170:171], v[86:87], v[86:87], v[170:171]
  v_pk_fma_f32 v[178:179], v[102:103], v[102:103], v[178:179]
  v_add_f32 v168, v168, v169
  v_add_f32 v176, v176, v177
  v_add_f32 v170, v170, v171
  v_add_f32 v178, v178, v179
  s_nop 0
  v_permlane16_swap_b32 v168, v170
  v_permlane16_swap_b32 v176, v178
  v_add_f32 v168, v168, v170
  v_add_f32 v176, v176, v178
  v_mov_b32 v170, v168
  v_mov_b32 v178, v176
  s_nop 0
  v_permlane32_swap_b32 v168, v170
  v_permlane32_swap_b32 v176, v178
  v_add_f32 v168, v168, v170
  v_add_f32 v176, v176, v178
  ds_write_b32 v172, v168 offset:256
  ds_write_b32 v172, v176 offset:384
  s_waitcnt lgkmcnt(0)
  s_barrier
  s_mul_i32 s85, s40, 7168
  s_add_u32 s85, s85, 8388608
  s_sub_u32 s75, s3, 0
  s_cmp_ge_u32 s75, 2
  s_cbranch_scc1 ow_2
  s_lshl_b32 s4, s3, 6
  v_add_u32 v2, s4, v1
  v_lshlrev_b32 v2, 3, v2
  v_add_u32 v3, 147456, v2
  ds_read_b64 v[216:217], v3 offset:0
  ds_read_b64 v[218:219], v3 offset:1024
  ds_read_b64 v[220:221], v3 offset:2048
  ds_read_b64 v[222:223], v3 offset:3072
  s_waitcnt vmcnt(8)
  v_cmp_le_u32 vcc, 16, v12
  s_cbranch_vccnz rok_3
  s_mov_b32 s75, 400000
rsp_4:
  s_sleep 1
  v_mov_b32 v9, 0
  buffer_load_dword v12, v9, s[28:31], 0 offen sc1
  s_waitcnt vmcnt(0)
  v_cmp_le_u32 vcc, 16, v12
  s_cbranch_vccnz rok_3
  s_sub_u32 s75, s75, 1
  s_cmp_lg_u32 s75, 0
  s_cbranch_scc1 rsp_4
rok_3:
  s_waitcnt lgkmcnt(0)
  v_pk_add_f32 v[216:217], v[216:217], v[218:219]
  v_pk_add_f32 v[220:221], v[220:221], v[222:223]
  v_pk_add_f32 v[216:217], v[216:217], v[220:221]
  v_or_b32 v217, 0x80000000, v217
  s_lshl_b32 s4, s79, 10
  s_add_u32 s4, s4, s85
  buffer_store_dwordx2 v[216:217], v2, s[8:11], s4 offen sc1
ow_2:
  s_sub_u32 s75, s3, 2
  s_cmp_ge_u32 s75, 2
  s_cbranch_scc1 ow_5
  s_waitcnt vmcnt(8)
  v_cmp_le_u32 vcc, 16, v12
  s_cbranch_vccnz rok_6
  s_mov_b32 s75, 400000
rsp_7:
  s_sleep 1
  v_mov_b32 v9, 0
  buffer_load_dword v12, v9, s[28:31], 0 offen sc1
  s_waitcnt vmcnt(0)
  v_cmp_le_u32 vcc, 16, v12
  s_cbranch_vccnz rok_6
  s_sub_u32 s75, s75, 1
  s_cmp_lg_u32 s75, 0
  s_cbranch_scc1 rsp_7
rok_6:
ow_5:
  s_lshl_b32 s76, s79, 4
  s_add_u32 s76, s76, s40
  s_lshl_b32 s76, s76, 2
  s_add_u32 s76, s76, 15728640
  v_mov_b32 v8, 2146435072
  buffer_store_dword v8, v8, s[8:11], 0 offen
  buffer_store_dword v8, v8, s[8:11], 0 offen
  buffer_store_dword v8, v8, s[8:11], 0 offen
  buffer_store_dword v8, v8, s[8:11], 0 offen
  buffer_store_dword v8, v8, s[8:11], 0 offen
  s_branch L_t23
L_aux:
  s_waitcnt lgkmcnt(0)
  s_mov_b32 s8, s72
  s_and_b32 s9, s73, 0xffff
  s_mov_b32 s10, 41943040
  s_mov_b32 s11, 0x20000
  s_mov_b32 s12, s48
  s_and_b32 s13, s49, 0xffff
  s_mov_b32 s14, 4194304
  s_mov_b32 s15, 0x20000
  s_mov_b32 s28, s52
  s_and_b32 s29, s53, 0xffff
  s_mov_b32 s30, 65536
  s_mov_b32 s31, 0x20000
  s_mov_b32 s74, 2
  v_mov_b32 v40, 0
  v_mov_b32 v41, 0
  v_mov_b32 v42, 0
  v_mov_b32 v43, 0
  v_lshlrev_b32 v2, 4, v13
  s_mul_i32 s4, s40, 7168
  s_add_u32 s4, s4, 8388608
  v_cmp_gt_u32 vcc, 7168, v2
  v_mov_b32 v3, 2146435072
  s_nop 0
  v_cndmask_b32 v3, v3, v2, vcc
  buffer_store_dwordx4 v[40:43], v3, s[8:11], s4 offen sc1
  s_lshl_b32 s4, s40, 9
  s_add_u32 s4, s4, 15728640
  v_cmp_gt_u32 vcc, 512, v2
  v_mov_b32 v3, 2146435072
  s_nop 0
  v_cndmask_b32 v3, v3, v2, vcc
  buffer_store_dwordx4 v[40:43], v3, s[8:11], s4 offen sc1
  s_waitcnt vmcnt(0)
  s_barrier
  s_and_b32 s4, s3, 3
  s_lshl_b32 s4, s4, 10
  s_add_u32 m0, s4, 155648
  s_lshl_b32 s5, s43, 12
  s_add_u32 s4, s4, s5
  v_lshlrev_b32 v2, 4, v1
  buffer_load_dwordx4 v2, s[28:31], s4 offen lds
  s_and_b32 s4, s3, 1
  s_lshl_b32 s5, s4, 2
  v_lshrrev_b32 v2, 4, v1
  v_or_b32 v2, s5, v2
  v_bfe_u32 v3, v1, 1, 3
  v_xor_b32 v2, v2, v3
  v_and_b32 v3, 1, v1
  v_lshlrev_b32 v3, 4, v3
  v_lshl_add_u32 v39, v2, 5, v3
  v_cmp_eq_u32 vcc, 7, v2
  v_mov_b32 v4, 2146435072
  s_nop 0
  v_cndmask_b32 v39, v39, v4, vcc
  v_and_b32 v2, 15, v1
  s_mul_i32 s4, s44, 8192
  s_mul_i32 s5, s82, 4096
  s_add_u32 s4, s4, s5
  v_lshlrev_b32 v2, 7, v2
  v_add_u32 v2, s4, v2
  v_bfe_u32 v3, v1, 1, 3
  v_lshrrev_b32 v4, 4, v1
  v_xor_b32 v4, v4, v3
  v_lshl_add_u32 v30, v4, 4, v2
  v_xor_b32 v31, 64, v30
  s_lshl_b32 s5, s83, 2
  v_lshrrev_b32 v2, 4, v1
  v_lshlrev_b32 v2, 3, v2
  v_bfe_u32 v3, v1, 2, 2
  v_add_u32 v2, v2, v3
  v_lshlrev_b32 v2, 8, v2
  v_add_u32 v2, 49152, v2
  v_and_b32 v4, 3, v1
  v_lshl_add_u32 v2, v4, 3, v2
  v_bfe_u32 v4, v1, 4, 1
  v_lshl_or_b32 v3, v4, 2, v3
  v_xor_b32 v3, s5, v3
  v_lshl_add_u32 v32, v3, 5, v2
  v_xor_b32 v33, 32, v32
  v_xor_b32 v34, 64, v32
  v_xor_b32 v35, 96, v32
  s_lshl_b32 s5, s83, 1
  v_lshrrev_b32 v2, 4, v1
  v_lshlrev_b32 v2, 3, v2
  v_bfe_u32 v3, v1, 2, 2
  v_add_u32 v2, v2, v3
  v_lshlrev_b32 v2, 7, v2
  v_add_u32 v2, 98304, v2
  v_and_b32 v4, 3, v1
  v_lshl_add_u32 v2, v4, 3, v2
  v_bfe_u32 v4, v1, 4, 1
  v_lshrrev_b32 v3, 1, v3
  v_lshl_or_b32 v3, v4, 1, v3
  v_xor_b32 v3, s5, v3
  v_lshl_add_u32 v36, v3, 5, v2
  v_xor_b32 v37, 32, v36
  s_cmp_lg_u32 s3, 0
  s_cbranch_scc1 ow_8
  s_mov_b32 s28, s70
  s_and_b32 s29, s71, 0xffff
  s_mov_b32 s30, 256
  s_mov_b32 s31, 0x20000
  v_mov_b32 v8, 1
  v_mov_b32 v9, 0
  s_mov_b64 exec, 1
  buffer_atomic_add v8, v9, s[28:31], 0 offen
  s_mov_b64 exec, -1
ow_8:
  s_mov_b32 s28, s66
  s_and_b32 s29, s67, 0xffff
  s_mov_b32 s30, 2048
  s_mov_b32 s31, 0x20000
  s_lshl_b32 s4, s3, 4
  s_lshl_b32 s5, s40, 7
  s_add_u32 s4, s4, s5
  v_and_b32 v2, 15, v1
  v_add_u32 v6, s4, v2
  v_and_b32 v4, 0x30, v1
  v_lshl_add_u32 v3, v6, 11, v4
  buffer_load_dwordx4 v[40:43], v3, s[12:15], 0 offen offset:0
  buffer_load_dwordx4 v[104:107], v4, s[28:31], 0 offen offset:0
  buffer_load_dwordx4 v[44:47], v3, s[12:15], 0 offen offset:64
  buffer_load_dwordx4 v[108:111], v4, s[28:31], 0 offen offset:64
  buffer_load_dwordx4 v[48:51], v3, s[12:15], 0 offen offset:128
  buffer_load_dwordx4 v[112:115], v4, s[28:31], 0 offen offset:128
  buffer_load_dwordx4 v[52:55], v3, s[12:15], 0 offen offset:192
  buffer_load_dwordx4 v[116:119], v4, s[28:31], 0 offen offset:192
  buffer_load_dwordx4 v[56:59], v3, s[12:15], 0 offen offset:256
  buffer_load_dwordx4 v[120:123], v4, s[28:31], 0 offen offset:256
  buffer_load_dwordx4 v[60:63], v3, s[12:15], 0 offen offset:320
  buffer_load_dwordx4 v[124:127], v4, s[28:31], 0 offen offset:320
  buffer_load_dwordx4 v[64:67], v3, s[12:15], 0 offen offset:384
  buffer_load_dwordx4 v[128:131], v4, s[28:31], 0 offen offset:384
  buffer_load_dwordx4 v[68:71], v3, s[12:15], 0 offen offset:448
  buffer_load_dwordx4 v[132:135], v4, s[28:31], 0 offen offset:448
  buffer_load_dwordx4 v[72:75], v3, s[12:15], 0 offen offset:512
  buffer_load_dwordx4 v[136:139], v4, s[28:31], 0 offen offset:512
  buffer_load_dwordx4 v[76:79], v3, s[12:15], 0 offen offset:576
  buffer_load_dwordx4 v[140:143], v4, s[28:31], 0 offen offset:576
  buffer_load_dwordx4 v[80:83], v3, s[12:15], 0 offen offset:640
  buffer_load_dwordx4 v[144:147], v4, s[28:31], 0 offen offset:640
  buffer_load_dwordx4 v[84:87], v3, s[12:15], 0 offen offset:704
  buffer_load_dwordx4 v[148:151], v4, s[28:31], 0 offen offset:704
  buffer_load_dwordx4 v[88:91], v3, s[12:15], 0 offen offset:768
  buffer_load_dwordx4 v[152:155], v4, s[28:31], 0 offen offset:768
  buffer_load_dwordx4 v[92:95], v3, s[12:15], 0 offen offset:832
  buffer_load_dwordx4 v[156:159], v4, s[28:31], 0 offen offset:832
  buffer_load_dwordx4 v[96:99], v3, s[12:15], 0 offen offset:896
  buffer_load_dwordx4 v[160:163], v4, s[28:31], 0 offen offset:896
  buffer_load_dwordx4 v[100:103], v3, s[12:15], 0 offen offset:960
  buffer_load_dwordx4 v[164:167], v4, s[28:31], 0 offen offset:960
  s_waitcnt vmcnt(0)
  v_mfma_f32_16x16x32_bf16 v[168:171], v[104:107], v[40:43], 0
  v_mfma_f32_16x16x32_bf16 v[168:171], v[108:111], v[44:47], v[168:171]
  v_mfma_f32_16x16x32_bf16 v[168:171], v[112:115], v[48:51], v[168:171]
  v_mfma_f32_16x16x32_bf16 v[168:171], v[116:119], v[52:55], v[168:171]
  v_mfma_f32_16x16x32_bf16 v[168:171], v[120:123], v[56:59], v[168:171]
  v_mfma_f32_16x16x32_bf16 v[168:171], v[124:127], v[60:63], v[168:171]
  v_mfma_f32_16x16x32_bf16 v[168:171], v[128:131], v[64:67], v[168:171]
  v_mfma_f32_16x16x32_bf16 v[168:171], v[132:135], v[68:71], v[168:171]
  v_mfma_f32_16x16x32_bf16 v[168:171], v[136:139], v[72:75], v[168:171]
  v_mfma_f32_16x16x32_bf16 v[168:171], v[140:143], v[76:79], v[168:171]
  v_mfma_f32_16x16x32_bf16 v[168:171], v[144:147], v[80:83], v[168:171]
  v_mfma_f32_16x16x32_bf16 v[168:171], v[148:151], v[84:87], v[168:171]
  v_mfma_f32_16x16x32_bf16 v[168:171], v[152:155], v[88:91], v[168:171]
  v_mfma_f32_16x16x32_bf16 v[168:171], v[156:159], v[92:95], v[168:171]
  v_mfma_f32_16x16x32_bf16 v[168:171], v[160:163], v[96:99], v[168:171]
  v_mfma_f32_16x16x32_bf16 v[168:171], v[164:167], v[100:103], v[168:171]
  buffer_load_dwordx4 v[40:43], v3, s[12:15], 0 offen offset:1024
  buffer_load_dwordx4 v[104:107], v4, s[28:31], 0 offen offset:1024
  buffer_load_dwordx4 v[44:47], v3, s[12:15], 0 offen offset:1088
  buffer_load_dwordx4 v[108:111], v4, s[28:31], 0 offen offset:1088
  buffer_load_dwordx4 v[48:51], v3, s[12:15], 0 offen offset:1152
  buffer_load_dwordx4 v[112:115], v4, s[28:31], 0 offen offset:1152
  buffer_load_dwordx4 v[52:55], v3, s[12:15], 0 offen offset:1216
  buffer_load_dwordx4 v[116:119], v4, s[28:31], 0 offen offset:1216
  buffer_load_dwordx4 v[56:59], v3, s[12:15], 0 offen offset:1280
  buffer_load_dwordx4 v[120:123], v4, s[28:31], 0 offen offset:1280
  buffer_load_dwordx4 v[60:63], v3, s[12:15], 0 offen offset:1344
  buffer_load_dwordx4 v[124:127], v4, s[28:31], 0 offen offset:1344
  buffer_load_dwordx4 v[64:67], v3, s[12:15], 0 offen offset:1408
  buffer_load_dwordx4 v[128:131], v4, s[28:31], 0 offen offset:1408
  buffer_load_dwordx4 v[68:71], v3, s[12:15], 0 offen offset:1472
  buffer_load_dwordx4 v[132:135], v4, s[28:31], 0 offen offset:1472
  buffer_load_dwordx4 v[72:75], v3, s[12:15], 0 offen offset:1536
  buffer_load_dwordx4 v[136:139], v4, s[28:31], 0 offen offset:1536
  buffer_load_dwordx4 v[76:79], v3, s[12:15], 0 offen offset:1600
  buffer_load_dwordx4 v[140:143], v4, s[28:31], 0 offen offset:1600
  buffer_load_dwordx4 v[80:83], v3, s[12:15], 0 offen offset:1664
  buffer_load_dwordx4 v[144:147], v4, s[28:31], 0 offen offset:1664
  buffer_load_dwordx4 v[84:87], v3, s[12:15], 0 offen offset:1728
  buffer_load_dwordx4 v[148:151], v4, s[28:31], 0 offen offset:1728
  buffer_load_dwordx4 v[88:91], v3, s[12:15], 0 offen offset:1792
  buffer_load_dwordx4 v[152:155], v4, s[28:31], 0 offen offset:1792
  buffer_load_dwordx4 v[92:95], v3, s[12:15], 0 offen offset:1856
  buffer_load_dwordx4 v[156:159], v4, s[28:31], 0 offen offset:1856
  buffer_load_dwordx4 v[96:99], v3, s[12:15], 0 offen offset:1920
  buffer_load_dwordx4 v[160:163], v4, s[28:31], 0 offen offset:1920
  buffer_load_dwordx4 v[100:103], v3, s[12:15], 0 offen offset:1984
  buffer_load_dwordx4 v[164:167], v4, s[28:31], 0 offen offset:1984
  s_waitcnt vmcnt(0)
  v_mfma_f32_16x16x32_bf16 v[168:171], v[104:107], v[40:43], v[168:171]
  v_mfma_f32_16x16x32_bf16 v[168:171], v[108:111], v[44:47], v[168:171]
  v_mfma_f32_16x16x32_bf16 v[168:171], v[112:115], v[48:51], v[168:171]
  v_mfma_f32_16x16x32_bf16 v[168:171], v[116:119], v[52:55], v[168:171]
  v_mfma_f32_16x16x32_bf16 v[168:171], v[120:123], v[56:59], v[168:171]
  v_mfma_f32_16x16x32_bf16 v[168:171], v[124:127], v[60:63], v[168:171]
  v_mfma_f32_16x16x32_bf16 v[168:171], v[128:131], v[64:67], v[168:171]
  v_mfma_f32_16x16x32_bf16 v[168:171], v[132:135], v[68:71], v[168:171]
  v_mfma_f32_16x16x32_bf16 v[168:171], v[136:139], v[72:75], v[168:171]
  v_mfma_f32_16x16x32_bf16 v[168:171], v[140:143], v[76:79], v[168:171]
  v_mfma_f32_16x16x32_bf16 v[168:171], v[144:147], v[80:83], v[168:171]
  v_mfma_f32_16x16x32_bf16 v[168:171], v[148:151], v[84:87], v[168:171]
  v_mfma_f32_16x16x32_bf16 v[168:171], v[152:155], v[88:91], v[168:171]
  v_mfma_f32_16x16x32_bf16 v[168:171], v[156:159], v[92:95], v[168:171]
  v_mfma_f32_16x16x32_bf16 v[168:171], v[160:163], v[96:99], v[168:171]
  v_mfma_f32_16x16x32_bf16 v[168:171], v[164:167], v[100:103], v[168:171]
  s_nop 7
  v_mul_f32 v216, 0xbfb8aa3b, v168
  v_exp_f32 v216, v216
  s_nop 0
  v_add_f32 v216, 1.0, v216
  v_rcp_f32 v216, v216
  s_nop 0
  v_mov_b32 v217, v216
  v_mov_b32 v218, v216
  v_mov_b32 v219, v216
  v_lshlrev_b32 v6, 4, v6
  v_add_u32 v6, 14942208, v6
  v_mov_b32 v249, 2146435072
  v_mov_b32 v250, 2146435072
  v_mov_b32 v251, 2146435072
  v_mov_b32 v252, 2146435072
  v_mov_b32 v253, 2146435072
  v_mov_b32 v254, 2146435072
  v_mov_b32 v255, 2146435072
  v_cmp_gt_u32 vcc, 16, v1
  s_nop 1
  v_cndmask_b32 v248, v249, v6, vcc
  s_lshl_b32 s32, s3, 11
  s_lshl_b32 s77, s42, 7
  s_mov_b32 s20, s58
  s_and_b32 s21, s59, 0xffff
  s_mov_b32 s22, 7340032
  s_mov_b32 s23, 0x20000
  s_mul_i32 s94, s3, 2048
  s_add_u32 s94, s94, 49152
  s_mul_i32 s36, s3, 1024
  s_add_u32 s36, s36, 98304
  s_lshl_b32 s4, s3, 4
  s_add_u32 s4, s4, s77
  s_mul_i32 s93, s4, 2048
  v_mul_u32_u24 v2, 2048, v0
  v_add_u32 v168, v2, v38
  v_xor_b32 v169, 64, v38
  v_add_u32 v2, 15360, v2
  v_add_u32 v169, v169, v2
  s_mul_i32 s78, s43, 224
  s_mul_i32 s95, s3, 57344
  s_add_u32 s95, s95, s78
  v_lshrrev_b32 v2, 4, v1
  v_mul_u32_u24 v2, 7168, v2
  v_add_u32 v170, v2, v39
  v_add_u32 v171, 27648, v170
  s_lshl_b32 s78, s43, 7
  s_mov_b32 s5, 6144
  s_mul_i32 s37, s3, 49152
  s_add_u32 s37, s37, s78
  s_lshl_b32 s4, s44, 1
  v_bfe_u32 v3, v1, 4, 1
  v_or_b32 v3, s4, v3
  v_bfe_u32 v4, v1, 1, 2
  v_xor_b32 v3, v3, v4
  v_and_b32 v4, 1, v1
  v_lshlrev_b32 v4, 4, v4
  v_lshl_add_u32 v3, v3, 5, v4
  v_mad_u32_u24 v172, v0, s5, v3
  v_mov_b32 v14, v168
  v_mov_b32 v15, v169
  v_mov_b32 v16, v170
  v_mov_b32 v17, v171
  v_mov_b32 v18, v172
  s_mov_b32 s24, s50
  s_and_b32 s25, s51, 0xffff
  s_mov_b32 s26, 6291456
  s_mov_b32 s27, 0x20000
  s_mov_b32 s28, s70
  s_and_b32 s29, s71, 0xffff
  s_mov_b32 s30, 256
  s_mov_b32 s31, 0x20000
  s_mov_b32 s16, s60
  s_and_b32 s17, s61, 0xffff
  s_cmp_lt_u32 s3, 4
  s_cselect_b32 s18, 8388608, 0
  s_mov_b32 s19, 0x20000
  s_lshl_b32 s38, s2, 15
  s_lshl_b32 s4, s3, 13
  s_add_u32 s38, s38, s4
  v_lshlrev_b32 v11, 7, v1
  s_mul_i32 s4, s43, 112
  s_lshr_b32 s5, s4, 8
  s_add_u32 s4, s4, 111
  s_lshr_b32 s4, s4, 8
  v_mov_b32 v2, s5
  v_mov_b32 v3, s4
  v_cmp_gt_u32 vcc, 16, v1
  s_nop 1
  v_cndmask_b32 v2, v3, v2, vcc
  v_and_b32 v3, 15, v1
  v_lshl_add_u32 v2, v2, 4, v3
  v_lshlrev_b32 v2, 2, v2
  v_add_u32 v13, 15728640, v2
  s_lshr_b32 s4, s2, 5
  s_lshl_b32 s4, s4, 6
  s_add_u32 s4, s4, 15729152
  v_lshl_add_u32 v2, v3, 2, s4
  v_cmp_le_u32 vcc, 32, v1
  s_nop 1
  v_cndmask_b32 v13, v13, v2, vcc
  s_lshl_b32 s4, s42, 2
  s_add_u32 s4, s4, 15730688
  v_mov_b32 v2, s4
  v_cmp_le_u32 vcc, 48, v1
  s_nop 1
  v_cndmask_b32 v13, v13, v2, vcc
  s_add_u32 m0, s32, 16384
  s_nop 0
  buffer_load_dwordx4 v14, s[12:15], s93 offen lds
  buffer_load_dwordx4 v15, s[12:15], s93 offen offset:1024 lds
  s_add_u32 s93, s93, 128
  s_add_u32 m0, s94, 32768
  s_nop 0
  buffer_load_dwordx4 v16, s[20:23], s95 offen lds
  buffer_load_dwordx4 v17, s[20:23], s95 offen offset:1024 lds
  s_add_u32 s95, s95, 458752
  s_add_u32 m0, s36, 0
  s_nop 0
  buffer_load_dwordx4 v18, s[24:27], s37 offen lds
  s_add_u32 s37, s37, 393216
  s_add_u32 m0, s32, 32768
  s_nop 0
  buffer_load_dwordx4 v14, s[12:15], s93 offen lds
  buffer_load_dwordx4 v15, s[12:15], s93 offen offset:1024 lds
  s_add_u32 s93, s93, 128
  s_add_u32 m0, s36, 8192
  s_nop 0
  buffer_load_dwordx4 v18, s[24:27], s37 offen lds
  s_add_u32 s37, s37, 393216
  s_barrier
  s_branch L_t23pro
L_auxepi:
  s_add_u32 m0, s94, 0
  s_nop 0
  buffer_load_dwordx4 v16, s[20:23], s95 offen lds
  buffer_load_dwordx4 v17, s[20:23], s95 offen offset:1024 lds
  s_add_u32 s95, s95, 458752
  s_add_u32 m0, s32, 0
  s_nop 0
  buffer_load_dwordx4 v14, s[12:15], s93 offen lds
  buffer_load_dwordx4 v15, s[12:15], s93 offen offset:1024 lds
  s_add_u32 s93, s93, 128
  s_add_u32 m0, s94, 16384
  s_nop 0
  buffer_load_dwordx4 v16, s[20:23], s95 offen lds
  buffer_load_dwordx4 v17, s[20:23], s95 offen offset:1024 lds
  s_add_u32 s95, s95, 458752
  s_add_u32 m0, s36, 16384
  s_nop 0
  buffer_load_dwordx4 v18, s[24:27], s37 offen lds
  s_add_u32 s37, s37, 393216
  buffer_store_dwordx4 v[216:219], v248, s[8:11], 0 offen sc1
  v_mov_b32 v8, 2146435072
  buffer_store_dword v8, v8, s[8:11], 0 offen
  buffer_store_dword v8, v8, s[8:11], 0 offen
  buffer_store_dword v8, v8, s[8:11], 0 offen
  buffer_store_dword v8, v8, s[8:11], 0 offen
  v_mov_b32 v248, 2146435072
  s_lshl_b32 s76, s40, 2
  s_add_u32 s76, s76, 15730688
L_t23:
  s_cmp_eq_u32 s83, 0
  s_cbranch_scc0 L_t23b
  s_waitcnt vmcnt(16)
  s_barrier
  ds_read_b128 v[104:107], v30 offset:16384
  ds_read_b64_tr_b16 v[120:121], v32 offset:32768
  ds_read_b64_tr_b16 v[122:123], v32 offset:33792
  ds_read_b64_tr_b16 v[124:125], v33 offset:32768
  ds_read_b64_tr_b16 v[126:127], v33 offset:33792
  ds_read_b64_tr_b16 v[128:129], v34 offset:32768
  ds_read_b64_tr_b16 v[130:131], v34 offset:33792
  ds_read_b64_tr_b16 v[132:133], v35 offset:32768
  ds_read_b64_tr_b16 v[134:135], v35 offset:33792
  ds_read_b64_tr_b16 v[136:137], v36 offset:0
  ds_read_b64_tr_b16 v[138:139], v36 offset:512
  ds_read_b64_tr_b16 v[140:141], v37 offset:0
  ds_read_b64_tr_b16 v[142:143], v37 offset:512
  ds_read_b128 v[108:111], v30 offset:18432
  s_waitcnt lgkmcnt(0)
  v_mfma_f32_16x16x32_bf16 v[168:171], v[120:123], v[104:107], 0
  ds_read_b128 v[112:115], v31 offset:16384
  ds_read_b64_tr_b16 v[144:145], v32 offset:40960
  v_mfma_f32_16x16x32_bf16 v[172:175], v[124:127], v[104:107], 0
  ds_read_b64_tr_b16 v[146:147], v32 offset:41984
  v_mfma_f32_16x16x32_bf16 v[176:179], v[128:131], v[104:107], 0
  ds_read_b64_tr_b16 v[148:149], v33 offset:40960
  v_mfma_f32_16x16x32_bf16 v[180:183], v[132:135], v[104:107], 0
  ds_read_b64_tr_b16 v[150:151], v33 offset:41984
  v_mfma_f32_16x16x32_bf16 v[184:187], v[136:139], v[104:107], 0
  ds_read_b64_tr_b16 v[152:153], v34 offset:40960
  v_mfma_f32_16x16x32_bf16 v[188:191], v[140:143], v[104:107], 0
  ds_read_b64_tr_b16 v[154:155], v34 offset:41984
  v_mfma_f32_16x16x32_bf16 v[212:215], v[140:143], v[108:111], 0
  ds_read_b64_tr_b16 v[156:157], v35 offset:40960
  ds_read_b64_tr_b16 v[158:159], v35 offset:41984
  v_mfma_f32_16x16x32_bf16 v[208:211], v[136:139], v[108:111], 0
  ds_read_b64_tr_b16 v[160:161], v36 offset:4096
  v_mfma_f32_16x16x32_bf16 v[204:207], v[132:135], v[108:111], 0
  ds_read_b64_tr_b16 v[162:163], v36 offset:4608
  v_mfma_f32_16x16x32_bf16 v[200:203], v[128:131], v[108:111], 0
  ds_read_b64_tr_b16 v[164:165], v37 offset:4096
  v_mfma_f32_16x16x32_bf16 v[196:199], v[124:127], v[108:111], 0
  ds_read_b64_tr_b16 v[166:167], v37 offset:4608
  v_mfma_f32_16x16x32_bf16 v[192:195], v[120:123], v[108:111], 0
  ds_read_b128 v[116:119], v31 offset:18432
  s_waitcnt vmcnt(10) lgkmcnt(0)
  s_barrier
  v_mfma_f32_16x16x32_bf16 v[168:171], v[144:147], v[112:115], v[168:171]
  ds_read_b128 v[104:107], v30 offset:32768
  ds_read_b64_tr_b16 v[120:121], v32 offset:0
  v_mfma_f32_16x16x32_bf16 v[172:175], v[148:151], v[112:115], v[172:175]
  ds_read_b64_tr_b16 v[122:123], v32 offset:1024
  v_mfma_f32_16x16x32_bf16 v[176:179], v[152:155], v[112:115], v[176:179]
  ds_read_b64_tr_b16 v[124:125], v33 offset:0
  s_add_u32 m0, s32, 16384
  s_nop 0
  buffer_load_dwordx4 v14, s[12:15], s93 offen lds
  v_mfma_f32_16x16x32_bf16 v[180:183], v[156:159], v[112:115], v[180:183]
  ds_read_b64_tr_b16 v[126:127], v33 offset:1024
  v_mfma_f32_16x16x32_bf16 v[184:187], v[160:163], v[112:115], v[184:187]
  ds_read_b64_tr_b16 v[128:129], v34 offset:0
  v_mfma_f32_16x16x32_bf16 v[188:191], v[164:167], v[112:115], v[188:191]
  ds_read_b64_tr_b16 v[130:131], v34 offset:1024
  v_mfma_f32_16x16x32_bf16 v[212:215], v[164:167], v[116:119], v[212:215]
  ds_read_b64_tr_b16 v[132:133], v35 offset:0
  ds_read_b64_tr_b16 v[134:135], v35 offset:1024
  buffer_load_dwordx4 v15, s[12:15], s93 offen offset:1024 lds
  s_add_u32 s93, s93, 128
  v_mfma_f32_16x16x32_bf16 v[208:211], v[160:163], v[116:119], v[208:211]
  ds_read_b64_tr_b16 v[136:137], v36 offset:8192
  v_mfma_f32_16x16x32_bf16 v[204:207], v[156:159], v[116:119], v[204:207]
  ds_read_b64_tr_b16 v[138:139], v36 offset:8704
  v_mfma_f32_16x16x32_bf16 v[200:203], v[152:155], v[116:119], v[200:203]
  ds_read_b64_tr_b16 v[140:141], v37 offset:8192
  v_mfma_f32_16x16x32_bf16 v[196:199], v[148:151], v[116:119], v[196:199]
  ds_read_b64_tr_b16 v[142:143], v37 offset:8704
  s_add_u32 m0, s94, 32768
  s_nop 0
  buffer_load_dwordx4 v16, s[20:23], s95 offen lds
  v_mfma_f32_16x16x32_bf16 v[192:195], v[144:147], v[116:119], v[192:195]
  ds_read_b128 v[108:111], v30 offset:34816
  s_waitcnt lgkmcnt(0)
  v_mfma_f32_16x16x32_bf16 v[168:171], v[120:123], v[104:107], v[168:171]
  ds_read_b128 v[112:115], v31 offset:32768
  ds_read_b64_tr_b16 v[144:145], v32 offset:8192
  v_mfma_f32_16x16x32_bf16 v[172:175], v[124:127], v[104:107], v[172:175]
  ds_read_b64_tr_b16 v[146:147], v32 offset:9216
  v_mfma_f32_16x16x32_bf16 v[176:179], v[128:131], v[104:107], v[176:179]
  ds_read_b64_tr_b16 v[148:149], v33 offset:8192
  v_mfma_f32_16x16x32_bf16 v[180:183], v[132:135], v[104:107], v[180:183]
  ds_read_b64_tr_b16 v[150:151], v33 offset:9216
  buffer_load_dwordx4 v17, s[20:23], s95 offen offset:1024 lds
  s_add_u32 s95, s95, 458752
  v_mfma_f32_16x16x32_bf16 v[184:187], v[136:139], v[104:107], v[184:187]
  ds_read_b64_tr_b16 v[152:153], v34 offset:8192
  v_mfma_f32_16x16x32_bf16 v[188:191], v[140:143], v[104:107], v[188:191]
  ds_read_b64_tr_b16 v[154:155], v34 offset:9216
  v_mfma_f32_16x16x32_bf16 v[212:215], v[140:143], v[108:111], v[212:215]
  ds_read_b64_tr_b16 v[156:157], v35 offset:8192
  ds_read_b64_tr_b16 v[158:159], v35 offset:9216
  v_mfma_f32_16x16x32_bf16 v[208:211], v[136:139], v[108:111], v[208:211]
  ds_read_b64_tr_b16 v[160:161], v36 offset:12288
  v_mfma_f32_16x16x32_bf16 v[204:207], v[132:135], v[108:111], v[204:207]
  ds_read_b64_tr_b16 v[162:163], v36 offset:12800
  v_mfma_f32_16x16x32_bf16 v[200:203], v[128:131], v[108:111], v[200:203]
  ds_read_b64_tr_b16 v[164:165], v37 offset:12288
  s_add_u32 m0, s36, 0
  s_nop 0
  buffer_load_dwordx4 v18, s[24:27], s37 offen lds
  s_add_u32 s37, s37, 393216
  v_mfma_f32_16x16x32_bf16 v[196:199], v[124:127], v[108:111], v[196:199]
  ds_read_b64_tr_b16 v[166:167], v37 offset:12800
  v_mfma_f32_16x16x32_bf16 v[192:195], v[120:123], v[108:111], v[192:195]
  ds_read_b128 v[116:119], v31 offset:34816
  s_waitcnt vmcnt(10) lgkmcnt(0)
  s_barrier
  s_cmp_lg_u32 s74, 1
  s_cbranch_scc1 nz2_9
  s_sub_u32 s75, s3, 2
  s_cmp_ge_u32 s75, 2
  s_cbranch_scc1 ow_10
  s_sub_u32 s4, s3, 2
  s_lshl_b32 s4, s4, 6
  v_add_u32 v11, s4, v1
  v_lshlrev_b32 v11, 3, v11
  s_add_u32 s5, s85, 4096
  buffer_load_dwordx2 v[216:217], v11, s[8:11], s85 offen offset:0 sc1
  buffer_load_dwordx2 v[218:219], v11, s[8:11], s85 offen offset:1024 sc1
  buffer_load_dwordx2 v[220:221], v11, s[8:11], s85 offen offset:2048 sc1
  buffer_load_dwordx2 v[222:223], v11, s[8:11], s85 offen offset:3072 sc1
  buffer_load_dwordx2 v[224:225], v11, s[8:11], s5 offen offset:0 sc1
  buffer_load_dwordx2 v[226:227], v11, s[8:11], s5 offen offset:1024 sc1
  buffer_load_dwordx2 v[228:229], v11, s[8:11], s5 offen offset:2048 sc1
ow_10:
nz2_9:
  v_mfma_f32_16x16x32_bf16 v[168:171], v[144:147], v[112:115], v[168:171]
  ds_read_b128 v[104:107], v30 offset:0
  ds_read_b64_tr_b16 v[120:121], v32 offset:16384
  v_mfma_f32_16x16x32_bf16 v[172:175], v[148:151], v[112:115], v[172:175]
  ds_read_b64_tr_b16 v[122:123], v32 offset:17408
  v_mfma_f32_16x16x32_bf16 v[176:179], v[152:155], v[112:115], v[176:179]
  ds_read_b64_tr_b16 v[124:125], v33 offset:16384
  s_add_u32 m0, s32, 32768
  s_nop 0
  buffer_load_dwordx4 v14, s[12:15], s93 offen lds
  v_mfma_f32_16x16x32_bf16 v[180:183], v[156:159], v[112:115], v[180:183]
  ds_read_b64_tr_b16 v[126:127], v33 offset:17408
  v_mfma_f32_16x16x32_bf16 v[184:187], v[160:163], v[112:115], v[184:187]
  ds_read_b64_tr_b16 v[128:129], v34 offset:16384
  v_mfma_f32_16x16x32_bf16 v[188:191], v[164:167], v[112:115], v[188:191]
  ds_read_b64_tr_b16 v[130:131], v34 offset:17408
  v_mfma_f32_16x16x32_bf16 v[212:215], v[164:167], v[116:119], v[212:215]
  ds_read_b64_tr_b16 v[132:133], v35 offset:16384
  ds_read_b64_tr_b16 v[134:135], v35 offset:17408
  buffer_load_dwordx4 v15, s[12:15], s93 offen offset:1024 lds
  s_add_u32 s93, s93, 128
  v_mfma_f32_16x16x32_bf16 v[208:211], v[160:163], v[116:119], v[208:211]
  ds_read_b64_tr_b16 v[136:137], v36 offset:16384
  v_mfma_f32_16x16x32_bf16 v[204:207], v[156:159], v[116:119], v[204:207]
  ds_read_b64_tr_b16 v[138:139], v36 offset:16896
  v_mfma_f32_16x16x32_bf16 v[200:203], v[152:155], v[116:119], v[200:203]
  ds_read_b64_tr_b16 v[140:141], v37 offset:16384
  v_mfma_f32_16x16x32_bf16 v[196:199], v[148:151], v[116:119], v[196:199]
  ds_read_b64_tr_b16 v[142:143], v37 offset:16896
  s_add_u32 m0, s94, 0
  s_nop 0
  buffer_load_dwordx4 v16, s[20:23], s95 offen lds
  v_mfma_f32_16x16x32_bf16 v[192:195], v[144:147], v[116:119], v[192:195]
  ds_read_b128 v[108:111], v30 offset:2048
  s_waitcnt lgkmcnt(0)
  v_mfma_f32_16x16x32_bf16 v[168:171], v[120:123], v[104:107], v[168:171]
  ds_read_b128 v[112:115], v31 offset:0
  ds_read_b64_tr_b16 v[144:145], v32 offset:24576
  v_mfma_f32_16x16x32_bf16 v[172:175], v[124:127], v[104:107], v[172:175]
  ds_read_b64_tr_b16 v[146:147], v32 offset:25600
  v_mfma_f32_16x16x32_bf16 v[176:179], v[128:131], v[104:107], v[176:179]
  ds_read_b64_tr_b16 v[148:149], v33 offset:24576
  v_mfma_f32_16x16x32_bf16 v[180:183], v[132:135], v[104:107], v[180:183]
  ds_read_b64_tr_b16 v[150:151], v33 offset:25600
  buffer_load_dwordx4 v17, s[20:23], s95 offen offset:1024 lds
  s_add_u32 s95, s95, 458752
  v_mfma_f32_16x16x32_bf16 v[184:187], v[136:139], v[104:107], v[184:187]
  ds_read_b64_tr_b16 v[152:153], v34 offset:24576
  v_mfma_f32_16x16x32_bf16 v[188:191], v[140:143], v[104:107], v[188:191]
  ds_read_b64_tr_b16 v[154:155], v34 offset:25600
  v_mfma_f32_16x16x32_bf16 v[212:215], v[140:143], v[108:111], v[212:215]
  ds_read_b64_tr_b16 v[156:157], v35 offset:24576
  ds_read_b64_tr_b16 v[158:159], v35 offset:25600
  v_mfma_f32_16x16x32_bf16 v[208:211], v[136:139], v[108:111], v[208:211]
  ds_read_b64_tr_b16 v[160:161], v36 offset:20480
  v_mfma_f32_16x16x32_bf16 v[204:207], v[132:135], v[108:111], v[204:207]
  ds_read_b64_tr_b16 v[162:163], v36 offset:20992
  v_mfma_f32_16x16x32_bf16 v[200:203], v[128:131], v[108:111], v[200:203]
  ds_read_b64_tr_b16 v[164:165], v37 offset:20480
  s_add_u32 m0, s36, 8192
  s_nop 0
  buffer_load_dwordx4 v18, s[24:27], s37 offen lds
  s_add_u32 s37, s37, 393216
  v_mfma_f32_16x16x32_bf16 v[196:199], v[124:127], v[108:111], v[196:199]
  ds_read_b64_tr_b16 v[166:167], v37 offset:20992
  v_mfma_f32_16x16x32_bf16 v[192:195], v[120:123], v[108:111], v[192:195]
  ds_read_b128 v[116:119], v31 offset:2048
  s_waitcnt vmcnt(5) lgkmcnt(0)
  s_barrier
  v_mfma_f32_16x16x32_bf16 v[168:171], v[144:147], v[112:115], v[168:171]
  ds_read_b128 v[104:107], v30 offset:16384
  ds_read_b64_tr_b16 v[120:121], v32 offset:32768
  v_mfma_f32_16x16x32_bf16 v[172:175], v[148:151], v[112:115], v[172:175]
  ds_read_b64_tr_b16 v[122:123], v32 offset:33792
  v_mfma_f32_16x16x32_bf16 v[176:179], v[152:155], v[112:115], v[176:179]
  ds_read_b64_tr_b16 v[124:125], v33 offset:32768
  s_add_u32 m0, s32, 0
  s_nop 0
  buffer_load_dwordx4 v14, s[12:15], s93 offen lds
  v_mfma_f32_16x16x32_bf16 v[180:183], v[156:159], v[112:115], v[180:183]
  ds_read_b64_tr_b16 v[126:127], v33 offset:33792
  v_mfma_f32_16x16x32_bf16 v[184:187], v[160:163], v[112:115], v[184:187]
  ds_read_b64_tr_b16 v[128:129], v34 offset:32768
  v_mfma_f32_16x16x32_bf16 v[188:191], v[164:167], v[112:115], v[188:191]
  ds_read_b64_tr_b16 v[130:131], v34 offset:33792
  v_mfma_f32_16x16x32_bf16 v[212:215], v[164:167], v[116:119], v[212:215]
  ds_read_b64_tr_b16 v[132:133], v35 offset:32768
  ds_read_b64_tr_b16 v[134:135], v35 offset:33792
  buffer_load_dwordx4 v15, s[12:15], s93 offen offset:1024 lds
  s_add_u32 s93, s93, 128
  v_mfma_f32_16x16x32_bf16 v[208:211], v[160:163], v[116:119], v[208:211]
  ds_read_b64_tr_b16 v[136:137], v36 offset:0
  v_mfma_f32_16x16x32_bf16 v[204:207], v[156:159], v[116:119], v[204:207]
  ds_read_b64_tr_b16 v[138:139], v36 offset:512
  v_mfma_f32_16x16x32_bf16 v[200:203], v[152:155], v[116:119], v[200:203]
  ds_read_b64_tr_b16 v[140:141], v37 offset:0
  v_mfma_f32_16x16x32_bf16 v[196:199], v[148:151], v[116:119], v[196:199]
  ds_read_b64_tr_b16 v[142:143], v37 offset:512
  s_add_u32 m0, s94, 16384
  s_nop 0
  buffer_load_dwordx4 v16, s[20:23], s95 offen lds
  v_mfma_f32_16x16x32_bf16 v[192:195], v[144:147], v[116:119], v[192:195]
  ds_read_b128 v[108:111], v30 offset:18432
  s_waitcnt lgkmcnt(0)
  v_mfma_f32_16x16x32_bf16 v[168:171], v[120:123], v[104:107], v[168:171]
  ds_read_b128 v[112:115], v31 offset:16384
  ds_read_b64_tr_b16 v[144:145], v32 offset:40960
  v_mfma_f32_16x16x32_bf16 v[172:175], v[124:127], v[104:107], v[172:175]
  ds_read_b64_tr_b16 v[146:147], v32 offset:41984
  v_mfma_f32_16x16x32_bf16 v[176:179], v[128:131], v[104:107], v[176:179]
  ds_read_b64_tr_b16 v[148:149], v33 offset:40960
  v_mfma_f32_16x16x32_bf16 v[180:183], v[132:135], v[104:107], v[180:183]
  ds_read_b64_tr_b16 v[150:151], v33 offset:41984
  buffer_load_dwordx4 v17, s[20:23], s95 offen offset:1024 lds
  s_add_u32 s95, s95, 458752
  v_mfma_f32_16x16x32_bf16 v[184:187], v[136:139], v[104:107], v[184:187]
  ds_read_b64_tr_b16 v[152:153], v34 offset:40960
  v_mfma_f32_16x16x32_bf16 v[188:191], v[140:143], v[104:107], v[188:191]
  ds_read_b64_tr_b16 v[154:155], v34 offset:41984
  v_mfma_f32_16x16x32_bf16 v[212:215], v[140:143], v[108:111], v[212:215]
  ds_read_b64_tr_b16 v[156:157], v35 offset:40960
  ds_read_b64_tr_b16 v[158:159], v35 offset:41984
  v_mfma_f32_16x16x32_bf16 v[208:211], v[136:139], v[108:111], v[208:211]
  ds_read_b64_tr_b16 v[160:161], v36 offset:4096
  v_mfma_f32_16x16x32_bf16 v[204:207], v[132:135], v[108:111], v[204:207]
  ds_read_b64_tr_b16 v[162:163], v36 offset:4608
  v_mfma_f32_16x16x32_bf16 v[200:203], v[128:131], v[108:111], v[200:203]
  ds_read_b64_tr_b16 v[164:165], v37 offset:4096
  s_add_u32 m0, s36, 16384
  s_nop 0
  buffer_load_dwordx4 v18, s[24:27], s37 offen lds
  s_add_u32 s37, s37, 393216
  v_mfma_f32_16x16x32_bf16 v[196:199], v[124:127], v[108:111], v[196:199]
  ds_read_b64_tr_b16 v[166:167], v37 offset:4608
  v_mfma_f32_16x16x32_bf16 v[192:195], v[120:123], v[108:111], v[192:195]
  ds_read_b128 v[116:119], v31 offset:18432
  s_cmp_lg_u32 s74, 1
  s_cbranch_scc1 nz2_11
  s_sub_u32 s75, s3, 2
  s_cmp_ge_u32 s75, 2
  s_cbranch_scc1 ow_12
  s_waitcnt vmcnt(10)
  v_and_b32 v4, v217, v219
  v_and_b32 v4, v4, v221
  v_and_b32 v4, v4, v223
  v_and_b32 v4, v4, v225
  v_and_b32 v4, v4, v227
  v_and_b32 v4, v4, v229
  v_cmp_gt_i32 vcc, 0, v4
  s_nop 0
  s_cmp_eq_u64 vcc, -1
  s_cbranch_scc1 lnok_13
  s_mov_b32 s75, 400000
lnsp_14:
  s_sub_u32 s4, s3, 2
  s_lshl_b32 s4, s4, 6
  v_add_u32 v11, s4, v1
  v_lshlrev_b32 v11, 3, v11
  s_add_u32 s5, s85, 4096
  buffer_load_dwordx2 v[216:217], v11, s[8:11], s85 offen offset:0 sc1
  buffer_load_dwordx2 v[218:219], v11, s[8:11], s85 offen offset:1024 sc1
  buffer_load_dwordx2 v[220:221], v11, s[8:11], s85 offen offset:2048 sc1
  buffer_load_dwordx2 v[222:223], v11, s[8:11], s85 offen offset:3072 sc1
  buffer_load_dwordx2 v[224:225], v11, s[8:11], s5 offen offset:0 sc1
  buffer_load_dwordx2 v[226:227], v11, s[8:11], s5 offen offset:1024 sc1
  buffer_load_dwordx2 v[228:229], v11, s[8:11], s5 offen offset:2048 sc1
  s_waitcnt vmcnt(0)
  v_and_b32 v4, v217, v219
  v_and_b32 v4, v4, v221
  v_and_b32 v4, v4, v223
  v_and_b32 v4, v4, v225
  v_and_b32 v4, v4, v227
  v_and_b32 v4, v4, v229
  v_cmp_gt_i32 vcc, 0, v4
  s_nop 0
  s_cmp_eq_u64 vcc, -1
  s_cbranch_scc1 lnok_13
  s_sub_u32 s75, s75, 1
  s_cmp_lg_u32 s75, 0
  s_cbranch_scc1 lnsp_14
lnok_13:
  v_and_b32 v217, 0x7fffffff, v217
  v_and_b32 v219, 0x7fffffff, v219
  v_and_b32 v221, 0x7fffffff, v221
  v_and_b32 v223, 0x7fffffff, v223
  v_and_b32 v225, 0x7fffffff, v225
  v_and_b32 v227, 0x7fffffff, v227
  v_and_b32 v229, 0x7fffffff, v229
  v_pk_add_f32 v[216:217], v[216:217], v[218:219]
  v_pk_add_f32 v[216:217], v[216:217], v[220:221]
  v_pk_add_f32 v[216:217], v[216:217], v[222:223]
  v_pk_add_f32 v[216:217], v[216:217], v[224:225]
  v_pk_add_f32 v[216:217], v[216:217], v[226:227]
  v_pk_add_f32 v[216:217], v[216:217], v[228:229]
  v_mul_f32 v4, 0x3a124925, v216
  v_mul_f32 v5, 0x3a124925, v217
  v_fma_f32 v5, -v4, v4, v5
  v_max_f32 v5, 0, v5
  v_add_f32 v5, 0x3727c5ac, v5
  v_rsq_f32 v216, v5
  s_nop 0
  v_mul_f32 v217, v4, v216
  v_add_u32 v3, 151552, v11
  ds_write_b64 v3, v[216:217]
ow_12:
nz2_11:
  s_waitcnt vmcnt(5) lgkmcnt(0)
  s_barrier
  s_cmp_eq_u32 s74, 1
  s_cbranch_scc1 pe_15
  s_cmp_lg_u32 s3, 0
  s_cbranch_scc1 ow_16
  v_cmp_le_u32 vcc, 16, v12
  s_cbranch_vccnz rk_17
  s_mov_b32 s28, s70
  s_and_b32 s29, s71, 0xffff
  s_mov_b32 s30, 256
  s_mov_b32 s31, 0x20000
  s_mov_b32 s75, 400000
rsp_19:
  s_sleep 1
  v_mov_b32 v9, 0
  buffer_load_dword v12, v9, s[28:31], 0 offen sc1
  s_waitcnt vmcnt(0)
  v_cmp_le_u32 vcc, 16, v12
  s_cbranch_vccnz rok_18
  s_sub_u32 s75, s75, 1
  s_cmp_lg_u32 s75, 0
  s_cbranch_scc1 rsp_19
rok_18:
rk_17:
ow_16:
  s_cmp_lg_u32 s3, 0
  s_cbranch_scc1 ow_20
  v_mov_b32 v8, 1
  v_mov_b32 v9, 0
  s_mov_b64 exec, 1
  buffer_store_dword v8, v9, s[8:11], s76 offen sc1
  s_mov_b64 exec, -1
ow_20:
pe_15:
  s_lshl_b32 s4, s44, 9
  s_add_u32 s4, s4, 151552
  v_and_b32 v11, 15, v1
  v_lshl_add_u32 v11, v11, 3, s4
  ds_read_b64 v[2:3], v11 offset:0
  ds_read_b64 v[4:5], v11 offset:128
  ds_read_b64 v[6:7], v11 offset:256
  ds_read_b64 v[8:9], v11 offset:384
  v_mfma_f32_16x16x32_bf16 v[168:171], v[144:147], v[112:115], v[168:171]
  ds_read_b128 v[104:107], v30 offset:32768
  ds_read_b64_tr_b16 v[120:121], v32 offset:0
  v_mfma_f32_16x16x32_bf16 v[172:175], v[148:151], v[112:115], v[172:175]
  ds_read_b64_tr_b16 v[122:123], v32 offset:1024
  v_mfma_f32_16x16x32_bf16 v[176:179], v[152:155], v[112:115], v[176:179]
  ds_read_b64_tr_b16 v[124:125], v33 offset:0
  s_add_u32 m0, s32, 16384
  s_nop 0
  buffer_load_dwordx4 v14, s[12:15], s93 offen lds
  v_mfma_f32_16x16x32_bf16 v[180:183], v[156:159], v[112:115], v[180:183]
  ds_read_b64_tr_b16 v[126:127], v33 offset:1024
  v_mfma_f32_16x16x32_bf16 v[184:187], v[160:163], v[112:115], v[184:187]
  ds_read_b64_tr_b16 v[128:129], v34 offset:0
  v_mfma_f32_16x16x32_bf16 v[188:191], v[164:167], v[112:115], v[188:191]
  ds_read_b64_tr_b16 v[130:131], v34 offset:1024
  v_mfma_f32_16x16x32_bf16 v[212:215], v[164:167], v[116:119], v[212:215]
  ds_read_b64_tr_b16 v[132:133], v35 offset:0
  ds_read_b64_tr_b16 v[134:135], v35 offset:1024
  buffer_load_dwordx4 v15, s[12:15], s93 offen offset:1024 lds
  s_add_u32 s93, s93, 128
  v_mfma_f32_16x16x32_bf16 v[208:211], v[160:163], v[116:119], v[208:211]
  ds_read_b64_tr_b16 v[136:137], v36 offset:8192
  v_mfma_f32_16x16x32_bf16 v[204:207], v[156:159], v[116:119], v[204:207]
  ds_read_b64_tr_b16 v[138:139], v36 offset:8704
  v_mfma_f32_16x16x32_bf16 v[200:203], v[152:155], v[116:119], v[200:203]
  ds_read_b64_tr_b16 v[140:141], v37 offset:8192
  v_mfma_f32_16x16x32_bf16 v[196:199], v[148:151], v[116:119], v[196:199]
  ds_read_b64_tr_b16 v[142:143], v37 offset:8704
  s_add_u32 m0, s94, 32768
  s_nop 0
  buffer_load_dwordx4 v16, s[20:23], s95 offen lds
  v_mfma_f32_16x16x32_bf16 v[192:195], v[144:147], v[116:119], v[192:195]
  ds_read_b128 v[108:111], v30 offset:34816
  s_waitcnt lgkmcnt(0)
  v_mfma_f32_16x16x32_bf16 v[168:171], v[120:123], v[104:107], v[168:171]
  ds_read_b128 v[112:115], v31 offset:32768
  ds_read_b64_tr_b16 v[144:145], v32 offset:8192
  v_fma_f32 v40, v40, v2, -v3
  v_fma_f32 v41, v41, v2, -v3
  v_mfma_f32_16x16x32_bf16 v[172:175], v[124:127], v[104:107], v[172:175]
  ds_read_b64_tr_b16 v[146:147], v32 offset:9216
  v_fma_f32 v42, v42, v2, -v3
  v_fma_f32 v43, v43, v2, -v3
  v_mfma_f32_16x16x32_bf16 v[176:179], v[128:131], v[104:107], v[176:179]
  ds_read_b64_tr_b16 v[148:149], v33 offset:8192
  v_fma_f32 v44, v44, v2, -v3
  v_mfma_f32_16x16x32_bf16 v[180:183], v[132:135], v[104:107], v[180:183]
  ds_read_b64_tr_b16 v[150:151], v33 offset:9216
  buffer_load_dwordx4 v17, s[20:23], s95 offen offset:1024 lds
  s_add_u32 s95, s95, 458752
  v_fma_f32 v45, v45, v2, -v3
  v_fma_f32 v46, v46, v2, -v3
  v_mfma_f32_16x16x32_bf16 v[184:187], v[136:139], v[104:107], v[184:187]
  ds_read_b64_tr_b16 v[152:153], v34 offset:8192
  v_fma_f32 v47, v47, v2, -v3
  v_fma_f32 v48, v48, v2, -v3
  v_mfma_f32_16x16x32_bf16 v[188:191], v[140:143], v[104:107], v[188:191]
  ds_read_b64_tr_b16 v[154:155], v34 offset:9216
  v_fma_f32 v49, v49, v2, -v3
  v_mfma_f32_16x16x32_bf16 v[212:215], v[140:143], v[108:111], v[212:215]
  ds_read_b64_tr_b16 v[156:157], v35 offset:8192
  ds_read_b64_tr_b16 v[158:159], v35 offset:9216
  v_fma_f32 v50, v50, v2, -v3
  v_fma_f32 v51, v51, v2, -v3
  v_mfma_f32_16x16x32_bf16 v[208:211], v[136:139], v[108:111], v[208:211]
  ds_read_b64_tr_b16 v[160:161], v36 offset:12288
  v_fma_f32 v52, v52, v2, -v3
  v_fma_f32 v53, v53, v2, -v3
  v_mfma_f32_16x16x32_bf16 v[204:207], v[132:135], v[108:111], v[204:207]
  ds_read_b64_tr_b16 v[162:163], v36 offset:12800
  v_fma_f32 v54, v54, v2, -v3
  v_mfma_f32_16x16x32_bf16 v[200:203], v[128:131], v[108:111], v[200:203]
  ds_read_b64_tr_b16 v[164:165], v37 offset:12288
  s_add_u32 m0, s36, 0
  s_nop 0
  buffer_load_dwordx4 v18, s[24:27], s37 offen lds
  s_add_u32 s37, s37, 393216
  v_fma_f32 v55, v55, v2, -v3
  v_cvt_pk_bf16_f32 v216, v40, v41
  v_mfma_f32_16x16x32_bf16 v[196:199], v[124:127], v[108:111], v[196:199]
  ds_read_b64_tr_b16 v[166:167], v37 offset:12800
  v_cvt_pk_bf16_f32 v217, v42, v43
  v_cvt_pk_bf16_f32 v218, v44, v45
  v_mfma_f32_16x16x32_bf16 v[192:195], v[120:123], v[108:111], v[192:195]
  ds_read_b128 v[116:119], v31 offset:34816
  v_cvt_pk_bf16_f32 v219, v46, v47
  s_waitcnt vmcnt(5) lgkmcnt(0)
  s_barrier
  v_mfma_f32_16x16x32_bf16 v[168:171], v[144:147], v[112:115], v[168:171]
  ds_read_b128 v[104:107], v30 offset:0
  ds_read_b64_tr_b16 v[120:121], v32 offset:16384
  v_cvt_pk_bf16_f32 v220, v48, v49
  v_cvt_pk_bf16_f32 v221, v50, v51
  v_mfma_f32_16x16x32_bf16 v[172:175], v[148:151], v[112:115], v[172:175]
  ds_read_b64_tr_b16 v[122:123], v32 offset:17408
  v_cvt_pk_bf16_f32 v222, v52, v53
  v_cvt_pk_bf16_f32 v223, v54, v55
  v_mfma_f32_16x16x32_bf16 v[176:179], v[152:155], v[112:115], v[176:179]
  ds_read_b64_tr_b16 v[124:125], v33 offset:16384
  s_add_u32 m0, s32, 32768
  s_nop 0
  buffer_load_dwordx4 v14, s[12:15], s93 offen lds
  v_permlane16_swap_b32 v216, v218
  v_mfma_f32_16x16x32_bf16 v[180:183], v[156:159], v[112:115], v[180:183]
  ds_read_b64_tr_b16 v[126:127], v33 offset:17408
  v_permlane16_swap_b32 v217, v219
  v_permlane16_swap_b32 v220, v222
  v_mfma_f32_16x16x32_bf16 v[184:187], v[160:163], v[112:115], v[184:187]
  ds_read_b64_tr_b16 v[128:129], v34 offset:16384
  v_permlane16_swap_b32 v221, v223
  buffer_store_dwordx4 v[216:219], v248, s[8:11], 0 offen sc1
  v_mfma_f32_16x16x32_bf16 v[188:191], v[164:167], v[112:115], v[188:191]
  ds_read_b64_tr_b16 v[130:131], v34 offset:17408
  buffer_store_dwordx4 v[220:223], v249, s[8:11], 0 offen sc1
  v_mfma_f32_16x16x32_bf16 v[212:215], v[164:167], v[116:119], v[212:215]
  ds_read_b64_tr_b16 v[132:133], v35 offset:16384
  ds_read_b64_tr_b16 v[134:135], v35 offset:17408
  buffer_load_dwordx4 v15, s[12:15], s93 offen offset:1024 lds
  s_add_u32 s93, s93, 128
  v_fma_f32 v56, v56, v4, -v5
  v_fma_f32 v57, v57, v4, -v5
  v_mfma_f32_16x16x32_bf16 v[208:211], v[160:163], v[116:119], v[208:211]
  ds_read_b64_tr_b16 v[136:137], v36 offset:16384
  v_fma_f32 v58, v58, v4, -v5
  v_fma_f32 v59, v59, v4, -v5
  v_mfma_f32_16x16x32_bf16 v[204:207], v[156:159], v[116:119], v[204:207]
  ds_read_b64_tr_b16 v[138:139], v36 offset:16896
  v_fma_f32 v60, v60, v4, -v5
  v_mfma_f32_16x16x32_bf16 v[200:203], v[152:155], v[116:119], v[200:203]
  ds_read_b64_tr_b16 v[140:141], v37 offset:16384
  v_fma_f32 v61, v61, v4, -v5
  v_fma_f32 v62, v62, v4, -v5
  v_mfma_f32_16x16x32_bf16 v[196:199], v[148:151], v[116:119], v[196:199]
  ds_read_b64_tr_b16 v[142:143], v37 offset:16896
  s_add_u32 m0, s94, 0
  s_nop 0
  buffer_load_dwordx4 v16, s[20:23], s95 offen lds
  v_fma_f32 v63, v63, v4, -v5
  v_fma_f32 v64, v64, v4, -v5
  v_mfma_f32_16x16x32_bf16 v[192:195], v[144:147], v[116:119], v[192:195]
  ds_read_b128 v[108:111], v30 offset:2048
  v_fma_f32 v65, v65, v4, -v5
  s_waitcnt lgkmcnt(0)
  v_mfma_f32_16x16x32_bf16 v[168:171], v[120:123], v[104:107], v[168:171]
  ds_read_b128 v[112:115], v31 offset:0
  ds_read_b64_tr_b16 v[144:145], v32 offset:24576
  v_fma_f32 v66, v66, v4, -v5
  v_fma_f32 v67, v67, v4, -v5
  v_mfma_f32_16x16x32_bf16 v[172:175], v[124:127], v[104:107], v[172:175]
  ds_read_b64_tr_b16 v[146:147], v32 offset:25600
  v_fma_f32 v68, v68, v4, -v5
  v_fma_f32 v69, v69, v4, -v5
  v_mfma_f32_16x16x32_bf16 v[176:179], v[128:131], v[104:107], v[176:179]
  ds_read_b64_tr_b16 v[148:149], v33 offset:24576
  v_fma_f32 v70, v70, v4, -v5
  v_mfma_f32_16x16x32_bf16 v[180:183], v[132:135], v[104:107], v[180:183]
  ds_read_b64_tr_b16 v[150:151], v33 offset:25600
  buffer_load_dwordx4 v17, s[20:23], s95 offen offset:1024 lds
  s_add_u32 s95, s95, 458752
  v_fma_f32 v71, v71, v4, -v5
  v_cvt_pk_bf16_f32 v224, v56, v57
  v_mfma_f32_16x16x32_bf16 v[184:187], v[136:139], v[104:107], v[184:187]
  ds_read_b64_tr_b16 v[152:153], v34 offset:24576
  v_cvt_pk_bf16_f32 v225, v58, v59
  v_cvt_pk_bf16_f32 v226, v60, v61
  v_mfma_f32_16x16x32_bf16 v[188:191], v[140:143], v[104:107], v[188:191]
  ds_read_b64_tr_b16 v[154:155], v34 offset:25600
  v_cvt_pk_bf16_f32 v227, v62, v63
  v_mfma_f32_16x16x32_bf16 v[212:215], v[140:143], v[108:111], v[212:215]
  ds_read_b64_tr_b16 v[156:157], v35 offset:24576
  ds_read_b64_tr_b16 v[158:159], v35 offset:25600
  v_cvt_pk_bf16_f32 v228, v64, v65
  v_cvt_pk_bf16_f32 v229, v66, v67
  v_mfma_f32_16x16x32_bf16 v[208:211], v[136:139], v[108:111], v[208:211]
  ds_read_b64_tr_b16 v[160:161], v36 offset:20480
  v_cvt_pk_bf16_f32 v230, v68, v69
  v_cvt_pk_bf16_f32 v231, v70, v71
  v_mfma_f32_16x16x32_bf16 v[204:207], v[132:135], v[108:111], v[204:207]
  ds_read_b64_tr_b16 v[162:163], v36 offset:20992
  v_permlane16_swap_b32 v224, v226
  v_mfma_f32_16x16x32_bf16 v[200:203], v[128:131], v[108:111], v[200:203]
  ds_read_b64_tr_b16 v[164:165], v37 offset:20480
  s_add_u32 m0, s36, 8192
  s_nop 0
  buffer_load_dwordx4 v18, s[24:27], s37 offen lds
  s_add_u32 s37, s37, 393216
  v_permlane16_swap_b32 v225, v227
  v_permlane16_swap_b32 v228, v230
  v_mfma_f32_16x16x32_bf16 v[196:199], v[124:127], v[108:111], v[196:199]
  ds_read_b64_tr_b16 v[166:167], v37 offset:20992
  v_permlane16_swap_b32 v229, v231
  buffer_store_dwordx4 v[224:227], v250, s[8:11], 0 offen sc1
  v_mfma_f32_16x16x32_bf16 v[192:195], v[120:123], v[108:111], v[192:195]
  ds_read_b128 v[116:119], v31 offset:2048
  buffer_store_dwordx4 v[228:231], v251, s[8:11], 0 offen sc1
  s_waitcnt vmcnt(9) lgkmcnt(0)
  s_barrier
  v_mfma_f32_16x16x32_bf16 v[168:171], v[144:147], v[112:115], v[168:171]
  ds_read_b128 v[104:107], v30 offset:16384
  ds_read_b64_tr_b16 v[120:121], v32 offset:32768
  v_fma_f32 v72, v72, v6, -v7
  v_fma_f32 v73, v73, v6, -v7
  v_mfma_f32_16x16x32_bf16 v[172:175], v[148:151], v[112:115], v[172:175]
  ds_read_b64_tr_b16 v[122:123], v32 offset:33792
  v_fma_f32 v74, v74, v6, -v7
  v_fma_f32 v75, v75, v6, -v7
  v_mfma_f32_16x16x32_bf16 v[176:179], v[152:155], v[112:115], v[176:179]
  ds_read_b64_tr_b16 v[124:125], v33 offset:32768
  s_add_u32 m0, s32, 0
  s_nop 0
  buffer_load_dwordx4 v14, s[12:15], s93 offen lds
  v_fma_f32 v76, v76, v6, -v7
  v_mfma_f32_16x16x32_bf16 v[180:183], v[156:159], v[112:115], v[180:183]
  ds_read_b64_tr_b16 v[126:127], v33 offset:33792
  v_fma_f32 v77, v77, v6, -v7
  v_fma_f32 v78, v78, v6, -v7
  v_mfma_f32_16x16x32_bf16 v[184:187], v[160:163], v[112:115], v[184:187]
  ds_read_b64_tr_b16 v[128:129], v34 offset:32768
  v_fma_f32 v79, v79, v6, -v7
  v_fma_f32 v80, v80, v6, -v7
  v_mfma_f32_16x16x32_bf16 v[188:191], v[164:167], v[112:115], v[188:191]
  ds_read_b64_tr_b16 v[130:131], v34 offset:33792
  v_fma_f32 v81, v81, v6, -v7
  v_mfma_f32_16x16x32_bf16 v[212:215], v[164:167], v[116:119], v[212:215]
  ds_read_b64_tr_b16 v[132:133], v35 offset:32768
  ds_read_b64_tr_b16 v[134:135], v35 offset:33792
  buffer_load_dwordx4 v15, s[12:15], s93 offen offset:1024 lds
  s_add_u32 s93, s93, 128
  v_fma_f32 v82, v82, v6, -v7
  v_fma_f32 v83, v83, v6, -v7
  v_mfma_f32_16x16x32_bf16 v[208:211], v[160:163], v[116:119], v[208:211]
  ds_read_b64_tr_b16 v[136:137], v36 offset:0
  v_fma_f32 v84, v84, v6, -v7
  v_fma_f32 v85, v85, v6, -v7
  v_mfma_f32_16x16x32_bf16 v[204:207], v[156:159], v[116:119], v[204:207]
  ds_read_b64_tr_b16 v[138:139], v36 offset:512
  v_fma_f32 v86, v86, v6, -v7
  v_mfma_f32_16x16x32_bf16 v[200:203], v[152:155], v[116:119], v[200:203]
  ds_read_b64_tr_b16 v[140:141], v37 offset:0
  v_fma_f32 v87, v87, v6, -v7
  v_cvt_pk_bf16_f32 v232, v72, v73
  v_mfma_f32_16x16x32_bf16 v[196:199], v[148:151], v[116:119], v[196:199]
  ds_read_b64_tr_b16 v[142:143], v37 offset:512
  s_add_u32 m0, s94, 16384
  s_nop 0
  buffer_load_dwordx4 v16, s[20:23], s95 offen lds
  v_cvt_pk_bf16_f32 v233, v74, v75
  v_cvt_pk_bf16_f32 v234, v76, v77
  v_mfma_f32_16x16x32_bf16 v[192:195], v[144:147], v[116:119], v[192:195]
  ds_read_b128 v[108:111], v30 offset:18432
  v_cvt_pk_bf16_f32 v235, v78, v79
  s_waitcnt lgkmcnt(0)
  v_mfma_f32_16x16x32_bf16 v[168:171], v[120:123], v[104:107], v[168:171]
  ds_read_b128 v[112:115], v31 offset:16384
  ds_read_b64_tr_b16 v[144:145], v32 offset:40960
  v_cvt_pk_bf16_f32 v236, v80, v81
  v_cvt_pk_bf16_f32 v237, v82, v83
  v_mfma_f32_16x16x32_bf16 v[172:175], v[124:127], v[104:107], v[172:175]
  ds_read_b64_tr_b16 v[146:147], v32 offset:41984
  v_cvt_pk_bf16_f32 v238, v84, v85
  v_cvt_pk_bf16_f32 v239, v86, v87
  v_mfma_f32_16x16x32_bf16 v[176:179], v[128:131], v[104:107], v[176:179]
  ds_read_b64_tr_b16 v[148:149], v33 offset:40960
  v_permlane16_swap_b32 v232, v234
  v_mfma_f32_16x16x32_bf16 v[180:183], v[132:135], v[104:107], v[180:183]
  ds_read_b64_tr_b16 v[150:151], v33 offset:41984
  buffer_load_dwordx4 v17, s[20:23], s95 offen offset:1024 lds
  s_add_u32 s95, s95, 458752
  v_permlane16_swap_b32 v233, v235
  v_permlane16_swap_b32 v236, v238
  v_mfma_f32_16x16x32_bf16 v[184:187], v[136:139], v[104:107], v[184:187]
  ds_read_b64_tr_b16 v[152:153], v34 offset:40960
  v_permlane16_swap_b32 v237, v239
  buffer_store_dwordx4 v[232:235], v252, s[8:11], 0 offen sc1
  v_mfma_f32_16x16x32_bf16 v[188:191], v[140:143], v[104:107], v[188:191]
  ds_read_b64_tr_b16 v[154:155], v34 offset:41984
  buffer_store_dwordx4 v[236:239], v253, s[8:11], 0 offen sc1
  v_mfma_f32_16x16x32_bf16 v[212:215], v[140:143], v[108:111], v[212:215]
  ds_read_b64_tr_b16 v[156:157], v35 offset:40960
  ds_read_b64_tr_b16 v[158:159], v35 offset:41984
  v_fma_f32 v88, v88, v8, -v9
  v_fma_f32 v89, v89, v8, -v9
  v_mfma_f32_16x16x32_bf16 v[208:211], v[136:139], v[108:111], v[208:211]
  ds_read_b64_tr_b16 v[160:161], v36 offset:4096
  v_fma_f32 v90, v90, v8, -v9
  v_fma_f32 v91, v91, v8, -v9
  v_mfma_f32_16x16x32_bf16 v[204:207], v[132:135], v[108:111], v[204:207]
  ds_read_b64_tr_b16 v[162:163], v36 offset:4608
  v_fma_f32 v92, v92, v8, -v9
  v_mfma_f32_16x16x32_bf16 v[200:203], v[128:131], v[108:111], v[200:203]
  ds_read_b64_tr_b16 v[164:165], v37 offset:4096
  s_add_u32 m0, s36, 16384
  s_nop 0
  buffer_load_dwordx4 v18, s[24:27], s37 offen lds
  s_add_u32 s37, s37, 393216
  v_fma_f32 v93, v93, v8, -v9
  v_fma_f32 v94, v94, v8, -v9
  v_mfma_f32_16x16x32_bf16 v[196:199], v[124:127], v[108:111], v[196:199]
  ds_read_b64_tr_b16 v[166:167], v37 offset:4608
  v_fma_f32 v95, v95, v8, -v9
  v_fma_f32 v96, v96, v8, -v9
  v_mfma_f32_16x16x32_bf16 v[192:195], v[120:123], v[108:111], v[192:195]
  ds_read_b128 v[116:119], v31 offset:18432
  v_fma_f32 v97, v97, v8, -v9
  s_waitcnt vmcnt(9) lgkmcnt(0)
  s_barrier
  v_mfma_f32_16x16x32_bf16 v[168:171], v[144:147], v[112:115], v[168:171]
  ds_read_b128 v[104:107], v30 offset:32768
  ds_read_b64_tr_b16 v[120:121], v32 offset:0
  v_fma_f32 v98, v98, v8, -v9
  v_fma_f32 v99, v99, v8, -v9
  v_mfma_f32_16x16x32_bf16 v[172:175], v[148:151], v[112:115], v[172:175]
  ds_read_b64_tr_b16 v[122:123], v32 offset:1024
  v_fma_f32 v100, v100, v8, -v9
  v_fma_f32 v101, v101, v8, -v9
  v_mfma_f32_16x16x32_bf16 v[176:179], v[152:155], v[112:115], v[176:179]
  ds_read_b64_tr_b16 v[124:125], v33 offset:0
  s_add_u32 m0, s32, 16384
  s_nop 0
  buffer_load_dwordx4 v14, s[12:15], s93 offen lds
  v_fma_f32 v102, v102, v8, -v9
  v_mfma_f32_16x16x32_bf16 v[180:183], v[156:159], v[112:115], v[180:183]
  ds_read_b64_tr_b16 v[126:127], v33 offset:1024
  v_fma_f32 v103, v103, v8, -v9
  v_cvt_pk_bf16_f32 v240, v88, v89
  v_mfma_f32_16x16x32_bf16 v[184:187], v[160:163], v[112:115], v[184:187]
  ds_read_b64_tr_b16 v[128:129], v34 offset:0
  v_cvt_pk_bf16_f32 v241, v90, v91
  v_cvt_pk_bf16_f32 v242, v92, v93
  v_mfma_f32_16x16x32_bf16 v[188:191], v[164:167], v[112:115], v[188:191]
  ds_read_b64_tr_b16 v[130:131], v34 offset:1024
  v_cvt_pk_bf16_f32 v243, v94, v95
  v_mfma_f32_16x16x32_bf16 v[212:215], v[164:167], v[116:119], v[212:215]
  ds_read_b64_tr_b16 v[132:133], v35 offset:0
  ds_read_b64_tr_b16 v[134:135], v35 offset:1024
  buffer_load_dwordx4 v15, s[12:15], s93 offen offset:1024 lds
  s_add_u32 s93, s93, 128
  v_cvt_pk_bf16_f32 v244, v96, v97
  v_cvt_pk_bf16_f32 v245, v98, v99
  v_mfma_f32_16x16x32_bf16 v[208:211], v[160:163], v[116:119], v[208:211]
  ds_read_b64_tr_b16 v[136:137], v36 offset:8192
  v_cvt_pk_bf16_f32 v246, v100, v101
  v_cvt_pk_bf16_f32 v247, v102, v103
  v_mfma_f32_16x16x32_bf16 v[204:207], v[156:159], v[116:119], v[204:207]
  ds_read_b64_tr_b16 v[138:139], v36 offset:8704
  v_permlane16_swap_b32 v240, v242
  v_mfma_f32_16x16x32_bf16 v[200:203], v[152:155], v[116:119], v[200:203]
  ds_read_b64_tr_b16 v[140:141], v37 offset:8192
  v_permlane16_swap_b32 v241, v243
  v_permlane16_swap_b32 v244, v246
  v_mfma_f32_16x16x32_bf16 v[196:199], v[148:151], v[116:119], v[196:199]
  ds_read_b64_tr_b16 v[142:143], v37 offset:8704
  s_add_u32 m0, s94, 32768
  s_nop 0
  buffer_load_dwordx4 v16, s[20:23], s95 offen lds
  v_permlane16_swap_b32 v245, v247
  buffer_store_dwordx4 v[240:243], v254, s[8:11], 0 offen sc1
  v_mfma_f32_16x16x32_bf16 v[192:195], v[144:147], v[116:119], v[192:195]
  ds_read_b128 v[108:111], v30 offset:34816
  buffer_store_dwordx4 v[244:247], v255, s[8:11], 0 offen sc1
  s_waitcnt lgkmcnt(0)
  v_mfma_f32_16x16x32_bf16 v[168:171], v[120:123], v[104:107], v[168:171]
  ds_read_b128 v[112:115], v31 offset:32768
  ds_read_b64_tr_b16 v[144:145], v32 offset:8192
  v_mfma_f32_16x16x32_bf16 v[172:175], v[124:127], v[104:107], v[172:175]
  ds_read_b64_tr_b16 v[146:147], v32 offset:9216
  v_mfma_f32_16x16x32_bf16 v[176:179], v[128:131], v[104:107], v[176:179]
  ds_read_b64_tr_b16 v[148:149], v33 offset:8192
  v_mfma_f32_16x16x32_bf16 v[180:183], v[132:135], v[104:107], v[180:183]
  ds_read_b64_tr_b16 v[150:151], v33 offset:9216
  buffer_load_dwordx4 v17, s[20:23], s95 offen offset:1024 lds
  s_add_u32 s95, s95, 458752
  v_mfma_f32_16x16x32_bf16 v[184:187], v[136:139], v[104:107], v[184:187]
  ds_read_b64_tr_b16 v[152:153], v34 offset:8192
  v_mfma_f32_16x16x32_bf16 v[188:191], v[140:143], v[104:107], v[188:191]
  ds_read_b64_tr_b16 v[154:155], v34 offset:9216
  v_mfma_f32_16x16x32_bf16 v[212:215], v[140:143], v[108:111], v[212:215]
  ds_read_b64_tr_b16 v[156:157], v35 offset:8192
  ds_read_b64_tr_b16 v[158:159], v35 offset:9216
  v_mfma_f32_16x16x32_bf16 v[208:211], v[136:139], v[108:111], v[208:211]
  ds_read_b64_tr_b16 v[160:161], v36 offset:12288
  v_mfma_f32_16x16x32_bf16 v[204:207], v[132:135], v[108:111], v[204:207]
  ds_read_b64_tr_b16 v[162:163], v36 offset:12800
  v_mfma_f32_16x16x32_bf16 v[200:203], v[128:131], v[108:111], v[200:203]
  ds_read_b64_tr_b16 v[164:165], v37 offset:12288
  s_add_u32 m0, s36, 0
  s_nop 0
  buffer_load_dwordx4 v18, s[24:27], s37 offen lds
  s_add_u32 s37, s37, 393216
  v_mfma_f32_16x16x32_bf16 v[196:199], v[124:127], v[108:111], v[196:199]
  ds_read_b64_tr_b16 v[166:167], v37 offset:12800
  v_mfma_f32_16x16x32_bf16 v[192:195], v[120:123], v[108:111], v[192:195]
  ds_read_b128 v[116:119], v31 offset:34816
  s_waitcnt vmcnt(7) lgkmcnt(0)
  s_barrier
  v_mfma_f32_16x16x32_bf16 v[168:171], v[144:147], v[112:115], v[168:171]
  ds_read_b128 v[104:107], v30 offset:0
  ds_read_b64_tr_b16 v[120:121], v32 offset:16384
  v_mfma_f32_16x16x32_bf16 v[172:175], v[148:151], v[112:115], v[172:175]
  ds_read_b64_tr_b16 v[122:123], v32 offset:17408
  v_mfma_f32_16x16x32_bf16 v[176:179], v[152:155], v[112:115], v[176:179]
  ds_read_b64_tr_b16 v[124:125], v33 offset:16384
  s_add_u32 m0, s32, 32768
  s_nop 0
  buffer_load_dwordx4 v14, s[12:15], s93 offen lds
  v_mfma_f32_16x16x32_bf16 v[180:183], v[156:159], v[112:115], v[180:183]
  ds_read_b64_tr_b16 v[126:127], v33 offset:17408
  v_mfma_f32_16x16x32_bf16 v[184:187], v[160:163], v[112:115], v[184:187]
  ds_read_b64_tr_b16 v[128:129], v34 offset:16384
  v_mfma_f32_16x16x32_bf16 v[188:191], v[164:167], v[112:115], v[188:191]
  ds_read_b64_tr_b16 v[130:131], v34 offset:17408
  v_mfma_f32_16x16x32_bf16 v[212:215], v[164:167], v[116:119], v[212:215]
  ds_read_b64_tr_b16 v[132:133], v35 offset:16384
  ds_read_b64_tr_b16 v[134:135], v35 offset:17408
  buffer_load_dwordx4 v15, s[12:15], s93 offen offset:1024 lds
  s_add_u32 s93, s93, 128
  v_mfma_f32_16x16x32_bf16 v[208:211], v[160:163], v[116:119], v[208:211]
  ds_read_b64_tr_b16 v[136:137], v36 offset:16384
  v_mfma_f32_16x16x32_bf16 v[204:207], v[156:159], v[116:119], v[204:207]
  ds_read_b64_tr_b16 v[138:139], v36 offset:16896
  v_mfma_f32_16x16x32_bf16 v[200:203], v[152:155], v[116:119], v[200:203]
  ds_read_b64_tr_b16 v[140:141], v37 offset:16384
  v_mfma_f32_16x16x32_bf16 v[196:199], v[148:151], v[116:119], v[196:199]
  ds_read_b64_tr_b16 v[142:143], v37 offset:16896
  s_add_u32 m0, s94, 0
  s_nop 0
  buffer_load_dwordx4 v16, s[20:23], s95 offen lds
  v_mfma_f32_16x16x32_bf16 v[192:195], v[144:147], v[116:119], v[192:195]
  ds_read_b128 v[108:111], v30 offset:2048
  s_waitcnt lgkmcnt(0)
  v_mfma_f32_16x16x32_bf16 v[168:171], v[120:123], v[104:107], v[168:171]
  ds_read_b128 v[112:115], v31 offset:0
  ds_read_b64_tr_b16 v[144:145], v32 offset:24576
  v_mfma_f32_16x16x32_bf16 v[172:175], v[124:127], v[104:107], v[172:175]
  ds_read_b64_tr_b16 v[146:147], v32 offset:25600
  v_mfma_f32_16x16x32_bf16 v[176:179], v[128:131], v[104:107], v[176:179]
  ds_read_b64_tr_b16 v[148:149], v33 offset:24576
  v_mfma_f32_16x16x32_bf16 v[180:183], v[132:135], v[104:107], v[180:183]
  ds_read_b64_tr_b16 v[150:151], v33 offset:25600
  buffer_load_dwordx4 v17, s[20:23], s95 offen offset:1024 lds
  s_add_u32 s95, s95, 458752
  v_mfma_f32_16x16x32_bf16 v[184:187], v[136:139], v[104:107], v[184:187]
  ds_read_b64_tr_b16 v[152:153], v34 offset:24576
  v_mfma_f32_16x16x32_bf16 v[188:191], v[140:143], v[104:107], v[188:191]
  ds_read_b64_tr_b16 v[154:155], v34 offset:25600
  v_mfma_f32_16x16x32_bf16 v[212:215], v[140:143], v[108:111], v[212:215]
  ds_read_b64_tr_b16 v[156:157], v35 offset:24576
  ds_read_b64_tr_b16 v[158:159], v35 offset:25600
  v_mfma_f32_16x16x32_bf16 v[208:211], v[136:139], v[108:111], v[208:211]
  ds_read_b64_tr_b16 v[160:161], v36 offset:20480
  v_mfma_f32_16x16x32_bf16 v[204:207], v[132:135], v[108:111], v[204:207]
  ds_read_b64_tr_b16 v[162:163], v36 offset:20992
  v_mfma_f32_16x16x32_bf16 v[200:203], v[128:131], v[108:111], v[200:203]
  ds_read_b64_tr_b16 v[164:165], v37 offset:20480
  s_add_u32 m0, s36, 8192
  s_nop 0
  buffer_load_dwordx4 v18, s[24:27], s37 offen lds
  s_add_u32 s37, s37, 393216
  v_mfma_f32_16x16x32_bf16 v[196:199], v[124:127], v[108:111], v[196:199]
  ds_read_b64_tr_b16 v[166:167], v37 offset:20992
  v_mfma_f32_16x16x32_bf16 v[192:195], v[120:123], v[108:111], v[192:195]
  ds_read_b128 v[116:119], v31 offset:2048
  s_waitcnt vmcnt(5) lgkmcnt(0)
  s_barrier
  v_mfma_f32_16x16x32_bf16 v[168:171], v[144:147], v[112:115], v[168:171]
  ds_read_b128 v[104:107], v30 offset:16384
  ds_read_b64_tr_b16 v[120:121], v32 offset:32768
  v_mfma_f32_16x16x32_bf16 v[172:175], v[148:151], v[112:115], v[172:175]
  ds_read_b64_tr_b16 v[122:123], v32 offset:33792
  v_mfma_f32_16x16x32_bf16 v[176:179], v[152:155], v[112:115], v[176:179]
  ds_read_b64_tr_b16 v[124:125], v33 offset:32768
  s_add_u32 m0, s32, 0
  s_nop 0
  buffer_load_dwordx4 v14, s[12:15], s93 offen lds
  v_mfma_f32_16x16x32_bf16 v[180:183], v[156:159], v[112:115], v[180:183]
  ds_read_b64_tr_b16 v[126:127], v33 offset:33792
  v_mfma_f32_16x16x32_bf16 v[184:187], v[160:163], v[112:115], v[184:187]
  ds_read_b64_tr_b16 v[128:129], v34 offset:32768
  v_mfma_f32_16x16x32_bf16 v[188:191], v[164:167], v[112:115], v[188:191]
  ds_read_b64_tr_b16 v[130:131], v34 offset:33792
  v_mfma_f32_16x16x32_bf16 v[212:215], v[164:167], v[116:119], v[212:215]
  ds_read_b64_tr_b16 v[132:133], v35 offset:32768
  ds_read_b64_tr_b16 v[134:135], v35 offset:33792
  buffer_load_dwordx4 v15, s[12:15], s93 offen offset:1024 lds
  s_add_u32 s93, s93, 128
  v_mfma_f32_16x16x32_bf16 v[208:211], v[160:163], v[116:119], v[208:211]
  ds_read_b64_tr_b16 v[136:137], v36 offset:0
  v_mfma_f32_16x16x32_bf16 v[204:207], v[156:159], v[116:119], v[204:207]
  ds_read_b64_tr_b16 v[138:139], v36 offset:512
  v_mfma_f32_16x16x32_bf16 v[200:203], v[152:155], v[116:119], v[200:203]
  ds_read_b64_tr_b16 v[140:141], v37 offset:0
  v_mfma_f32_16x16x32_bf16 v[196:199], v[148:151], v[116:119], v[196:199]
  ds_read_b64_tr_b16 v[142:143], v37 offset:512
  s_add_u32 m0, s94, 16384
  s_nop 0
  buffer_load_dwordx4 v16, s[20:23], s95 offen lds
  v_mfma_f32_16x16x32_bf16 v[192:195], v[144:147], v[116:119], v[192:195]
  ds_read_b128 v[108:111], v30 offset:18432
  s_waitcnt lgkmcnt(0)
  v_mfma_f32_16x16x32_bf16 v[168:171], v[120:123], v[104:107], v[168:171]
  ds_read_b128 v[112:115], v31 offset:16384
  ds_read_b64_tr_b16 v[144:145], v32 offset:40960
  v_mfma_f32_16x16x32_bf16 v[172:175], v[124:127], v[104:107], v[172:175]
  ds_read_b64_tr_b16 v[146:147], v32 offset:41984
  v_mfma_f32_16x16x32_bf16 v[176:179], v[128:131], v[104:107], v[176:179]
  ds_read_b64_tr_b16 v[148:149], v33 offset:40960
  v_mfma_f32_16x16x32_bf16 v[180:183], v[132:135], v[104:107], v[180:183]
  ds_read_b64_tr_b16 v[150:151], v33 offset:41984
  buffer_load_dwordx4 v17, s[20:23], s95 offen offset:1024 lds
  s_add_u32 s95, s95, 458752
  v_mfma_f32_16x16x32_bf16 v[184:187], v[136:139], v[104:107], v[184:187]
  ds_read_b64_tr_b16 v[152:153], v34 offset:40960
  v_mfma_f32_16x16x32_bf16 v[188:191], v[140:143], v[104:107], v[188:191]
  ds_read_b64_tr_b16 v[154:155], v34 offset:41984
  v_mfma_f32_16x16x32_bf16 v[212:215], v[140:143], v[108:111], v[212:215]
  ds_read_b64_tr_b16 v[156:157], v35 offset:40960
  ds_read_b64_tr_b16 v[158:159], v35 offset:41984
  v_mfma_f32_16x16x32_bf16 v[208:211], v[136:139], v[108:111], v[208:211]
  ds_read_b64_tr_b16 v[160:161], v36 offset:4096
  v_mfma_f32_16x16x32_bf16 v[204:207], v[132:135], v[108:111], v[204:207]
  ds_read_b64_tr_b16 v[162:163], v36 offset:4608
  v_mfma_f32_16x16x32_bf16 v[200:203], v[128:131], v[108:111], v[200:203]
  ds_read_b64_tr_b16 v[164:165], v37 offset:4096
  s_add_u32 m0, s36, 16384
  s_nop 0
  buffer_load_dwordx4 v18, s[24:27], s37 offen lds
  s_add_u32 s37, s37, 393216
  v_mfma_f32_16x16x32_bf16 v[196:199], v[124:127], v[108:111], v[196:199]
  ds_read_b64_tr_b16 v[166:167], v37 offset:4608
  v_mfma_f32_16x16x32_bf16 v[192:195], v[120:123], v[108:111], v[192:195]
  ds_read_b128 v[116:119], v31 offset:18432
  s_waitcnt vmcnt(5) lgkmcnt(0)
  s_barrier
  s_cmp_lg_u32 s74, 1
  s_cbranch_scc1 nz2_21
  s_cmp_lg_u32 s3, 0
  s_cbranch_scc1 ow_22
  v_mov_b32 v8, 1
  v_mov_b32 v9, 0
  s_mov_b64 exec, 1
  buffer_store_dword v8, v9, s[8:11], s76 offen sc1
  s_mov_b64 exec, -1
ow_22:
nz2_21:
  v_mfma_f32_16x16x32_bf16 v[168:171], v[144:147], v[112:115], v[168:171]
  ds_read_b128 v[104:107], v30 offset:32768
  ds_read_b64_tr_b16 v[120:121], v32 offset:0
  v_mfma_f32_16x16x32_bf16 v[172:175], v[148:151], v[112:115], v[172:175]
  ds_read_b64_tr_b16 v[122:123], v32 offset:1024
  v_mfma_f32_16x16x32_bf16 v[176:179], v[152:155], v[112:115], v[176:179]
  ds_read_b64_tr_b16 v[124:125], v33 offset:0
  s_add_u32 m0, s32, 16384
  s_nop 0
  buffer_load_dwordx4 v14, s[12:15], s93 offen lds
  v_mfma_f32_16x16x32_bf16 v[180:183], v[156:159], v[112:115], v[180:183]
  ds_read_b64_tr_b16 v[126:127], v33 offset:1024
  v_mfma_f32_16x16x32_bf16 v[184:187], v[160:163], v[112:115], v[184:187]
  ds_read_b64_tr_b16 v[128:129], v34 offset:0
  v_mfma_f32_16x16x32_bf16 v[188:191], v[164:167], v[112:115], v[188:191]
  ds_read_b64_tr_b16 v[130:131], v34 offset:1024
  v_mfma_f32_16x16x32_bf16 v[212:215], v[164:167], v[116:119], v[212:215]
  ds_read_b64_tr_b16 v[132:133], v35 offset:0
  ds_read_b64_tr_b16 v[134:135], v35 offset:1024
  buffer_load_dwordx4 v15, s[12:15], s93 offen offset:1024 lds
  s_add_u32 s93, s93, 128
  v_mfma_f32_16x16x32_bf16 v[208:211], v[160:163], v[116:119], v[208:211]
  ds_read_b64_tr_b16 v[136:137], v36 offset:8192
  v_mfma_f32_16x16x32_bf16 v[204:207], v[156:159], v[116:119], v[204:207]
  ds_read_b64_tr_b16 v[138:139], v36 offset:8704
  v_mfma_f32_16x16x32_bf16 v[200:203], v[152:155], v[116:119], v[200:203]
  ds_read_b64_tr_b16 v[140:141], v37 offset:8192
  v_mfma_f32_16x16x32_bf16 v[196:199], v[148:151], v[116:119], v[196:199]
  ds_read_b64_tr_b16 v[142:143], v37 offset:8704
  s_add_u32 m0, s94, 32768
  s_nop 0
  buffer_load_dwordx4 v16, s[20:23], s95 offen lds
  v_mfma_f32_16x16x32_bf16 v[192:195], v[144:147], v[116:119], v[192:195]
  ds_read_b128 v[108:111], v30 offset:34816
  s_waitcnt lgkmcnt(0)
  v_mfma_f32_16x16x32_bf16 v[168:171], v[120:123], v[104:107], v[168:171]
  ds_read_b128 v[112:115], v31 offset:32768
  ds_read_b64_tr_b16 v[144:145], v32 offset:8192
  v_mfma_f32_16x16x32_bf16 v[172:175], v[124:127], v[104:107], v[172:175]
  ds_read_b64_tr_b16 v[146:147], v32 offset:9216
  v_mfma_f32_16x16x32_bf16 v[176:179], v[128:131], v[104:107], v[176:179]
  ds_read_b64_tr_b16 v[148:149], v33 offset:8192
  v_mfma_f32_16x16x32_bf16 v[180:183], v[132:135], v[104:107], v[180:183]
  ds_read_b64_tr_b16 v[150:151], v33 offset:9216
  buffer_load_dwordx4 v17, s[20:23], s95 offen offset:1024 lds
  s_add_u32 s95, s95, 458752
  v_mfma_f32_16x16x32_bf16 v[184:187], v[136:139], v[104:107], v[184:187]
  ds_read_b64_tr_b16 v[152:153], v34 offset:8192
  v_mfma_f32_16x16x32_bf16 v[188:191], v[140:143], v[104:107], v[188:191]
  ds_read_b64_tr_b16 v[154:155], v34 offset:9216
  v_mfma_f32_16x16x32_bf16 v[212:215], v[140:143], v[108:111], v[212:215]
  ds_read_b64_tr_b16 v[156:157], v35 offset:8192
  ds_read_b64_tr_b16 v[158:159], v35 offset:9216
  v_mfma_f32_16x16x32_bf16 v[208:211], v[136:139], v[108:111], v[208:211]
  ds_read_b64_tr_b16 v[160:161], v36 offset:12288
  v_mfma_f32_16x16x32_bf16 v[204:207], v[132:135], v[108:111], v[204:207]
  ds_read_b64_tr_b16 v[162:163], v36 offset:12800
  v_mfma_f32_16x16x32_bf16 v[200:203], v[128:131], v[108:111], v[200:203]
  ds_read_b64_tr_b16 v[164:165], v37 offset:12288
  s_add_u32 m0, s36, 0
  s_nop 0
  buffer_load_dwordx4 v18, s[24:27], s37 offen lds
  s_add_u32 s37, s37, 393216
  v_mfma_f32_16x16x32_bf16 v[196:199], v[124:127], v[108:111], v[196:199]
  ds_read_b64_tr_b16 v[166:167], v37 offset:12800
  v_mfma_f32_16x16x32_bf16 v[192:195], v[120:123], v[108:111], v[192:195]
  ds_read_b128 v[116:119], v31 offset:34816
  s_waitcnt vmcnt(5) lgkmcnt(0)
  s_barrier
  v_mfma_f32_16x16x32_bf16 v[168:171], v[144:147], v[112:115], v[168:171]
  ds_read_b128 v[104:107], v30 offset:0
  ds_read_b64_tr_b16 v[120:121], v32 offset:16384
  v_mfma_f32_16x16x32_bf16 v[172:175], v[148:151], v[112:115], v[172:175]
  ds_read_b64_tr_b16 v[122:123], v32 offset:17408
  v_mfma_f32_16x16x32_bf16 v[176:179], v[152:155], v[112:115], v[176:179]
  ds_read_b64_tr_b16 v[124:125], v33 offset:16384
  s_add_u32 m0, s32, 32768
  s_nop 0
  buffer_load_dwordx4 v14, s[12:15], s93 offen lds
  v_mfma_f32_16x16x32_bf16 v[180:183], v[156:159], v[112:115], v[180:183]
  ds_read_b64_tr_b16 v[126:127], v33 offset:17408
  v_mfma_f32_16x16x32_bf16 v[184:187], v[160:163], v[112:115], v[184:187]
  ds_read_b64_tr_b16 v[128:129], v34 offset:16384
  v_mfma_f32_16x16x32_bf16 v[188:191], v[164:167], v[112:115], v[188:191]
  ds_read_b64_tr_b16 v[130:131], v34 offset:17408
  v_mfma_f32_16x16x32_bf16 v[212:215], v[164:167], v[116:119], v[212:215]
  ds_read_b64_tr_b16 v[132:133], v35 offset:16384
  ds_read_b64_tr_b16 v[134:135], v35 offset:17408
  buffer_load_dwordx4 v15, s[12:15], s93 offen offset:1024 lds
  s_add_u32 s93, s93, 128
  v_mfma_f32_16x16x32_bf16 v[208:211], v[160:163], v[116:119], v[208:211]
  ds_read_b64_tr_b16 v[136:137], v36 offset:16384
  v_mfma_f32_16x16x32_bf16 v[204:207], v[156:159], v[116:119], v[204:207]
  ds_read_b64_tr_b16 v[138:139], v36 offset:16896
  v_mfma_f32_16x16x32_bf16 v[200:203], v[152:155], v[116:119], v[200:203]
  ds_read_b64_tr_b16 v[140:141], v37 offset:16384
  v_mfma_f32_16x16x32_bf16 v[196:199], v[148:151], v[116:119], v[196:199]
  ds_read_b64_tr_b16 v[142:143], v37 offset:16896
  s_add_u32 m0, s94, 0
  s_nop 0
  buffer_load_dwordx4 v16, s[20:23], s95 offen lds
  v_mfma_f32_16x16x32_bf16 v[192:195], v[144:147], v[116:119], v[192:195]
  ds_read_b128 v[108:111], v30 offset:2048
  s_waitcnt lgkmcnt(0)
  v_mfma_f32_16x16x32_bf16 v[168:171], v[120:123], v[104:107], v[168:171]
  ds_read_b128 v[112:115], v31 offset:0
  ds_read_b64_tr_b16 v[144:145], v32 offset:24576
  v_mfma_f32_16x16x32_bf16 v[172:175], v[124:127], v[104:107], v[172:175]
  ds_read_b64_tr_b16 v[146:147], v32 offset:25600
  v_mfma_f32_16x16x32_bf16 v[176:179], v[128:131], v[104:107], v[176:179]
  ds_read_b64_tr_b16 v[148:149], v33 offset:24576
  v_mfma_f32_16x16x32_bf16 v[180:183], v[132:135], v[104:107], v[180:183]
  ds_read_b64_tr_b16 v[150:151], v33 offset:25600
  buffer_load_dwordx4 v17, s[20:23], s95 offen offset:1024 lds
  s_add_u32 s95, s95, 458752
  v_mfma_f32_16x16x32_bf16 v[184:187], v[136:139], v[104:107], v[184:187]
  ds_read_b64_tr_b16 v[152:153], v34 offset:24576
  v_mfma_f32_16x16x32_bf16 v[188:191], v[140:143], v[104:107], v[188:191]
  ds_read_b64_tr_b16 v[154:155], v34 offset:25600
  v_mfma_f32_16x16x32_bf16 v[212:215], v[140:143], v[108:111], v[212:215]
  ds_read_b64_tr_b16 v[156:157], v35 offset:24576
  ds_read_b64_tr_b16 v[158:159], v35 offset:25600
  v_mfma_f32_16x16x32_bf16 v[208:211], v[136:139], v[108:111], v[208:211]
  ds_read_b64_tr_b16 v[160:161], v36 offset:20480
  v_mfma_f32_16x16x32_bf16 v[204:207], v[132:135], v[108:111], v[204:207]
  ds_read_b64_tr_b16 v[162:163], v36 offset:20992
  v_mfma_f32_16x16x32_bf16 v[200:203], v[128:131], v[108:111], v[200:203]
  ds_read_b64_tr_b16 v[164:165], v37 offset:20480
  s_add_u32 m0, s36, 8192
  s_nop 0
  buffer_load_dwordx4 v18, s[24:27], s37 offen lds
  s_add_u32 s37, s37, 393216
  v_mfma_f32_16x16x32_bf16 v[196:199], v[124:127], v[108:111], v[196:199]
  ds_read_b64_tr_b16 v[166:167], v37 offset:20992
  v_mfma_f32_16x16x32_bf16 v[192:195], v[120:123], v[108:111], v[192:195]
  ds_read_b128 v[116:119], v31 offset:2048
  s_waitcnt vmcnt(5) lgkmcnt(0)
  s_barrier
  s_cmp_lg_u32 s3, 0
  s_cbranch_scc1 ow_23
  buffer_load_dword v12, v13, s[8:11], 0 offen sc1
ow_23:
  v_mfma_f32_16x16x32_bf16 v[168:171], v[144:147], v[112:115], v[168:171]
  ds_read_b128 v[104:107], v30 offset:16384
  ds_read_b64_tr_b16 v[120:121], v32 offset:32768
  v_mfma_f32_16x16x32_bf16 v[172:175], v[148:151], v[112:115], v[172:175]
  ds_read_b64_tr_b16 v[122:123], v32 offset:33792
  v_mfma_f32_16x16x32_bf16 v[176:179], v[152:155], v[112:115], v[176:179]
  ds_read_b64_tr_b16 v[124:125], v33 offset:32768
  s_add_u32 m0, s32, 0
  s_nop 0
  buffer_load_dwordx4 v14, s[12:15], s93 offen lds
  v_mfma_f32_16x16x32_bf16 v[180:183], v[156:159], v[112:115], v[180:183]
  ds_read_b64_tr_b16 v[126:127], v33 offset:33792
  v_mfma_f32_16x16x32_bf16 v[184:187], v[160:163], v[112:115], v[184:187]
  ds_read_b64_tr_b16 v[128:129], v34 offset:32768
  v_mfma_f32_16x16x32_bf16 v[188:191], v[164:167], v[112:115], v[188:191]
  ds_read_b64_tr_b16 v[130:131], v34 offset:33792
  v_mfma_f32_16x16x32_bf16 v[212:215], v[164:167], v[116:119], v[212:215]
  ds_read_b64_tr_b16 v[132:133], v35 offset:32768
  ds_read_b64_tr_b16 v[134:135], v35 offset:33792
  buffer_load_dwordx4 v15, s[12:15], s93 offen offset:1024 lds
  s_add_u32 s93, s93, 128
  v_mfma_f32_16x16x32_bf16 v[208:211], v[160:163], v[116:119], v[208:211]
  ds_read_b64_tr_b16 v[136:137], v36 offset:0
  v_mfma_f32_16x16x32_bf16 v[204:207], v[156:159], v[116:119], v[204:207]
  ds_read_b64_tr_b16 v[138:139], v36 offset:512
  v_mfma_f32_16x16x32_bf16 v[200:203], v[152:155], v[116:119], v[200:203]
  ds_read_b64_tr_b16 v[140:141], v37 offset:0
  v_mfma_f32_16x16x32_bf16 v[196:199], v[148:151], v[116:119], v[196:199]
  ds_read_b64_tr_b16 v[142:143], v37 offset:512
  s_add_u32 m0, s94, 16384
  s_nop 0
  buffer_load_dwordx4 v16, s[20:23], s95 offen lds
  v_mfma_f32_16x16x32_bf16 v[192:195], v[144:147], v[116:119], v[192:195]
  ds_read_b128 v[108:111], v30 offset:18432
  s_waitcnt lgkmcnt(0)
  v_mfma_f32_16x16x32_bf16 v[168:171], v[120:123], v[104:107], v[168:171]
  ds_read_b128 v[112:115], v31 offset:16384
  ds_read_b64_tr_b16 v[144:145], v32 offset:40960
  v_mfma_f32_16x16x32_bf16 v[172:175], v[124:127], v[104:107], v[172:175]
  ds_read_b64_tr_b16 v[146:147], v32 offset:41984
  v_mfma_f32_16x16x32_bf16 v[176:179], v[128:131], v[104:107], v[176:179]
  ds_read_b64_tr_b16 v[148:149], v33 offset:40960
  v_mfma_f32_16x16x32_bf16 v[180:183], v[132:135], v[104:107], v[180:183]
  ds_read_b64_tr_b16 v[150:151], v33 offset:41984
  buffer_load_dwordx4 v17, s[20:23], s95 offen offset:1024 lds
  s_add_u32 s95, s95, 458752
  v_mfma_f32_16x16x32_bf16 v[184:187], v[136:139], v[104:107], v[184:187]
  ds_read_b64_tr_b16 v[152:153], v34 offset:40960
  v_mfma_f32_16x16x32_bf16 v[188:191], v[140:143], v[104:107], v[188:191]
  ds_read_b64_tr_b16 v[154:155], v34 offset:41984
  v_mfma_f32_16x16x32_bf16 v[212:215], v[140:143], v[108:111], v[212:215]
  ds_read_b64_tr_b16 v[156:157], v35 offset:40960
  ds_read_b64_tr_b16 v[158:159], v35 offset:41984
  v_mfma_f32_16x16x32_bf16 v[208:211], v[136:139], v[108:111], v[208:211]
  ds_read_b64_tr_b16 v[160:161], v36 offset:4096
  v_mfma_f32_16x16x32_bf16 v[204:207], v[132:135], v[108:111], v[204:207]
  ds_read_b64_tr_b16 v[162:163], v36 offset:4608
  v_mfma_f32_16x16x32_bf16 v[200:203], v[128:131], v[108:111], v[200:203]
  ds_read_b64_tr_b16 v[164:165], v37 offset:4096
  s_add_u32 m0, s36, 16384
  s_nop 0
  buffer_load_dwordx4 v18, s[24:27], s37 offen lds
  s_add_u32 s37, s37, 393216
  v_mfma_f32_16x16x32_bf16 v[196:199], v[124:127], v[108:111], v[196:199]
  ds_read_b64_tr_b16 v[166:167], v37 offset:4608
  v_mfma_f32_16x16x32_bf16 v[192:195], v[120:123], v[108:111], v[192:195]
  ds_read_b128 v[116:119], v31 offset:18432
  s_waitcnt vmcnt(5) lgkmcnt(0)
  s_barrier
  v_mfma_f32_16x16x32_bf16 v[168:171], v[144:147], v[112:115], v[168:171]
  ds_read_b128 v[104:107], v30 offset:32768
  ds_read_b64_tr_b16 v[120:121], v32 offset:0
  v_mfma_f32_16x16x32_bf16 v[172:175], v[148:151], v[112:115], v[172:175]
  ds_read_b64_tr_b16 v[122:123], v32 offset:1024
  v_mfma_f32_16x16x32_bf16 v[176:179], v[152:155], v[112:115], v[176:179]
  ds_read_b64_tr_b16 v[124:125], v33 offset:0
  s_add_u32 m0, s32, 16384
  s_nop 0
  buffer_load_dwordx4 v14, s[12:15], s93 offen lds
  v_mfma_f32_16x16x32_bf16 v[180:183], v[156:159], v[112:115], v[180:183]
  ds_read_b64_tr_b16 v[126:127], v33 offset:1024
  v_mfma_f32_16x16x32_bf16 v[184:187], v[160:163], v[112:115], v[184:187]
  ds_read_b64_tr_b16 v[128:129], v34 offset:0
  v_mfma_f32_16x16x32_bf16 v[188:191], v[164:167], v[112:115], v[188:191]
  ds_read_b64_tr_b16 v[130:131], v34 offset:1024
  v_mfma_f32_16x16x32_bf16 v[212:215], v[164:167], v[116:119], v[212:215]
  ds_read_b64_tr_b16 v[132:133], v35 offset:0
  ds_read_b64_tr_b16 v[134:135], v35 offset:1024
  buffer_load_dwordx4 v15, s[12:15], s93 offen offset:1024 lds
  s_add_u32 s93, s93, 128
  v_mfma_f32_16x16x32_bf16 v[208:211], v[160:163], v[116:119], v[208:211]
  ds_read_b64_tr_b16 v[136:137], v36 offset:8192
  v_mfma_f32_16x16x32_bf16 v[204:207], v[156:159], v[116:119], v[204:207]
  ds_read_b64_tr_b16 v[138:139], v36 offset:8704
  v_mfma_f32_16x16x32_bf16 v[200:203], v[152:155], v[116:119], v[200:203]
  ds_read_b64_tr_b16 v[140:141], v37 offset:8192
  v_mfma_f32_16x16x32_bf16 v[196:199], v[148:151], v[116:119], v[196:199]
  ds_read_b64_tr_b16 v[142:143], v37 offset:8704
  s_add_u32 m0, s94, 32768
  s_nop 0
  buffer_load_dwordx4 v16, s[20:23], s95 offen lds
  v_mfma_f32_16x16x32_bf16 v[192:195], v[144:147], v[116:119], v[192:195]
  ds_read_b128 v[108:111], v30 offset:34816
  s_waitcnt lgkmcnt(0)
  v_mfma_f32_16x16x32_bf16 v[168:171], v[120:123], v[104:107], v[168:171]
  ds_read_b128 v[112:115], v31 offset:32768
  ds_read_b64_tr_b16 v[144:145], v32 offset:8192
  v_mfma_f32_16x16x32_bf16 v[172:175], v[124:127], v[104:107], v[172:175]
  ds_read_b64_tr_b16 v[146:147], v32 offset:9216
  v_mfma_f32_16x16x32_bf16 v[176:179], v[128:131], v[104:107], v[176:179]
  ds_read_b64_tr_b16 v[148:149], v33 offset:8192
  v_mfma_f32_16x16x32_bf16 v[180:183], v[132:135], v[104:107], v[180:183]
  ds_read_b64_tr_b16 v[150:151], v33 offset:9216
  buffer_load_dwordx4 v17, s[20:23], s95 offen offset:1024 lds
  s_add_u32 s95, s95, 458752
  v_mfma_f32_16x16x32_bf16 v[184:187], v[136:139], v[104:107], v[184:187]
  ds_read_b64_tr_b16 v[152:153], v34 offset:8192
  v_mfma_f32_16x16x32_bf16 v[188:191], v[140:143], v[104:107], v[188:191]
  ds_read_b64_tr_b16 v[154:155], v34 offset:9216
  v_mfma_f32_16x16x32_bf16 v[212:215], v[140:143], v[108:111], v[212:215]
  ds_read_b64_tr_b16 v[156:157], v35 offset:8192
  ds_read_b64_tr_b16 v[158:159], v35 offset:9216
  v_mfma_f32_16x16x32_bf16 v[208:211], v[136:139], v[108:111], v[208:211]
  ds_read_b64_tr_b16 v[160:161], v36 offset:12288
  v_mfma_f32_16x16x32_bf16 v[204:207], v[132:135], v[108:111], v[204:207]
  ds_read_b64_tr_b16 v[162:163], v36 offset:12800
  v_mfma_f32_16x16x32_bf16 v[200:203], v[128:131], v[108:111], v[200:203]
  ds_read_b64_tr_b16 v[164:165], v37 offset:12288
  s_add_u32 m0, s36, 0
  s_nop 0
  buffer_load_dwordx4 v18, s[24:27], s37 offen lds
  s_add_u32 s37, s37, 393216
  v_mfma_f32_16x16x32_bf16 v[196:199], v[124:127], v[108:111], v[196:199]
  ds_read_b64_tr_b16 v[166:167], v37 offset:12800
  v_mfma_f32_16x16x32_bf16 v[192:195], v[120:123], v[108:111], v[192:195]
  ds_read_b128 v[116:119], v31 offset:34816
  s_cmp_lg_u32 s3, 0
  s_cbranch_scc1 ow_24
  s_waitcnt vmcnt(10)
  v_cmp_ne_u32 vcc, 0, v12
  s_cmp_eq_u32 vcc_hi, -1
  s_cbranch_scc1 pok_25
  s_mov_b32 s75, 400000
psp_26:
  buffer_load_dword v12, v13, s[8:11], 0 offen sc1
  s_waitcnt vmcnt(0)
  v_cmp_ne_u32 vcc, 0, v12
  s_cmp_eq_u32 vcc_hi, -1
  s_cbranch_scc1 pok_25
  s_sub_u32 s75, s75, 1
  s_cmp_lg_u32 s75, 0
  s_cbranch_scc1 psp_26
pok_25:
ow_24:
  s_waitcnt vmcnt(5) lgkmcnt(0)
  s_barrier
  s_lshr_b32 s4, s2, 3
  s_lshl_b32 s4, s4, 17
  s_bfe_u32 s5, s2, 0x20001
  s_lshl_b32 s5, s5, 10
  s_add_u32 s4, s4, s5
  s_and_b32 s5, s2, 1
  s_lshl_b32 s5, s5, 3
  s_add_u32 s4, s4, s5
  s_lshl_b32 s5, s3, 14
  s_add_u32 s4, s4, s5
  s_add_u32 s4, s4, 33554432
  v_lshlrev_b32 v3, 4, v1
  buffer_load_dwordx2 v[216:217], v3, s[8:11], s4 offen sc1
  s_add_u32 s4, s4, 4096
  buffer_load_dwordx2 v[218:219], v3, s[8:11], s4 offen sc1
  s_add_u32 s4, s4, 4096
  buffer_load_dwordx2 v[220:221], v3, s[8:11], s4 offen sc1
  s_add_u32 s4, s4, 4096
  buffer_load_dwordx2 v[222:223], v3, s[8:11], s4 offen sc1
  s_lshr_b32 s4, s2, 3
  s_lshl_b32 s4, s4, 13
  s_lshl_b32 s5, s3, 10
  s_add_u32 s4, s4, s5
  s_add_u32 s4, s4, 13631488
  v_lshlrev_b32 v3, 2, v1
  buffer_load_dword v224, v3, s[8:11], s4 offen offset:0 sc1
  buffer_load_dword v225, v3, s[8:11], s4 offen offset:256 sc1
  buffer_load_dword v226, v3, s[8:11], s4 offen offset:512 sc1
  buffer_load_dword v227, v3, s[8:11], s4 offen offset:768 sc1
  s_lshl_b32 s4, s44, 6
  s_lshl_b32 s5, s82, 5
  s_add_u32 s4, s4, s5
  s_add_u32 s4, s4, s77
  v_and_b32 v20, 15, v1
  v_add_u32 v20, s4, v20
  v_lshlrev_b32 v4, 4, v20
  s_mov_b32 s4, 14942208
  buffer_load_dword v21, v4, s[8:11], s4 offen sc1
  buffer_load_dword v22, v4, s[8:11], s4 offen offset:256 sc1
  s_mov_b32 s28, s62
  s_and_b32 s29, s63, 0xffff
  s_mov_b32 s30, 4096
  s_mov_b32 s31, 0x20000
  v_lshlrev_b32 v4, 1, v20
  buffer_load_ushort v23, v4, s[28:31], 0 offen
  buffer_load_ushort v24, v4, s[28:31], 0 offen offset:32
  v_mfma_f32_16x16x32_bf16 v[168:171], v[144:147], v[112:115], v[168:171]
  ds_read_b128 v[104:107], v30 offset:0
  ds_read_b64_tr_b16 v[120:121], v32 offset:16384
  v_mfma_f32_16x16x32_bf16 v[172:175], v[148:151], v[112:115], v[172:175]
  ds_read_b64_tr_b16 v[122:123], v32 offset:17408
  v_mfma_f32_16x16x32_bf16 v[176:179], v[152:155], v[112:115], v[176:179]
  ds_read_b64_tr_b16 v[124:125], v33 offset:16384
  v_mfma_f32_16x16x32_bf16 v[180:183], v[156:159], v[112:115], v[180:183]
  ds_read_b64_tr_b16 v[126:127], v33 offset:17408
  v_mfma_f32_16x16x32_bf16 v[184:187], v[160:163], v[112:115], v[184:187]
  ds_read_b64_tr_b16 v[128:129], v34 offset:16384
  v_mfma_f32_16x16x32_bf16 v[188:191], v[164:167], v[112:115], v[188:191]
  ds_read_b64_tr_b16 v[130:131], v34 offset:17408
  v_mfma_f32_16x16x32_bf16 v[212:215], v[164:167], v[116:119], v[212:215]
  ds_read_b64_tr_b16 v[132:133], v35 offset:16384
  ds_read_b64_tr_b16 v[134:135], v35 offset:17408
  v_mfma_f32_16x16x32_bf16 v[208:211], v[160:163], v[116:119], v[208:211]
  ds_read_b64_tr_b16 v[136:137], v36 offset:16384
  v_mfma_f32_16x16x32_bf16 v[204:207], v[156:159], v[116:119], v[204:207]
  ds_read_b64_tr_b16 v[138:139], v36 offset:16896
  v_mfma_f32_16x16x32_bf16 v[200:203], v[152:155], v[116:119], v[200:203]
  ds_read_b64_tr_b16 v[140:141], v37 offset:16384
  v_mfma_f32_16x16x32_bf16 v[196:199], v[148:151], v[116:119], v[196:199]
  ds_read_b64_tr_b16 v[142:143], v37 offset:16896
  v_mfma_f32_16x16x32_bf16 v[192:195], v[144:147], v[116:119], v[192:195]
  ds_read_b128 v[108:111], v30 offset:2048
  s_waitcnt lgkmcnt(0)
  v_mfma_f32_16x16x32_bf16 v[168:171], v[120:123], v[104:107], v[168:171]
  ds_read_b128 v[112:115], v31 offset:0
  ds_read_b64_tr_b16 v[144:145], v32 offset:24576
  s_mov_b32 s12, s60
  s_and_b32 s13, s61, 0xffff
  v_mfma_f32_16x16x32_bf16 v[172:175], v[124:127], v[104:107], v[172:175]
  ds_read_b64_tr_b16 v[146:147], v32 offset:25600
  s_mov_b32 s14, 8388608
  s_mov_b32 s15, 0x20000
  v_mfma_f32_16x16x32_bf16 v[176:179], v[128:131], v[104:107], v[176:179]
  ds_read_b64_tr_b16 v[148:149], v33 offset:24576
  s_mov_b32 s16, s72
  s_and_b32 s17, s73, 0xffff
  v_mfma_f32_16x16x32_bf16 v[180:183], v[132:135], v[104:107], v[180:183]
  ds_read_b64_tr_b16 v[150:151], v33 offset:25600
  s_mov_b32 s18, 7340032
  s_mov_b32 s19, 0x20000
  v_mfma_f32_16x16x32_bf16 v[184:187], v[136:139], v[104:107], v[184:187]
  ds_read_b64_tr_b16 v[152:153], v34 offset:24576
  s_lshl_b32 s32, s3, 11
  s_mul_i32 s34, s3, 2048
  v_mfma_f32_16x16x32_bf16 v[188:191], v[140:143], v[104:107], v[188:191]
  ds_read_b64_tr_b16 v[154:155], v34 offset:25600
  s_add_u32 s34, s34, 65536
  v_mfma_f32_16x16x32_bf16 v[212:215], v[140:143], v[108:111], v[212:215]
  ds_read_b64_tr_b16 v[156:157], v35 offset:24576
  ds_read_b64_tr_b16 v[158:159], v35 offset:25600
  s_lshl_b32 s4, s3, 4
  s_add_u32 s4, s4, s77
  v_mfma_f32_16x16x32_bf16 v[208:211], v[136:139], v[108:111], v[208:211]
  ds_read_b64_tr_b16 v[160:161], v36 offset:20480
  s_mul_i32 s33, s4, 4096
  v_mul_u32_u24 v2, 4096, v0
  v_mfma_f32_16x16x32_bf16 v[204:207], v[132:135], v[108:111], v[204:207]
  ds_read_b64_tr_b16 v[162:163], v36 offset:20992
  v_add_u32 v14, v2, v38
  v_xor_b32 v15, 64, v38
  v_mfma_f32_16x16x32_bf16 v[200:203], v[128:131], v[108:111], v[200:203]
  ds_read_b64_tr_b16 v[164:165], v37 offset:20480
  v_add_u32 v2, 31744, v2
  v_add_u32 v15, v15, v2
  v_mfma_f32_16x16x32_bf16 v[196:199], v[124:127], v[108:111], v[196:199]
  ds_read_b64_tr_b16 v[166:167], v37 offset:20992
  s_mul_i32 s34, s3, 2176
  s_add_u32 s34, s34, 65536
  v_mfma_f32_16x16x32_bf16 v[192:195], v[120:123], v[108:111], v[192:195]
  ds_read_b128 v[116:119], v31 offset:2048
  s_mul_i32 s35, s43, 458752
  s_waitcnt vmcnt(12) lgkmcnt(0)
  s_barrier
  s_cmp_lg_u32 s3, 0
  s_cbranch_scc1 ow_27
  buffer_load_dword v12, v13, s[8:11], 0 offen sc1
ow_27:
  v_mfma_f32_16x16x32_bf16 v[168:171], v[144:147], v[112:115], v[168:171]
  ds_read_b128 v[104:107], v30 offset:16384
  ds_read_b64_tr_b16 v[120:121], v32 offset:32768
  s_lshl_b32 s4, s3, 11
  s_add_u32 s35, s35, s4
  v_mfma_f32_16x16x32_bf16 v[172:175], v[148:151], v[112:115], v[172:175]
  ds_read_b64_tr_b16 v[122:123], v32 offset:33792
  v_lshlrev_b32 v16, 4, v1
  s_cmp_eq_u32 s3, 7
  s_cselect_b32 s4, 2146435072, 0
  s_cselect_b32 s34, 163840, s34
  v_mfma_f32_16x16x32_bf16 v[176:179], v[152:155], v[112:115], v[176:179]
  ds_read_b64_tr_b16 v[124:125], v33 offset:32768
  v_add_u32 v16, s4, v16
  v_mov_b32 v17, v16
  v_mfma_f32_16x16x32_bf16 v[180:183], v[156:159], v[112:115], v[180:183]
  ds_read_b64_tr_b16 v[126:127], v33 offset:33792
  s_mov_b32 s24, s54
  s_cmp_eq_u32 s3, 1
  s_cselect_b32 s24, s64, s24
  v_mfma_f32_16x16x32_bf16 v[184:187], v[160:163], v[112:115], v[184:187]
  ds_read_b64_tr_b16 v[128:129], v34 offset:32768
  s_cmp_eq_u32 s3, 2
  s_cselect_b32 s24, s64, s24
  s_mov_b32 s25, s55
  v_mfma_f32_16x16x32_bf16 v[188:191], v[164:167], v[112:115], v[188:191]
  ds_read_b64_tr_b16 v[130:131], v34 offset:33792
  s_cmp_eq_u32 s3, 1
  s_cselect_b32 s25, s65, s25
  s_cmp_eq_u32 s3, 2
  s_cselect_b32 s25, s65, s25
  v_mfma_f32_16x16x32_bf16 v[212:215], v[164:167], v[116:119], v[212:215]
  ds_read_b64_tr_b16 v[132:133], v35 offset:32768
  ds_read_b64_tr_b16 v[134:135], v35 offset:33792
  s_and_b32 s25, s25, 0xffff
  s_mov_b32 s26, 2097152
  v_mfma_f32_16x16x32_bf16 v[208:211], v[160:163], v[116:119], v[208:211]
  ds_read_b64_tr_b16 v[136:137], v36 offset:0
  s_cmp_eq_u32 s3, 1
  s_cselect_b32 s26, 3670016, s26
  s_cmp_eq_u32 s3, 2
  s_cselect_b32 s26, 3670016, s26
  v_mfma_f32_16x16x32_bf16 v[204:207], v[156:159], v[116:119], v[204:207]
  ds_read_b64_tr_b16 v[138:139], v36 offset:512
  s_cmp_eq_u32 s3, 3
  s_cselect_b32 s26, 0, s26
  s_cmp_eq_u32 s3, 4
  s_cselect_b32 s26, 0, s26
  v_mfma_f32_16x16x32_bf16 v[200:203], v[152:155], v[116:119], v[200:203]
  ds_read_b64_tr_b16 v[140:141], v37 offset:0
  s_cmp_eq_u32 s3, 5
  s_cselect_b32 s26, 0, s26
  s_cmp_eq_u32 s3, 6
  s_cselect_b32 s26, 0, s26
  v_mfma_f32_16x16x32_bf16 v[196:199], v[148:151], v[116:119], v[196:199]
  ds_read_b64_tr_b16 v[142:143], v37 offset:512
  s_cmp_eq_u32 s3, 7
  s_cselect_b32 s26, 0, s26
  s_mov_b32 s27, 0x20000
  v_mfma_f32_16x16x32_bf16 v[192:195], v[144:147], v[116:119], v[192:195]
  ds_read_b128 v[108:111], v30 offset:18432
  s_mov_b32 s39, 8192
  s_waitcnt lgkmcnt(0)
  v_mfma_f32_16x16x32_bf16 v[168:171], v[120:123], v[104:107], v[168:171]
  ds_read_b128 v[112:115], v31 offset:16384
  ds_read_b64_tr_b16 v[144:145], v32 offset:40960
  s_cmp_eq_u32 s3, 1
  s_cselect_b32 s39, 14336, s39
  s_cmp_eq_u32 s3, 2
  s_cselect_b32 s39, 14336, s39
  v_mfma_f32_16x16x32_bf16 v[172:175], v[124:127], v[104:107], v[172:175]
  ds_read_b64_tr_b16 v[146:147], v32 offset:41984
  s_cmp_eq_u32 s3, 3
  s_cselect_b32 s39, 0, s39
  s_cmp_eq_u32 s3, 4
  s_cselect_b32 s39, 0, s39
  v_mfma_f32_16x16x32_bf16 v[176:179], v[128:131], v[104:107], v[176:179]
  ds_read_b64_tr_b16 v[148:149], v33 offset:40960
  s_cmp_eq_u32 s3, 5
  s_cselect_b32 s39, 0, s39
  s_cmp_eq_u32 s3, 6
  s_cselect_b32 s39, 0, s39
  v_mfma_f32_16x16x32_bf16 v[180:183], v[132:135], v[104:107], v[180:183]
  ds_read_b64_tr_b16 v[150:151], v33 offset:41984
  s_cmp_eq_u32 s3, 7
  s_cselect_b32 s39, 0, s39
  s_mul_i32 s38, s39, s2
  v_mfma_f32_16x16x32_bf16 v[184:187], v[136:139], v[104:107], v[184:187]
  ds_read_b64_tr_b16 v[152:153], v34 offset:40960
  s_cmp_eq_u32 s3, 2
  s_cselect_b32 s4, 8192, 0
  s_add_u32 s38, s38, s4
  v_mfma_f32_16x16x32_bf16 v[188:191], v[140:143], v[104:107], v[188:191]
  ds_read_b64_tr_b16 v[154:155], v34 offset:41984
  s_mov_b32 s4, 63
  v_mfma_f32_16x16x32_bf16 v[212:215], v[140:143], v[108:111], v[212:215]
  ds_read_b64_tr_b16 v[156:157], v35 offset:40960
  ds_read_b64_tr_b16 v[158:159], v35 offset:41984
  s_cmp_eq_u32 s3, 2
  s_cselect_b32 s4, 47, s4
  s_cmp_eq_u32 s3, 3
  s_cselect_b32 s4, 0, s4
  v_mfma_f32_16x16x32_bf16 v[208:211], v[136:139], v[108:111], v[208:211]
  ds_read_b64_tr_b16 v[160:161], v36 offset:4096
  s_cmp_eq_u32 s3, 4
  s_cselect_b32 s4, 0, s4
  s_cmp_eq_u32 s3, 5
  s_cselect_b32 s4, 0, s4
  v_mfma_f32_16x16x32_bf16 v[204:207], v[132:135], v[108:111], v[204:207]
  ds_read_b64_tr_b16 v[162:163], v36 offset:4608
  s_cmp_eq_u32 s3, 6
  s_cselect_b32 s4, 0, s4
  s_cmp_eq_u32 s3, 7
  s_cselect_b32 s4, 0, s4
  v_mfma_f32_16x16x32_bf16 v[200:203], v[128:131], v[108:111], v[200:203]
  ds_read_b64_tr_b16 v[164:165], v37 offset:4096
  v_min_u32 v2, s4, v1
  v_lshlrev_b32 v11, 7, v2
  v_mfma_f32_16x16x32_bf16 v[196:199], v[124:127], v[108:111], v[196:199]
  ds_read_b64_tr_b16 v[166:167], v37 offset:4608
  v_and_b32 v2, 15, v1
  s_mul_i32 s4, s44, 8192
  v_mfma_f32_16x16x32_bf16 v[192:195], v[120:123], v[108:111], v[192:195]
  ds_read_b128 v[116:119], v31 offset:18432
  v_lshlrev_b32 v2, 7, v2
  s_waitcnt lgkmcnt(0)
  v_mfma_f32_16x16x32_bf16 v[168:171], v[144:147], v[112:115], v[168:171]
  v_add_u32 v2, s4, v2
  v_bfe_u32 v3, v1, 1, 3
  v_mfma_f32_16x16x32_bf16 v[172:175], v[148:151], v[112:115], v[172:175]
  v_lshrrev_b32 v4, 4, v1
  s_lshl_b32 s4, s82, 2
  v_mfma_f32_16x16x32_bf16 v[176:179], v[152:155], v[112:115], v[176:179]
  v_add_u32 v4, s4, v4
  v_xor_b32 v4, v4, v3
  v_mfma_f32_16x16x32_bf16 v[180:183], v[156:159], v[112:115], v[180:183]
  v_lshl_add_u32 v28, v4, 4, v2
  v_lshrrev_b32 v2, 4, v1
  v_mfma_f32_16x16x32_bf16 v[184:187], v[160:163], v[112:115], v[184:187]
  v_lshlrev_b32 v2, 3, v2
  v_bfe_u32 v3, v1, 2, 2
  v_mfma_f32_16x16x32_bf16 v[188:191], v[164:167], v[112:115], v[188:191]
  v_add_u32 v2, v2, v3
  v_mfma_f32_16x16x32_bf16 v[212:215], v[164:167], v[116:119], v[212:215]
  s_lshl_b32 s4, s82, 5
  v_add_u32 v2, s4, v2
  v_mfma_f32_16x16x32_bf16 v[208:211], v[160:163], v[116:119], v[208:211]
  v_lshlrev_b32 v2, 4, v2
  v_and_b32 v3, 1, v1
  v_mfma_f32_16x16x32_bf16 v[204:207], v[156:159], v[116:119], v[204:207]
  v_lshl_add_u32 v2, v3, 3, v2
  v_bfe_u32 v3, v1, 1, 1
  v_mfma_f32_16x16x32_bf16 v[200:203], v[152:155], v[116:119], v[200:203]
  v_mul_u32_u24 v3, 1088, v3
  v_add_u32 v2, v2, v3
  v_mfma_f32_16x16x32_bf16 v[196:199], v[148:151], v[116:119], v[196:199]
  s_mul_i32 s4, s83, 8704
  s_add_u32 s4, s4, 65536
  v_mfma_f32_16x16x32_bf16 v[192:195], v[144:147], v[116:119], v[192:195]
  v_add_u32 v29, s4, v2
  s_branch L_t23j
L_t23b:
  s_waitcnt vmcnt(16)
  s_barrier
  ds_read_b128 v[104:107], v30 offset:16384
  ds_read_b64_tr_b16 v[120:121], v32 offset:32768
  ds_read_b64_tr_b16 v[122:123], v32 offset:33792
  ds_read_b64_tr_b16 v[124:125], v33 offset:32768
  ds_read_b64_tr_b16 v[126:127], v33 offset:33792
  ds_read_b64_tr_b16 v[128:129], v34 offset:32768
  ds_read_b64_tr_b16 v[130:131], v34 offset:33792
  ds_read_b64_tr_b16 v[132:133], v36 offset:0
  ds_read_b64_tr_b16 v[134:135], v36 offset:512
  ds_read_b64_tr_b16 v[136:137], v37 offset:0
  ds_read_b64_tr_b16 v[138:139], v37 offset:512
  ds_read_b128 v[108:111], v30 offset:18432
  s_waitcnt lgkmcnt(0)
  v_mfma_f32_16x16x32_bf16 v[168:171], v[120:123], v[104:107], 0
  ds_read_b128 v[112:115], v31 offset:16384
  ds_read_b64_tr_b16 v[144:145], v32 offset:40960
  v_mfma_f32_16x16x32_bf16 v[172:175], v[124:127], v[104:107], 0
  ds_read_b64_tr_b16 v[146:147], v32 offset:41984
  v_mfma_f32_16x16x32_bf16 v[176:179], v[128:131], v[104:107], 0
  ds_read_b64_tr_b16 v[148:149], v33 offset:40960
  v_mfma_f32_16x16x32_bf16 v[184:187], v[132:135], v[104:107], 0
  ds_read_b64_tr_b16 v[150:151], v33 offset:41984
  v_mfma_f32_16x16x32_bf16 v[188:191], v[136:139], v[104:107], 0
  ds_read_b64_tr_b16 v[152:153], v34 offset:40960
  v_mfma_f32_16x16x32_bf16 v[212:215], v[136:139], v[108:111], 0
  ds_read_b64_tr_b16 v[154:155], v34 offset:41984
  ds_read_b64_tr_b16 v[156:157], v36 offset:4096
  v_mfma_f32_16x16x32_bf16 v[208:211], v[132:135], v[108:111], 0
  ds_read_b64_tr_b16 v[158:159], v36 offset:4608
  v_mfma_f32_16x16x32_bf16 v[200:203], v[128:131], v[108:111], 0
  ds_read_b64_tr_b16 v[160:161], v37 offset:4096
  v_mfma_f32_16x16x32_bf16 v[196:199], v[124:127], v[108:111], 0
  ds_read_b64_tr_b16 v[162:163], v37 offset:4608
  v_mfma_f32_16x16x32_bf16 v[192:195], v[120:123], v[108:111], 0
  ds_read_b128 v[116:119], v31 offset:18432
  s_waitcnt vmcnt(10) lgkmcnt(0)
  s_barrier
  v_mfma_f32_16x16x32_bf16 v[168:171], v[144:147], v[112:115], v[168:171]
  ds_read_b128 v[104:107], v30 offset:32768
  ds_read_b64_tr_b16 v[120:121], v32 offset:0
  v_mfma_f32_16x16x32_bf16 v[172:175], v[148:151], v[112:115], v[172:175]
  ds_read_b64_tr_b16 v[122:123], v32 offset:1024
  s_add_u32 m0, s32, 16384
  s_nop 0
  buffer_load_dwordx4 v14, s[12:15], s93 offen lds
  v_mfma_f32_16x16x32_bf16 v[176:179], v[152:155], v[112:115], v[176:179]
  ds_read_b64_tr_b16 v[124:125], v33 offset:0
  v_mfma_f32_16x16x32_bf16 v[184:187], v[156:159], v[112:115], v[184:187]
  ds_read_b64_tr_b16 v[126:127], v33 offset:1024
  v_mfma_f32_16x16x32_bf16 v[188:191], v[160:163], v[112:115], v[188:191]
  ds_read_b64_tr_b16 v[128:129], v34 offset:0
  v_mfma_f32_16x16x32_bf16 v[212:215], v[160:163], v[116:119], v[212:215]
  ds_read_b64_tr_b16 v[130:131], v34 offset:1024
  ds_read_b64_tr_b16 v[132:133], v36 offset:8192
  buffer_load_dwordx4 v15, s[12:15], s93 offen offset:1024 lds
  s_add_u32 s93, s93, 128
  v_mfma_f32_16x16x32_bf16 v[208:211], v[156:159], v[116:119], v[208:211]
  ds_read_b64_tr_b16 v[134:135], v36 offset:8704
  v_mfma_f32_16x16x32_bf16 v[200:203], v[152:155], v[116:119], v[200:203]
  ds_read_b64_tr_b16 v[136:137], v37 offset:8192
  v_mfma_f32_16x16x32_bf16 v[196:199], v[148:151], v[116:119], v[196:199]
  ds_read_b64_tr_b16 v[138:139], v37 offset:8704
  s_add_u32 m0, s94, 32768
  s_nop 0
  buffer_load_dwordx4 v16, s[20:23], s95 offen lds
  v_mfma_f32_16x16x32_bf16 v[192:195], v[144:147], v[116:119], v[192:195]
  ds_read_b128 v[108:111], v30 offset:34816
  s_waitcnt lgkmcnt(0)
  v_mfma_f32_16x16x32_bf16 v[168:171], v[120:123], v[104:107], v[168:171]
  ds_read_b128 v[112:115], v31 offset:32768
  ds_read_b64_tr_b16 v[144:145], v32 offset:8192
  v_mfma_f32_16x16x32_bf16 v[172:175], v[124:127], v[104:107], v[172:175]
  ds_read_b64_tr_b16 v[146:147], v32 offset:9216
  v_mfma_f32_16x16x32_bf16 v[176:179], v[128:131], v[104:107], v[176:179]
  ds_read_b64_tr_b16 v[148:149], v33 offset:8192
  buffer_load_dwordx4 v17, s[20:23], s95 offen offset:1024 lds
  s_add_u32 s95, s95, 458752
  v_mfma_f32_16x16x32_bf16 v[184:187], v[132:135], v[104:107], v[184:187]
  ds_read_b64_tr_b16 v[150:151], v33 offset:9216
  v_mfma_f32_16x16x32_bf16 v[188:191], v[136:139], v[104:107], v[188:191]
  ds_read_b64_tr_b16 v[152:153], v34 offset:8192
  v_mfma_f32_16x16x32_bf16 v[212:215], v[136:139], v[108:111], v[212:215]
  ds_read_b64_tr_b16 v[154:155], v34 offset:9216
  ds_read_b64_tr_b16 v[156:157], v36 offset:12288
  v_mfma_f32_16x16x32_bf16 v[208:211], v[132:135], v[108:111], v[208:211]
  ds_read_b64_tr_b16 v[158:159], v36 offset:12800
  v_mfma_f32_16x16x32_bf16 v[200:203], v[128:131], v[108:111], v[200:203]
  ds_read_b64_tr_b16 v[160:161], v37 offset:12288
  s_add_u32 m0, s36, 0
  s_nop 0
  buffer_load_dwordx4 v18, s[24:27], s37 offen lds
  s_add_u32 s37, s37, 393216
  v_mfma_f32_16x16x32_bf16 v[196:199], v[124:127], v[108:111], v[196:199]
  ds_read_b64_tr_b16 v[162:163], v37 offset:12800
  v_mfma_f32_16x16x32_bf16 v[192:195], v[120:123], v[108:111], v[192:195]
  ds_read_b128 v[116:119], v31 offset:34816
  s_waitcnt vmcnt(10) lgkmcnt(0)
  s_barrier
  s_cmp_lg_u32 s74, 1
  s_cbranch_scc1 nz2_28
  s_sub_u32 s75, s3, 2
  s_cmp_ge_u32 s75, 2
  s_cbranch_scc1 ow_29
  s_sub_u32 s4, s3, 2
  s_lshl_b32 s4, s4, 6
  v_add_u32 v11, s4, v1
  v_lshlrev_b32 v11, 3, v11
  s_add_u32 s5, s85, 4096
  buffer_load_dwordx2 v[216:217], v11, s[8:11], s85 offen offset:0 sc1
  buffer_load_dwordx2 v[218:219], v11, s[8:11], s85 offen offset:1024 sc1
  buffer_load_dwordx2 v[220:221], v11, s[8:11], s85 offen offset:2048 sc1
  buffer_load_dwordx2 v[222:223], v11, s[8:11], s85 offen offset:3072 sc1
  buffer_load_dwordx2 v[224:225], v11, s[8:11], s5 offen offset:0 sc1
  buffer_load_dwordx2 v[226:227], v11, s[8:11], s5 offen offset:1024 sc1
  buffer_load_dwordx2 v[228:229], v11, s[8:11], s5 offen offset:2048 sc1
ow_29:
nz2_28:
  v_mfma_f32_16x16x32_bf16 v[168:171], v[144:147], v[112:115], v[168:171]
  ds_read_b128 v[104:107], v30 offset:0
  ds_read_b64_tr_b16 v[120:121], v32 offset:16384
  v_mfma_f32_16x16x32_bf16 v[172:175], v[148:151], v[112:115], v[172:175]
  ds_read_b64_tr_b16 v[122:123], v32 offset:17408
  s_add_u32 m0, s32, 32768
  s_nop 0
  buffer_load_dwordx4 v14, s[12:15], s93 offen lds
  v_mfma_f32_16x16x32_bf16 v[176:179], v[152:155], v[112:115], v[176:179]
  ds_read_b64_tr_b16 v[124:125], v33 offset:16384
  v_mfma_f32_16x16x32_bf16 v[184:187], v[156:159], v[112:115], v[184:187]
  ds_read_b64_tr_b16 v[126:127], v33 offset:17408
  v_mfma_f32_16x16x32_bf16 v[188:191], v[160:163], v[112:115], v[188:191]
  ds_read_b64_tr_b16 v[128:129], v34 offset:16384
  v_mfma_f32_16x16x32_bf16 v[212:215], v[160:163], v[116:119], v[212:215]
  ds_read_b64_tr_b16 v[130:131], v34 offset:17408
  ds_read_b64_tr_b16 v[132:133], v36 offset:16384
  buffer_load_dwordx4 v15, s[12:15], s93 offen offset:1024 lds
  s_add_u32 s93, s93, 128
  v_mfma_f32_16x16x32_bf16 v[208:211], v[156:159], v[116:119], v[208:211]
  ds_read_b64_tr_b16 v[134:135], v36 offset:16896
  v_mfma_f32_16x16x32_bf16 v[200:203], v[152:155], v[116:119], v[200:203]
  ds_read_b64_tr_b16 v[136:137], v37 offset:16384
  v_mfma_f32_16x16x32_bf16 v[196:199], v[148:151], v[116:119], v[196:199]
  ds_read_b64_tr_b16 v[138:139], v37 offset:16896
  s_add_u32 m0, s94, 0
  s_nop 0
  buffer_load_dwordx4 v16, s[20:23], s95 offen lds
  v_mfma_f32_16x16x32_bf16 v[192:195], v[144:147], v[116:119], v[192:195]
  ds_read_b128 v[108:111], v30 offset:2048
  s_waitcnt lgkmcnt(0)
  v_mfma_f32_16x16x32_bf16 v[168:171], v[120:123], v[104:107], v[168:171]
  ds_read_b128 v[112:115], v31 offset:0
  ds_read_b64_tr_b16 v[144:145], v32 offset:24576
  v_mfma_f32_16x16x32_bf16 v[172:175], v[124:127], v[104:107], v[172:175]
  ds_read_b64_tr_b16 v[146:147], v32 offset:25600
  v_mfma_f32_16x16x32_bf16 v[176:179], v[128:131], v[104:107], v[176:179]
  ds_read_b64_tr_b16 v[148:149], v33 offset:24576
  buffer_load_dwordx4 v17, s[20:23], s95 offen offset:1024 lds
  s_add_u32 s95, s95, 458752
  v_mfma_f32_16x16x32_bf16 v[184:187], v[132:135], v[104:107], v[184:187]
  ds_read_b64_tr_b16 v[150:151], v33 offset:25600
  v_mfma_f32_16x16x32_bf16 v[188:191], v[136:139], v[104:107], v[188:191]
  ds_read_b64_tr_b16 v[152:153], v34 offset:24576
  v_mfma_f32_16x16x32_bf16 v[212:215], v[136:139], v[108:111], v[212:215]
  ds_read_b64_tr_b16 v[154:155], v34 offset:25600
  ds_read_b64_tr_b16 v[156:157], v36 offset:20480
  v_mfma_f32_16x16x32_bf16 v[208:211], v[132:135], v[108:111], v[208:211]
  ds_read_b64_tr_b16 v[158:159], v36 offset:20992
  v_mfma_f32_16x16x32_bf16 v[200:203], v[128:131], v[108:111], v[200:203]
  ds_read_b64_tr_b16 v[160:161], v37 offset:20480
  s_add_u32 m0, s36, 8192
  s_nop 0
  buffer_load_dwordx4 v18, s[24:27], s37 offen lds
  s_add_u32 s37, s37, 393216
  v_mfma_f32_16x16x32_bf16 v[196:199], v[124:127], v[108:111], v[196:199]
  ds_read_b64_tr_b16 v[162:163], v37 offset:20992
  v_mfma_f32_16x16x32_bf16 v[192:195], v[120:123], v[108:111], v[192:195]
  ds_read_b128 v[116:119], v31 offset:2048
  s_waitcnt vmcnt(5) lgkmcnt(0)
  s_barrier
  v_mfma_f32_16x16x32_bf16 v[168:171], v[144:147], v[112:115], v[168:171]
  ds_read_b128 v[104:107], v30 offset:16384
  ds_read_b64_tr_b16 v[120:121], v32 offset:32768
  v_mfma_f32_16x16x32_bf16 v[172:175], v[148:151], v[112:115], v[172:175]
  ds_read_b64_tr_b16 v[122:123], v32 offset:33792
  s_add_u32 m0, s32, 0
  s_nop 0
  buffer_load_dwordx4 v14, s[12:15], s93 offen lds
  v_mfma_f32_16x16x32_bf16 v[176:179], v[152:155], v[112:115], v[176:179]
  ds_read_b64_tr_b16 v[124:125], v33 offset:32768
  v_mfma_f32_16x16x32_bf16 v[184:187], v[156:159], v[112:115], v[184:187]
  ds_read_b64_tr_b16 v[126:127], v33 offset:33792
  v_mfma_f32_16x16x32_bf16 v[188:191], v[160:163], v[112:115], v[188:191]
  ds_read_b64_tr_b16 v[128:129], v34 offset:32768
  v_mfma_f32_16x16x32_bf16 v[212:215], v[160:163], v[116:119], v[212:215]
  ds_read_b64_tr_b16 v[130:131], v34 offset:33792
  ds_read_b64_tr_b16 v[132:133], v36 offset:0
  buffer_load_dwordx4 v15, s[12:15], s93 offen offset:1024 lds
  s_add_u32 s93, s93, 128
  v_mfma_f32_16x16x32_bf16 v[208:211], v[156:159], v[116:119], v[208:211]
  ds_read_b64_tr_b16 v[134:135], v36 offset:512
  v_mfma_f32_16x16x32_bf16 v[200:203], v[152:155], v[116:119], v[200:203]
  ds_read_b64_tr_b16 v[136:137], v37 offset:0
  v_mfma_f32_16x16x32_bf16 v[196:199], v[148:151], v[116:119], v[196:199]
  ds_read_b64_tr_b16 v[138:139], v37 offset:512
  s_add_u32 m0, s94, 16384
  s_nop 0
  buffer_load_dwordx4 v16, s[20:23], s95 offen lds
  v_mfma_f32_16x16x32_bf16 v[192:195], v[144:147], v[116:119], v[192:195]
  ds_read_b128 v[108:111], v30 offset:18432
  s_waitcnt lgkmcnt(0)
  v_mfma_f32_16x16x32_bf16 v[168:171], v[120:123], v[104:107], v[168:171]
  ds_read_b128 v[112:115], v31 offset:16384
  ds_read_b64_tr_b16 v[144:145], v32 offset:40960
  v_mfma_f32_16x16x32_bf16 v[172:175], v[124:127], v[104:107], v[172:175]
  ds_read_b64_tr_b16 v[146:147], v32 offset:41984
  v_mfma_f32_16x16x32_bf16 v[176:179], v[128:131], v[104:107], v[176:179]
  ds_read_b64_tr_b16 v[148:149], v33 offset:40960
  buffer_load_dwordx4 v17, s[20:23], s95 offen offset:1024 lds
  s_add_u32 s95, s95, 458752
  v_mfma_f32_16x16x32_bf16 v[184:187], v[132:135], v[104:107], v[184:187]
  ds_read_b64_tr_b16 v[150:151], v33 offset:41984
  v_mfma_f32_16x16x32_bf16 v[188:191], v[136:139], v[104:107], v[188:191]
  ds_read_b64_tr_b16 v[152:153], v34 offset:40960
  v_mfma_f32_16x16x32_bf16 v[212:215], v[136:139], v[108:111], v[212:215]
  ds_read_b64_tr_b16 v[154:155], v34 offset:41984
  ds_read_b64_tr_b16 v[156:157], v36 offset:4096
  v_mfma_f32_16x16x32_bf16 v[208:211], v[132:135], v[108:111], v[208:211]
  ds_read_b64_tr_b16 v[158:159], v36 offset:4608
  v_mfma_f32_16x16x32_bf16 v[200:203], v[128:131], v[108:111], v[200:203]
  ds_read_b64_tr_b16 v[160:161], v37 offset:4096
  s_add_u32 m0, s36, 16384
  s_nop 0
  buffer_load_dwordx4 v18, s[24:27], s37 offen lds
  s_add_u32 s37, s37, 393216
  v_mfma_f32_16x16x32_bf16 v[196:199], v[124:127], v[108:111], v[196:199]
  ds_read_b64_tr_b16 v[162:163], v37 offset:4608
  v_mfma_f32_16x16x32_bf16 v[192:195], v[120:123], v[108:111], v[192:195]
  ds_read_b128 v[116:119], v31 offset:18432
  s_cmp_lg_u32 s74, 1
  s_cbranch_scc1 nz2_30
  s_sub_u32 s75, s3, 2
  s_cmp_ge_u32 s75, 2
  s_cbranch_scc1 ow_31
  s_waitcnt vmcnt(10)
  v_and_b32 v4, v217, v219
  v_and_b32 v4, v4, v221
  v_and_b32 v4, v4, v223
  v_and_b32 v4, v4, v225
  v_and_b32 v4, v4, v227
  v_and_b32 v4, v4, v229
  v_cmp_gt_i32 vcc, 0, v4
  s_nop 0
  s_cmp_eq_u64 vcc, -1
  s_cbranch_scc1 lnok_32
  s_mov_b32 s75, 400000
lnsp_33:
  s_sub_u32 s4, s3, 2
  s_lshl_b32 s4, s4, 6
  v_add_u32 v11, s4, v1
  v_lshlrev_b32 v11, 3, v11
  s_add_u32 s5, s85, 4096
  buffer_load_dwordx2 v[216:217], v11, s[8:11], s85 offen offset:0 sc1
  buffer_load_dwordx2 v[218:219], v11, s[8:11], s85 offen offset:1024 sc1
  buffer_load_dwordx2 v[220:221], v11, s[8:11], s85 offen offset:2048 sc1
  buffer_load_dwordx2 v[222:223], v11, s[8:11], s85 offen offset:3072 sc1
  buffer_load_dwordx2 v[224:225], v11, s[8:11], s5 offen offset:0 sc1
  buffer_load_dwordx2 v[226:227], v11, s[8:11], s5 offen offset:1024 sc1
  buffer_load_dwordx2 v[228:229], v11, s[8:11], s5 offen offset:2048 sc1
  s_waitcnt vmcnt(0)
  v_and_b32 v4, v217, v219
  v_and_b32 v4, v4, v221
  v_and_b32 v4, v4, v223
  v_and_b32 v4, v4, v225
  v_and_b32 v4, v4, v227
  v_and_b32 v4, v4, v229
  v_cmp_gt_i32 vcc, 0, v4
  s_nop 0
  s_cmp_eq_u64 vcc, -1
  s_cbranch_scc1 lnok_32
  s_sub_u32 s75, s75, 1
  s_cmp_lg_u32 s75, 0
  s_cbranch_scc1 lnsp_33
lnok_32:
  v_and_b32 v217, 0x7fffffff, v217
  v_and_b32 v219, 0x7fffffff, v219
  v_and_b32 v221, 0x7fffffff, v221
  v_and_b32 v223, 0x7fffffff, v223
  v_and_b32 v225, 0x7fffffff, v225
  v_and_b32 v227, 0x7fffffff, v227
  v_and_b32 v229, 0x7fffffff, v229
  v_pk_add_f32 v[216:217], v[216:217], v[218:219]
  v_pk_add_f32 v[216:217], v[216:217], v[220:221]
  v_pk_add_f32 v[216:217], v[216:217], v[222:223]
  v_pk_add_f32 v[216:217], v[216:217], v[224:225]
  v_pk_add_f32 v[216:217], v[216:217], v[226:227]
  v_pk_add_f32 v[216:217], v[216:217], v[228:229]
  v_mul_f32 v4, 0x3a124925, v216
  v_mul_f32 v5, 0x3a124925, v217
  v_fma_f32 v5, -v4, v4, v5
  v_max_f32 v5, 0, v5
  v_add_f32 v5, 0x3727c5ac, v5
  v_rsq_f32 v216, v5
  s_nop 0
  v_mul_f32 v217, v4, v216
  v_add_u32 v3, 151552, v11
  ds_write_b64 v3, v[216:217]
ow_31:
nz2_30:
  s_waitcnt vmcnt(5) lgkmcnt(0)
  s_barrier
  s_cmp_eq_u32 s74, 1
  s_cbranch_scc1 pe_34
  s_cmp_lg_u32 s3, 0
  s_cbranch_scc1 ow_35
  v_cmp_le_u32 vcc, 16, v12
  s_cbranch_vccnz rk_36
  s_mov_b32 s28, s70
  s_and_b32 s29, s71, 0xffff
  s_mov_b32 s30, 256
  s_mov_b32 s31, 0x20000
  s_mov_b32 s75, 400000
rsp_38:
  s_sleep 1
  v_mov_b32 v9, 0
  buffer_load_dword v12, v9, s[28:31], 0 offen sc1
  s_waitcnt vmcnt(0)
  v_cmp_le_u32 vcc, 16, v12
  s_cbranch_vccnz rok_37
  s_sub_u32 s75, s75, 1
  s_cmp_lg_u32 s75, 0
  s_cbranch_scc1 rsp_38
rok_37:
rk_36:
ow_35:
  s_cmp_lg_u32 s3, 0
  s_cbranch_scc1 ow_39
  v_mov_b32 v8, 1
  v_mov_b32 v9, 0
  s_mov_b64 exec, 1
  buffer_store_dword v8, v9, s[8:11], s76 offen sc1
  s_mov_b64 exec, -1
ow_39:
pe_34:
  s_lshl_b32 s4, s44, 9
  s_add_u32 s4, s4, 151552
  v_and_b32 v11, 15, v1
  v_lshl_add_u32 v11, v11, 3, s4
  ds_read_b64 v[2:3], v11 offset:0
  ds_read_b64 v[4:5], v11 offset:128
  ds_read_b64 v[6:7], v11 offset:256
  ds_read_b64 v[8:9], v11 offset:384
  v_mfma_f32_16x16x32_bf16 v[168:171], v[144:147], v[112:115], v[168:171]
  ds_read_b128 v[104:107], v30 offset:32768
  ds_read_b64_tr_b16 v[120:121], v32 offset:0
  v_mfma_f32_16x16x32_bf16 v[172:175], v[148:151], v[112:115], v[172:175]
  ds_read_b64_tr_b16 v[122:123], v32 offset:1024
  s_add_u32 m0, s32, 16384
  s_nop 0
  buffer_load_dwordx4 v14, s[12:15], s93 offen lds
  v_mfma_f32_16x16x32_bf16 v[176:179], v[152:155], v[112:115], v[176:179]
  ds_read_b64_tr_b16 v[124:125], v33 offset:0
  v_mfma_f32_16x16x32_bf16 v[184:187], v[156:159], v[112:115], v[184:187]
  ds_read_b64_tr_b16 v[126:127], v33 offset:1024
  v_mfma_f32_16x16x32_bf16 v[188:191], v[160:163], v[112:115], v[188:191]
  ds_read_b64_tr_b16 v[128:129], v34 offset:0
  v_mfma_f32_16x16x32_bf16 v[212:215], v[160:163], v[116:119], v[212:215]
  ds_read_b64_tr_b16 v[130:131], v34 offset:1024
  ds_read_b64_tr_b16 v[132:133], v36 offset:8192
  buffer_load_dwordx4 v15, s[12:15], s93 offen offset:1024 lds
  s_add_u32 s93, s93, 128
  v_mfma_f32_16x16x32_bf16 v[208:211], v[156:159], v[116:119], v[208:211]
  ds_read_b64_tr_b16 v[134:135], v36 offset:8704
  v_mfma_f32_16x16x32_bf16 v[200:203], v[152:155], v[116:119], v[200:203]
  ds_read_b64_tr_b16 v[136:137], v37 offset:8192
  v_mfma_f32_16x16x32_bf16 v[196:199], v[148:151], v[116:119], v[196:199]
  ds_read_b64_tr_b16 v[138:139], v37 offset:8704
  s_add_u32 m0, s94, 32768
  s_nop 0
  buffer_load_dwordx4 v16, s[20:23], s95 offen lds
  v_mfma_f32_16x16x32_bf16 v[192:195], v[144:147], v[116:119], v[192:195]
  ds_read_b128 v[108:111], v30 offset:34816
  s_waitcnt lgkmcnt(0)
  v_mfma_f32_16x16x32_bf16 v[168:171], v[120:123], v[104:107], v[168:171]
  ds_read_b128 v[112:115], v31 offset:32768
  ds_read_b64_tr_b16 v[144:145], v32 offset:8192
  v_fma_f32 v40, v40, v2, -v3
  v_fma_f32 v41, v41, v2, -v3
  v_mfma_f32_16x16x32_bf16 v[172:175], v[124:127], v[104:107], v[172:175]
  ds_read_b64_tr_b16 v[146:147], v32 offset:9216
  v_fma_f32 v42, v42, v2, -v3
  v_fma_f32 v43, v43, v2, -v3
  v_mfma_f32_16x16x32_bf16 v[176:179], v[128:131], v[104:107], v[176:179]
  ds_read_b64_tr_b16 v[148:149], v33 offset:8192
  buffer_load_dwordx4 v17, s[20:23], s95 offen offset:1024 lds
  s_add_u32 s95, s95, 458752
  v_fma_f32 v44, v44, v2, -v3
  v_fma_f32 v45, v45, v2, -v3
  v_mfma_f32_16x16x32_bf16 v[184:187], v[132:135], v[104:107], v[184:187]
  ds_read_b64_tr_b16 v[150:151], v33 offset:9216
  v_fma_f32 v46, v46, v2, -v3
  v_fma_f32 v47, v47, v2, -v3
  v_mfma_f32_16x16x32_bf16 v[188:191], v[136:139], v[104:107], v[188:191]
  ds_read_b64_tr_b16 v[152:153], v34 offset:8192
  v_fma_f32 v48, v48, v2, -v3
  v_fma_f32 v49, v49, v2, -v3
  v_mfma_f32_16x16x32_bf16 v[212:215], v[136:139], v[108:111], v[212:215]
  ds_read_b64_tr_b16 v[154:155], v34 offset:9216
  ds_read_b64_tr_b16 v[156:157], v36 offset:12288
  v_fma_f32 v50, v50, v2, -v3
  v_fma_f32 v51, v51, v2, -v3
  v_mfma_f32_16x16x32_bf16 v[208:211], v[132:135], v[108:111], v[208:211]
  ds_read_b64_tr_b16 v[158:159], v36 offset:12800
  v_fma_f32 v52, v52, v2, -v3
  v_fma_f32 v53, v53, v2, -v3
  v_mfma_f32_16x16x32_bf16 v[200:203], v[128:131], v[108:111], v[200:203]
  ds_read_b64_tr_b16 v[160:161], v37 offset:12288
  s_add_u32 m0, s36, 0
  s_nop 0
  buffer_load_dwordx4 v18, s[24:27], s37 offen lds
  s_add_u32 s37, s37, 393216
  v_fma_f32 v54, v54, v2, -v3
  v_fma_f32 v55, v55, v2, -v3
  v_mfma_f32_16x16x32_bf16 v[196:199], v[124:127], v[108:111], v[196:199]
  ds_read_b64_tr_b16 v[162:163], v37 offset:12800
  v_cvt_pk_bf16_f32 v216, v40, v41
  v_cvt_pk_bf16_f32 v217, v42, v43
  v_mfma_f32_16x16x32_bf16 v[192:195], v[120:123], v[108:111], v[192:195]
  ds_read_b128 v[116:119], v31 offset:34816
  v_cvt_pk_bf16_f32 v218, v44, v45
  v_cvt_pk_bf16_f32 v219, v46, v47
  s_waitcnt vmcnt(5) lgkmcnt(0)
  s_barrier
  v_mfma_f32_16x16x32_bf16 v[168:171], v[144:147], v[112:115], v[168:171]
  ds_read_b128 v[104:107], v30 offset:0
  ds_read_b64_tr_b16 v[120:121], v32 offset:16384
  v_cvt_pk_bf16_f32 v220, v48, v49
  v_cvt_pk_bf16_f32 v221, v50, v51
  v_mfma_f32_16x16x32_bf16 v[172:175], v[148:151], v[112:115], v[172:175]
  ds_read_b64_tr_b16 v[122:123], v32 offset:17408
  s_add_u32 m0, s32, 32768
  s_nop 0
  buffer_load_dwordx4 v14, s[12:15], s93 offen lds
  v_cvt_pk_bf16_f32 v222, v52, v53
  v_cvt_pk_bf16_f32 v223, v54, v55
  v_mfma_f32_16x16x32_bf16 v[176:179], v[152:155], v[112:115], v[176:179]
  ds_read_b64_tr_b16 v[124:125], v33 offset:16384
  v_permlane16_swap_b32 v216, v218
  v_permlane16_swap_b32 v217, v219
  v_mfma_f32_16x16x32_bf16 v[184:187], v[156:159], v[112:115], v[184:187]
  ds_read_b64_tr_b16 v[126:127], v33 offset:17408
  v_permlane16_swap_b32 v220, v222
  v_permlane16_swap_b32 v221, v223
  v_mfma_f32_16x16x32_bf16 v[188:191], v[160:163], v[112:115], v[188:191]
  ds_read_b64_tr_b16 v[128:129], v34 offset:16384
  buffer_store_dwordx4 v[216:219], v248, s[8:11], 0 offen sc1
  buffer_store_dwordx4 v[220:223], v249, s[8:11], 0 offen sc1
  v_mfma_f32_16x16x32_bf16 v[212:215], v[160:163], v[116:119], v[212:215]
  ds_read_b64_tr_b16 v[130:131], v34 offset:17408
  ds_read_b64_tr_b16 v[132:133], v36 offset:16384
  buffer_load_dwordx4 v15, s[12:15], s93 offen offset:1024 lds
  s_add_u32 s93, s93, 128
  v_fma_f32 v56, v56, v4, -v5
  v_fma_f32 v57, v57, v4, -v5
  v_mfma_f32_16x16x32_bf16 v[208:211], v[156:159], v[116:119], v[208:211]
  ds_read_b64_tr_b16 v[134:135], v36 offset:16896
  v_fma_f32 v58, v58, v4, -v5
  v_fma_f32 v59, v59, v4, -v5
  v_mfma_f32_16x16x32_bf16 v[200:203], v[152:155], v[116:119], v[200:203]
  ds_read_b64_tr_b16 v[136:137], v37 offset:16384
  v_fma_f32 v60, v60, v4, -v5
  v_fma_f32 v61, v61, v4, -v5
  v_mfma_f32_16x16x32_bf16 v[196:199], v[148:151], v[116:119], v[196:199]
  ds_read_b64_tr_b16 v[138:139], v37 offset:16896
  s_add_u32 m0, s94, 0
  s_nop 0
  buffer_load_dwordx4 v16, s[20:23], s95 offen lds
  v_fma_f32 v62, v62, v4, -v5
  v_fma_f32 v63, v63, v4, -v5
  v_mfma_f32_16x16x32_bf16 v[192:195], v[144:147], v[116:119], v[192:195]
  ds_read_b128 v[108:111], v30 offset:2048
  v_fma_f32 v64, v64, v4, -v5
  v_fma_f32 v65, v65, v4, -v5
  s_waitcnt lgkmcnt(0)
  v_mfma_f32_16x16x32_bf16 v[168:171], v[120:123], v[104:107], v[168:171]
  ds_read_b128 v[112:115], v31 offset:0
  ds_read_b64_tr_b16 v[144:145], v32 offset:24576
  v_fma_f32 v66, v66, v4, -v5
  v_fma_f32 v67, v67, v4, -v5
  v_mfma_f32_16x16x32_bf16 v[172:175], v[124:127], v[104:107], v[172:175]
  ds_read_b64_tr_b16 v[146:147], v32 offset:25600
  v_fma_f32 v68, v68, v4, -v5
  v_fma_f32 v69, v69, v4, -v5
  v_mfma_f32_16x16x32_bf16 v[176:179], v[128:131], v[104:107], v[176:179]
  ds_read_b64_tr_b16 v[148:149], v33 offset:24576
  buffer_load_dwordx4 v17, s[20:23], s95 offen offset:1024 lds
  s_add_u32 s95, s95, 458752
  v_fma_f32 v70, v70, v4, -v5
  v_fma_f32 v71, v71, v4, -v5
  v_mfma_f32_16x16x32_bf16 v[184:187], v[132:135], v[104:107], v[184:187]
  ds_read_b64_tr_b16 v[150:151], v33 offset:25600
  v_cvt_pk_bf16_f32 v224, v56, v57
  v_cvt_pk_bf16_f32 v225, v58, v59
  v_mfma_f32_16x16x32_bf16 v[188:191], v[136:139], v[104:107], v[188:191]
  ds_read_b64_tr_b16 v[152:153], v34 offset:24576
  v_cvt_pk_bf16_f32 v226, v60, v61
  v_cvt_pk_bf16_f32 v227, v62, v63
  v_mfma_f32_16x16x32_bf16 v[212:215], v[136:139], v[108:111], v[212:215]
  ds_read_b64_tr_b16 v[154:155], v34 offset:25600
  ds_read_b64_tr_b16 v[156:157], v36 offset:20480
  v_cvt_pk_bf16_f32 v228, v64, v65
  v_cvt_pk_bf16_f32 v229, v66, v67
  v_mfma_f32_16x16x32_bf16 v[208:211], v[132:135], v[108:111], v[208:211]
  ds_read_b64_tr_b16 v[158:159], v36 offset:20992
  v_cvt_pk_bf16_f32 v230, v68, v69
  v_cvt_pk_bf16_f32 v231, v70, v71
  v_mfma_f32_16x16x32_bf16 v[200:203], v[128:131], v[108:111], v[200:203]
  ds_read_b64_tr_b16 v[160:161], v37 offset:20480
  s_add_u32 m0, s36, 8192
  s_nop 0
  buffer_load_dwordx4 v18, s[24:27], s37 offen lds
  s_add_u32 s37, s37, 393216
  v_permlane16_swap_b32 v224, v226
  v_permlane16_swap_b32 v225, v227
  v_mfma_f32_16x16x32_bf16 v[196:199], v[124:127], v[108:111], v[196:199]
  ds_read_b64_tr_b16 v[162:163], v37 offset:20992
  v_permlane16_swap_b32 v228, v230
  v_permlane16_swap_b32 v229, v231
  v_mfma_f32_16x16x32_bf16 v[192:195], v[120:123], v[108:111], v[192:195]
  ds_read_b128 v[116:119], v31 offset:2048
  buffer_store_dwordx4 v[224:227], v250, s[8:11], 0 offen sc1
  buffer_store_dwordx4 v[228:231], v251, s[8:11], 0 offen sc1
  s_waitcnt vmcnt(9) lgkmcnt(0)
  s_barrier
  v_mfma_f32_16x16x32_bf16 v[168:171], v[144:147], v[112:115], v[168:171]
  ds_read_b128 v[104:107], v30 offset:16384
  ds_read_b64_tr_b16 v[120:121], v32 offset:32768
  v_fma_f32 v72, v72, v6, -v7
  v_fma_f32 v73, v73, v6, -v7
  v_mfma_f32_16x16x32_bf16 v[172:175], v[148:151], v[112:115], v[172:175]
  ds_read_b64_tr_b16 v[122:123], v32 offset:33792
  s_add_u32 m0, s32, 0
  s_nop 0
  buffer_load_dwordx4 v14, s[12:15], s93 offen lds
  v_fma_f32 v74, v74, v6, -v7
  v_fma_f32 v75, v75, v6, -v7
  v_mfma_f32_16x16x32_bf16 v[176:179], v[152:155], v[112:115], v[176:179]
  ds_read_b64_tr_b16 v[124:125], v33 offset:32768
  v_fma_f32 v76, v76, v6, -v7
  v_fma_f32 v77, v77, v6, -v7
  v_mfma_f32_16x16x32_bf16 v[184:187], v[156:159], v[112:115], v[184:187]
  ds_read_b64_tr_b16 v[126:127], v33 offset:33792
  v_fma_f32 v78, v78, v6, -v7
  v_fma_f32 v79, v79, v6, -v7
  v_mfma_f32_16x16x32_bf16 v[188:191], v[160:163], v[112:115], v[188:191]
  ds_read_b64_tr_b16 v[128:129], v34 offset:32768
  v_fma_f32 v80, v80, v6, -v7
  v_fma_f32 v81, v81, v6, -v7
  v_mfma_f32_16x16x32_bf16 v[212:215], v[160:163], v[116:119], v[212:215]
  ds_read_b64_tr_b16 v[130:131], v34 offset:33792
  ds_read_b64_tr_b16 v[132:133], v36 offset:0
  buffer_load_dwordx4 v15, s[12:15], s93 offen offset:1024 lds
  s_add_u32 s93, s93, 128
  v_fma_f32 v82, v82, v6, -v7
  v_fma_f32 v83, v83, v6, -v7
  v_mfma_f32_16x16x32_bf16 v[208:211], v[156:159], v[116:119], v[208:211]
  ds_read_b64_tr_b16 v[134:135], v36 offset:512
  v_fma_f32 v84, v84, v6, -v7
  v_fma_f32 v85, v85, v6, -v7
  v_mfma_f32_16x16x32_bf16 v[200:203], v[152:155], v[116:119], v[200:203]
  ds_read_b64_tr_b16 v[136:137], v37 offset:0
  v_fma_f32 v86, v86, v6, -v7
  v_fma_f32 v87, v87, v6, -v7
  v_mfma_f32_16x16x32_bf16 v[196:199], v[148:151], v[116:119], v[196:199]
  ds_read_b64_tr_b16 v[138:139], v37 offset:512
  s_add_u32 m0, s94, 16384
  s_nop 0
  buffer_load_dwordx4 v16, s[20:23], s95 offen lds
  v_cvt_pk_bf16_f32 v232, v72, v73
  v_cvt_pk_bf16_f32 v233, v74, v75
  v_mfma_f32_16x16x32_bf16 v[192:195], v[144:147], v[116:119], v[192:195]
  ds_read_b128 v[108:111], v30 offset:18432
  v_cvt_pk_bf16_f32 v234, v76, v77
  v_cvt_pk_bf16_f32 v235, v78, v79
  s_waitcnt lgkmcnt(0)
  v_mfma_f32_16x16x32_bf16 v[168:171], v[120:123], v[104:107], v[168:171]
  ds_read_b128 v[112:115], v31 offset:16384
  ds_read_b64_tr_b16 v[144:145], v32 offset:40960
  v_cvt_pk_bf16_f32 v236, v80, v81
  v_cvt_pk_bf16_f32 v237, v82, v83
  v_mfma_f32_16x16x32_bf16 v[172:175], v[124:127], v[104:107], v[172:175]
  ds_read_b64_tr_b16 v[146:147], v32 offset:41984
  v_cvt_pk_bf16_f32 v238, v84, v85
  v_cvt_pk_bf16_f32 v239, v86, v87
  v_mfma_f32_16x16x32_bf16 v[176:179], v[128:131], v[104:107], v[176:179]
  ds_read_b64_tr_b16 v[148:149], v33 offset:40960
  buffer_load_dwordx4 v17, s[20:23], s95 offen offset:1024 lds
  s_add_u32 s95, s95, 458752
  v_permlane16_swap_b32 v232, v234
  v_permlane16_swap_b32 v233, v235
  v_mfma_f32_16x16x32_bf16 v[184:187], v[132:135], v[104:107], v[184:187]
  ds_read_b64_tr_b16 v[150:151], v33 offset:41984
  v_permlane16_swap_b32 v236, v238
  v_permlane16_swap_b32 v237, v239
  v_mfma_f32_16x16x32_bf16 v[188:191], v[136:139], v[104:107], v[188:191]
  ds_read_b64_tr_b16 v[152:153], v34 offset:40960
  buffer_store_dwordx4 v[232:235], v252, s[8:11], 0 offen sc1
  buffer_store_dwordx4 v[236:239], v253, s[8:11], 0 offen sc1
  v_mfma_f32_16x16x32_bf16 v[212:215], v[136:139], v[108:111], v[212:215]
  ds_read_b64_tr_b16 v[154:155], v34 offset:41984
  ds_read_b64_tr_b16 v[156:157], v36 offset:4096
  v_fma_f32 v88, v88, v8, -v9
  v_fma_f32 v89, v89, v8, -v9
  v_mfma_f32_16x16x32_bf16 v[208:211], v[132:135], v[108:111], v[208:211]
  ds_read_b64_tr_b16 v[158:159], v36 offset:4608
  v_fma_f32 v90, v90, v8, -v9
  v_fma_f32 v91, v91, v8, -v9
  v_mfma_f32_16x16x32_bf16 v[200:203], v[128:131], v[108:111], v[200:203]
  ds_read_b64_tr_b16 v[160:161], v37 offset:4096
  s_add_u32 m0, s36, 16384
  s_nop 0
  buffer_load_dwordx4 v18, s[24:27], s37 offen lds
  s_add_u32 s37, s37, 393216
  v_fma_f32 v92, v92, v8, -v9
  v_fma_f32 v93, v93, v8, -v9
  v_mfma_f32_16x16x32_bf16 v[196:199], v[124:127], v[108:111], v[196:199]
  ds_read_b64_tr_b16 v[162:163], v37 offset:4608
  v_fma_f32 v94, v94, v8, -v9
  v_fma_f32 v95, v95, v8, -v9
  v_mfma_f32_16x16x32_bf16 v[192:195], v[120:123], v[108:111], v[192:195]
  ds_read_b128 v[116:119], v31 offset:18432
  v_fma_f32 v96, v96, v8, -v9
  v_fma_f32 v97, v97, v8, -v9
  s_waitcnt vmcnt(9) lgkmcnt(0)
  s_barrier
  v_mfma_f32_16x16x32_bf16 v[168:171], v[144:147], v[112:115], v[168:171]
  ds_read_b128 v[104:107], v30 offset:32768
  ds_read_b64_tr_b16 v[120:121], v32 offset:0
  v_fma_f32 v98, v98, v8, -v9
  v_fma_f32 v99, v99, v8, -v9
  v_mfma_f32_16x16x32_bf16 v[172:175], v[148:151], v[112:115], v[172:175]
  ds_read_b64_tr_b16 v[122:123], v32 offset:1024
  s_add_u32 m0, s32, 16384
  s_nop 0
  buffer_load_dwordx4 v14, s[12:15], s93 offen lds
  v_fma_f32 v100, v100, v8, -v9
  v_fma_f32 v101, v101, v8, -v9
  v_mfma_f32_16x16x32_bf16 v[176:179], v[152:155], v[112:115], v[176:179]
  ds_read_b64_tr_b16 v[124:125], v33 offset:0
  v_fma_f32 v102, v102, v8, -v9
  v_fma_f32 v103, v103, v8, -v9
  v_mfma_f32_16x16x32_bf16 v[184:187], v[156:159], v[112:115], v[184:187]
  ds_read_b64_tr_b16 v[126:127], v33 offset:1024
  v_cvt_pk_bf16_f32 v240, v88, v89
  v_cvt_pk_bf16_f32 v241, v90, v91
  v_mfma_f32_16x16x32_bf16 v[188:191], v[160:163], v[112:115], v[188:191]
  ds_read_b64_tr_b16 v[128:129], v34 offset:0
  v_cvt_pk_bf16_f32 v242, v92, v93
  v_cvt_pk_bf16_f32 v243, v94, v95
  v_mfma_f32_16x16x32_bf16 v[212:215], v[160:163], v[116:119], v[212:215]
  ds_read_b64_tr_b16 v[130:131], v34 offset:1024
  ds_read_b64_tr_b16 v[132:133], v36 offset:8192
  buffer_load_dwordx4 v15, s[12:15], s93 offen offset:1024 lds
  s_add_u32 s93, s93, 128
  v_cvt_pk_bf16_f32 v244, v96, v97
  v_cvt_pk_bf16_f32 v245, v98, v99
  v_mfma_f32_16x16x32_bf16 v[208:211], v[156:159], v[116:119], v[208:211]
  ds_read_b64_tr_b16 v[134:135], v36 offset:8704
  v_cvt_pk_bf16_f32 v246, v100, v101
  v_cvt_pk_bf16_f32 v247, v102, v103
  v_mfma_f32_16x16x32_bf16 v[200:203], v[152:155], v[116:119], v[200:203]
  ds_read_b64_tr_b16 v[136:137], v37 offset:8192
  v_permlane16_swap_b32 v240, v242
  v_permlane16_swap_b32 v241, v243
  v_mfma_f32_16x16x32_bf16 v[196:199], v[148:151], v[116:119], v[196:199]
  ds_read_b64_tr_b16 v[138:139], v37 offset:8704
  s_add_u32 m0, s94, 32768
  s_nop 0
  buffer_load_dwordx4 v16, s[20:23], s95 offen lds
  v_permlane16_swap_b32 v244, v246
  v_permlane16_swap_b32 v245, v247
  v_mfma_f32_16x16x32_bf16 v[192:195], v[144:147], v[116:119], v[192:195]
  ds_read_b128 v[108:111], v30 offset:34816
  buffer_store_dwordx4 v[240:243], v254, s[8:11], 0 offen sc1
  buffer_store_dwordx4 v[244:247], v255, s[8:11], 0 offen sc1
  s_waitcnt lgkmcnt(0)
  v_mfma_f32_16x16x32_bf16 v[168:171], v[120:123], v[104:107], v[168:171]
  ds_read_b128 v[112:115], v31 offset:32768
  ds_read_b64_tr_b16 v[144:145], v32 offset:8192
  v_mfma_f32_16x16x32_bf16 v[172:175], v[124:127], v[104:107], v[172:175]
  ds_read_b64_tr_b16 v[146:147], v32 offset:9216
  v_mfma_f32_16x16x32_bf16 v[176:179], v[128:131], v[104:107], v[176:179]
  ds_read_b64_tr_b16 v[148:149], v33 offset:8192
  buffer_load_dwordx4 v17, s[20:23], s95 offen offset:1024 lds
  s_add_u32 s95, s95, 458752
  v_mfma_f32_16x16x32_bf16 v[184:187], v[132:135], v[104:107], v[184:187]
  ds_read_b64_tr_b16 v[150:151], v33 offset:9216
  v_mfma_f32_16x16x32_bf16 v[188:191], v[136:139], v[104:107], v[188:191]
  ds_read_b64_tr_b16 v[152:153], v34 offset:8192
  v_mfma_f32_16x16x32_bf16 v[212:215], v[136:139], v[108:111], v[212:215]
  ds_read_b64_tr_b16 v[154:155], v34 offset:9216
  ds_read_b64_tr_b16 v[156:157], v36 offset:12288
  v_mfma_f32_16x16x32_bf16 v[208:211], v[132:135], v[108:111], v[208:211]
  ds_read_b64_tr_b16 v[158:159], v36 offset:12800
  v_mfma_f32_16x16x32_bf16 v[200:203], v[128:131], v[108:111], v[200:203]
  ds_read_b64_tr_b16 v[160:161], v37 offset:12288
  s_add_u32 m0, s36, 0
  s_nop 0
  buffer_load_dwordx4 v18, s[24:27], s37 offen lds
  s_add_u32 s37, s37, 393216
  v_mfma_f32_16x16x32_bf16 v[196:199], v[124:127], v[108:111], v[196:199]
  ds_read_b64_tr_b16 v[162:163], v37 offset:12800
  v_mfma_f32_16x16x32_bf16 v[192:195], v[120:123], v[108:111], v[192:195]
  ds_read_b128 v[116:119], v31 offset:34816
  s_waitcnt vmcnt(7) lgkmcnt(0)
  s_barrier
  v_mfma_f32_16x16x32_bf16 v[168:171], v[144:147], v[112:115], v[168:171]
  ds_read_b128 v[104:107], v30 offset:0
  ds_read_b64_tr_b16 v[120:121], v32 offset:16384
  v_mfma_f32_16x16x32_bf16 v[172:175], v[148:151], v[112:115], v[172:175]
  ds_read_b64_tr_b16 v[122:123], v32 offset:17408
  s_add_u32 m0, s32, 32768
  s_nop 0
  buffer_load_dwordx4 v14, s[12:15], s93 offen lds
  v_mfma_f32_16x16x32_bf16 v[176:179], v[152:155], v[112:115], v[176:179]
  ds_read_b64_tr_b16 v[124:125], v33 offset:16384
  v_mfma_f32_16x16x32_bf16 v[184:187], v[156:159], v[112:115], v[184:187]
  ds_read_b64_tr_b16 v[126:127], v33 offset:17408
  v_mfma_f32_16x16x32_bf16 v[188:191], v[160:163], v[112:115], v[188:191]
  ds_read_b64_tr_b16 v[128:129], v34 offset:16384
  v_mfma_f32_16x16x32_bf16 v[212:215], v[160:163], v[116:119], v[212:215]
  ds_read_b64_tr_b16 v[130:131], v34 offset:17408
  ds_read_b64_tr_b16 v[132:133], v36 offset:16384
  buffer_load_dwordx4 v15, s[12:15], s93 offen offset:1024 lds
  s_add_u32 s93, s93, 128
  v_mfma_f32_16x16x32_bf16 v[208:211], v[156:159], v[116:119], v[208:211]
  ds_read_b64_tr_b16 v[134:135], v36 offset:16896
  v_mfma_f32_16x16x32_bf16 v[200:203], v[152:155], v[116:119], v[200:203]
  ds_read_b64_tr_b16 v[136:137], v37 offset:16384
  v_mfma_f32_16x16x32_bf16 v[196:199], v[148:151], v[116:119], v[196:199]
  ds_read_b64_tr_b16 v[138:139], v37 offset:16896
  s_add_u32 m0, s94, 0
  s_nop 0
  buffer_load_dwordx4 v16, s[20:23], s95 offen lds
  v_mfma_f32_16x16x32_bf16 v[192:195], v[144:147], v[116:119], v[192:195]
  ds_read_b128 v[108:111], v30 offset:2048
  s_waitcnt lgkmcnt(0)
  v_mfma_f32_16x16x32_bf16 v[168:171], v[120:123], v[104:107], v[168:171]
  ds_read_b128 v[112:115], v31 offset:0
  ds_read_b64_tr_b16 v[144:145], v32 offset:24576
  v_mfma_f32_16x16x32_bf16 v[172:175], v[124:127], v[104:107], v[172:175]
  ds_read_b64_tr_b16 v[146:147], v32 offset:25600
  v_mfma_f32_16x16x32_bf16 v[176:179], v[128:131], v[104:107], v[176:179]
  ds_read_b64_tr_b16 v[148:149], v33 offset:24576
  buffer_load_dwordx4 v17, s[20:23], s95 offen offset:1024 lds
  s_add_u32 s95, s95, 458752
  v_mfma_f32_16x16x32_bf16 v[184:187], v[132:135], v[104:107], v[184:187]
  ds_read_b64_tr_b16 v[150:151], v33 offset:25600
  v_mfma_f32_16x16x32_bf16 v[188:191], v[136:139], v[104:107], v[188:191]
  ds_read_b64_tr_b16 v[152:153], v34 offset:24576
  v_mfma_f32_16x16x32_bf16 v[212:215], v[136:139], v[108:111], v[212:215]
  ds_read_b64_tr_b16 v[154:155], v34 offset:25600
  ds_read_b64_tr_b16 v[156:157], v36 offset:20480
  v_mfma_f32_16x16x32_bf16 v[208:211], v[132:135], v[108:111], v[208:211]
  ds_read_b64_tr_b16 v[158:159], v36 offset:20992
  v_mfma_f32_16x16x32_bf16 v[200:203], v[128:131], v[108:111], v[200:203]
  ds_read_b64_tr_b16 v[160:161], v37 offset:20480
  s_add_u32 m0, s36, 8192
  s_nop 0
  buffer_load_dwordx4 v18, s[24:27], s37 offen lds
  s_add_u32 s37, s37, 393216
  v_mfma_f32_16x16x32_bf16 v[196:199], v[124:127], v[108:111], v[196:199]
  ds_read_b64_tr_b16 v[162:163], v37 offset:20992
  v_mfma_f32_16x16x32_bf16 v[192:195], v[120:123], v[108:111], v[192:195]
  ds_read_b128 v[116:119], v31 offset:2048
  s_waitcnt vmcnt(5) lgkmcnt(0)
  s_barrier
  v_mfma_f32_16x16x32_bf16 v[168:171], v[144:147], v[112:115], v[168:171]
  ds_read_b128 v[104:107], v30 offset:16384
  ds_read_b64_tr_b16 v[120:121], v32 offset:32768
  v_mfma_f32_16x16x32_bf16 v[172:175], v[148:151], v[112:115], v[172:175]
  ds_read_b64_tr_b16 v[122:123], v32 offset:33792
  s_add_u32 m0, s32, 0
  s_nop 0
  buffer_load_dwordx4 v14, s[12:15], s93 offen lds
  v_mfma_f32_16x16x32_bf16 v[176:179], v[152:155], v[112:115], v[176:179]
  ds_read_b64_tr_b16 v[124:125], v33 offset:32768
  v_mfma_f32_16x16x32_bf16 v[184:187], v[156:159], v[112:115], v[184:187]
  ds_read_b64_tr_b16 v[126:127], v33 offset:33792
  v_mfma_f32_16x16x32_bf16 v[188:191], v[160:163], v[112:115], v[188:191]
  ds_read_b64_tr_b16 v[128:129], v34 offset:32768
  v_mfma_f32_16x16x32_bf16 v[212:215], v[160:163], v[116:119], v[212:215]
  ds_read_b64_tr_b16 v[130:131], v34 offset:33792
  ds_read_b64_tr_b16 v[132:133], v36 offset:0
  buffer_load_dwordx4 v15, s[12:15], s93 offen offset:1024 lds
  s_add_u32 s93, s93, 128
  v_mfma_f32_16x16x32_bf16 v[208:211], v[156:159], v[116:119], v[208:211]
  ds_read_b64_tr_b16 v[134:135], v36 offset:512
  v_mfma_f32_16x16x32_bf16 v[200:203], v[152:155], v[116:119], v[200:203]
  ds_read_b64_tr_b16 v[136:137], v37 offset:0
  v_mfma_f32_16x16x32_bf16 v[196:199], v[148:151], v[116:119], v[196:199]
  ds_read_b64_tr_b16 v[138:139], v37 offset:512
  s_add_u32 m0, s94, 16384
  s_nop 0
  buffer_load_dwordx4 v16, s[20:23], s95 offen lds
  v_mfma_f32_16x16x32_bf16 v[192:195], v[144:147], v[116:119], v[192:195]
  ds_read_b128 v[108:111], v30 offset:18432
  s_waitcnt lgkmcnt(0)
  v_mfma_f32_16x16x32_bf16 v[168:171], v[120:123], v[104:107], v[168:171]
  ds_read_b128 v[112:115], v31 offset:16384
  ds_read_b64_tr_b16 v[144:145], v32 offset:40960
  v_mfma_f32_16x16x32_bf16 v[172:175], v[124:127], v[104:107], v[172:175]
  ds_read_b64_tr_b16 v[146:147], v32 offset:41984
  v_mfma_f32_16x16x32_bf16 v[176:179], v[128:131], v[104:107], v[176:179]
  ds_read_b64_tr_b16 v[148:149], v33 offset:40960
  buffer_load_dwordx4 v17, s[20:23], s95 offen offset:1024 lds
  s_add_u32 s95, s95, 458752
  v_mfma_f32_16x16x32_bf16 v[184:187], v[132:135], v[104:107], v[184:187]
  ds_read_b64_tr_b16 v[150:151], v33 offset:41984
  v_mfma_f32_16x16x32_bf16 v[188:191], v[136:139], v[104:107], v[188:191]
  ds_read_b64_tr_b16 v[152:153], v34 offset:40960
  v_mfma_f32_16x16x32_bf16 v[212:215], v[136:139], v[108:111], v[212:215]
  ds_read_b64_tr_b16 v[154:155], v34 offset:41984
  ds_read_b64_tr_b16 v[156:157], v36 offset:4096
  v_mfma_f32_16x16x32_bf16 v[208:211], v[132:135], v[108:111], v[208:211]
  ds_read_b64_tr_b16 v[158:159], v36 offset:4608
  v_mfma_f32_16x16x32_bf16 v[200:203], v[128:131], v[108:111], v[200:203]
  ds_read_b64_tr_b16 v[160:161], v37 offset:4096
  s_add_u32 m0, s36, 16384
  s_nop 0
  buffer_load_dwordx4 v18, s[24:27], s37 offen lds
  s_add_u32 s37, s37, 393216
  v_mfma_f32_16x16x32_bf16 v[196:199], v[124:127], v[108:111], v[196:199]
  ds_read_b64_tr_b16 v[162:163], v37 offset:4608
  v_mfma_f32_16x16x32_bf16 v[192:195], v[120:123], v[108:111], v[192:195]
  ds_read_b128 v[116:119], v31 offset:18432
  s_waitcnt vmcnt(5) lgkmcnt(0)
  s_barrier
  s_cmp_lg_u32 s74, 1
  s_cbranch_scc1 nz2_40
  s_cmp_lg_u32 s3, 0
  s_cbranch_scc1 ow_41
  v_mov_b32 v8, 1
  v_mov_b32 v9, 0
  s_mov_b64 exec, 1
  buffer_store_dword v8, v9, s[8:11], s76 offen sc1
  s_mov_b64 exec, -1
ow_41:
nz2_40:
  v_mfma_f32_16x16x32_bf16 v[168:171], v[144:147], v[112:115], v[168:171]
  ds_read_b128 v[104:107], v30 offset:32768
  ds_read_b64_tr_b16 v[120:121], v32 offset:0
  v_mfma_f32_16x16x32_bf16 v[172:175], v[148:151], v[112:115], v[172:175]
  ds_read_b64_tr_b16 v[122:123], v32 offset:1024
  s_add_u32 m0, s32, 16384
  s_nop 0
  buffer_load_dwordx4 v14, s[12:15], s93 offen lds
  v_mfma_f32_16x16x32_bf16 v[176:179], v[152:155], v[112:115], v[176:179]
  ds_read_b64_tr_b16 v[124:125], v33 offset:0
  v_mfma_f32_16x16x32_bf16 v[184:187], v[156:159], v[112:115], v[184:187]
  ds_read_b64_tr_b16 v[126:127], v33 offset:1024
  v_mfma_f32_16x16x32_bf16 v[188:191], v[160:163], v[112:115], v[188:191]
  ds_read_b64_tr_b16 v[128:129], v34 offset:0
  v_mfma_f32_16x16x32_bf16 v[212:215], v[160:163], v[116:119], v[212:215]
  ds_read_b64_tr_b16 v[130:131], v34 offset:1024
  ds_read_b64_tr_b16 v[132:133], v36 offset:8192
  buffer_load_dwordx4 v15, s[12:15], s93 offen offset:1024 lds
  s_add_u32 s93, s93, 128
  v_mfma_f32_16x16x32_bf16 v[208:211], v[156:159], v[116:119], v[208:211]
  ds_read_b64_tr_b16 v[134:135], v36 offset:8704
  v_mfma_f32_16x16x32_bf16 v[200:203], v[152:155], v[116:119], v[200:203]
  ds_read_b64_tr_b16 v[136:137], v37 offset:8192
  v_mfma_f32_16x16x32_bf16 v[196:199], v[148:151], v[116:119], v[196:199]
  ds_read_b64_tr_b16 v[138:139], v37 offset:8704
  s_add_u32 m0, s94, 32768
  s_nop 0
  buffer_load_dwordx4 v16, s[20:23], s95 offen lds
  v_mfma_f32_16x16x32_bf16 v[192:195], v[144:147], v[116:119], v[192:195]
  ds_read_b128 v[108:111], v30 offset:34816
  s_waitcnt lgkmcnt(0)
  v_mfma_f32_16x16x32_bf16 v[168:171], v[120:123], v[104:107], v[168:171]
  ds_read_b128 v[112:115], v31 offset:32768
  ds_read_b64_tr_b16 v[144:145], v32 offset:8192
  v_mfma_f32_16x16x32_bf16 v[172:175], v[124:127], v[104:107], v[172:175]
  ds_read_b64_tr_b16 v[146:147], v32 offset:9216
  v_mfma_f32_16x16x32_bf16 v[176:179], v[128:131], v[104:107], v[176:179]
  ds_read_b64_tr_b16 v[148:149], v33 offset:8192
  buffer_load_dwordx4 v17, s[20:23], s95 offen offset:1024 lds
  s_add_u32 s95, s95, 458752
  v_mfma_f32_16x16x32_bf16 v[184:187], v[132:135], v[104:107], v[184:187]
  ds_read_b64_tr_b16 v[150:151], v33 offset:9216
  v_mfma_f32_16x16x32_bf16 v[188:191], v[136:139], v[104:107], v[188:191]
  ds_read_b64_tr_b16 v[152:153], v34 offset:8192
  v_mfma_f32_16x16x32_bf16 v[212:215], v[136:139], v[108:111], v[212:215]
  ds_read_b64_tr_b16 v[154:155], v34 offset:9216
  ds_read_b64_tr_b16 v[156:157], v36 offset:12288
  v_mfma_f32_16x16x32_bf16 v[208:211], v[132:135], v[108:111], v[208:211]
  ds_read_b64_tr_b16 v[158:159], v36 offset:12800
  v_mfma_f32_16x16x32_bf16 v[200:203], v[128:131], v[108:111], v[200:203]
  ds_read_b64_tr_b16 v[160:161], v37 offset:12288
  s_add_u32 m0, s36, 0
  s_nop 0
  buffer_load_dwordx4 v18, s[24:27], s37 offen lds
  s_add_u32 s37, s37, 393216
  v_mfma_f32_16x16x32_bf16 v[196:199], v[124:127], v[108:111], v[196:199]
  ds_read_b64_tr_b16 v[162:163], v37 offset:12800
  v_mfma_f32_16x16x32_bf16 v[192:195], v[120:123], v[108:111], v[192:195]
  ds_read_b128 v[116:119], v31 offset:34816
  s_waitcnt vmcnt(5) lgkmcnt(0)
  s_barrier
  v_mfma_f32_16x16x32_bf16 v[168:171], v[144:147], v[112:115], v[168:171]
  ds_read_b128 v[104:107], v30 offset:0
  ds_read_b64_tr_b16 v[120:121], v32 offset:16384
  v_mfma_f32_16x16x32_bf16 v[172:175], v[148:151], v[112:115], v[172:175]
  ds_read_b64_tr_b16 v[122:123], v32 offset:17408
  s_add_u32 m0, s32, 32768
  s_nop 0
  buffer_load_dwordx4 v14, s[12:15], s93 offen lds
  v_mfma_f32_16x16x32_bf16 v[176:179], v[152:155], v[112:115], v[176:179]
  ds_read_b64_tr_b16 v[124:125], v33 offset:16384
  v_mfma_f32_16x16x32_bf16 v[184:187], v[156:159], v[112:115], v[184:187]
  ds_read_b64_tr_b16 v[126:127], v33 offset:17408
  v_mfma_f32_16x16x32_bf16 v[188:191], v[160:163], v[112:115], v[188:191]
  ds_read_b64_tr_b16 v[128:129], v34 offset:16384
  v_mfma_f32_16x16x32_bf16 v[212:215], v[160:163], v[116:119], v[212:215]
  ds_read_b64_tr_b16 v[130:131], v34 offset:17408
  ds_read_b64_tr_b16 v[132:133], v36 offset:16384
  buffer_load_dwordx4 v15, s[12:15], s93 offen offset:1024 lds
  s_add_u32 s93, s93, 128
  v_mfma_f32_16x16x32_bf16 v[208:211], v[156:159], v[116:119], v[208:211]
  ds_read_b64_tr_b16 v[134:135], v36 offset:16896
  v_mfma_f32_16x16x32_bf16 v[200:203], v[152:155], v[116:119], v[200:203]
  ds_read_b64_tr_b16 v[136:137], v37 offset:16384
  v_mfma_f32_16x16x32_bf16 v[196:199], v[148:151], v[116:119], v[196:199]
  ds_read_b64_tr_b16 v[138:139], v37 offset:16896
  s_add_u32 m0, s94, 0
  s_nop 0
  buffer_load_dwordx4 v16, s[20:23], s95 offen lds
  v_mfma_f32_16x16x32_bf16 v[192:195], v[144:147], v[116:119], v[192:195]
  ds_read_b128 v[108:111], v30 offset:2048
  s_waitcnt lgkmcnt(0)
  v_mfma_f32_16x16x32_bf16 v[168:171], v[120:123], v[104:107], v[168:171]
  ds_read_b128 v[112:115], v31 offset:0
  ds_read_b64_tr_b16 v[144:145], v32 offset:24576
  v_mfma_f32_16x16x32_bf16 v[172:175], v[124:127], v[104:107], v[172:175]
  ds_read_b64_tr_b16 v[146:147], v32 offset:25600
  v_mfma_f32_16x16x32_bf16 v[176:179], v[128:131], v[104:107], v[176:179]
  ds_read_b64_tr_b16 v[148:149], v33 offset:24576
  buffer_load_dwordx4 v17, s[20:23], s95 offen offset:1024 lds
  s_add_u32 s95, s95, 458752
  v_mfma_f32_16x16x32_bf16 v[184:187], v[132:135], v[104:107], v[184:187]
  ds_read_b64_tr_b16 v[150:151], v33 offset:25600
  v_mfma_f32_16x16x32_bf16 v[188:191], v[136:139], v[104:107], v[188:191]
  ds_read_b64_tr_b16 v[152:153], v34 offset:24576
  v_mfma_f32_16x16x32_bf16 v[212:215], v[136:139], v[108:111], v[212:215]
  ds_read_b64_tr_b16 v[154:155], v34 offset:25600
  ds_read_b64_tr_b16 v[156:157], v36 offset:20480
  v_mfma_f32_16x16x32_bf16 v[208:211], v[132:135], v[108:111], v[208:211]
  ds_read_b64_tr_b16 v[158:159], v36 offset:20992
  v_mfma_f32_16x16x32_bf16 v[200:203], v[128:131], v[108:111], v[200:203]
  ds_read_b64_tr_b16 v[160:161], v37 offset:20480
  s_add_u32 m0, s36, 8192
  s_nop 0
  buffer_load_dwordx4 v18, s[24:27], s37 offen lds
  s_add_u32 s37, s37, 393216
  v_mfma_f32_16x16x32_bf16 v[196:199], v[124:127], v[108:111], v[196:199]
  ds_read_b64_tr_b16 v[162:163], v37 offset:20992
  v_mfma_f32_16x16x32_bf16 v[192:195], v[120:123], v[108:111], v[192:195]
  ds_read_b128 v[116:119], v31 offset:2048
  s_waitcnt vmcnt(5) lgkmcnt(0)
  s_barrier
  s_cmp_lg_u32 s3, 0
  s_cbranch_scc1 ow_42
  buffer_load_dword v12, v13, s[8:11], 0 offen sc1
ow_42:
  v_mfma_f32_16x16x32_bf16 v[168:171], v[144:147], v[112:115], v[168:171]
  ds_read_b128 v[104:107], v30 offset:16384
  ds_read_b64_tr_b16 v[120:121], v32 offset:32768
  v_mfma_f32_16x16x32_bf16 v[172:175], v[148:151], v[112:115], v[172:175]
  ds_read_b64_tr_b16 v[122:123], v32 offset:33792
  s_add_u32 m0, s32, 0
  s_nop 0
  buffer_load_dwordx4 v14, s[12:15], s93 offen lds
  v_mfma_f32_16x16x32_bf16 v[176:179], v[152:155], v[112:115], v[176:179]
  ds_read_b64_tr_b16 v[124:125], v33 offset:32768
  v_mfma_f32_16x16x32_bf16 v[184:187], v[156:159], v[112:115], v[184:187]
  ds_read_b64_tr_b16 v[126:127], v33 offset:33792
  v_mfma_f32_16x16x32_bf16 v[188:191], v[160:163], v[112:115], v[188:191]
  ds_read_b64_tr_b16 v[128:129], v34 offset:32768
  v_mfma_f32_16x16x32_bf16 v[212:215], v[160:163], v[116:119], v[212:215]
  ds_read_b64_tr_b16 v[130:131], v34 offset:33792
  ds_read_b64_tr_b16 v[132:133], v36 offset:0
  buffer_load_dwordx4 v15, s[12:15], s93 offen offset:1024 lds
  s_add_u32 s93, s93, 128
  v_mfma_f32_16x16x32_bf16 v[208:211], v[156:159], v[116:119], v[208:211]
  ds_read_b64_tr_b16 v[134:135], v36 offset:512
  v_mfma_f32_16x16x32_bf16 v[200:203], v[152:155], v[116:119], v[200:203]
  ds_read_b64_tr_b16 v[136:137], v37 offset:0
  v_mfma_f32_16x16x32_bf16 v[196:199], v[148:151], v[116:119], v[196:199]
  ds_read_b64_tr_b16 v[138:139], v37 offset:512
  s_add_u32 m0, s94, 16384
  s_nop 0
  buffer_load_dwordx4 v16, s[20:23], s95 offen lds
  v_mfma_f32_16x16x32_bf16 v[192:195], v[144:147], v[116:119], v[192:195]
  ds_read_b128 v[108:111], v30 offset:18432
  s_waitcnt lgkmcnt(0)
  v_mfma_f32_16x16x32_bf16 v[168:171], v[120:123], v[104:107], v[168:171]
  ds_read_b128 v[112:115], v31 offset:16384
  ds_read_b64_tr_b16 v[144:145], v32 offset:40960
  v_mfma_f32_16x16x32_bf16 v[172:175], v[124:127], v[104:107], v[172:175]
  ds_read_b64_tr_b16 v[146:147], v32 offset:41984
  v_mfma_f32_16x16x32_bf16 v[176:179], v[128:131], v[104:107], v[176:179]
  ds_read_b64_tr_b16 v[148:149], v33 offset:40960
  buffer_load_dwordx4 v17, s[20:23], s95 offen offset:1024 lds
  s_add_u32 s95, s95, 458752
  v_mfma_f32_16x16x32_bf16 v[184:187], v[132:135], v[104:107], v[184:187]
  ds_read_b64_tr_b16 v[150:151], v33 offset:41984
  v_mfma_f32_16x16x32_bf16 v[188:191], v[136:139], v[104:107], v[188:191]
  ds_read_b64_tr_b16 v[152:153], v34 offset:40960
  v_mfma_f32_16x16x32_bf16 v[212:215], v[136:139], v[108:111], v[212:215]
  ds_read_b64_tr_b16 v[154:155], v34 offset:41984
  ds_read_b64_tr_b16 v[156:157], v36 offset:4096
  v_mfma_f32_16x16x32_bf16 v[208:211], v[132:135], v[108:111], v[208:211]
  ds_read_b64_tr_b16 v[158:159], v36 offset:4608
  v_mfma_f32_16x16x32_bf16 v[200:203], v[128:131], v[108:111], v[200:203]
  ds_read_b64_tr_b16 v[160:161], v37 offset:4096
  s_add_u32 m0, s36, 16384
  s_nop 0
  buffer_load_dwordx4 v18, s[24:27], s37 offen lds
  s_add_u32 s37, s37, 393216
  v_mfma_f32_16x16x32_bf16 v[196:199], v[124:127], v[108:111], v[196:199]
  ds_read_b64_tr_b16 v[162:163], v37 offset:4608
  v_mfma_f32_16x16x32_bf16 v[192:195], v[120:123], v[108:111], v[192:195]
  ds_read_b128 v[116:119], v31 offset:18432
  s_waitcnt vmcnt(5) lgkmcnt(0)
  s_barrier
  v_mfma_f32_16x16x32_bf16 v[168:171], v[144:147], v[112:115], v[168:171]
  ds_read_b128 v[104:107], v30 offset:32768
  ds_read_b64_tr_b16 v[120:121], v32 offset:0
  v_mfma_f32_16x16x32_bf16 v[172:175], v[148:151], v[112:115], v[172:175]
  ds_read_b64_tr_b16 v[122:123], v32 offset:1024
  s_add_u32 m0, s32, 16384
  s_nop 0
  buffer_load_dwordx4 v14, s[12:15], s93 offen lds
  v_mfma_f32_16x16x32_bf16 v[176:179], v[152:155], v[112:115], v[176:179]
  ds_read_b64_tr_b16 v[124:125], v33 offset:0
  v_mfma_f32_16x16x32_bf16 v[184:187], v[156:159], v[112:115], v[184:187]
  ds_read_b64_tr_b16 v[126:127], v33 offset:1024
  v_mfma_f32_16x16x32_bf16 v[188:191], v[160:163], v[112:115], v[188:191]
  ds_read_b64_tr_b16 v[128:129], v34 offset:0
  v_mfma_f32_16x16x32_bf16 v[212:215], v[160:163], v[116:119], v[212:215]
  ds_read_b64_tr_b16 v[130:131], v34 offset:1024
  ds_read_b64_tr_b16 v[132:133], v36 offset:8192
  buffer_load_dwordx4 v15, s[12:15], s93 offen offset:1024 lds
  s_add_u32 s93, s93, 128
  v_mfma_f32_16x16x32_bf16 v[208:211], v[156:159], v[116:119], v[208:211]
  ds_read_b64_tr_b16 v[134:135], v36 offset:8704
  v_mfma_f32_16x16x32_bf16 v[200:203], v[152:155], v[116:119], v[200:203]
  ds_read_b64_tr_b16 v[136:137], v37 offset:8192
  v_mfma_f32_16x16x32_bf16 v[196:199], v[148:151], v[116:119], v[196:199]
  ds_read_b64_tr_b16 v[138:139], v37 offset:8704
  s_add_u32 m0, s94, 32768
  s_nop 0
  buffer_load_dwordx4 v16, s[20:23], s95 offen lds
  v_mfma_f32_16x16x32_bf16 v[192:195], v[144:147], v[116:119], v[192:195]
  ds_read_b128 v[108:111], v30 offset:34816
  s_waitcnt lgkmcnt(0)
  v_mfma_f32_16x16x32_bf16 v[168:171], v[120:123], v[104:107], v[168:171]
  ds_read_b128 v[112:115], v31 offset:32768
  ds_read_b64_tr_b16 v[144:145], v32 offset:8192
  v_mfma_f32_16x16x32_bf16 v[172:175], v[124:127], v[104:107], v[172:175]
  ds_read_b64_tr_b16 v[146:147], v32 offset:9216
  v_mfma_f32_16x16x32_bf16 v[176:179], v[128:131], v[104:107], v[176:179]
  ds_read_b64_tr_b16 v[148:149], v33 offset:8192
  buffer_load_dwordx4 v17, s[20:23], s95 offen offset:1024 lds
  s_add_u32 s95, s95, 458752
  v_mfma_f32_16x16x32_bf16 v[184:187], v[132:135], v[104:107], v[184:187]
  ds_read_b64_tr_b16 v[150:151], v33 offset:9216
  v_mfma_f32_16x16x32_bf16 v[188:191], v[136:139], v[104:107], v[188:191]
  ds_read_b64_tr_b16 v[152:153], v34 offset:8192
  v_mfma_f32_16x16x32_bf16 v[212:215], v[136:139], v[108:111], v[212:215]
  ds_read_b64_tr_b16 v[154:155], v34 offset:9216
  ds_read_b64_tr_b16 v[156:157], v36 offset:12288
  v_mfma_f32_16x16x32_bf16 v[208:211], v[132:135], v[108:111], v[208:211]
  ds_read_b64_tr_b16 v[158:159], v36 offset:12800
  v_mfma_f32_16x16x32_bf16 v[200:203], v[128:131], v[108:111], v[200:203]
  ds_read_b64_tr_b16 v[160:161], v37 offset:12288
  s_add_u32 m0, s36, 0
  s_nop 0
  buffer_load_dwordx4 v18, s[24:27], s37 offen lds
  s_add_u32 s37, s37, 393216
  v_mfma_f32_16x16x32_bf16 v[196:199], v[124:127], v[108:111], v[196:199]
  ds_read_b64_tr_b16 v[162:163], v37 offset:12800
  v_mfma_f32_16x16x32_bf16 v[192:195], v[120:123], v[108:111], v[192:195]
  ds_read_b128 v[116:119], v31 offset:34816
  s_cmp_lg_u32 s3, 0
  s_cbranch_scc1 ow_43
  s_waitcnt vmcnt(10)
  v_cmp_ne_u32 vcc, 0, v12
  s_cmp_eq_u32 vcc_hi, -1
  s_cbranch_scc1 pok_44
  s_mov_b32 s75, 400000
psp_45:
  buffer_load_dword v12, v13, s[8:11], 0 offen sc1
  s_waitcnt vmcnt(0)
  v_cmp_ne_u32 vcc, 0, v12
  s_cmp_eq_u32 vcc_hi, -1
  s_cbranch_scc1 pok_44
  s_sub_u32 s75, s75, 1
  s_cmp_lg_u32 s75, 0
  s_cbranch_scc1 psp_45
pok_44:
ow_43:
  s_waitcnt vmcnt(5) lgkmcnt(0)
  s_barrier
  s_lshr_b32 s4, s2, 3
  s_lshl_b32 s4, s4, 17
  s_bfe_u32 s5, s2, 0x20001
  s_lshl_b32 s5, s5, 10
  s_add_u32 s4, s4, s5
  s_and_b32 s5, s2, 1
  s_lshl_b32 s5, s5, 3
  s_add_u32 s4, s4, s5
  s_lshl_b32 s5, s3, 14
  s_add_u32 s4, s4, s5
  s_add_u32 s4, s4, 33554432
  v_lshlrev_b32 v3, 4, v1
  buffer_load_dwordx2 v[216:217], v3, s[8:11], s4 offen sc1
  s_add_u32 s4, s4, 4096
  buffer_load_dwordx2 v[218:219], v3, s[8:11], s4 offen sc1
  s_add_u32 s4, s4, 4096
  buffer_load_dwordx2 v[220:221], v3, s[8:11], s4 offen sc1
  s_add_u32 s4, s4, 4096
  buffer_load_dwordx2 v[222:223], v3, s[8:11], s4 offen sc1
  s_lshr_b32 s4, s2, 3
  s_lshl_b32 s4, s4, 13
  s_lshl_b32 s5, s3, 10
  s_add_u32 s4, s4, s5
  s_add_u32 s4, s4, 13631488
  v_lshlrev_b32 v3, 2, v1
  buffer_load_dword v224, v3, s[8:11], s4 offen offset:0 sc1
  buffer_load_dword v225, v3, s[8:11], s4 offen offset:256 sc1
  buffer_load_dword v226, v3, s[8:11], s4 offen offset:512 sc1
  buffer_load_dword v227, v3, s[8:11], s4 offen offset:768 sc1
  s_lshl_b32 s4, s44, 6
  s_lshl_b32 s5, s82, 5
  s_add_u32 s4, s4, s5
  s_add_u32 s4, s4, s77
  v_and_b32 v20, 15, v1
  v_add_u32 v20, s4, v20
  v_lshlrev_b32 v4, 4, v20
  s_mov_b32 s4, 14942208
  buffer_load_dword v21, v4, s[8:11], s4 offen sc1
  buffer_load_dword v22, v4, s[8:11], s4 offen offset:256 sc1
  s_mov_b32 s28, s62
  s_and_b32 s29, s63, 0xffff
  s_mov_b32 s30, 4096
  s_mov_b32 s31, 0x20000
  v_lshlrev_b32 v4, 1, v20
  buffer_load_ushort v23, v4, s[28:31], 0 offen
  buffer_load_ushort v24, v4, s[28:31], 0 offen offset:32
  v_mfma_f32_16x16x32_bf16 v[168:171], v[144:147], v[112:115], v[168:171]
  ds_read_b128 v[104:107], v30 offset:0
  ds_read_b64_tr_b16 v[120:121], v32 offset:16384
  v_mfma_f32_16x16x32_bf16 v[172:175], v[148:151], v[112:115], v[172:175]
  ds_read_b64_tr_b16 v[122:123], v32 offset:17408
  v_mfma_f32_16x16x32_bf16 v[176:179], v[152:155], v[112:115], v[176:179]
  ds_read_b64_tr_b16 v[124:125], v33 offset:16384
  v_mfma_f32_16x16x32_bf16 v[184:187], v[156:159], v[112:115], v[184:187]
  ds_read_b64_tr_b16 v[126:127], v33 offset:17408
  v_mfma_f32_16x16x32_bf16 v[188:191], v[160:163], v[112:115], v[188:191]
  ds_read_b64_tr_b16 v[128:129], v34 offset:16384
  v_mfma_f32_16x16x32_bf16 v[212:215], v[160:163], v[116:119], v[212:215]
  ds_read_b64_tr_b16 v[130:131], v34 offset:17408
  ds_read_b64_tr_b16 v[132:133], v36 offset:16384
  v_mfma_f32_16x16x32_bf16 v[208:211], v[156:159], v[116:119], v[208:211]
  ds_read_b64_tr_b16 v[134:135], v36 offset:16896
  v_mfma_f32_16x16x32_bf16 v[200:203], v[152:155], v[116:119], v[200:203]
  ds_read_b64_tr_b16 v[136:137], v37 offset:16384
  v_mfma_f32_16x16x32_bf16 v[196:199], v[148:151], v[116:119], v[196:199]
  ds_read_b64_tr_b16 v[138:139], v37 offset:16896
  v_mfma_f32_16x16x32_bf16 v[192:195], v[144:147], v[116:119], v[192:195]
  ds_read_b128 v[108:111], v30 offset:2048
  s_waitcnt lgkmcnt(0)
  v_mfma_f32_16x16x32_bf16 v[168:171], v[120:123], v[104:107], v[168:171]
  ds_read_b128 v[112:115], v31 offset:0
  ds_read_b64_tr_b16 v[144:145], v32 offset:24576
  s_mov_b32 s12, s60
  s_and_b32 s13, s61, 0xffff
  s_mov_b32 s14, 8388608
  v_mfma_f32_16x16x32_bf16 v[172:175], v[124:127], v[104:107], v[172:175]
  ds_read_b64_tr_b16 v[146:147], v32 offset:25600
  s_mov_b32 s15, 0x20000
  s_mov_b32 s16, s72
  v_mfma_f32_16x16x32_bf16 v[176:179], v[128:131], v[104:107], v[176:179]
  ds_read_b64_tr_b16 v[148:149], v33 offset:24576
  s_and_b32 s17, s73, 0xffff
  s_mov_b32 s18, 7340032
  v_mfma_f32_16x16x32_bf16 v[184:187], v[132:135], v[104:107], v[184:187]
  ds_read_b64_tr_b16 v[150:151], v33 offset:25600
  s_mov_b32 s19, 0x20000
  s_lshl_b32 s32, s3, 11
  v_mfma_f32_16x16x32_bf16 v[188:191], v[136:139], v[104:107], v[188:191]
  ds_read_b64_tr_b16 v[152:153], v34 offset:24576
  s_mul_i32 s34, s3, 2048
  s_add_u32 s34, s34, 65536
  v_mfma_f32_16x16x32_bf16 v[212:215], v[136:139], v[108:111], v[212:215]
  ds_read_b64_tr_b16 v[154:155], v34 offset:25600
  ds_read_b64_tr_b16 v[156:157], v36 offset:20480
  s_lshl_b32 s4, s3, 4
  s_add_u32 s4, s4, s77
  s_mul_i32 s33, s4, 4096
  v_mfma_f32_16x16x32_bf16 v[208:211], v[132:135], v[108:111], v[208:211]
  ds_read_b64_tr_b16 v[158:159], v36 offset:20992
  v_mul_u32_u24 v2, 4096, v0
  v_add_u32 v14, v2, v38
  v_mfma_f32_16x16x32_bf16 v[200:203], v[128:131], v[108:111], v[200:203]
  ds_read_b64_tr_b16 v[160:161], v37 offset:20480
  v_xor_b32 v15, 64, v38
  v_add_u32 v2, 31744, v2
  v_mfma_f32_16x16x32_bf16 v[196:199], v[124:127], v[108:111], v[196:199]
  ds_read_b64_tr_b16 v[162:163], v37 offset:20992
  v_add_u32 v15, v15, v2
  s_mul_i32 s34, s3, 2176
  v_mfma_f32_16x16x32_bf16 v[192:195], v[120:123], v[108:111], v[192:195]
  ds_read_b128 v[116:119], v31 offset:2048
  s_add_u32 s34, s34, 65536
  s_mul_i32 s35, s43, 458752
  s_waitcnt vmcnt(12) lgkmcnt(0)
  s_barrier
  s_cmp_lg_u32 s3, 0
  s_cbranch_scc1 ow_46
  buffer_load_dword v12, v13, s[8:11], 0 offen sc1
ow_46:
  v_mfma_f32_16x16x32_bf16 v[168:171], v[144:147], v[112:115], v[168:171]
  ds_read_b128 v[104:107], v30 offset:16384
  ds_read_b64_tr_b16 v[120:121], v32 offset:32768
  s_lshl_b32 s4, s3, 11
  s_add_u32 s35, s35, s4
  v_lshlrev_b32 v16, 4, v1
  v_mfma_f32_16x16x32_bf16 v[172:175], v[148:151], v[112:115], v[172:175]
  ds_read_b64_tr_b16 v[122:123], v32 offset:33792
  s_cmp_eq_u32 s3, 7
  s_cselect_b32 s4, 2146435072, 0
  s_cselect_b32 s34, 163840, s34
  v_add_u32 v16, s4, v16
  v_mfma_f32_16x16x32_bf16 v[176:179], v[152:155], v[112:115], v[176:179]
  ds_read_b64_tr_b16 v[124:125], v33 offset:32768
  v_mov_b32 v17, v16
  s_mov_b32 s24, s54
  v_mfma_f32_16x16x32_bf16 v[184:187], v[156:159], v[112:115], v[184:187]
  ds_read_b64_tr_b16 v[126:127], v33 offset:33792
  s_cmp_eq_u32 s3, 1
  s_cselect_b32 s24, s64, s24
  s_cmp_eq_u32 s3, 2
  s_cselect_b32 s24, s64, s24
  s_mov_b32 s25, s55
  v_mfma_f32_16x16x32_bf16 v[188:191], v[160:163], v[112:115], v[188:191]
  ds_read_b64_tr_b16 v[128:129], v34 offset:32768
  s_cmp_eq_u32 s3, 1
  s_cselect_b32 s25, s65, s25
  s_cmp_eq_u32 s3, 2
  s_cselect_b32 s25, s65, s25
  v_mfma_f32_16x16x32_bf16 v[212:215], v[160:163], v[116:119], v[212:215]
  ds_read_b64_tr_b16 v[130:131], v34 offset:33792
  ds_read_b64_tr_b16 v[132:133], v36 offset:0
  s_and_b32 s25, s25, 0xffff
  s_mov_b32 s26, 2097152
  v_mfma_f32_16x16x32_bf16 v[208:211], v[156:159], v[116:119], v[208:211]
  ds_read_b64_tr_b16 v[134:135], v36 offset:512
  s_cmp_eq_u32 s3, 1
  s_cselect_b32 s26, 3670016, s26
  s_cmp_eq_u32 s3, 2
  s_cselect_b32 s26, 3670016, s26
  s_cmp_eq_u32 s3, 3
  s_cselect_b32 s26, 0, s26
  v_mfma_f32_16x16x32_bf16 v[200:203], v[152:155], v[116:119], v[200:203]
  ds_read_b64_tr_b16 v[136:137], v37 offset:0
  s_cmp_eq_u32 s3, 4
  s_cselect_b32 s26, 0, s26
  s_cmp_eq_u32 s3, 5
  s_cselect_b32 s26, 0, s26
  v_mfma_f32_16x16x32_bf16 v[196:199], v[148:151], v[116:119], v[196:199]
  ds_read_b64_tr_b16 v[138:139], v37 offset:512
  s_cmp_eq_u32 s3, 6
  s_cselect_b32 s26, 0, s26
  s_cmp_eq_u32 s3, 7
  s_cselect_b32 s26, 0, s26
  v_mfma_f32_16x16x32_bf16 v[192:195], v[144:147], v[116:119], v[192:195]
  ds_read_b128 v[108:111], v30 offset:18432
  s_mov_b32 s27, 0x20000
  s_mov_b32 s39, 8192
  s_waitcnt lgkmcnt(0)
  v_mfma_f32_16x16x32_bf16 v[168:171], v[120:123], v[104:107], v[168:171]
  ds_read_b128 v[112:115], v31 offset:16384
  ds_read_b64_tr_b16 v[144:145], v32 offset:40960
  s_cmp_eq_u32 s3, 1
  s_cselect_b32 s39, 14336, s39
  s_cmp_eq_u32 s3, 2
  s_cselect_b32 s39, 14336, s39
  s_cmp_eq_u32 s3, 3
  s_cselect_b32 s39, 0, s39
  v_mfma_f32_16x16x32_bf16 v[172:175], v[124:127], v[104:107], v[172:175]
  ds_read_b64_tr_b16 v[146:147], v32 offset:41984
  s_cmp_eq_u32 s3, 4
  s_cselect_b32 s39, 0, s39
  s_cmp_eq_u32 s3, 5
  s_cselect_b32 s39, 0, s39
  v_mfma_f32_16x16x32_bf16 v[176:179], v[128:131], v[104:107], v[176:179]
  ds_read_b64_tr_b16 v[148:149], v33 offset:40960
  s_cmp_eq_u32 s3, 6
  s_cselect_b32 s39, 0, s39
  s_cmp_eq_u32 s3, 7
  s_cselect_b32 s39, 0, s39
  v_mfma_f32_16x16x32_bf16 v[184:187], v[132:135], v[104:107], v[184:187]
  ds_read_b64_tr_b16 v[150:151], v33 offset:41984
  s_mul_i32 s38, s39, s2
  s_cmp_eq_u32 s3, 2
  s_cselect_b32 s4, 8192, 0
  v_mfma_f32_16x16x32_bf16 v[188:191], v[136:139], v[104:107], v[188:191]
  ds_read_b64_tr_b16 v[152:153], v34 offset:40960
  s_add_u32 s38, s38, s4
  s_mov_b32 s4, 63
  v_mfma_f32_16x16x32_bf16 v[212:215], v[136:139], v[108:111], v[212:215]
  ds_read_b64_tr_b16 v[154:155], v34 offset:41984
  ds_read_b64_tr_b16 v[156:157], v36 offset:4096
  s_cmp_eq_u32 s3, 2
  s_cselect_b32 s4, 47, s4
  s_cmp_eq_u32 s3, 3
  s_cselect_b32 s4, 0, s4
  s_cmp_eq_u32 s3, 4
  s_cselect_b32 s4, 0, s4
  v_mfma_f32_16x16x32_bf16 v[208:211], v[132:135], v[108:111], v[208:211]
  ds_read_b64_tr_b16 v[158:159], v36 offset:4608
  s_cmp_eq_u32 s3, 5
  s_cselect_b32 s4, 0, s4
  s_cmp_eq_u32 s3, 6
  s_cselect_b32 s4, 0, s4
  v_mfma_f32_16x16x32_bf16 v[200:203], v[128:131], v[108:111], v[200:203]
  ds_read_b64_tr_b16 v[160:161], v37 offset:4096
  s_cmp_eq_u32 s3, 7
  s_cselect_b32 s4, 0, s4
  v_min_u32 v2, s4, v1
  v_mfma_f32_16x16x32_bf16 v[196:199], v[124:127], v[108:111], v[196:199]
  ds_read_b64_tr_b16 v[162:163], v37 offset:4608
  v_lshlrev_b32 v11, 7, v2
  v_and_b32 v2, 15, v1
  v_mfma_f32_16x16x32_bf16 v[192:195], v[120:123], v[108:111], v[192:195]
  ds_read_b128 v[116:119], v31 offset:18432
  s_mul_i32 s4, s44, 8192
  v_lshlrev_b32 v2, 7, v2
  s_waitcnt lgkmcnt(0)
  v_mfma_f32_16x16x32_bf16 v[168:171], v[144:147], v[112:115], v[168:171]
  v_add_u32 v2, s4, v2
  v_bfe_u32 v3, v1, 1, 3
  v_lshrrev_b32 v4, 4, v1
  v_mfma_f32_16x16x32_bf16 v[172:175], v[148:151], v[112:115], v[172:175]
  s_lshl_b32 s4, s82, 2
  v_add_u32 v4, s4, v4
  v_mfma_f32_16x16x32_bf16 v[176:179], v[152:155], v[112:115], v[176:179]
  v_xor_b32 v4, v4, v3
  v_lshl_add_u32 v28, v4, 4, v2
  v_mfma_f32_16x16x32_bf16 v[184:187], v[156:159], v[112:115], v[184:187]
  v_lshrrev_b32 v2, 4, v1
  v_lshlrev_b32 v2, 3, v2
  v_mfma_f32_16x16x32_bf16 v[188:191], v[160:163], v[112:115], v[188:191]
  v_bfe_u32 v3, v1, 2, 2
  v_add_u32 v2, v2, v3
  v_mfma_f32_16x16x32_bf16 v[212:215], v[160:163], v[116:119], v[212:215]
  s_lshl_b32 s4, s82, 5
  v_add_u32 v2, s4, v2
  v_lshlrev_b32 v2, 4, v2
  v_mfma_f32_16x16x32_bf16 v[208:211], v[156:159], v[116:119], v[208:211]
  v_and_b32 v3, 1, v1
  v_lshl_add_u32 v2, v3, 3, v2
  v_mfma_f32_16x16x32_bf16 v[200:203], v[152:155], v[116:119], v[200:203]
  v_bfe_u32 v3, v1, 1, 1
  v_mul_u32_u24 v3, 1088, v3
  v_mfma_f32_16x16x32_bf16 v[196:199], v[148:151], v[116:119], v[196:199]
  v_add_u32 v2, v2, v3
  s_mul_i32 s4, s83, 8704
  v_mfma_f32_16x16x32_bf16 v[192:195], v[144:147], v[116:119], v[192:195]
  s_add_u32 s4, s4, 65536
  v_add_u32 v29, s4, v2
  v_mov_b64 v[180:181], 0
  v_mov_b64 v[182:183], 0
  v_mov_b64 v[204:205], 0
  v_mov_b64 v[206:207], 0
L_t23j:
  s_lshl_b32 s4, s83, 11
  s_add_u32 s4, s4, 155648
  v_lshrrev_b32 v4, 4, v1
  v_lshlrev_b32 v4, 2, v4
  v_bfe_u32 v5, v1, 2, 2
  v_add_u32 v4, v4, v5
  v_lshlrev_b32 v4, 6, v4
  v_and_b32 v5, 3, v1
  v_lshl_add_u32 v4, v5, 3, v4
  v_add_u32 v4, s4, v4
  ds_read_b64_tr_b16 v[104:105], v4 offset:0
  ds_read_b64_tr_b16 v[106:107], v4 offset:1024
  ds_read_b64_tr_b16 v[108:109], v4 offset:32
  ds_read_b64_tr_b16 v[110:111], v4 offset:1056
  s_waitcnt vmcnt(0)
  v_lshlrev_b32 v228, 16, v216
  v_and_b32 v229, 0xffff0000, v216
  v_lshlrev_b32 v230, 16, v217
  v_and_b32 v231, 0xffff0000, v217
  v_lshlrev_b32 v232, 16, v218
  v_and_b32 v233, 0xffff0000, v218
  v_lshlrev_b32 v234, 16, v219
  v_and_b32 v235, 0xffff0000, v219
  v_pk_add_f32 v[228:229], v[228:229], v[232:233]
  v_pk_add_f32 v[230:231], v[230:231], v[234:235]
  v_add_f32 v224, v224, v225
  v_lshlrev_b32 v232, 16, v220
  v_and_b32 v233, 0xffff0000, v220
  v_lshlrev_b32 v234, 16, v221
  v_and_b32 v235, 0xffff0000, v221
  v_pk_add_f32 v[228:229], v[228:229], v[232:233]
  v_pk_add_f32 v[230:231], v[230:231], v[234:235]
  v_add_f32 v224, v224, v226
  v_lshlrev_b32 v232, 16, v222
  v_and_b32 v233, 0xffff0000, v222
  v_lshlrev_b32 v234, 16, v223
  v_and_b32 v235, 0xffff0000, v223
  v_pk_add_f32 v[228:229], v[228:229], v[232:233]
  v_pk_add_f32 v[230:231], v[230:231], v[234:235]
  v_add_f32 v224, v224, v227
  s_lshl_b32 s4, s3, 10
  s_add_u32 s4, s4, 147456
  v_lshl_add_u32 v2, v1, 4, s4
  ds_write_b128 v2, v[228:231]
  s_lshl_b32 s4, s3, 8
  s_add_u32 s4, s4, 159744
  v_lshl_add_u32 v3, v1, 2, s4
  ds_write_b32 v3, v224
  v_cvt_pk_bf16_f32 v248, v184, v185
  v_cvt_pk_bf16_f32 v249, v186, v187
  v_cvt_pk_bf16_f32 v250, v188, v189
  v_cvt_pk_bf16_f32 v251, v190, v191
  v_cvt_pk_bf16_f32 v252, v208, v209
  v_cvt_pk_bf16_f32 v253, v210, v211
  v_cvt_pk_bf16_f32 v254, v212, v213
  v_cvt_pk_bf16_f32 v255, v214, v215
  s_waitcnt lgkmcnt(0)
  v_mfma_f32_16x16x32_bf16 v[184:187], v[104:107], v[248:251], 0
  v_mfma_f32_16x16x32_bf16 v[188:191], v[108:111], v[248:251], 0
  v_mfma_f32_16x16x32_bf16 v[208:211], v[104:107], v[252:255], 0
  v_mfma_f32_16x16x32_bf16 v[212:215], v[108:111], v[252:255], 0
  s_cmp_lg_u32 s3, 0
  s_cbranch_scc1 ow_47
  v_cmp_ne_u32 vcc, 0, v12
  s_cmp_eq_u32 vcc_lo, -1
  s_cbranch_scc1 pok_48
  s_mov_b32 s75, 400000
psp_49:
  buffer_load_dword v12, v13, s[8:11], 0 offen sc1
  s_waitcnt vmcnt(0)
  v_cmp_ne_u32 vcc, 0, v12
  s_cmp_eq_u32 vcc_lo, -1
  s_cbranch_scc1 pok_48
  s_sub_u32 s75, s75, 1
  s_cmp_lg_u32 s75, 0
  s_cbranch_scc1 psp_49
pok_48:
ow_47:
  s_barrier
  s_add_u32 m0, s32, 0
  s_nop 0
  buffer_load_dwordx4 v14, s[12:15], s33 offen lds
  buffer_load_dwordx4 v15, s[12:15], s33 offen offset:1024 lds
  s_add_u32 s33, s33, 128
  s_add_u32 m0, s34, 0
  s_nop 0
  buffer_load_dwordx4 v16, s[16:19], s35 offen lds
  s_add_u32 m0, s34, 64
  s_nop 0
  buffer_load_dwordx4 v17, s[16:19], s35 offen offset:1024 lds
  s_add_u32 s35, s35, 14336
  s_lshl_b32 s76, s2, 2
  s_add_u32 s76, s76, 15729664
  s_lshl_b32 s4, s43, 6
  s_add_u32 s4, s4, 15729664
  v_and_b32 v2, 15, v1
  v_lshl_add_u32 v13, v2, 2, s4
  v_mov_b32 v26, 0xbdd2d3e8
  v_mov_b32 v27, 1.0
  v_pk_mul_f32 v[40:41], v[168:169], v[168:169]
  v_pk_mul_f32 v[56:57], v[192:193], v[192:193]
  v_pk_mul_f32 v[42:43], v[170:171], v[170:171]
  v_pk_mul_f32 v[58:59], v[194:195], v[194:195]
  v_pk_mul_f32 v[44:45], v[172:173], v[172:173]
  v_pk_mul_f32 v[60:61], v[196:197], v[196:197]
  v_pk_mul_f32 v[46:47], v[174:175], v[174:175]
  v_pk_mul_f32 v[62:63], v[198:199], v[198:199]
  v_pk_mul_f32 v[48:49], v[176:177], v[176:177]
  v_pk_mul_f32 v[64:65], v[200:201], v[200:201]
  v_pk_mul_f32 v[50:51], v[178:179], v[178:179]
  s_add_u32 m0, s32, 16384
  s_nop 0
  buffer_load_dwordx4 v14, s[12:15], s33 offen lds
  v_pk_mul_f32 v[66:67], v[202:203], v[202:203]
  v_pk_mul_f32 v[52:53], v[180:181], v[180:181]
  v_pk_mul_f32 v[68:69], v[204:205], v[204:205]
  v_pk_mul_f32 v[54:55], v[182:183], v[182:183]
  v_pk_mul_f32 v[70:71], v[206:207], v[206:207]
  v_pk_fma_f32 v[40:41], v[40:41], v[26:27], s[80:81] op_sel_hi:[1,0,0]
  v_pk_fma_f32 v[56:57], v[56:57], v[26:27], s[80:81] op_sel_hi:[1,0,0]
  v_pk_fma_f32 v[42:43], v[42:43], v[26:27], s[80:81] op_sel_hi:[1,0,0]
  v_pk_fma_f32 v[58:59], v[58:59], v[26:27], s[80:81] op_sel_hi:[1,0,0]
  v_pk_fma_f32 v[44:45], v[44:45], v[26:27], s[80:81] op_sel_hi:[1,0,0]
  v_pk_fma_f32 v[60:61], v[60:61], v[26:27], s[80:81] op_sel_hi:[1,0,0]
  v_pk_fma_f32 v[46:47], v[46:47], v[26:27], s[80:81] op_sel_hi:[1,0,0]
  v_pk_fma_f32 v[62:63], v[62:63], v[26:27], s[80:81] op_sel_hi:[1,0,0]
  v_pk_fma_f32 v[48:49], v[48:49], v[26:27], s[80:81] op_sel_hi:[1,0,0]
  v_pk_fma_f32 v[64:65], v[64:65], v[26:27], s[80:81] op_sel_hi:[1,0,0]
  v_pk_fma_f32 v[50:51], v[50:51], v[26:27], s[80:81] op_sel_hi:[1,0,0]
  v_pk_fma_f32 v[66:67], v[66:67], v[26:27], s[80:81] op_sel_hi:[1,0,0]
  v_pk_fma_f32 v[52:53], v[52:53], v[26:27], s[80:81] op_sel_hi:[1,0,0]
  v_pk_fma_f32 v[68:69], v[68:69], v[26:27], s[80:81] op_sel_hi:[1,0,0]
  v_pk_fma_f32 v[54:55], v[54:55], v[26:27], s[80:81] op_sel_hi:[1,0,0]
  v_pk_fma_f32 v[70:71], v[70:71], v[26:27], s[80:81] op_sel_hi:[1,0,0]
  v_pk_mul_f32 v[40:41], v[168:169], v[40:41]
  v_pk_mul_f32 v[56:57], v[192:193], v[56:57]
  v_pk_mul_f32 v[42:43], v[170:171], v[42:43]
  buffer_load_dwordx4 v15, s[12:15], s33 offen offset:1024 lds
  s_add_u32 s33, s33, 128
  v_pk_mul_f32 v[58:59], v[194:195], v[58:59]
  v_pk_mul_f32 v[44:45], v[172:173], v[44:45]
  v_pk_mul_f32 v[60:61], v[196:197], v[60:61]
  v_pk_mul_f32 v[46:47], v[174:175], v[46:47]
  v_pk_mul_f32 v[62:63], v[198:199], v[62:63]
  v_pk_mul_f32 v[48:49], v[176:177], v[48:49]
  v_pk_mul_f32 v[64:65], v[200:201], v[64:65]
  v_pk_mul_f32 v[50:51], v[178:179], v[50:51]
  v_pk_mul_f32 v[66:67], v[202:203], v[66:67]
  v_pk_mul_f32 v[52:53], v[180:181], v[52:53]
  v_pk_mul_f32 v[68:69], v[204:205], v[68:69]
  v_pk_mul_f32 v[54:55], v[182:183], v[54:55]
  v_pk_mul_f32 v[70:71], v[206:207], v[70:71]
  v_exp_f32 v40, v40
  v_exp_f32 v56, v56
  v_exp_f32 v41, v41
  v_exp_f32 v57, v57
  v_exp_f32 v42, v42
  v_exp_f32 v58, v58
  v_exp_f32 v43, v43
  v_exp_f32 v59, v59
  v_exp_f32 v44, v44
  v_exp_f32 v60, v60
  v_exp_f32 v45, v45
  s_add_u32 m0, s34, 15232
  s_nop 0
  buffer_load_dwordx4 v16, s[16:19], s35 offen lds
  v_exp_f32 v61, v61
  v_exp_f32 v46, v46
  v_exp_f32 v62, v62
  v_exp_f32 v47, v47
  v_exp_f32 v63, v63
  v_exp_f32 v48, v48
  v_exp_f32 v64, v64
  v_exp_f32 v49, v49
  v_exp_f32 v65, v65
  v_exp_f32 v50, v50
  v_exp_f32 v66, v66
  v_exp_f32 v51, v51
  v_exp_f32 v67, v67
  v_exp_f32 v52, v52
  v_exp_f32 v68, v68
  v_exp_f32 v53, v53
  v_exp_f32 v69, v69
  v_exp_f32 v54, v54
  v_exp_f32 v70, v70
  v_exp_f32 v55, v55
  v_exp_f32 v71, v71
  v_pk_add_f32 v[40:41], v[40:41], v[26:27] op_sel:[0,1] op_sel_hi:[1,1]
  v_pk_add_f32 v[56:57], v[56:57], v[26:27] op_sel:[0,1] op_sel_hi:[1,1]
  s_add_u32 m0, s34, 15296
  s_nop 0
  buffer_load_dwordx4 v17, s[16:19], s35 offen offset:1024 lds
  s_add_u32 s35, s35, 14336
  v_pk_add_f32 v[42:43], v[42:43], v[26:27] op_sel:[0,1] op_sel_hi:[1,1]
  v_pk_add_f32 v[58:59], v[58:59], v[26:27] op_sel:[0,1] op_sel_hi:[1,1]
  v_pk_add_f32 v[44:45], v[44:45], v[26:27] op_sel:[0,1] op_sel_hi:[1,1]
  v_pk_add_f32 v[60:61], v[60:61], v[26:27] op_sel:[0,1] op_sel_hi:[1,1]
  v_pk_add_f32 v[46:47], v[46:47], v[26:27] op_sel:[0,1] op_sel_hi:[1,1]
  v_pk_add_f32 v[62:63], v[62:63], v[26:27] op_sel:[0,1] op_sel_hi:[1,1]
  v_pk_add_f32 v[48:49], v[48:49], v[26:27] op_sel:[0,1] op_sel_hi:[1,1]
  v_pk_add_f32 v[64:65], v[64:65], v[26:27] op_sel:[0,1] op_sel_hi:[1,1]
  v_pk_add_f32 v[50:51], v[50:51], v[26:27] op_sel:[0,1] op_sel_hi:[1,1]
  v_pk_add_f32 v[66:67], v[66:67], v[26:27] op_sel:[0,1] op_sel_hi:[1,1]
  v_pk_add_f32 v[52:53], v[52:53], v[26:27] op_sel:[0,1] op_sel_hi:[1,1]
  v_pk_add_f32 v[68:69], v[68:69], v[26:27] op_sel:[0,1] op_sel_hi:[1,1]
  v_pk_add_f32 v[54:55], v[54:55], v[26:27] op_sel:[0,1] op_sel_hi:[1,1]
  v_pk_add_f32 v[70:71], v[70:71], v[26:27] op_sel:[0,1] op_sel_hi:[1,1]
  v_rcp_f32 v40, v40
  v_rcp_f32 v56, v56
  v_rcp_f32 v41, v41
  v_rcp_f32 v57, v57
  v_rcp_f32 v42, v42
  v_rcp_f32 v58, v58
  v_rcp_f32 v43, v43
  v_rcp_f32 v59, v59
  v_rcp_f32 v44, v44
  v_rcp_f32 v60, v60
  s_add_u32 m0, s32, 32768
  s_nop 0
  buffer_load_dwordx4 v14, s[12:15], s33 offen lds
  v_rcp_f32 v45, v45
  v_rcp_f32 v61, v61
  v_rcp_f32 v46, v46
  v_rcp_f32 v62, v62
  v_rcp_f32 v47, v47
  v_rcp_f32 v63, v63
  v_rcp_f32 v48, v48
  v_rcp_f32 v64, v64
  v_rcp_f32 v49, v49
  v_rcp_f32 v65, v65
  v_rcp_f32 v50, v50
  v_rcp_f32 v66, v66
  v_rcp_f32 v51, v51
  v_rcp_f32 v67, v67
  v_rcp_f32 v52, v52
  v_rcp_f32 v68, v68
  v_rcp_f32 v53, v53
  v_rcp_f32 v69, v69
  v_rcp_f32 v54, v54
  v_rcp_f32 v70, v70
  v_rcp_f32 v55, v55
  v_rcp_f32 v71, v71
  v_pk_mul_f32 v[168:169], v[168:169], v[40:41]
  v_pk_mul_f32 v[192:193], v[192:193], v[56:57]
  buffer_load_dwordx4 v15, s[12:15], s33 offen offset:1024 lds
  s_add_u32 s33, s33, 128
  v_pk_mul_f32 v[170:171], v[170:171], v[42:43]
  v_pk_mul_f32 v[194:195], v[194:195], v[58:59]
  v_pk_mul_f32 v[172:173], v[172:173], v[44:45]
  v_pk_mul_f32 v[196:197], v[196:197], v[60:61]
  v_pk_mul_f32 v[174:175], v[174:175], v[46:47]
  v_pk_mul_f32 v[198:199], v[198:199], v[62:63]
  v_pk_mul_f32 v[176:177], v[176:177], v[48:49]
  v_pk_mul_f32 v[200:201], v[200:201], v[64:65]
  v_pk_mul_f32 v[178:179], v[178:179], v[50:51]
  v_pk_mul_f32 v[202:203], v[202:203], v[66:67]
  v_pk_mul_f32 v[180:181], v[180:181], v[52:53]
  v_pk_mul_f32 v[204:205], v[204:205], v[68:69]
  v_pk_mul_f32 v[182:183], v[182:183], v[54:55]
  v_pk_mul_f32 v[206:207], v[206:207], v[70:71]
  v_cvt_pk_bf16_f32 v216, v168, v169
  v_cvt_pk_bf16_f32 v224, v192, v193
  v_cvt_pk_bf16_f32 v217, v170, v171
  v_cvt_pk_bf16_f32 v225, v194, v195
  v_cvt_pk_bf16_f32 v218, v172, v173
  v_cvt_pk_bf16_f32 v226, v196, v197
  v_cvt_pk_bf16_f32 v219, v174, v175
  v_cvt_pk_bf16_f32 v227, v198, v199
  v_cvt_pk_bf16_f32 v220, v176, v177
  v_cvt_pk_bf16_f32 v228, v200, v201
  s_add_u32 m0, s34, 30464
  s_nop 0
  buffer_load_dwordx4 v16, s[16:19], s35 offen lds
  v_cvt_pk_bf16_f32 v221, v178, v179
  v_cvt_pk_bf16_f32 v229, v202, v203
  v_cvt_pk_bf16_f32 v222, v180, v181
  v_cvt_pk_bf16_f32 v230, v204, v205
  v_cvt_pk_bf16_f32 v223, v182, v183
  v_cvt_pk_bf16_f32 v231, v206, v207
  v_max3_f32 v248, v184, v185, v186
  v_max3_f32 v252, v208, v209, v210
  v_max3_f32 v250, -v184, -v185, -v186
  v_max3_f32 v254, -v208, -v209, -v210
  v_max3_f32 v248, v248, v187, v188
  v_max3_f32 v252, v252, v211, v212
  v_max3_f32 v250, v250, -v187, -v188
  v_max3_f32 v254, v254, -v211, -v212
  v_max3_f32 v248, v248, v189, v190
  v_max3_f32 v252, v252, v213, v214
  v_max3_f32 v250, v250, -v189, -v190
  v_max3_f32 v254, v254, -v213, -v214
  v_max_f32 v248, v248, v191
  v_max_f32 v252, v252, v215
  v_max_f32 v250, v250, -v191
  v_max_f32 v254, v254, -v215
  s_nop 0
  v_permlane16_swap_b32 v248, v250
  s_add_u32 m0, s34, 30528
  s_nop 0
  buffer_load_dwordx4 v17, s[16:19], s35 offen offset:1024 lds
  s_add_u32 s35, s35, 14336
  v_permlane16_swap_b32 v252, v254
  v_max_f32 v248, v248, v250
  v_max_f32 v252, v252, v254
  v_mov_b32 v250, v248
  v_mov_b32 v254, v252
  s_nop 0
  v_permlane32_swap_b32 v248, v250
  v_permlane32_swap_b32 v252, v254
  v_max_f32 v248, v248, v250
  v_max_f32 v252, v252, v254
  v_mov_b32 v250, v248
  v_mov_b32 v254, v252
  s_nop 0
  v_permlane16_swap_b32 v248, v250
  v_permlane16_swap_b32 v252, v254
  v_mul_f32 v248, s46, v248
  v_mul_f32 v252, s46, v252
  v_mul_f32 v250, s46, v250
  v_mul_f32 v254, s46, v254
  v_pk_fma_f32 v[72:73], v[184:185], s[46:47], v[248:249] op_sel_hi:[1,0,0] neg_lo:[0,0,1] neg_hi:[0,0,1]
  v_pk_fma_f32 v[88:89], v[208:209], s[46:47], v[252:253] op_sel_hi:[1,0,0] neg_lo:[0,0,1] neg_hi:[0,0,1]
  v_pk_fma_f32 v[80:81], v[184:185], s[46:47], v[250:251] op_sel_hi:[1,0,0] neg_lo:[1,0,1] neg_hi:[1,0,1]
  v_pk_fma_f32 v[96:97], v[208:209], s[46:47], v[254:255] op_sel_hi:[1,0,0] neg_lo:[1,0,1] neg_hi:[1,0,1]
  v_pk_fma_f32 v[74:75], v[186:187], s[46:47], v[248:249] op_sel_hi:[1,0,0] neg_lo:[0,0,1] neg_hi:[0,0,1]
  v_pk_fma_f32 v[90:91], v[210:211], s[46:47], v[252:253] op_sel_hi:[1,0,0] neg_lo:[0,0,1] neg_hi:[0,0,1]
  v_pk_fma_f32 v[82:83], v[186:187], s[46:47], v[250:251] op_sel_hi:[1,0,0] neg_lo:[1,0,1] neg_hi:[1,0,1]
  s_add_u32 m0, s32, 49152
  s_nop 0
  buffer_load_dwordx4 v14, s[12:15], s33 offen lds
  v_pk_fma_f32 v[98:99], v[210:211], s[46:47], v[254:255] op_sel_hi:[1,0,0] neg_lo:[1,0,1] neg_hi:[1,0,1]
  v_pk_fma_f32 v[76:77], v[188:189], s[46:47], v[248:249] op_sel_hi:[1,0,0] neg_lo:[0,0,1] neg_hi:[0,0,1]
  v_pk_fma_f32 v[92:93], v[212:213], s[46:47], v[252:253] op_sel_hi:[1,0,0] neg_lo:[0,0,1] neg_hi:[0,0,1]
  v_pk_fma_f32 v[84:85], v[188:189], s[46:47], v[250:251] op_sel_hi:[1,0,0] neg_lo:[1,0,1] neg_hi:[1,0,1]
  v_pk_fma_f32 v[100:101], v[212:213], s[46:47], v[254:255] op_sel_hi:[1,0,0] neg_lo:[1,0,1] neg_hi:[1,0,1]
  v_pk_fma_f32 v[78:79], v[190:191], s[46:47], v[248:249] op_sel_hi:[1,0,0] neg_lo:[0,0,1] neg_hi:[0,0,1]
  v_pk_fma_f32 v[94:95], v[214:215], s[46:47], v[252:253] op_sel_hi:[1,0,0] neg_lo:[0,0,1] neg_hi:[0,0,1]
  v_pk_fma_f32 v[86:87], v[190:191], s[46:47], v[250:251] op_sel_hi:[1,0,0] neg_lo:[1,0,1] neg_hi:[1,0,1]
  v_pk_fma_f32 v[102:103], v[214:215], s[46:47], v[254:255] op_sel_hi:[1,0,0] neg_lo:[1,0,1] neg_hi:[1,0,1]
  v_exp_f32 v72, v72
  v_exp_f32 v88, v88
  v_exp_f32 v73, v73
  v_exp_f32 v89, v89
  v_exp_f32 v74, v74
  v_exp_f32 v90, v90
  v_exp_f32 v75, v75
  v_exp_f32 v91, v91
  v_exp_f32 v76, v76
  v_exp_f32 v92, v92
  v_exp_f32 v77, v77
  v_exp_f32 v93, v93
  v_exp_f32 v78, v78
  v_exp_f32 v94, v94
  v_exp_f32 v79, v79
  buffer_load_dwordx4 v15, s[12:15], s33 offen offset:1024 lds
  s_add_u32 s33, s33, 128
  v_exp_f32 v95, v95
  v_exp_f32 v80, v80
  v_exp_f32 v96, v96
  v_exp_f32 v81, v81
  v_exp_f32 v97, v97
  v_exp_f32 v82, v82
  v_exp_f32 v98, v98
  v_exp_f32 v83, v83
  v_exp_f32 v99, v99
  v_exp_f32 v84, v84
  v_exp_f32 v100, v100
  v_exp_f32 v85, v85
  v_exp_f32 v101, v101
  v_exp_f32 v86, v86
  v_exp_f32 v102, v102
  v_exp_f32 v87, v87
  v_exp_f32 v103, v103
  v_pk_add_f32 v[184:185], v[72:73], v[74:75]
  v_pk_add_f32 v[208:209], v[88:89], v[90:91]
  v_pk_add_f32 v[186:187], v[80:81], v[82:83]
  v_pk_add_f32 v[210:211], v[96:97], v[98:99]
  v_pk_add_f32 v[188:189], v[76:77], v[78:79]
  v_pk_add_f32 v[212:213], v[92:93], v[94:95]
  s_add_u32 m0, s34, 45696
  s_nop 0
  buffer_load_dwordx4 v16, s[16:19], s35 offen lds
  v_pk_add_f32 v[190:191], v[84:85], v[86:87]
  v_pk_add_f32 v[214:215], v[100:101], v[102:103]
  v_pk_add_f32 v[184:185], v[184:185], v[188:189]
  v_pk_add_f32 v[208:209], v[208:209], v[212:213]
  v_pk_add_f32 v[186:187], v[186:187], v[190:191]
  v_pk_add_f32 v[210:211], v[210:211], v[214:215]
  v_add_f32 v248, v184, v185
  v_add_f32 v252, v208, v209
  v_add_f32 v250, v186, v187
  v_add_f32 v254, v210, v211
  s_nop 0
  v_permlane16_swap_b32 v248, v250
  v_permlane16_swap_b32 v252, v254
  v_add_f32 v248, v248, v250
  v_add_f32 v252, v252, v254
  v_mov_b32 v250, v248
  v_mov_b32 v254, v252
  s_nop 0
  v_permlane32_swap_b32 v248, v250
  v_permlane32_swap_b32 v252, v254
  v_add_f32 v248, v248, v250
  v_add_f32 v252, v252, v254
  v_mov_b32 v250, v248
  v_mov_b32 v254, v252
  s_nop 0
  v_permlane16_swap_b32 v248, v250
  v_permlane16_swap_b32 v252, v254
  s_add_u32 m0, s34, 45760
  s_nop 0
  buffer_load_dwordx4 v17, s[16:19], s35 offen offset:1024 lds
  s_add_u32 s35, s35, 14336
  v_rcp_f32 v248, v248
  v_rcp_f32 v252, v252
  v_rcp_f32 v250, v250
  v_rcp_f32 v254, v254
  v_pk_mul_f32 v[72:73], v[72:73], v[248:249] op_sel_hi:[1,0]
  v_pk_mul_f32 v[88:89], v[88:89], v[252:253] op_sel_hi:[1,0]
  v_pk_mul_f32 v[80:81], v[80:81], v[250:251] op_sel_hi:[1,0]
  v_pk_mul_f32 v[96:97], v[96:97], v[254:255] op_sel_hi:[1,0]
  v_pk_mul_f32 v[74:75], v[74:75], v[248:249] op_sel_hi:[1,0]
  v_pk_mul_f32 v[90:91], v[90:91], v[252:253] op_sel_hi:[1,0]
  v_pk_mul_f32 v[82:83], v[82:83], v[250:251] op_sel_hi:[1,0]
  v_pk_mul_f32 v[98:99], v[98:99], v[254:255] op_sel_hi:[1,0]
  v_pk_mul_f32 v[76:77], v[76:77], v[248:249] op_sel_hi:[1,0]
  v_pk_mul_f32 v[92:93], v[92:93], v[252:253] op_sel_hi:[1,0]
  v_pk_mul_f32 v[84:85], v[84:85], v[250:251] op_sel_hi:[1,0]
  v_pk_mul_f32 v[100:101], v[100:101], v[254:255] op_sel_hi:[1,0]
  v_pk_mul_f32 v[78:79], v[78:79], v[248:249] op_sel_hi:[1,0]
  v_pk_mul_f32 v[94:95], v[94:95], v[252:253] op_sel_hi:[1,0]
  v_pk_mul_f32 v[86:87], v[86:87], v[250:251] op_sel_hi:[1,0]
  v_pk_mul_f32 v[102:103], v[102:103], v[254:255] op_sel_hi:[1,0]
  v_cvt_pk_bf16_f32 v232, v72, v73
  v_cvt_pk_bf16_f32 v240, v88, v89
  v_cvt_pk_bf16_f32 v236, v80, v81
  v_cvt_pk_bf16_f32 v244, v96, v97
  buffer_load_dword v10, v11, s[24:27], s38 offen
  v_cvt_pk_bf16_f32 v233, v74, v75
  v_cvt_pk_bf16_f32 v241, v90, v91
  v_cvt_pk_bf16_f32 v237, v82, v83
  v_cvt_pk_bf16_f32 v245, v98, v99
  v_cvt_pk_bf16_f32 v234, v76, v77
  v_cvt_pk_bf16_f32 v242, v92, v93
  v_cvt_pk_bf16_f32 v238, v84, v85
  v_cvt_pk_bf16_f32 v246, v100, v101
  v_cvt_pk_bf16_f32 v235, v78, v79
  v_cvt_pk_bf16_f32 v243, v94, v95
  v_cvt_pk_bf16_f32 v239, v86, v87
  v_cvt_pk_bf16_f32 v247, v102, v103
  s_cmp_eq_u32 s83, 0
  s_cbranch_scc0 L_t4b
  s_waitcnt vmcnt(13)
  s_barrier
  ds_read_b128 v[104:107], v28 offset:0
  ds_read_b64_tr_b16 v[136:137], v29 offset:0
  ds_read_b64_tr_b16 v[138:139], v29 offset:64
  ds_read_b64_tr_b16 v[140:141], v29 offset:2176
  ds_read_b64_tr_b16 v[142:143], v29 offset:2240
  ds_read_b64_tr_b16 v[144:145], v29 offset:4352
  ds_read_b64_tr_b16 v[146:147], v29 offset:4416
  ds_read_b64_tr_b16 v[148:149], v29 offset:6528
  ds_read_b64_tr_b16 v[150:151], v29 offset:6592
  ds_read_b128 v[108:111], v28 offset:2048
  ds_read_b128 v[112:115], v28 offset:4096
  ds_read_b128 v[116:119], v28 offset:6144
  s_waitcnt vmcnt(9) lgkmcnt(0)
  s_barrier
  s_cmp_lg_u32 s3, 0
  s_cbranch_scc1 ow_50
  v_lshlrev_b32 v12, 4, v1
  v_add_u32 v11, 147456, v12
  ds_read_b128 v[2:5], v11 offset:0
  ds_read_b128 v[6:9], v11 offset:1024
  ds_read_b128 v[248:251], v11 offset:2048
  ds_read_b128 v[252:255], v11 offset:3072
  s_waitcnt lgkmcnt(0)
  v_pk_add_f32 v[2:3], v[2:3], v[6:7]
  v_pk_add_f32 v[4:5], v[4:5], v[8:9]
  v_pk_add_f32 v[2:3], v[2:3], v[248:249]
  v_pk_add_f32 v[4:5], v[4:5], v[250:251]
  v_pk_add_f32 v[2:3], v[2:3], v[252:253]
  v_pk_add_f32 v[4:5], v[4:5], v[254:255]
  ds_read_b128 v[6:9], v11 offset:4096
  ds_read_b128 v[248:251], v11 offset:5120
  ds_read_b128 v[252:255], v11 offset:6144
  s_waitcnt lgkmcnt(0)
  v_pk_add_f32 v[2:3], v[2:3], v[6:7]
  v_pk_add_f32 v[4:5], v[4:5], v[8:9]
  v_pk_add_f32 v[2:3], v[2:3], v[248:249]
  v_pk_add_f32 v[4:5], v[4:5], v[250:251]
  v_pk_add_f32 v[2:3], v[2:3], v[252:253]
  v_pk_add_f32 v[4:5], v[4:5], v[254:255]
  ds_read_b128 v[6:9], v11 offset:7168
  s_waitcnt lgkmcnt(0)
  v_pk_add_f32 v[2:3], v[2:3], v[6:7]
  v_pk_add_f32 v[4:5], v[4:5], v[8:9]
  v_cvt_pk_bf16_f32 v2, v2, v3
  v_cvt_pk_bf16_f32 v3, v4, v5
  s_and_b32 s6, s2, 7
  s_lshr_b32 s4, s6, 2
  s_lshl_b32 s4, s4, 1
  s_and_b32 s5, s6, 1
  s_add_u32 s4, s4, s5
  s_lshl_b32 s4, s4, 10
  s_bfe_u32 s5, s6, 0x10001
  s_lshl_b32 s5, s5, 3
  s_add_u32 s4, s4, s5
  s_lshr_b32 s5, s2, 3
  s_lshl_b32 s5, s5, 12
  s_add_u32 s4, s4, s5
  s_add_u32 s4, s4, 14680064
  buffer_store_dwordx2 v[2:3], v12, s[8:11], s4 offen sc1
ow_50:
  s_cmp_lg_u32 s3, 1
  s_cbranch_scc1 ow_51
  s_and_b32 s4, s2, 7
  s_cmp_lg_u32 s4, 0
  s_cbranch_scc1 nz_52
  v_lshlrev_b32 v12, 2, v1
  v_add_u32 v12, 159744, v12
  ds_read_b32 v2, v12 offset:0
  ds_read_b32 v3, v12 offset:256
  ds_read_b32 v4, v12 offset:512
  ds_read_b32 v5, v12 offset:768
  ds_read_b32 v6, v12 offset:1024
  ds_read_b32 v7, v12 offset:1280
  ds_read_b32 v8, v12 offset:1536
  ds_read_b32 v9, v12 offset:1792
  s_waitcnt lgkmcnt(0)
  v_add_f32 v2, v2, v3
  v_add_f32 v2, v2, v4
  v_add_f32 v2, v2, v5
  v_add_f32 v2, v2, v6
  v_add_f32 v2, v2, v7
  v_add_f32 v2, v2, v8
  v_add_f32 v2, v2, v9
  v_cvt_pk_bf16_f32 v2, v2, v2
  v_lshrrev_b32 v3, 5, v1
  v_lshlrev_b32 v3, 6, v3
  v_bfe_u32 v4, v1, 2, 2
  v_lshl_add_u32 v3, v4, 4, v3
  v_bfe_u32 v4, v1, 4, 1
  v_lshl_add_u32 v3, v4, 3, v3
  v_and_b32 v4, 3, v1
  v_lshl_add_u32 v3, v4, 1, v3
  s_lshr_b32 s4, s2, 3
  s_lshl_b32 s4, s4, 7
  s_add_u32 s4, s4, 14811136
  buffer_store_short v2, v3, s[8:11], s4 offen sc1
nz_52:
ow_51:
  v_mfma_f32_16x16x32_bf16 v[40:43], v[136:139], v[104:107], 0
  ds_read_b128 v[120:123], v28 offset:16384
  v_mfma_f32_16x16x32_bf16 v[44:47], v[140:143], v[104:107], 0
  ds_read_b64_tr_b16 v[152:153], v29 offset:15232
  v_mfma_f32_16x16x32_bf16 v[48:51], v[144:147], v[104:107], 0
  ds_read_b64_tr_b16 v[154:155], v29 offset:15296
  s_add_u32 m0, s32, 0
  s_nop 0
  buffer_load_dwordx4 v14, s[12:15], s33 offen lds
  v_mfma_f32_16x16x32_bf16 v[52:55], v[148:151], v[104:107], 0
  ds_read_b64_tr_b16 v[156:157], v29 offset:17408
  v_mfma_f32_16x16x32_bf16 v[68:71], v[148:151], v[108:111], 0
  ds_read_b64_tr_b16 v[158:159], v29 offset:17472
  v_mfma_f32_16x16x32_bf16 v[64:67], v[144:147], v[108:111], 0
  ds_read_b64_tr_b16 v[160:161], v29 offset:19584
  v_mfma_f32_16x16x32_bf16 v[60:63], v[140:143], v[108:111], 0
  ds_read_b64_tr_b16 v[162:163], v29 offset:19648
  buffer_load_dwordx4 v15, s[12:15], s33 offen offset:1024 lds
  s_add_u32 s33, s33, 128
  v_mfma_f32_16x16x32_bf16 v[56:59], v[136:139], v[108:111], 0
  ds_read_b64_tr_b16 v[164:165], v29 offset:21760
  v_mfma_f32_16x16x32_bf16 v[72:75], v[136:139], v[112:115], 0
  ds_read_b64_tr_b16 v[166:167], v29 offset:21824
  v_mfma_f32_16x16x32_bf16 v[76:79], v[140:143], v[112:115], 0
  ds_read_b128 v[124:127], v28 offset:18432
  v_mfma_f32_16x16x32_bf16 v[80:83], v[144:147], v[112:115], 0
  ds_read_b128 v[128:131], v28 offset:20480
  s_add_u32 m0, s34, 0
  s_nop 0
  buffer_load_dwordx4 v16, s[16:19], s35 offen lds
  v_mfma_f32_16x16x32_bf16 v[84:87], v[148:151], v[112:115], 0
  ds_read_b128 v[132:135], v28 offset:22528
  v_mfma_f32_16x16x32_bf16 v[100:103], v[148:151], v[116:119], 0
  v_mfma_f32_16x16x32_bf16 v[96:99], v[144:147], v[116:119], 0
  v_mfma_f32_16x16x32_bf16 v[92:95], v[140:143], v[116:119], 0
  s_add_u32 m0, s34, 64
  s_nop 0
  buffer_load_dwordx4 v17, s[16:19], s35 offen offset:1024 lds
  s_add_u32 s35, s35, 14336
  v_mfma_f32_16x16x32_bf16 v[88:91], v[136:139], v[116:119], 0
  s_waitcnt vmcnt(9) lgkmcnt(0)
  s_barrier
  v_mfma_f32_16x16x32_bf16 v[40:43], v[152:155], v[120:123], v[40:43]
  ds_read_b128 v[104:107], v28 offset:32768
  v_mfma_f32_16x16x32_bf16 v[44:47], v[156:159], v[120:123], v[44:47]
  ds_read_b64_tr_b16 v[136:137], v29 offset:30464
  v_mfma_f32_16x16x32_bf16 v[48:51], v[160:163], v[120:123], v[48:51]
  ds_read_b64_tr_b16 v[138:139], v29 offset:30528
  s_add_u32 m0, s32, 16384
  s_nop 0
  buffer_load_dwordx4 v14, s[12:15], s33 offen lds
  v_mfma_f32_16x16x32_bf16 v[52:55], v[164:167], v[120:123], v[52:55]
  ds_read_b64_tr_b16 v[140:141], v29 offset:32640
  v_mfma_f32_16x16x32_bf16 v[68:71], v[164:167], v[124:127], v[68:71]
  ds_read_b64_tr_b16 v[142:143], v29 offset:32704
  v_mfma_f32_16x16x32_bf16 v[64:67], v[160:163], v[124:127], v[64:67]
  ds_read_b64_tr_b16 v[144:145], v29 offset:34816
  v_mfma_f32_16x16x32_bf16 v[60:63], v[156:159], v[124:127], v[60:63]
  ds_read_b64_tr_b16 v[146:147], v29 offset:34880
  buffer_load_dwordx4 v15, s[12:15], s33 offen offset:1024 lds
  s_add_u32 s33, s33, 128
  v_mfma_f32_16x16x32_bf16 v[56:59], v[152:155], v[124:127], v[56:59]
  ds_read_b64_tr_b16 v[148:149], v29 offset:36992
  v_mfma_f32_16x16x32_bf16 v[72:75], v[152:155], v[128:131], v[72:75]
  ds_read_b64_tr_b16 v[150:151], v29 offset:37056
  v_mfma_f32_16x16x32_bf16 v[76:79], v[156:159], v[128:131], v[76:79]
  ds_read_b128 v[108:111], v28 offset:34816
  v_mfma_f32_16x16x32_bf16 v[80:83], v[160:163], v[128:131], v[80:83]
  ds_read_b128 v[112:115], v28 offset:36864
  s_add_u32 m0, s34, 15232
  s_nop 0
  buffer_load_dwordx4 v16, s[16:19], s35 offen lds
  v_mfma_f32_16x16x32_bf16 v[84:87], v[164:167], v[128:131], v[84:87]
  ds_read_b128 v[116:119], v28 offset:38912
  v_mfma_f32_16x16x32_bf16 v[100:103], v[164:167], v[132:135], v[100:103]
  v_mfma_f32_16x16x32_bf16 v[96:99], v[160:163], v[132:135], v[96:99]
  v_mfma_f32_16x16x32_bf16 v[92:95], v[156:159], v[132:135], v[92:95]
  s_add_u32 m0, s34, 15296
  s_nop 0
  buffer_load_dwordx4 v17, s[16:19], s35 offen offset:1024 lds
  s_add_u32 s35, s35, 14336
  v_mfma_f32_16x16x32_bf16 v[88:91], v[152:155], v[132:135], v[88:91]
  s_waitcnt vmcnt(9) lgkmcnt(0)
  s_barrier
  v_mfma_f32_16x16x32_bf16 v[40:43], v[136:139], v[104:107], v[40:43]
  ds_read_b128 v[120:123], v28 offset:49152
  v_mfma_f32_16x16x32_bf16 v[44:47], v[140:143], v[104:107], v[44:47]
  ds_read_b64_tr_b16 v[152:153], v29 offset:45696
  v_mfma_f32_16x16x32_bf16 v[48:51], v[144:147], v[104:107], v[48:51]
  ds_read_b64_tr_b16 v[154:155], v29 offset:45760
  s_add_u32 m0, s32, 32768
  s_nop 0
  buffer_load_dwordx4 v14, s[12:15], s33 offen lds
  v_mfma_f32_16x16x32_bf16 v[52:55], v[148:151], v[104:107], v[52:55]
  ds_read_b64_tr_b16 v[156:157], v29 offset:47872
  v_mfma_f32_16x16x32_bf16 v[68:71], v[148:151], v[108:111], v[68:71]
  ds_read_b64_tr_b16 v[158:159], v29 offset:47936
  v_mfma_f32_16x16x32_bf16 v[64:67], v[144:147], v[108:111], v[64:67]
  ds_read_b64_tr_b16 v[160:161], v29 offset:50048
  v_mfma_f32_16x16x32_bf16 v[60:63], v[140:143], v[108:111], v[60:63]
  ds_read_b64_tr_b16 v[162:163], v29 offset:50112
  buffer_load_dwordx4 v15, s[12:15], s33 offen offset:1024 lds
  s_add_u32 s33, s33, 128
  v_mfma_f32_16x16x32_bf16 v[56:59], v[136:139], v[108:111], v[56:59]
  ds_read_b64_tr_b16 v[164:165], v29 offset:52224
  v_mfma_f32_16x16x32_bf16 v[72:75], v[136:139], v[112:115], v[72:75]
  ds_read_b64_tr_b16 v[166:167], v29 offset:52288
  v_mfma_f32_16x16x32_bf16 v[76:79], v[140:143], v[112:115], v[76:79]
  ds_read_b128 v[124:127], v28 offset:51200
  v_mfma_f32_16x16x32_bf16 v[80:83], v[144:147], v[112:115], v[80:83]
  ds_read_b128 v[128:131], v28 offset:53248
  s_add_u32 m0, s34, 30464
  s_nop 0
  buffer_load_dwordx4 v16, s[16:19], s35 offen lds
  v_mfma_f32_16x16x32_bf16 v[84:87], v[148:151], v[112:115], v[84:87]
  ds_read_b128 v[132:135], v28 offset:55296
  v_mfma_f32_16x16x32_bf16 v[100:103], v[148:151], v[116:119], v[100:103]
  v_mfma_f32_16x16x32_bf16 v[96:99], v[144:147], v[116:119], v[96:99]
  v_mfma_f32_16x16x32_bf16 v[92:95], v[140:143], v[116:119], v[92:95]
  s_add_u32 m0, s34, 30528
  s_nop 0
  buffer_load_dwordx4 v17, s[16:19], s35 offen offset:1024 lds
  s_add_u32 s35, s35, 14336
  v_mfma_f32_16x16x32_bf16 v[88:91], v[136:139], v[116:119], v[88:91]
  s_waitcnt vmcnt(8) lgkmcnt(0)
  s_barrier
  v_mfma_f32_16x16x32_bf16 v[40:43], v[152:155], v[120:123], v[40:43]
  ds_read_b128 v[104:107], v28 offset:0
  v_mfma_f32_16x16x32_bf16 v[44:47], v[156:159], v[120:123], v[44:47]
  ds_read_b64_tr_b16 v[136:137], v29 offset:0
  v_mfma_f32_16x16x32_bf16 v[48:51], v[160:163], v[120:123], v[48:51]
  ds_read_b64_tr_b16 v[138:139], v29 offset:64
  s_add_u32 m0, s32, 49152
  s_nop 0
  buffer_load_dwordx4 v14, s[12:15], s33 offen lds
  v_mfma_f32_16x16x32_bf16 v[52:55], v[164:167], v[120:123], v[52:55]
  ds_read_b64_tr_b16 v[140:141], v29 offset:2176
  v_mfma_f32_16x16x32_bf16 v[68:71], v[164:167], v[124:127], v[68:71]
  ds_read_b64_tr_b16 v[142:143], v29 offset:2240
  v_mfma_f32_16x16x32_bf16 v[64:67], v[160:163], v[124:127], v[64:67]
  ds_read_b64_tr_b16 v[144:145], v29 offset:4352
  v_mfma_f32_16x16x32_bf16 v[60:63], v[156:159], v[124:127], v[60:63]
  ds_read_b64_tr_b16 v[146:147], v29 offset:4416
  buffer_load_dwordx4 v15, s[12:15], s33 offen offset:1024 lds
  s_add_u32 s33, s33, 128
  v_mfma_f32_16x16x32_bf16 v[56:59], v[152:155], v[124:127], v[56:59]
  ds_read_b64_tr_b16 v[148:149], v29 offset:6528
  v_mfma_f32_16x16x32_bf16 v[72:75], v[152:155], v[128:131], v[72:75]
  ds_read_b64_tr_b16 v[150:151], v29 offset:6592
  v_mfma_f32_16x16x32_bf16 v[76:79], v[156:159], v[128:131], v[76:79]
  ds_read_b128 v[108:111], v28 offset:2048
  v_mfma_f32_16x16x32_bf16 v[80:83], v[160:163], v[128:131], v[80:83]
  ds_read_b128 v[112:115], v28 offset:4096
  s_add_u32 m0, s34, 45696
  s_nop 0
  buffer_load_dwordx4 v16, s[16:19], s35 offen lds
  v_mfma_f32_16x16x32_bf16 v[84:87], v[164:167], v[128:131], v[84:87]
  ds_read_b128 v[116:119], v28 offset:6144
  v_mfma_f32_16x16x32_bf16 v[100:103], v[164:167], v[132:135], v[100:103]
  v_mfma_f32_16x16x32_bf16 v[96:99], v[160:163], v[132:135], v[96:99]
  v_mfma_f32_16x16x32_bf16 v[92:95], v[156:159], v[132:135], v[92:95]
  s_add_u32 m0, s34, 45760
  s_nop 0
  buffer_load_dwordx4 v17, s[16:19], s35 offen offset:1024 lds
  s_add_u32 s35, s35, 14336
  v_mfma_f32_16x16x32_bf16 v[88:91], v[152:155], v[132:135], v[88:91]
  s_waitcnt vmcnt(8) lgkmcnt(0)
  s_barrier
  s_cmp_lg_u32 s3, 0
  s_cbranch_scc1 ow_53
  v_mov_b32 v8, 1
  v_mov_b32 v9, 0
  s_mov_b64 exec, 1
  buffer_store_dword v8, v9, s[8:11], s76 offen sc1
  s_mov_b64 exec, -1
ow_53:
  v_mfma_f32_16x16x32_bf16 v[40:43], v[136:139], v[104:107], v[40:43]
  ds_read_b128 v[120:123], v28 offset:16384
  v_mfma_f32_16x16x32_bf16 v[44:47], v[140:143], v[104:107], v[44:47]
  ds_read_b64_tr_b16 v[152:153], v29 offset:15232
  v_mfma_f32_16x16x32_bf16 v[48:51], v[144:147], v[104:107], v[48:51]
  ds_read_b64_tr_b16 v[154:155], v29 offset:15296
  s_add_u32 m0, s32, 0
  s_nop 0
  buffer_load_dwordx4 v14, s[12:15], s33 offen lds
  v_mfma_f32_16x16x32_bf16 v[52:55], v[148:151], v[104:107], v[52:55]
  ds_read_b64_tr_b16 v[156:157], v29 offset:17408
  v_mfma_f32_16x16x32_bf16 v[68:71], v[148:151], v[108:111], v[68:71]
  ds_read_b64_tr_b16 v[158:159], v29 offset:17472
  v_mfma_f32_16x16x32_bf16 v[64:67], v[144:147], v[108:111], v[64:67]
  ds_read_b64_tr_b16 v[160:161], v29 offset:19584
  v_mfma_f32_16x16x32_bf16 v[60:63], v[140:143], v[108:111], v[60:63]
  ds_read_b64_tr_b16 v[162:163], v29 offset:19648
  buffer_load_dwordx4 v15, s[12:15], s33 offen offset:1024 lds
  s_add_u32 s33, s33, 128
  v_mfma_f32_16x16x32_bf16 v[56:59], v[136:139], v[108:111], v[56:59]
  ds_read_b64_tr_b16 v[164:165], v29 offset:21760
  v_mfma_f32_16x16x32_bf16 v[72:75], v[136:139], v[112:115], v[72:75]
  ds_read_b64_tr_b16 v[166:167], v29 offset:21824
  v_mfma_f32_16x16x32_bf16 v[76:79], v[140:143], v[112:115], v[76:79]
  ds_read_b128 v[124:127], v28 offset:18432
  v_mfma_f32_16x16x32_bf16 v[80:83], v[144:147], v[112:115], v[80:83]
  ds_read_b128 v[128:131], v28 offset:20480
  s_add_u32 m0, s34, 0
  s_nop 0
  buffer_load_dwordx4 v16, s[16:19], s35 offen lds
  v_mfma_f32_16x16x32_bf16 v[84:87], v[148:151], v[112:115], v[84:87]
  ds_read_b128 v[132:135], v28 offset:22528
  v_mfma_f32_16x16x32_bf16 v[100:103], v[148:151], v[116:119], v[100:103]
  v_mfma_f32_16x16x32_bf16 v[96:99], v[144:147], v[116:119], v[96:99]
  v_mfma_f32_16x16x32_bf16 v[92:95], v[140:143], v[116:119], v[92:95]
  s_add_u32 m0, s34, 64
  s_nop 0
  buffer_load_dwordx4 v17, s[16:19], s35 offen offset:1024 lds
  s_add_u32 s35, s35, 14336
  v_mfma_f32_16x16x32_bf16 v[88:91], v[136:139], v[116:119], v[88:91]
  s_waitcnt vmcnt(8) lgkmcnt(0)
  s_barrier
  v_mfma_f32_16x16x32_bf16 v[40:43], v[152:155], v[120:123], v[40:43]
  ds_read_b128 v[104:107], v28 offset:32768
  v_mfma_f32_16x16x32_bf16 v[44:47], v[156:159], v[120:123], v[44:47]
  ds_read_b64_tr_b16 v[136:137], v29 offset:30464
  v_mfma_f32_16x16x32_bf16 v[48:51], v[160:163], v[120:123], v[48:51]
  ds_read_b64_tr_b16 v[138:139], v29 offset:30528
  s_add_u32 m0, s32, 16384
  s_nop 0
  buffer_load_dwordx4 v14, s[12:15], s33 offen lds
  v_mfma_f32_16x16x32_bf16 v[52:55], v[164:167], v[120:123], v[52:55]
  ds_read_b64_tr_b16 v[140:141], v29 offset:32640
  v_mfma_f32_16x16x32_bf16 v[68:71], v[164:167], v[124:127], v[68:71]
  ds_read_b64_tr_b16 v[142:143], v29 offset:32704
  v_mfma_f32_16x16x32_bf16 v[64:67], v[160:163], v[124:127], v[64:67]
  ds_read_b64_tr_b16 v[144:145], v29 offset:34816
  v_mfma_f32_16x16x32_bf16 v[60:63], v[156:159], v[124:127], v[60:63]
  ds_read_b64_tr_b16 v[146:147], v29 offset:34880
  buffer_load_dwordx4 v15, s[12:15], s33 offen offset:1024 lds
  s_add_u32 s33, s33, 128
  v_mfma_f32_16x16x32_bf16 v[56:59], v[152:155], v[124:127], v[56:59]
  ds_read_b64_tr_b16 v[148:149], v29 offset:36992
  v_mfma_f32_16x16x32_bf16 v[72:75], v[152:155], v[128:131], v[72:75]
  ds_read_b64_tr_b16 v[150:151], v29 offset:37056
  v_mfma_f32_16x16x32_bf16 v[76:79], v[156:159], v[128:131], v[76:79]
  ds_read_b128 v[108:111], v28 offset:34816
  v_mfma_f32_16x16x32_bf16 v[80:83], v[160:163], v[128:131], v[80:83]
  ds_read_b128 v[112:115], v28 offset:36864
  s_add_u32 m0, s34, 15232
  s_nop 0
  buffer_load_dwordx4 v16, s[16:19], s35 offen lds
  v_mfma_f32_16x16x32_bf16 v[84:87], v[164:167], v[128:131], v[84:87]
  ds_read_b128 v[116:119], v28 offset:38912
  v_mfma_f32_16x16x32_bf16 v[100:103], v[164:167], v[132:135], v[100:103]
  v_mfma_f32_16x16x32_bf16 v[96:99], v[160:163], v[132:135], v[96:99]
  v_mfma_f32_16x16x32_bf16 v[92:95], v[156:159], v[132:135], v[92:95]
  s_add_u32 m0, s34, 15296
  s_nop 0
  buffer_load_dwordx4 v17, s[16:19], s35 offen offset:1024 lds
  s_add_u32 s35, s35, 14336
  v_mfma_f32_16x16x32_bf16 v[88:91], v[152:155], v[132:135], v[88:91]
  s_waitcnt vmcnt(8) lgkmcnt(0)
  s_barrier
  v_mfma_f32_16x16x32_bf16 v[40:43], v[136:139], v[104:107], v[40:43]
  ds_read_b128 v[120:123], v28 offset:49152
  v_mfma_f32_16x16x32_bf16 v[44:47], v[140:143], v[104:107], v[44:47]
  ds_read_b64_tr_b16 v[152:153], v29 offset:45696
  v_mfma_f32_16x16x32_bf16 v[48:51], v[144:147], v[104:107], v[48:51]
  ds_read_b64_tr_b16 v[154:155], v29 offset:45760
  s_add_u32 m0, s32, 32768
  s_nop 0
  buffer_load_dwordx4 v14, s[12:15], s33 offen lds
  v_mfma_f32_16x16x32_bf16 v[52:55], v[148:151], v[104:107], v[52:55]
  ds_read_b64_tr_b16 v[156:157], v29 offset:47872
  v_mfma_f32_16x16x32_bf16 v[68:71], v[148:151], v[108:111], v[68:71]
  ds_read_b64_tr_b16 v[158:159], v29 offset:47936
  v_mfma_f32_16x16x32_bf16 v[64:67], v[144:147], v[108:111], v[64:67]
  ds_read_b64_tr_b16 v[160:161], v29 offset:50048
  v_mfma_f32_16x16x32_bf16 v[60:63], v[140:143], v[108:111], v[60:63]
  ds_read_b64_tr_b16 v[162:163], v29 offset:50112
  buffer_load_dwordx4 v15, s[12:15], s33 offen offset:1024 lds
  s_add_u32 s33, s33, 128
  v_mfma_f32_16x16x32_bf16 v[56:59], v[136:139], v[108:111], v[56:59]
  ds_read_b64_tr_b16 v[164:165], v29 offset:52224
  v_mfma_f32_16x16x32_bf16 v[72:75], v[136:139], v[112:115], v[72:75]
  ds_read_b64_tr_b16 v[166:167], v29 offset:52288
  v_mfma_f32_16x16x32_bf16 v[76:79], v[140:143], v[112:115], v[76:79]
  ds_read_b128 v[124:127], v28 offset:51200
  v_mfma_f32_16x16x32_bf16 v[80:83], v[144:147], v[112:115], v[80:83]
  ds_read_b128 v[128:131], v28 offset:53248
  s_add_u32 m0, s34, 30464
  s_nop 0
  buffer_load_dwordx4 v16, s[16:19], s35 offen lds
  v_mfma_f32_16x16x32_bf16 v[84:87], v[148:151], v[112:115], v[84:87]
  ds_read_b128 v[132:135], v28 offset:55296
  v_mfma_f32_16x16x32_bf16 v[100:103], v[148:151], v[116:119], v[100:103]
  v_mfma_f32_16x16x32_bf16 v[96:99], v[144:147], v[116:119], v[96:99]
  v_mfma_f32_16x16x32_bf16 v[92:95], v[140:143], v[116:119], v[92:95]
  s_add_u32 m0, s34, 30528
  s_nop 0
  buffer_load_dwordx4 v17, s[16:19], s35 offen offset:1024 lds
  s_add_u32 s35, s35, 14336
  v_mfma_f32_16x16x32_bf16 v[88:91], v[136:139], v[116:119], v[88:91]
  s_waitcnt vmcnt(8) lgkmcnt(0)
  s_barrier
  v_mfma_f32_16x16x32_bf16 v[40:43], v[152:155], v[120:123], v[40:43]
  ds_read_b128 v[104:107], v28 offset:0
  v_mfma_f32_16x16x32_bf16 v[44:47], v[156:159], v[120:123], v[44:47]
  ds_read_b64_tr_b16 v[136:137], v29 offset:0
  v_mfma_f32_16x16x32_bf16 v[48:51], v[160:163], v[120:123], v[48:51]
  ds_read_b64_tr_b16 v[138:139], v29 offset:64
  s_add_u32 m0, s32, 49152
  s_nop 0
  buffer_load_dwordx4 v14, s[12:15], s33 offen lds
  v_mfma_f32_16x16x32_bf16 v[52:55], v[164:167], v[120:123], v[52:55]
  ds_read_b64_tr_b16 v[140:141], v29 offset:2176
  v_mfma_f32_16x16x32_bf16 v[68:71], v[164:167], v[124:127], v[68:71]
  ds_read_b64_tr_b16 v[142:143], v29 offset:2240
  v_mfma_f32_16x16x32_bf16 v[64:67], v[160:163], v[124:127], v[64:67]
  ds_read_b64_tr_b16 v[144:145], v29 offset:4352
  v_mfma_f32_16x16x32_bf16 v[60:63], v[156:159], v[124:127], v[60:63]
  ds_read_b64_tr_b16 v[146:147], v29 offset:4416
  buffer_load_dwordx4 v15, s[12:15], s33 offen offset:1024 lds
  s_add_u32 s33, s33, 128
  v_mfma_f32_16x16x32_bf16 v[56:59], v[152:155], v[124:127], v[56:59]
  ds_read_b64_tr_b16 v[148:149], v29 offset:6528
  v_mfma_f32_16x16x32_bf16 v[72:75], v[152:155], v[128:131], v[72:75]
  ds_read_b64_tr_b16 v[150:151], v29 offset:6592
  v_mfma_f32_16x16x32_bf16 v[76:79], v[156:159], v[128:131], v[76:79]
  ds_read_b128 v[108:111], v28 offset:2048
  v_mfma_f32_16x16x32_bf16 v[80:83], v[160:163], v[128:131], v[80:83]
  ds_read_b128 v[112:115], v28 offset:4096
  s_add_u32 m0, s34, 45696
  s_nop 0
  buffer_load_dwordx4 v16, s[16:19], s35 offen lds
  v_mfma_f32_16x16x32_bf16 v[84:87], v[164:167], v[128:131], v[84:87]
  ds_read_b128 v[116:119], v28 offset:6144
  v_mfma_f32_16x16x32_bf16 v[100:103], v[164:167], v[132:135], v[100:103]
  v_mfma_f32_16x16x32_bf16 v[96:99], v[160:163], v[132:135], v[96:99]
  v_mfma_f32_16x16x32_bf16 v[92:95], v[156:159], v[132:135], v[92:95]
  s_add_u32 m0, s34, 45760
  s_nop 0
  buffer_load_dwordx4 v17, s[16:19], s35 offen offset:1024 lds
  s_add_u32 s35, s35, 14336
  v_mfma_f32_16x16x32_bf16 v[88:91], v[152:155], v[132:135], v[88:91]
  s_waitcnt vmcnt(8) lgkmcnt(0)
  s_barrier
  v_mfma_f32_16x16x32_bf16 v[40:43], v[136:139], v[104:107], v[40:43]
  ds_read_b128 v[120:123], v28 offset:16384
  v_mfma_f32_16x16x32_bf16 v[44:47], v[140:143], v[104:107], v[44:47]
  ds_read_b64_tr_b16 v[152:153], v29 offset:15232
  v_mfma_f32_16x16x32_bf16 v[48:51], v[144:147], v[104:107], v[48:51]
  ds_read_b64_tr_b16 v[154:155], v29 offset:15296
  s_add_u32 m0, s32, 0
  s_nop 0
  buffer_load_dwordx4 v14, s[12:15], s33 offen lds
  v_mfma_f32_16x16x32_bf16 v[52:55], v[148:151], v[104:107], v[52:55]
  ds_read_b64_tr_b16 v[156:157], v29 offset:17408
  v_mfma_f32_16x16x32_bf16 v[68:71], v[148:151], v[108:111], v[68:71]
  ds_read_b64_tr_b16 v[158:159], v29 offset:17472
  v_mfma_f32_16x16x32_bf16 v[64:67], v[144:147], v[108:111], v[64:67]
  ds_read_b64_tr_b16 v[160:161], v29 offset:19584
  v_mfma_f32_16x16x32_bf16 v[60:63], v[140:143], v[108:111], v[60:63]
  ds_read_b64_tr_b16 v[162:163], v29 offset:19648
  buffer_load_dwordx4 v15, s[12:15], s33 offen offset:1024 lds
  s_add_u32 s33, s33, 128
  v_mfma_f32_16x16x32_bf16 v[56:59], v[136:139], v[108:111], v[56:59]
  ds_read_b64_tr_b16 v[164:165], v29 offset:21760
  v_mfma_f32_16x16x32_bf16 v[72:75], v[136:139], v[112:115], v[72:75]
  ds_read_b64_tr_b16 v[166:167], v29 offset:21824
  v_mfma_f32_16x16x32_bf16 v[76:79], v[140:143], v[112:115], v[76:79]
  ds_read_b128 v[124:127], v28 offset:18432
  v_mfma_f32_16x16x32_bf16 v[80:83], v[144:147], v[112:115], v[80:83]
  ds_read_b128 v[128:131], v28 offset:20480
  s_add_u32 m0, s34, 0
  s_nop 0
  buffer_load_dwordx4 v16, s[16:19], s35 offen lds
  v_mfma_f32_16x16x32_bf16 v[84:87], v[148:151], v[112:115], v[84:87]
  ds_read_b128 v[132:135], v28 offset:22528
  v_mfma_f32_16x16x32_bf16 v[100:103], v[148:151], v[116:119], v[100:103]
  v_mfma_f32_16x16x32_bf16 v[96:99], v[144:147], v[116:119], v[96:99]
  v_mfma_f32_16x16x32_bf16 v[92:95], v[140:143], v[116:119], v[92:95]
  s_add_u32 m0, s34, 64
  s_nop 0
  buffer_load_dwordx4 v17, s[16:19], s35 offen offset:1024 lds
  s_add_u32 s35, s35, 14336
  v_mfma_f32_16x16x32_bf16 v[88:91], v[136:139], v[116:119], v[88:91]
  s_waitcnt vmcnt(8) lgkmcnt(0)
  s_barrier
  v_mfma_f32_16x16x32_bf16 v[40:43], v[152:155], v[120:123], v[40:43]
  ds_read_b128 v[104:107], v28 offset:32768
  v_mfma_f32_16x16x32_bf16 v[44:47], v[156:159], v[120:123], v[44:47]
  ds_read_b64_tr_b16 v[136:137], v29 offset:30464
  v_mfma_f32_16x16x32_bf16 v[48:51], v[160:163], v[120:123], v[48:51]
  ds_read_b64_tr_b16 v[138:139], v29 offset:30528
  s_add_u32 m0, s32, 16384
  s_nop 0
  buffer_load_dwordx4 v14, s[12:15], s33 offen lds
  v_mfma_f32_16x16x32_bf16 v[52:55], v[164:167], v[120:123], v[52:55]
  ds_read_b64_tr_b16 v[140:141], v29 offset:32640
  v_mfma_f32_16x16x32_bf16 v[68:71], v[164:167], v[124:127], v[68:71]
  ds_read_b64_tr_b16 v[142:143], v29 offset:32704
  v_mfma_f32_16x16x32_bf16 v[64:67], v[160:163], v[124:127], v[64:67]
  ds_read_b64_tr_b16 v[144:145], v29 offset:34816
  v_mfma_f32_16x16x32_bf16 v[60:63], v[156:159], v[124:127], v[60:63]
  ds_read_b64_tr_b16 v[146:147], v29 offset:34880
  buffer_load_dwordx4 v15, s[12:15], s33 offen offset:1024 lds
  s_add_u32 s33, s33, 128
  v_mfma_f32_16x16x32_bf16 v[56:59], v[152:155], v[124:127], v[56:59]
  ds_read_b64_tr_b16 v[148:149], v29 offset:36992
  v_mfma_f32_16x16x32_bf16 v[72:75], v[152:155], v[128:131], v[72:75]
  ds_read_b64_tr_b16 v[150:151], v29 offset:37056
  v_mfma_f32_16x16x32_bf16 v[76:79], v[156:159], v[128:131], v[76:79]
  ds_read_b128 v[108:111], v28 offset:34816
  v_mfma_f32_16x16x32_bf16 v[80:83], v[160:163], v[128:131], v[80:83]
  ds_read_b128 v[112:115], v28 offset:36864
  s_add_u32 m0, s34, 15232
  s_nop 0
  buffer_load_dwordx4 v16, s[16:19], s35 offen lds
  v_mfma_f32_16x16x32_bf16 v[84:87], v[164:167], v[128:131], v[84:87]
  ds_read_b128 v[116:119], v28 offset:38912
  v_mfma_f32_16x16x32_bf16 v[100:103], v[164:167], v[132:135], v[100:103]
  v_mfma_f32_16x16x32_bf16 v[96:99], v[160:163], v[132:135], v[96:99]
  v_mfma_f32_16x16x32_bf16 v[92:95], v[156:159], v[132:135], v[92:95]
  s_add_u32 m0, s34, 15296
  s_nop 0
  buffer_load_dwordx4 v17, s[16:19], s35 offen offset:1024 lds
  s_add_u32 s35, s35, 14336
  v_mfma_f32_16x16x32_bf16 v[88:91], v[152:155], v[132:135], v[88:91]
  s_waitcnt vmcnt(8) lgkmcnt(0)
  s_barrier
  v_mfma_f32_16x16x32_bf16 v[40:43], v[136:139], v[104:107], v[40:43]
  ds_read_b128 v[120:123], v28 offset:49152
  v_mfma_f32_16x16x32_bf16 v[44:47], v[140:143], v[104:107], v[44:47]
  ds_read_b64_tr_b16 v[152:153], v29 offset:45696
  v_mfma_f32_16x16x32_bf16 v[48:51], v[144:147], v[104:107], v[48:51]
  ds_read_b64_tr_b16 v[154:155], v29 offset:45760
  s_add_u32 m0, s32, 32768
  s_nop 0
  buffer_load_dwordx4 v14, s[12:15], s33 offen lds
  v_mfma_f32_16x16x32_bf16 v[52:55], v[148:151], v[104:107], v[52:55]
  ds_read_b64_tr_b16 v[156:157], v29 offset:47872
  v_mfma_f32_16x16x32_bf16 v[68:71], v[148:151], v[108:111], v[68:71]
  ds_read_b64_tr_b16 v[158:159], v29 offset:47936
  v_mfma_f32_16x16x32_bf16 v[64:67], v[144:147], v[108:111], v[64:67]
  ds_read_b64_tr_b16 v[160:161], v29 offset:50048
  v_mfma_f32_16x16x32_bf16 v[60:63], v[140:143], v[108:111], v[60:63]
  ds_read_b64_tr_b16 v[162:163], v29 offset:50112
  buffer_load_dwordx4 v15, s[12:15], s33 offen offset:1024 lds
  s_add_u32 s33, s33, 128
  v_mfma_f32_16x16x32_bf16 v[56:59], v[136:139], v[108:111], v[56:59]
  ds_read_b64_tr_b16 v[164:165], v29 offset:52224
  v_mfma_f32_16x16x32_bf16 v[72:75], v[136:139], v[112:115], v[72:75]
  ds_read_b64_tr_b16 v[166:167], v29 offset:52288
  v_mfma_f32_16x16x32_bf16 v[76:79], v[140:143], v[112:115], v[76:79]
  ds_read_b128 v[124:127], v28 offset:51200
  v_mfma_f32_16x16x32_bf16 v[80:83], v[144:147], v[112:115], v[80:83]
  ds_read_b128 v[128:131], v28 offset:53248
  s_add_u32 m0, s34, 30464
  s_nop 0
  buffer_load_dwordx4 v16, s[16:19], s35 offen lds
  v_mfma_f32_16x16x32_bf16 v[84:87], v[148:151], v[112:115], v[84:87]
  ds_read_b128 v[132:135], v28 offset:55296
  v_mfma_f32_16x16x32_bf16 v[100:103], v[148:151], v[116:119], v[100:103]
  v_mfma_f32_16x16x32_bf16 v[96:99], v[144:147], v[116:119], v[96:99]
  v_mfma_f32_16x16x32_bf16 v[92:95], v[140:143], v[116:119], v[92:95]
  s_add_u32 m0, s34, 30528
  s_nop 0
  buffer_load_dwordx4 v17, s[16:19], s35 offen offset:1024 lds
  s_add_u32 s35, s35, 14336
  v_mfma_f32_16x16x32_bf16 v[88:91], v[136:139], v[116:119], v[88:91]
  s_waitcnt vmcnt(8) lgkmcnt(0)
  s_barrier
  v_mfma_f32_16x16x32_bf16 v[40:43], v[152:155], v[120:123], v[40:43]
  ds_read_b128 v[104:107], v28 offset:0
  v_mfma_f32_16x16x32_bf16 v[44:47], v[156:159], v[120:123], v[44:47]
  ds_read_b64_tr_b16 v[136:137], v29 offset:0
  v_mfma_f32_16x16x32_bf16 v[48:51], v[160:163], v[120:123], v[48:51]
  ds_read_b64_tr_b16 v[138:139], v29 offset:64
  s_add_u32 m0, s32, 49152
  s_nop 0
  buffer_load_dwordx4 v14, s[12:15], s33 offen lds
  v_mfma_f32_16x16x32_bf16 v[52:55], v[164:167], v[120:123], v[52:55]
  ds_read_b64_tr_b16 v[140:141], v29 offset:2176
  v_mfma_f32_16x16x32_bf16 v[68:71], v[164:167], v[124:127], v[68:71]
  ds_read_b64_tr_b16 v[142:143], v29 offset:2240
  v_mfma_f32_16x16x32_bf16 v[64:67], v[160:163], v[124:127], v[64:67]
  ds_read_b64_tr_b16 v[144:145], v29 offset:4352
  v_mfma_f32_16x16x32_bf16 v[60:63], v[156:159], v[124:127], v[60:63]
  ds_read_b64_tr_b16 v[146:147], v29 offset:4416
  buffer_load_dwordx4 v15, s[12:15], s33 offen offset:1024 lds
  s_add_u32 s33, s33, 128
  v_mfma_f32_16x16x32_bf16 v[56:59], v[152:155], v[124:127], v[56:59]
  ds_read_b64_tr_b16 v[148:149], v29 offset:6528
  v_mfma_f32_16x16x32_bf16 v[72:75], v[152:155], v[128:131], v[72:75]
  ds_read_b64_tr_b16 v[150:151], v29 offset:6592
  v_mfma_f32_16x16x32_bf16 v[76:79], v[156:159], v[128:131], v[76:79]
  ds_read_b128 v[108:111], v28 offset:2048
  v_mfma_f32_16x16x32_bf16 v[80:83], v[160:163], v[128:131], v[80:83]
  ds_read_b128 v[112:115], v28 offset:4096
  s_add_u32 m0, s34, 45696
  s_nop 0
  buffer_load_dwordx4 v16, s[16:19], s35 offen lds
  v_mfma_f32_16x16x32_bf16 v[84:87], v[164:167], v[128:131], v[84:87]
  ds_read_b128 v[116:119], v28 offset:6144
  v_mfma_f32_16x16x32_bf16 v[100:103], v[164:167], v[132:135], v[100:103]
  v_mfma_f32_16x16x32_bf16 v[96:99], v[160:163], v[132:135], v[96:99]
  v_mfma_f32_16x16x32_bf16 v[92:95], v[156:159], v[132:135], v[92:95]
  s_add_u32 m0, s34, 45760
  s_nop 0
  buffer_load_dwordx4 v17, s[16:19], s35 offen offset:1024 lds
  s_add_u32 s35, s35, 14336
  v_mfma_f32_16x16x32_bf16 v[88:91], v[152:155], v[132:135], v[88:91]
  s_waitcnt vmcnt(8) lgkmcnt(0)
  s_barrier
  s_cmp_lg_u32 s3, 0
  s_cbranch_scc1 ow_54
  buffer_load_dword v12, v13, s[8:11], 0 offen sc1
ow_54:
  v_mfma_f32_16x16x32_bf16 v[40:43], v[136:139], v[104:107], v[40:43]
  ds_read_b128 v[120:123], v28 offset:16384
  v_mfma_f32_16x16x32_bf16 v[44:47], v[140:143], v[104:107], v[44:47]
  ds_read_b64_tr_b16 v[152:153], v29 offset:15232
  v_mfma_f32_16x16x32_bf16 v[48:51], v[144:147], v[104:107], v[48:51]
  ds_read_b64_tr_b16 v[154:155], v29 offset:15296
  s_add_u32 m0, s32, 0
  s_nop 0
  buffer_load_dwordx4 v14, s[12:15], s33 offen lds
  v_mfma_f32_16x16x32_bf16 v[52:55], v[148:151], v[104:107], v[52:55]
  ds_read_b64_tr_b16 v[156:157], v29 offset:17408
  v_mfma_f32_16x16x32_bf16 v[68:71], v[148:151], v[108:111], v[68:71]
  ds_read_b64_tr_b16 v[158:159], v29 offset:17472
  v_mfma_f32_16x16x32_bf16 v[64:67], v[144:147], v[108:111], v[64:67]
  ds_read_b64_tr_b16 v[160:161], v29 offset:19584
  v_mfma_f32_16x16x32_bf16 v[60:63], v[140:143], v[108:111], v[60:63]
  ds_read_b64_tr_b16 v[162:163], v29 offset:19648
  buffer_load_dwordx4 v15, s[12:15], s33 offen offset:1024 lds
  s_add_u32 s33, s33, 128
  v_mfma_f32_16x16x32_bf16 v[56:59], v[136:139], v[108:111], v[56:59]
  ds_read_b64_tr_b16 v[164:165], v29 offset:21760
  v_mfma_f32_16x16x32_bf16 v[72:75], v[136:139], v[112:115], v[72:75]
  ds_read_b64_tr_b16 v[166:167], v29 offset:21824
  v_mfma_f32_16x16x32_bf16 v[76:79], v[140:143], v[112:115], v[76:79]
  ds_read_b128 v[124:127], v28 offset:18432
  v_mfma_f32_16x16x32_bf16 v[80:83], v[144:147], v[112:115], v[80:83]
  ds_read_b128 v[128:131], v28 offset:20480
  s_add_u32 m0, s34, 0
  s_nop 0
  buffer_load_dwordx4 v16, s[16:19], s35 offen lds
  v_mfma_f32_16x16x32_bf16 v[84:87], v[148:151], v[112:115], v[84:87]
  ds_read_b128 v[132:135], v28 offset:22528
  v_mfma_f32_16x16x32_bf16 v[100:103], v[148:151], v[116:119], v[100:103]
  v_mfma_f32_16x16x32_bf16 v[96:99], v[144:147], v[116:119], v[96:99]
  v_mfma_f32_16x16x32_bf16 v[92:95], v[140:143], v[116:119], v[92:95]
  s_add_u32 m0, s34, 64
  s_nop 0
  buffer_load_dwordx4 v17, s[16:19], s35 offen offset:1024 lds
  s_add_u32 s35, s35, 14336
  v_mfma_f32_16x16x32_bf16 v[88:91], v[136:139], v[116:119], v[88:91]
  s_waitcnt vmcnt(8) lgkmcnt(0)
  s_barrier
  v_mfma_f32_16x16x32_bf16 v[40:43], v[152:155], v[120:123], v[40:43]
  ds_read_b128 v[104:107], v28 offset:32768
  v_mfma_f32_16x16x32_bf16 v[44:47], v[156:159], v[120:123], v[44:47]
  ds_read_b64_tr_b16 v[136:137], v29 offset:30464
  v_mfma_f32_16x16x32_bf16 v[48:51], v[160:163], v[120:123], v[48:51]
  ds_read_b64_tr_b16 v[138:139], v29 offset:30528
  s_add_u32 m0, s32, 16384
  s_nop 0
  buffer_load_dwordx4 v14, s[12:15], s33 offen lds
  v_mfma_f32_16x16x32_bf16 v[52:55], v[164:167], v[120:123], v[52:55]
  ds_read_b64_tr_b16 v[140:141], v29 offset:32640
  v_mfma_f32_16x16x32_bf16 v[68:71], v[164:167], v[124:127], v[68:71]
  ds_read_b64_tr_b16 v[142:143], v29 offset:32704
  v_mfma_f32_16x16x32_bf16 v[64:67], v[160:163], v[124:127], v[64:67]
  ds_read_b64_tr_b16 v[144:145], v29 offset:34816
  v_mfma_f32_16x16x32_bf16 v[60:63], v[156:159], v[124:127], v[60:63]
  ds_read_b64_tr_b16 v[146:147], v29 offset:34880
  buffer_load_dwordx4 v15, s[12:15], s33 offen offset:1024 lds
  s_add_u32 s33, s33, 128
  v_mfma_f32_16x16x32_bf16 v[56:59], v[152:155], v[124:127], v[56:59]
  ds_read_b64_tr_b16 v[148:149], v29 offset:36992
  v_mfma_f32_16x16x32_bf16 v[72:75], v[152:155], v[128:131], v[72:75]
  ds_read_b64_tr_b16 v[150:151], v29 offset:37056
  v_mfma_f32_16x16x32_bf16 v[76:79], v[156:159], v[128:131], v[76:79]
  ds_read_b128 v[108:111], v28 offset:34816
  v_mfma_f32_16x16x32_bf16 v[80:83], v[160:163], v[128:131], v[80:83]
  ds_read_b128 v[112:115], v28 offset:36864
  s_add_u32 m0, s34, 15232
  s_nop 0
  buffer_load_dwordx4 v16, s[16:19], s35 offen lds
  v_mfma_f32_16x16x32_bf16 v[84:87], v[164:167], v[128:131], v[84:87]
  ds_read_b128 v[116:119], v28 offset:38912
  v_mfma_f32_16x16x32_bf16 v[100:103], v[164:167], v[132:135], v[100:103]
  v_mfma_f32_16x16x32_bf16 v[96:99], v[160:163], v[132:135], v[96:99]
  v_mfma_f32_16x16x32_bf16 v[92:95], v[156:159], v[132:135], v[92:95]
  s_add_u32 m0, s34, 15296
  s_nop 0
  buffer_load_dwordx4 v17, s[16:19], s35 offen offset:1024 lds
  s_add_u32 s35, s35, 14336
  v_mfma_f32_16x16x32_bf16 v[88:91], v[152:155], v[132:135], v[88:91]
  s_cmp_lg_u32 s3, 0
  s_cbranch_scc1 ow_55
  s_waitcnt vmcnt(8)
  v_cmp_ne_u32 vcc, 0, v12
  s_nop 0
  s_cmp_eq_u64 vcc, -1
  s_cbranch_scc1 pok_56
  s_mov_b32 s75, 400000
psp_57:
  buffer_load_dword v12, v13, s[8:11], 0 offen sc1
  s_waitcnt vmcnt(0)
  v_cmp_ne_u32 vcc, 0, v12
  s_nop 0
  s_cmp_eq_u64 vcc, -1
  s_cbranch_scc1 pok_56
  s_sub_u32 s75, s75, 1
  s_cmp_lg_u32 s75, 0
  s_cbranch_scc1 psp_57
pok_56:
ow_55:
  s_waitcnt vmcnt(8) lgkmcnt(0)
  s_barrier
  s_lshl_b32 s5, s43, 1
  s_add_u32 s5, s5, s83
  s_lshl_b32 s4, s5, 12
  s_add_u32 s4, s4, 14680064
  v_lshlrev_b32 v2, 4, v1
  buffer_load_dwordx4 v[168:171], v2, s[8:11], s4 offen offset:0 sc1
  buffer_load_dwordx4 v[172:175], v2, s[8:11], s4 offen offset:1024 sc1
  buffer_load_dwordx4 v[176:179], v2, s[8:11], s4 offen offset:2048 sc1
  buffer_load_dwordx4 v[180:183], v2, s[8:11], s4 offen offset:3072 sc1
  s_lshl_b32 s4, s5, 7
  s_add_u32 s4, s4, 14811136
  v_and_b32 v2, 0x30, v1
  buffer_load_dwordx4 v[184:187], v2, s[8:11], s4 offen offset:0 sc1
  buffer_load_dwordx4 v[188:191], v2, s[8:11], s4 offen offset:64 sc1
  v_mfma_f32_16x16x32_bf16 v[40:43], v[136:139], v[104:107], v[40:43]
  ds_read_b128 v[120:123], v28 offset:49152
  v_mfma_f32_16x16x32_bf16 v[44:47], v[140:143], v[104:107], v[44:47]
  ds_read_b64_tr_b16 v[152:153], v29 offset:45696
  v_mfma_f32_16x16x32_bf16 v[48:51], v[144:147], v[104:107], v[48:51]
  ds_read_b64_tr_b16 v[154:155], v29 offset:45760
  s_add_u32 m0, s32, 32768
  s_nop 0
  buffer_load_dwordx4 v14, s[12:15], s33 offen lds
  v_mfma_f32_16x16x32_bf16 v[52:55], v[148:151], v[104:107], v[52:55]
  ds_read_b64_tr_b16 v[156:157], v29 offset:47872
  v_mfma_f32_16x16x32_bf16 v[68:71], v[148:151], v[108:111], v[68:71]
  ds_read_b64_tr_b16 v[158:159], v29 offset:47936
  v_mfma_f32_16x16x32_bf16 v[64:67], v[144:147], v[108:111], v[64:67]
  ds_read_b64_tr_b16 v[160:161], v29 offset:50048
  v_mfma_f32_16x16x32_bf16 v[60:63], v[140:143], v[108:111], v[60:63]
  ds_read_b64_tr_b16 v[162:163], v29 offset:50112
  buffer_load_dwordx4 v15, s[12:15], s33 offen offset:1024 lds
  s_add_u32 s33, s33, 128
  v_mfma_f32_16x16x32_bf16 v[56:59], v[136:139], v[108:111], v[56:59]
  ds_read_b64_tr_b16 v[164:165], v29 offset:52224
  v_mfma_f32_16x16x32_bf16 v[72:75], v[136:139], v[112:115], v[72:75]
  ds_read_b64_tr_b16 v[166:167], v29 offset:52288
  v_mfma_f32_16x16x32_bf16 v[76:79], v[140:143], v[112:115], v[76:79]
  ds_read_b128 v[124:127], v28 offset:51200
  v_mfma_f32_16x16x32_bf16 v[80:83], v[144:147], v[112:115], v[80:83]
  ds_read_b128 v[128:131], v28 offset:53248
  s_add_u32 m0, s34, 30464
  s_nop 0
  buffer_load_dwordx4 v16, s[16:19], s35 offen lds
  v_mfma_f32_16x16x32_bf16 v[84:87], v[148:151], v[112:115], v[84:87]
  ds_read_b128 v[132:135], v28 offset:55296
  v_mfma_f32_16x16x32_bf16 v[100:103], v[148:151], v[116:119], v[100:103]
  v_mfma_f32_16x16x32_bf16 v[96:99], v[144:147], v[116:119], v[96:99]
  v_mfma_f32_16x16x32_bf16 v[92:95], v[140:143], v[116:119], v[92:95]
  s_add_u32 m0, s34, 30528
  s_nop 0
  buffer_load_dwordx4 v17, s[16:19], s35 offen offset:1024 lds
  s_add_u32 s35, s35, 14336
  v_mfma_f32_16x16x32_bf16 v[88:91], v[136:139], v[116:119], v[88:91]
  s_waitcnt vmcnt(14) lgkmcnt(0)
  s_barrier
  v_mfma_f32_16x16x32_bf16 v[40:43], v[152:155], v[120:123], v[40:43]
  ds_read_b128 v[104:107], v28 offset:0
  v_mfma_f32_16x16x32_bf16 v[44:47], v[156:159], v[120:123], v[44:47]
  ds_read_b64_tr_b16 v[136:137], v29 offset:0
  v_mfma_f32_16x16x32_bf16 v[48:51], v[160:163], v[120:123], v[48:51]
  ds_read_b64_tr_b16 v[138:139], v29 offset:64
  s_add_u32 m0, s32, 49152
  s_nop 0
  buffer_load_dwordx4 v14, s[12:15], s33 offen lds
  v_mfma_f32_16x16x32_bf16 v[52:55], v[164:167], v[120:123], v[52:55]
  ds_read_b64_tr_b16 v[140:141], v29 offset:2176
  v_mfma_f32_16x16x32_bf16 v[68:71], v[164:167], v[124:127], v[68:71]
  ds_read_b64_tr_b16 v[142:143], v29 offset:2240
  v_mfma_f32_16x16x32_bf16 v[64:67], v[160:163], v[124:127], v[64:67]
  ds_read_b64_tr_b16 v[144:145], v29 offset:4352
  v_mfma_f32_16x16x32_bf16 v[60:63], v[156:159], v[124:127], v[60:63]
  ds_read_b64_tr_b16 v[146:147], v29 offset:4416
  buffer_load_dwordx4 v15, s[12:15], s33 offen offset:1024 lds
  s_add_u32 s33, s33, 128
  v_mfma_f32_16x16x32_bf16 v[56:59], v[152:155], v[124:127], v[56:59]
  ds_read_b64_tr_b16 v[148:149], v29 offset:6528
  v_mfma_f32_16x16x32_bf16 v[72:75], v[152:155], v[128:131], v[72:75]
  ds_read_b64_tr_b16 v[150:151], v29 offset:6592
  v_mfma_f32_16x16x32_bf16 v[76:79], v[156:159], v[128:131], v[76:79]
  ds_read_b128 v[108:111], v28 offset:2048
  v_mfma_f32_16x16x32_bf16 v[80:83], v[160:163], v[128:131], v[80:83]
  ds_read_b128 v[112:115], v28 offset:4096
  s_add_u32 m0, s34, 45696
  s_nop 0
  buffer_load_dwordx4 v16, s[16:19], s35 offen lds
  v_mfma_f32_16x16x32_bf16 v[84:87], v[164:167], v[128:131], v[84:87]
  ds_read_b128 v[116:119], v28 offset:6144
  v_mfma_f32_16x16x32_bf16 v[100:103], v[164:167], v[132:135], v[100:103]
  v_mfma_f32_16x16x32_bf16 v[96:99], v[160:163], v[132:135], v[96:99]
  v_mfma_f32_16x16x32_bf16 v[92:95], v[156:159], v[132:135], v[92:95]
  s_add_u32 m0, s34, 45760
  s_nop 0
  buffer_load_dwordx4 v17, s[16:19], s35 offen offset:1024 lds
  s_add_u32 s35, s35, 14336
  v_mfma_f32_16x16x32_bf16 v[88:91], v[152:155], v[132:135], v[88:91]
  s_waitcnt vmcnt(14) lgkmcnt(0)
  s_barrier
  v_mfma_f32_16x16x32_bf16 v[40:43], v[136:139], v[104:107], v[40:43]
  ds_read_b128 v[120:123], v28 offset:16384
  v_mfma_f32_16x16x32_bf16 v[44:47], v[140:143], v[104:107], v[44:47]
  ds_read_b64_tr_b16 v[152:153], v29 offset:15232
  v_mfma_f32_16x16x32_bf16 v[48:51], v[144:147], v[104:107], v[48:51]
  ds_read_b64_tr_b16 v[154:155], v29 offset:15296
  s_add_u32 m0, s32, 0
  s_nop 0
  buffer_load_dwordx4 v14, s[12:15], s33 offen lds
  v_mfma_f32_16x16x32_bf16 v[52:55], v[148:151], v[104:107], v[52:55]
  ds_read_b64_tr_b16 v[156:157], v29 offset:17408
  v_mfma_f32_16x16x32_bf16 v[68:71], v[148:151], v[108:111], v[68:71]
  ds_read_b64_tr_b16 v[158:159], v29 offset:17472
  v_mfma_f32_16x16x32_bf16 v[64:67], v[144:147], v[108:111], v[64:67]
  ds_read_b64_tr_b16 v[160:161], v29 offset:19584
  v_mfma_f32_16x16x32_bf16 v[60:63], v[140:143], v[108:111], v[60:63]
  ds_read_b64_tr_b16 v[162:163], v29 offset:19648
  buffer_load_dwordx4 v15, s[12:15], s33 offen offset:1024 lds
  s_add_u32 s33, s33, 128
  v_mfma_f32_16x16x32_bf16 v[56:59], v[136:139], v[108:111], v[56:59]
  ds_read_b64_tr_b16 v[164:165], v29 offset:21760
  v_mfma_f32_16x16x32_bf16 v[72:75], v[136:139], v[112:115], v[72:75]
  ds_read_b64_tr_b16 v[166:167], v29 offset:21824
  v_mfma_f32_16x16x32_bf16 v[76:79], v[140:143], v[112:115], v[76:79]
  ds_read_b128 v[124:127], v28 offset:18432
  v_mfma_f32_16x16x32_bf16 v[80:83], v[144:147], v[112:115], v[80:83]
  ds_read_b128 v[128:131], v28 offset:20480
  s_add_u32 m0, s34, 0
  s_nop 0
  buffer_load_dwordx4 v16, s[16:19], s35 offen lds
  v_mfma_f32_16x16x32_bf16 v[84:87], v[148:151], v[112:115], v[84:87]
  ds_read_b128 v[132:135], v28 offset:22528
  v_mfma_f32_16x16x32_bf16 v[100:103], v[148:151], v[116:119], v[100:103]
  v_mfma_f32_16x16x32_bf16 v[96:99], v[144:147], v[116:119], v[96:99]
  v_mfma_f32_16x16x32_bf16 v[92:95], v[140:143], v[116:119], v[92:95]
  s_add_u32 m0, s34, 64
  s_nop 0
  buffer_load_dwordx4 v17, s[16:19], s35 offen offset:1024 lds
  s_add_u32 s35, s35, 14336
  v_mfma_f32_16x16x32_bf16 v[88:91], v[136:139], v[116:119], v[88:91]
  s_waitcnt vmcnt(8) lgkmcnt(0)
  s_barrier
  v_mfma_f32_16x16x32_bf16 v[40:43], v[152:155], v[120:123], v[40:43]
  ds_read_b128 v[104:107], v28 offset:32768
  v_mfma_f32_16x16x32_bf16 v[44:47], v[156:159], v[120:123], v[44:47]
  ds_read_b64_tr_b16 v[136:137], v29 offset:30464
  v_mfma_f32_16x16x32_bf16 v[48:51], v[160:163], v[120:123], v[48:51]
  ds_read_b64_tr_b16 v[138:139], v29 offset:30528
  s_add_u32 m0, s32, 16384
  s_nop 0
  buffer_load_dwordx4 v14, s[12:15], s33 offen lds
  v_mfma_f32_16x16x32_bf16 v[52:55], v[164:167], v[120:123], v[52:55]
  ds_read_b64_tr_b16 v[140:141], v29 offset:32640
  v_mfma_f32_16x16x32_bf16 v[68:71], v[164:167], v[124:127], v[68:71]
  ds_read_b64_tr_b16 v[142:143], v29 offset:32704
  v_mfma_f32_16x16x32_bf16 v[64:67], v[160:163], v[124:127], v[64:67]
  ds_read_b64_tr_b16 v[144:145], v29 offset:34816
  v_mfma_f32_16x16x32_bf16 v[60:63], v[156:159], v[124:127], v[60:63]
  ds_read_b64_tr_b16 v[146:147], v29 offset:34880
  buffer_load_dwordx4 v15, s[12:15], s33 offen offset:1024 lds
  s_add_u32 s33, s33, 128
  v_mfma_f32_16x16x32_bf16 v[56:59], v[152:155], v[124:127], v[56:59]
  ds_read_b64_tr_b16 v[148:149], v29 offset:36992
  v_mfma_f32_16x16x32_bf16 v[72:75], v[152:155], v[128:131], v[72:75]
  ds_read_b64_tr_b16 v[150:151], v29 offset:37056
  v_mfma_f32_16x16x32_bf16 v[76:79], v[156:159], v[128:131], v[76:79]
  ds_read_b128 v[108:111], v28 offset:34816
  v_mfma_f32_16x16x32_bf16 v[80:83], v[160:163], v[128:131], v[80:83]
  ds_read_b128 v[112:115], v28 offset:36864
  s_add_u32 m0, s34, 15232
  s_nop 0
  buffer_load_dwordx4 v16, s[16:19], s35 offen lds
  v_mfma_f32_16x16x32_bf16 v[84:87], v[164:167], v[128:131], v[84:87]
  ds_read_b128 v[116:119], v28 offset:38912
  v_mfma_f32_16x16x32_bf16 v[100:103], v[164:167], v[132:135], v[100:103]
  v_mfma_f32_16x16x32_bf16 v[96:99], v[160:163], v[132:135], v[96:99]
  v_mfma_f32_16x16x32_bf16 v[92:95], v[156:159], v[132:135], v[92:95]
  s_add_u32 m0, s34, 15296
  s_nop 0
  buffer_load_dwordx4 v17, s[16:19], s35 offen offset:1024 lds
  s_add_u32 s35, s35, 14336
  v_mfma_f32_16x16x32_bf16 v[88:91], v[152:155], v[132:135], v[88:91]
  s_waitcnt vmcnt(16)
  s_lshl_b32 s5, s43, 1
  s_add_u32 s5, s5, s83
  s_lshl_b32 s5, s5, 2
  v_bfe_u32 v2, v1, 4, 1
  v_lshrrev_b32 v3, 5, v1
  v_lshl_add_u32 v2, v2, 1, v3
  v_add_u32 v2, s5, v2
  v_and_b32 v3, 127, v20
  v_lshlrev_b32 v3, 4, v3
  v_lshl_add_u32 v25, v2, 11, v3
  s_mul_i32 s4, s42, 720896
  v_add_u32 v25, s4, v25
  v_mfma_f32_16x16x32_bf16 v[192:195], v[168:171], v[232:235], 0
  v_mfma_f32_16x16x32_bf16 v[196:199], v[172:175], v[232:235], 0
  v_mfma_f32_16x16x32_bf16 v[200:203], v[184:187], v[232:235], 0
  v_mfma_f32_16x16x32_bf16 v[192:195], v[176:179], v[236:239], v[192:195]
  v_mfma_f32_16x16x32_bf16 v[196:199], v[180:183], v[236:239], v[196:199]
  v_mfma_f32_16x16x32_bf16 v[200:203], v[188:191], v[236:239], v[200:203]
  s_nop 7
  v_add_f32 v212, 0x358637bd, v200
  v_rcp_f32 v212, v212
  s_nop 0
  v_mul_f32 v212, v212, v21
  v_pk_mul_f32 v[192:193], v[192:193], v[212:213] op_sel_hi:[1,0]
  v_pk_mul_f32 v[194:195], v[194:195], v[212:213] op_sel_hi:[1,0]
  v_pk_mul_f32 v[196:197], v[196:197], v[212:213] op_sel_hi:[1,0]
  v_pk_mul_f32 v[198:199], v[198:199], v[212:213] op_sel_hi:[1,0]
  v_cvt_pk_bf16_f32 v204, v192, v193
  v_cvt_pk_bf16_f32 v205, v194, v195
  v_cvt_pk_bf16_f32 v206, v196, v197
  v_cvt_pk_bf16_f32 v207, v198, v199
  s_nop 0
  v_permlane16_swap_b32 v204, v206
  v_permlane16_swap_b32 v205, v207
  s_mov_b32 s4, 16777216
  buffer_store_dwordx4 v[204:207], v25, s[8:11], s4 offen sc1
  v_mfma_f32_16x16x32_bf16 v[192:195], v[168:171], v[240:243], 0
  v_mfma_f32_16x16x32_bf16 v[196:199], v[172:175], v[240:243], 0
  v_mfma_f32_16x16x32_bf16 v[200:203], v[184:187], v[240:243], 0
  v_mfma_f32_16x16x32_bf16 v[192:195], v[176:179], v[244:247], v[192:195]
  v_mfma_f32_16x16x32_bf16 v[196:199], v[180:183], v[244:247], v[196:199]
  v_mfma_f32_16x16x32_bf16 v[200:203], v[188:191], v[244:247], v[200:203]
  s_nop 7
  v_add_f32 v212, 0x358637bd, v200
  v_rcp_f32 v212, v212
  s_nop 0
  v_mul_f32 v212, v212, v22
  v_pk_mul_f32 v[192:193], v[192:193], v[212:213] op_sel_hi:[1,0]
  v_pk_mul_f32 v[194:195], v[194:195], v[212:213] op_sel_hi:[1,0]
  v_pk_mul_f32 v[196:197], v[196:197], v[212:213] op_sel_hi:[1,0]
  v_pk_mul_f32 v[198:199], v[198:199], v[212:213] op_sel_hi:[1,0]
  v_cvt_pk_bf16_f32 v208, v192, v193
  v_cvt_pk_bf16_f32 v209, v194, v195
  v_cvt_pk_bf16_f32 v210, v196, v197
  v_cvt_pk_bf16_f32 v211, v198, v199
  s_nop 0
  v_permlane16_swap_b32 v208, v210
  v_permlane16_swap_b32 v209, v211
  s_mov_b32 s4, 16777472
  buffer_store_dwordx4 v[208:211], v25, s[8:11], s4 offen sc1
  s_lshl_b32 s4, s42, 6
  s_add_u32 s4, s4, 15730944
  v_and_b32 v2, 15, v1
  v_lshl_add_u32 v13, v2, 2, s4
  s_lshl_b32 s76, s43, 2
  s_add_u32 s76, s76, s4
  s_waitcnt vmcnt(10) lgkmcnt(0)
  s_barrier
  v_mfma_f32_16x16x32_bf16 v[40:43], v[136:139], v[104:107], v[40:43]
  ds_read_b128 v[120:123], v28 offset:49152
  v_mfma_f32_16x16x32_bf16 v[44:47], v[140:143], v[104:107], v[44:47]
  ds_read_b64_tr_b16 v[152:153], v29 offset:45696
  v_mfma_f32_16x16x32_bf16 v[48:51], v[144:147], v[104:107], v[48:51]
  ds_read_b64_tr_b16 v[154:155], v29 offset:45760
  s_add_u32 m0, s32, 32768
  s_nop 0
  buffer_load_dwordx4 v14, s[12:15], s33 offen lds
  v_mfma_f32_16x16x32_bf16 v[52:55], v[148:151], v[104:107], v[52:55]
  ds_read_b64_tr_b16 v[156:157], v29 offset:47872
  v_mfma_f32_16x16x32_bf16 v[68:71], v[148:151], v[108:111], v[68:71]
  ds_read_b64_tr_b16 v[158:159], v29 offset:47936
  v_mfma_f32_16x16x32_bf16 v[64:67], v[144:147], v[108:111], v[64:67]
  ds_read_b64_tr_b16 v[160:161], v29 offset:50048
  v_mfma_f32_16x16x32_bf16 v[60:63], v[140:143], v[108:111], v[60:63]
  ds_read_b64_tr_b16 v[162:163], v29 offset:50112
  buffer_load_dwordx4 v15, s[12:15], s33 offen offset:1024 lds
  s_add_u32 s33, s33, 128
  v_mfma_f32_16x16x32_bf16 v[56:59], v[136:139], v[108:111], v[56:59]
  ds_read_b64_tr_b16 v[164:165], v29 offset:52224
  v_mfma_f32_16x16x32_bf16 v[72:75], v[136:139], v[112:115], v[72:75]
  ds_read_b64_tr_b16 v[166:167], v29 offset:52288
  v_mfma_f32_16x16x32_bf16 v[76:79], v[140:143], v[112:115], v[76:79]
  ds_read_b128 v[124:127], v28 offset:51200
  v_mfma_f32_16x16x32_bf16 v[80:83], v[144:147], v[112:115], v[80:83]
  ds_read_b128 v[128:131], v28 offset:53248
  s_add_u32 m0, s34, 30464
  s_nop 0
  buffer_load_dwordx4 v16, s[16:19], s35 offen lds
  v_mfma_f32_16x16x32_bf16 v[84:87], v[148:151], v[112:115], v[84:87]
  ds_read_b128 v[132:135], v28 offset:55296
  v_mfma_f32_16x16x32_bf16 v[100:103], v[148:151], v[116:119], v[100:103]
  v_mfma_f32_16x16x32_bf16 v[96:99], v[144:147], v[116:119], v[96:99]
  v_mfma_f32_16x16x32_bf16 v[92:95], v[140:143], v[116:119], v[92:95]
  s_add_u32 m0, s34, 30528
  s_nop 0
  buffer_load_dwordx4 v17, s[16:19], s35 offen offset:1024 lds
  s_add_u32 s35, s35, 14336
  v_mfma_f32_16x16x32_bf16 v[88:91], v[136:139], v[116:119], v[88:91]
  s_waitcnt vmcnt(10) lgkmcnt(0)
  s_barrier
  v_mfma_f32_16x16x32_bf16 v[40:43], v[152:155], v[120:123], v[40:43]
  ds_read_b128 v[104:107], v28 offset:0
  v_mfma_f32_16x16x32_bf16 v[44:47], v[156:159], v[120:123], v[44:47]
  ds_read_b64_tr_b16 v[136:137], v29 offset:0
  v_mfma_f32_16x16x32_bf16 v[48:51], v[160:163], v[120:123], v[48:51]
  ds_read_b64_tr_b16 v[138:139], v29 offset:64
  s_add_u32 m0, s32, 49152
  s_nop 0
  buffer_load_dwordx4 v14, s[12:15], s33 offen lds
  v_mfma_f32_16x16x32_bf16 v[52:55], v[164:167], v[120:123], v[52:55]
  ds_read_b64_tr_b16 v[140:141], v29 offset:2176
  v_mfma_f32_16x16x32_bf16 v[68:71], v[164:167], v[124:127], v[68:71]
  ds_read_b64_tr_b16 v[142:143], v29 offset:2240
  v_mfma_f32_16x16x32_bf16 v[64:67], v[160:163], v[124:127], v[64:67]
  ds_read_b64_tr_b16 v[144:145], v29 offset:4352
  v_mfma_f32_16x16x32_bf16 v[60:63], v[156:159], v[124:127], v[60:63]
  ds_read_b64_tr_b16 v[146:147], v29 offset:4416
  buffer_load_dwordx4 v15, s[12:15], s33 offen offset:1024 lds
  s_add_u32 s33, s33, 128
  v_mfma_f32_16x16x32_bf16 v[56:59], v[152:155], v[124:127], v[56:59]
  ds_read_b64_tr_b16 v[148:149], v29 offset:6528
  v_mfma_f32_16x16x32_bf16 v[72:75], v[152:155], v[128:131], v[72:75]
  ds_read_b64_tr_b16 v[150:151], v29 offset:6592
  v_mfma_f32_16x16x32_bf16 v[76:79], v[156:159], v[128:131], v[76:79]
  ds_read_b128 v[108:111], v28 offset:2048
  v_mfma_f32_16x16x32_bf16 v[80:83], v[160:163], v[128:131], v[80:83]
  ds_read_b128 v[112:115], v28 offset:4096
  s_add_u32 m0, s34, 45696
  s_nop 0
  buffer_load_dwordx4 v16, s[16:19], s35 offen lds
  v_mfma_f32_16x16x32_bf16 v[84:87], v[164:167], v[128:131], v[84:87]
  ds_read_b128 v[116:119], v28 offset:6144
  v_mfma_f32_16x16x32_bf16 v[100:103], v[164:167], v[132:135], v[100:103]
  v_mfma_f32_16x16x32_bf16 v[96:99], v[160:163], v[132:135], v[96:99]
  v_mfma_f32_16x16x32_bf16 v[92:95], v[156:159], v[132:135], v[92:95]
  s_add_u32 m0, s34, 45760
  s_nop 0
  buffer_load_dwordx4 v17, s[16:19], s35 offen offset:1024 lds
  s_add_u32 s35, s35, 14336
  v_mfma_f32_16x16x32_bf16 v[88:91], v[152:155], v[132:135], v[88:91]
  s_waitcnt vmcnt(10) lgkmcnt(0)
  s_barrier
  v_mfma_f32_16x16x32_bf16 v[40:43], v[136:139], v[104:107], v[40:43]
  ds_read_b128 v[120:123], v28 offset:16384
  v_mfma_f32_16x16x32_bf16 v[44:47], v[140:143], v[104:107], v[44:47]
  ds_read_b64_tr_b16 v[152:153], v29 offset:15232
  v_mfma_f32_16x16x32_bf16 v[48:51], v[144:147], v[104:107], v[48:51]
  ds_read_b64_tr_b16 v[154:155], v29 offset:15296
  s_add_u32 m0, s32, 0
  s_nop 0
  buffer_load_dwordx4 v14, s[12:15], s33 offen lds
  v_mfma_f32_16x16x32_bf16 v[52:55], v[148:151], v[104:107], v[52:55]
  ds_read_b64_tr_b16 v[156:157], v29 offset:17408
  v_mfma_f32_16x16x32_bf16 v[68:71], v[148:151], v[108:111], v[68:71]
  ds_read_b64_tr_b16 v[158:159], v29 offset:17472
  v_mfma_f32_16x16x32_bf16 v[64:67], v[144:147], v[108:111], v[64:67]
  ds_read_b64_tr_b16 v[160:161], v29 offset:19584
  v_mfma_f32_16x16x32_bf16 v[60:63], v[140:143], v[108:111], v[60:63]
  ds_read_b64_tr_b16 v[162:163], v29 offset:19648
  buffer_load_dwordx4 v15, s[12:15], s33 offen offset:1024 lds
  s_add_u32 s33, s33, 128
  v_mfma_f32_16x16x32_bf16 v[56:59], v[136:139], v[108:111], v[56:59]
  ds_read_b64_tr_b16 v[164:165], v29 offset:21760
  v_mfma_f32_16x16x32_bf16 v[72:75], v[136:139], v[112:115], v[72:75]
  ds_read_b64_tr_b16 v[166:167], v29 offset:21824
  v_mfma_f32_16x16x32_bf16 v[76:79], v[140:143], v[112:115], v[76:79]
  ds_read_b128 v[124:127], v28 offset:18432
  v_mfma_f32_16x16x32_bf16 v[80:83], v[144:147], v[112:115], v[80:83]
  ds_read_b128 v[128:131], v28 offset:20480
  s_add_u32 m0, s34, 0
  s_nop 0
  buffer_load_dwordx4 v16, s[16:19], s35 offen lds
  v_mfma_f32_16x16x32_bf16 v[84:87], v[148:151], v[112:115], v[84:87]
  ds_read_b128 v[132:135], v28 offset:22528
  v_mfma_f32_16x16x32_bf16 v[100:103], v[148:151], v[116:119], v[100:103]
  v_mfma_f32_16x16x32_bf16 v[96:99], v[144:147], v[116:119], v[96:99]
  v_mfma_f32_16x16x32_bf16 v[92:95], v[140:143], v[116:119], v[92:95]
  s_add_u32 m0, s34, 64
  s_nop 0
  buffer_load_dwordx4 v17, s[16:19], s35 offen offset:1024 lds
  s_add_u32 s35, s35, 14336
  v_mfma_f32_16x16x32_bf16 v[88:91], v[136:139], v[116:119], v[88:91]
  s_waitcnt vmcnt(8) lgkmcnt(0)
  s_barrier
  s_cmp_lg_u32 s3, 0
  s_cbranch_scc1 ow_58
  v_mov_b32 v8, 1
  v_mov_b32 v9, 0
  s_mov_b64 exec, 1
  buffer_store_dword v8, v9, s[8:11], s76 offen sc1
  s_mov_b64 exec, -1
ow_58:
  v_mfma_f32_16x16x32_bf16 v[40:43], v[152:155], v[120:123], v[40:43]
  ds_read_b128 v[104:107], v28 offset:32768
  v_mfma_f32_16x16x32_bf16 v[44:47], v[156:159], v[120:123], v[44:47]
  ds_read_b64_tr_b16 v[136:137], v29 offset:30464
  v_mfma_f32_16x16x32_bf16 v[48:51], v[160:163], v[120:123], v[48:51]
  ds_read_b64_tr_b16 v[138:139], v29 offset:30528
  s_add_u32 m0, s32, 16384
  s_nop 0
  buffer_load_dwordx4 v14, s[12:15], s33 offen lds
  v_mfma_f32_16x16x32_bf16 v[52:55], v[164:167], v[120:123], v[52:55]
  ds_read_b64_tr_b16 v[140:141], v29 offset:32640
  v_mfma_f32_16x16x32_bf16 v[68:71], v[164:167], v[124:127], v[68:71]
  ds_read_b64_tr_b16 v[142:143], v29 offset:32704
  v_mfma_f32_16x16x32_bf16 v[64:67], v[160:163], v[124:127], v[64:67]
  ds_read_b64_tr_b16 v[144:145], v29 offset:34816
  v_mfma_f32_16x16x32_bf16 v[60:63], v[156:159], v[124:127], v[60:63]
  ds_read_b64_tr_b16 v[146:147], v29 offset:34880
  buffer_load_dwordx4 v15, s[12:15], s33 offen offset:1024 lds
  s_add_u32 s33, s33, 128
  v_mfma_f32_16x16x32_bf16 v[56:59], v[152:155], v[124:127], v[56:59]
  ds_read_b64_tr_b16 v[148:149], v29 offset:36992
  v_mfma_f32_16x16x32_bf16 v[72:75], v[152:155], v[128:131], v[72:75]
  ds_read_b64_tr_b16 v[150:151], v29 offset:37056
  v_mfma_f32_16x16x32_bf16 v[76:79], v[156:159], v[128:131], v[76:79]
  ds_read_b128 v[108:111], v28 offset:34816
  v_mfma_f32_16x16x32_bf16 v[80:83], v[160:163], v[128:131], v[80:83]
  ds_read_b128 v[112:115], v28 offset:36864
  s_add_u32 m0, s34, 15232
  s_nop 0
  buffer_load_dwordx4 v16, s[16:19], s35 offen lds
  v_mfma_f32_16x16x32_bf16 v[84:87], v[164:167], v[128:131], v[84:87]
  ds_read_b128 v[116:119], v28 offset:38912
  v_mfma_f32_16x16x32_bf16 v[100:103], v[164:167], v[132:135], v[100:103]
  v_mfma_f32_16x16x32_bf16 v[96:99], v[160:163], v[132:135], v[96:99]
  v_mfma_f32_16x16x32_bf16 v[92:95], v[156:159], v[132:135], v[92:95]
  s_add_u32 m0, s34, 15296
  s_nop 0
  buffer_load_dwordx4 v17, s[16:19], s35 offen offset:1024 lds
  s_add_u32 s35, s35, 14336
  v_mfma_f32_16x16x32_bf16 v[88:91], v[152:155], v[132:135], v[88:91]
  s_waitcnt vmcnt(8) lgkmcnt(0)
  s_barrier
  v_mfma_f32_16x16x32_bf16 v[40:43], v[136:139], v[104:107], v[40:43]
  ds_read_b128 v[120:123], v28 offset:49152
  s_add_u32 s20, s72, 16777216
  s_addc_u32 s21, s73, 0
  v_mfma_f32_16x16x32_bf16 v[44:47], v[140:143], v[104:107], v[44:47]
  ds_read_b64_tr_b16 v[152:153], v29 offset:45696
  s_and_b32 s21, s21, 0xffff
  v_mfma_f32_16x16x32_bf16 v[48:51], v[144:147], v[104:107], v[48:51]
  ds_read_b64_tr_b16 v[154:155], v29 offset:45760
  s_add_u32 m0, s32, 32768
  s_nop 0
  buffer_load_dwordx4 v14, s[12:15], s33 offen lds
  s_mov_b32 s22, 11534336
  v_mfma_f32_16x16x32_bf16 v[52:55], v[148:151], v[104:107], v[52:55]
  ds_read_b64_tr_b16 v[156:157], v29 offset:47872
  v_mfma_f32_16x16x32_bf16 v[68:71], v[148:151], v[108:111], v[68:71]
  ds_read_b64_tr_b16 v[158:159], v29 offset:47936
  s_mov_b32 s23, 0x20000
  v_mfma_f32_16x16x32_bf16 v[64:67], v[144:147], v[108:111], v[64:67]
  ds_read_b64_tr_b16 v[160:161], v29 offset:50048
  s_mov_b32 s24, s54
  v_mfma_f32_16x16x32_bf16 v[60:63], v[140:143], v[108:111], v[60:63]
  ds_read_b64_tr_b16 v[162:163], v29 offset:50112
  buffer_load_dwordx4 v15, s[12:15], s33 offen offset:1024 lds
  s_add_u32 s33, s33, 128
  s_and_b32 s25, s55, 0xffff
  v_mfma_f32_16x16x32_bf16 v[56:59], v[136:139], v[108:111], v[56:59]
  ds_read_b64_tr_b16 v[164:165], v29 offset:52224
  v_mfma_f32_16x16x32_bf16 v[72:75], v[136:139], v[112:115], v[72:75]
  ds_read_b64_tr_b16 v[166:167], v29 offset:52288
  s_mov_b32 s26, 2097152
  v_mfma_f32_16x16x32_bf16 v[76:79], v[140:143], v[112:115], v[76:79]
  ds_read_b128 v[124:127], v28 offset:51200
  s_mov_b32 s27, 0x20000
  v_mfma_f32_16x16x32_bf16 v[80:83], v[144:147], v[112:115], v[80:83]
  ds_read_b128 v[128:131], v28 offset:53248
  s_add_u32 m0, s34, 30464
  s_nop 0
  buffer_load_dwordx4 v16, s[16:19], s35 offen lds
  s_lshl_b32 s36, s3, 10
  v_mfma_f32_16x16x32_bf16 v[84:87], v[148:151], v[112:115], v[84:87]
  ds_read_b128 v[132:135], v28 offset:55296
  v_mfma_f32_16x16x32_bf16 v[100:103], v[148:151], v[116:119], v[100:103]
  s_add_u32 s36, s36, 131072
  v_mfma_f32_16x16x32_bf16 v[96:99], v[144:147], v[116:119], v[96:99]
  s_mul_i32 s92, s42, 720896
  v_mfma_f32_16x16x32_bf16 v[92:95], v[140:143], v[116:119], v[92:95]
  s_add_u32 m0, s34, 30528
  s_nop 0
  buffer_load_dwordx4 v17, s[16:19], s35 offen offset:1024 lds
  s_add_u32 s35, s35, 14336
  s_lshl_b32 s4, s3, 11
  v_mfma_f32_16x16x32_bf16 v[88:91], v[136:139], v[116:119], v[88:91]
  s_waitcnt vmcnt(8) lgkmcnt(0)
  s_barrier
  v_mfma_f32_16x16x32_bf16 v[40:43], v[152:155], v[120:123], v[40:43]
  ds_read_b128 v[104:107], v28 offset:0
  s_add_u32 s92, s92, s4
  v_mfma_f32_16x16x32_bf16 v[44:47], v[156:159], v[120:123], v[44:47]
  ds_read_b64_tr_b16 v[136:137], v29 offset:0
  v_lshlrev_b32 v18, 4, v1
  v_mfma_f32_16x16x32_bf16 v[48:51], v[160:163], v[120:123], v[48:51]
  ds_read_b64_tr_b16 v[138:139], v29 offset:64
  s_add_u32 m0, s32, 49152
  s_nop 0
  buffer_load_dwordx4 v14, s[12:15], s33 offen lds
  s_lshl_b32 s78, s43, 7
  v_mfma_f32_16x16x32_bf16 v[52:55], v[164:167], v[120:123], v[52:55]
  ds_read_b64_tr_b16 v[140:141], v29 offset:2176
  v_mfma_f32_16x16x32_bf16 v[68:71], v[164:167], v[124:127], v[68:71]
  ds_read_b64_tr_b16 v[142:143], v29 offset:2240
  s_mov_b32 s5, 2048
  v_mfma_f32_16x16x32_bf16 v[64:67], v[160:163], v[124:127], v[64:67]
  ds_read_b64_tr_b16 v[144:145], v29 offset:4352
  s_mul_i32 s37, s3, 16384
  v_mfma_f32_16x16x32_bf16 v[60:63], v[156:159], v[124:127], v[60:63]
  ds_read_b64_tr_b16 v[146:147], v29 offset:4416
  buffer_load_dwordx4 v15, s[12:15], s33 offen offset:1024 lds
  s_add_u32 s33, s33, 128
  s_add_u32 s37, s37, s78
  v_mfma_f32_16x16x32_bf16 v[56:59], v[152:155], v[124:127], v[56:59]
  ds_read_b64_tr_b16 v[148:149], v29 offset:6528
  v_mfma_f32_16x16x32_bf16 v[72:75], v[152:155], v[128:131], v[72:75]
  ds_read_b64_tr_b16 v[150:151], v29 offset:6592
  s_lshl_b32 s4, s44, 1
  v_mfma_f32_16x16x32_bf16 v[76:79], v[156:159], v[128:131], v[76:79]
  ds_read_b128 v[108:111], v28 offset:2048
  v_bfe_u32 v3, v1, 4, 1
  v_mfma_f32_16x16x32_bf16 v[80:83], v[160:163], v[128:131], v[80:83]
  ds_read_b128 v[112:115], v28 offset:4096
  s_add_u32 m0, s34, 45696
  s_nop 0
  buffer_load_dwordx4 v16, s[16:19], s35 offen lds
  v_or_b32 v3, s4, v3
  v_mfma_f32_16x16x32_bf16 v[84:87], v[164:167], v[128:131], v[84:87]
  ds_read_b128 v[116:119], v28 offset:6144
  v_mfma_f32_16x16x32_bf16 v[100:103], v[164:167], v[132:135], v[100:103]
  v_bfe_u32 v4, v1, 1, 2
  v_mfma_f32_16x16x32_bf16 v[96:99], v[160:163], v[132:135], v[96:99]
  v_xor_b32 v3, v3, v4
  v_mfma_f32_16x16x32_bf16 v[92:95], v[156:159], v[132:135], v[92:95]
  s_add_u32 m0, s34, 45760
  s_nop 0
  buffer_load_dwordx4 v17, s[16:19], s35 offen offset:1024 lds
  s_add_u32 s35, s35, 14336
  v_and_b32 v4, 1, v1
  v_mfma_f32_16x16x32_bf16 v[88:91], v[152:155], v[132:135], v[88:91]
  s_waitcnt vmcnt(8) lgkmcnt(0)
  s_barrier
  v_mfma_f32_16x16x32_bf16 v[40:43], v[136:139], v[104:107], v[40:43]
  ds_read_b128 v[120:123], v28 offset:16384
  v_lshlrev_b32 v4, 4, v4
  v_mfma_f32_16x16x32_bf16 v[44:47], v[140:143], v[104:107], v[44:47]
  ds_read_b64_tr_b16 v[152:153], v29 offset:15232
  v_lshl_add_u32 v3, v3, 5, v4
  v_mfma_f32_16x16x32_bf16 v[48:51], v[144:147], v[104:107], v[48:51]
  ds_read_b64_tr_b16 v[154:155], v29 offset:15296
  s_add_u32 m0, s32, 0
  s_nop 0
  buffer_load_dwordx4 v14, s[12:15], s33 offen lds
  v_mfma_f32_16x16x32_bf16 v[52:55], v[148:151], v[104:107], v[52:55]
  ds_read_b64_tr_b16 v[156:157], v29 offset:17408
  v_mad_u32_u24 v19, v0, s5, v3
  v_mfma_f32_16x16x32_bf16 v[68:71], v[148:151], v[108:111], v[68:71]
  ds_read_b64_tr_b16 v[158:159], v29 offset:17472
  v_lshrrev_b32 v2, 4, v1
  v_mfma_f32_16x16x32_bf16 v[64:67], v[144:147], v[108:111], v[64:67]
  ds_read_b64_tr_b16 v[160:161], v29 offset:19584
  v_mfma_f32_16x16x32_bf16 v[60:63], v[140:143], v[108:111], v[60:63]
  ds_read_b64_tr_b16 v[162:163], v29 offset:19648
  buffer_load_dwordx4 v15, s[12:15], s33 offen offset:1024 lds
  s_add_u32 s33, s33, 128
  v_and_b32 v3, 127, v20
  v_mfma_f32_16x16x32_bf16 v[56:59], v[136:139], v[108:111], v[56:59]
  ds_read_b64_tr_b16 v[164:165], v29 offset:21760
  v_mfma_f32_16x16x32_bf16 v[72:75], v[136:139], v[112:115], v[72:75]
  ds_read_b64_tr_b16 v[166:167], v29 offset:21824
  v_lshlrev_b32 v3, 4, v3
  v_mfma_f32_16x16x32_bf16 v[76:79], v[140:143], v[112:115], v[76:79]
  ds_read_b128 v[124:127], v28 offset:18432
  v_lshl_add_u32 v30, v2, 11, v3
  v_mfma_f32_16x16x32_bf16 v[80:83], v[144:147], v[112:115], v[80:83]
  ds_read_b128 v[128:131], v28 offset:20480
  s_add_u32 m0, s34, 0
  s_nop 0
  buffer_load_dwordx4 v16, s[16:19], s35 offen lds
  v_mfma_f32_16x16x32_bf16 v[84:87], v[148:151], v[112:115], v[84:87]
  ds_read_b128 v[132:135], v28 offset:22528
  v_add_u32 v31, 8192, v30
  v_mfma_f32_16x16x32_bf16 v[100:103], v[148:151], v[116:119], v[100:103]
  v_add_u32 v36, 32768, v36
  v_mfma_f32_16x16x32_bf16 v[96:99], v[144:147], v[116:119], v[96:99]
  v_mfma_f32_16x16x32_bf16 v[92:95], v[140:143], v[116:119], v[92:95]
  s_add_u32 m0, s34, 64
  s_nop 0
  buffer_load_dwordx4 v17, s[16:19], s35 offen offset:1024 lds
  s_add_u32 s35, s35, 14336
  v_add_u32 v37, 32768, v37
  v_mfma_f32_16x16x32_bf16 v[88:91], v[136:139], v[116:119], v[88:91]
  s_waitcnt vmcnt(8) lgkmcnt(0)
  s_barrier
  v_mfma_f32_16x16x32_bf16 v[40:43], v[152:155], v[120:123], v[40:43]
  ds_read_b128 v[104:107], v28 offset:32768
  v_mfma_f32_16x16x32_bf16 v[44:47], v[156:159], v[120:123], v[44:47]
  ds_read_b64_tr_b16 v[136:137], v29 offset:30464
  v_mfma_f32_16x16x32_bf16 v[48:51], v[160:163], v[120:123], v[48:51]
  ds_read_b64_tr_b16 v[138:139], v29 offset:30528
  s_add_u32 m0, s32, 16384
  s_nop 0
  buffer_load_dwordx4 v14, s[12:15], s33 offen lds
  v_mfma_f32_16x16x32_bf16 v[52:55], v[164:167], v[120:123], v[52:55]
  ds_read_b64_tr_b16 v[140:141], v29 offset:32640
  v_mfma_f32_16x16x32_bf16 v[68:71], v[164:167], v[124:127], v[68:71]
  ds_read_b64_tr_b16 v[142:143], v29 offset:32704
  v_mfma_f32_16x16x32_bf16 v[64:67], v[160:163], v[124:127], v[64:67]
  ds_read_b64_tr_b16 v[144:145], v29 offset:34816
  v_mfma_f32_16x16x32_bf16 v[60:63], v[156:159], v[124:127], v[60:63]
  ds_read_b64_tr_b16 v[146:147], v29 offset:34880
  buffer_load_dwordx4 v15, s[12:15], s33 offen offset:1024 lds
  s_add_u32 s33, s33, 128
  v_mfma_f32_16x16x32_bf16 v[56:59], v[152:155], v[124:127], v[56:59]
  ds_read_b64_tr_b16 v[148:149], v29 offset:36992
  v_mfma_f32_16x16x32_bf16 v[72:75], v[152:155], v[128:131], v[72:75]
  ds_read_b64_tr_b16 v[150:151], v29 offset:37056
  v_mfma_f32_16x16x32_bf16 v[76:79], v[156:159], v[128:131], v[76:79]
  ds_read_b128 v[108:111], v28 offset:34816
  v_mfma_f32_16x16x32_bf16 v[80:83], v[160:163], v[128:131], v[80:83]
  ds_read_b128 v[112:115], v28 offset:36864
  s_add_u32 m0, s34, 15232
  s_nop 0
  buffer_load_dwordx4 v16, s[16:19], s35 offen lds
  v_mfma_f32_16x16x32_bf16 v[84:87], v[164:167], v[128:131], v[84:87]
  ds_read_b128 v[116:119], v28 offset:38912
  v_mfma_f32_16x16x32_bf16 v[100:103], v[164:167], v[132:135], v[100:103]
  v_mfma_f32_16x16x32_bf16 v[96:99], v[160:163], v[132:135], v[96:99]
  v_mfma_f32_16x16x32_bf16 v[92:95], v[156:159], v[132:135], v[92:95]
  s_add_u32 m0, s34, 15296
  s_nop 0
  buffer_load_dwordx4 v17, s[16:19], s35 offen offset:1024 lds
  s_add_u32 s35, s35, 14336
  v_mfma_f32_16x16x32_bf16 v[88:91], v[152:155], v[132:135], v[88:91]
  s_waitcnt vmcnt(8) lgkmcnt(0)
  s_barrier
  s_cmp_lg_u32 s3, 0
  s_cbranch_scc1 ow_59
  buffer_load_dword v12, v13, s[8:11], 0 offen sc1
ow_59:
  v_mfma_f32_16x16x32_bf16 v[40:43], v[136:139], v[104:107], v[40:43]
  ds_read_b128 v[120:123], v28 offset:49152
  v_mfma_f32_16x16x32_bf16 v[44:47], v[140:143], v[104:107], v[44:47]
  ds_read_b64_tr_b16 v[152:153], v29 offset:45696
  v_mfma_f32_16x16x32_bf16 v[48:51], v[144:147], v[104:107], v[48:51]
  ds_read_b64_tr_b16 v[154:155], v29 offset:45760
  s_add_u32 m0, s32, 32768
  s_nop 0
  buffer_load_dwordx4 v14, s[12:15], s33 offen lds
  v_mfma_f32_16x16x32_bf16 v[52:55], v[148:151], v[104:107], v[52:55]
  ds_read_b64_tr_b16 v[156:157], v29 offset:47872
  v_mfma_f32_16x16x32_bf16 v[68:71], v[148:151], v[108:111], v[68:71]
  ds_read_b64_tr_b16 v[158:159], v29 offset:47936
  v_mfma_f32_16x16x32_bf16 v[64:67], v[144:147], v[108:111], v[64:67]
  ds_read_b64_tr_b16 v[160:161], v29 offset:50048
  v_mfma_f32_16x16x32_bf16 v[60:63], v[140:143], v[108:111], v[60:63]
  ds_read_b64_tr_b16 v[162:163], v29 offset:50112
  buffer_load_dwordx4 v15, s[12:15], s33 offen offset:1024 lds
  s_add_u32 s33, s33, 128
  v_mfma_f32_16x16x32_bf16 v[56:59], v[136:139], v[108:111], v[56:59]
  ds_read_b64_tr_b16 v[164:165], v29 offset:52224
  v_mfma_f32_16x16x32_bf16 v[72:75], v[136:139], v[112:115], v[72:75]
  ds_read_b64_tr_b16 v[166:167], v29 offset:52288
  v_mfma_f32_16x16x32_bf16 v[76:79], v[140:143], v[112:115], v[76:79]
  ds_read_b128 v[124:127], v28 offset:51200
  v_mfma_f32_16x16x32_bf16 v[80:83], v[144:147], v[112:115], v[80:83]
  ds_read_b128 v[128:131], v28 offset:53248
  s_add_u32 m0, s34, 30464
  s_nop 0
  buffer_load_dwordx4 v16, s[16:19], s35 offen lds
  v_mfma_f32_16x16x32_bf16 v[84:87], v[148:151], v[112:115], v[84:87]
  ds_read_b128 v[132:135], v28 offset:55296
  v_mfma_f32_16x16x32_bf16 v[100:103], v[148:151], v[116:119], v[100:103]
  v_mfma_f32_16x16x32_bf16 v[96:99], v[144:147], v[116:119], v[96:99]
  v_mfma_f32_16x16x32_bf16 v[92:95], v[140:143], v[116:119], v[92:95]
  s_add_u32 m0, s34, 30528
  s_nop 0
  buffer_load_dwordx4 v17, s[16:19], s35 offen offset:1024 lds
  s_add_u32 s35, s35, 14336
  v_mfma_f32_16x16x32_bf16 v[88:91], v[136:139], v[116:119], v[88:91]
  s_waitcnt vmcnt(8) lgkmcnt(0)
  s_barrier
  v_mfma_f32_16x16x32_bf16 v[40:43], v[152:155], v[120:123], v[40:43]
  ds_read_b128 v[104:107], v28 offset:0
  v_mfma_f32_16x16x32_bf16 v[44:47], v[156:159], v[120:123], v[44:47]
  ds_read_b64_tr_b16 v[136:137], v29 offset:0
  v_mfma_f32_16x16x32_bf16 v[48:51], v[160:163], v[120:123], v[48:51]
  ds_read_b64_tr_b16 v[138:139], v29 offset:64
  s_add_u32 m0, s32, 49152
  s_nop 0
  buffer_load_dwordx4 v14, s[12:15], s33 offen lds
  v_mfma_f32_16x16x32_bf16 v[52:55], v[164:167], v[120:123], v[52:55]
  ds_read_b64_tr_b16 v[140:141], v29 offset:2176
  v_mfma_f32_16x16x32_bf16 v[68:71], v[164:167], v[124:127], v[68:71]
  ds_read_b64_tr_b16 v[142:143], v29 offset:2240
  v_mfma_f32_16x16x32_bf16 v[64:67], v[160:163], v[124:127], v[64:67]
  ds_read_b64_tr_b16 v[144:145], v29 offset:4352
  v_mfma_f32_16x16x32_bf16 v[60:63], v[156:159], v[124:127], v[60:63]
  ds_read_b64_tr_b16 v[146:147], v29 offset:4416
  buffer_load_dwordx4 v15, s[12:15], s33 offen offset:1024 lds
  s_add_u32 s33, s33, 128
  v_mfma_f32_16x16x32_bf16 v[56:59], v[152:155], v[124:127], v[56:59]
  ds_read_b64_tr_b16 v[148:149], v29 offset:6528
  v_mfma_f32_16x16x32_bf16 v[72:75], v[152:155], v[128:131], v[72:75]
  ds_read_b64_tr_b16 v[150:151], v29 offset:6592
  v_mfma_f32_16x16x32_bf16 v[76:79], v[156:159], v[128:131], v[76:79]
  ds_read_b128 v[108:111], v28 offset:2048
  v_mfma_f32_16x16x32_bf16 v[80:83], v[160:163], v[128:131], v[80:83]
  ds_read_b128 v[112:115], v28 offset:4096
  s_add_u32 m0, s34, 45696
  s_nop 0
  buffer_load_dwordx4 v16, s[16:19], s35 offen lds
  v_mfma_f32_16x16x32_bf16 v[84:87], v[164:167], v[128:131], v[84:87]
  ds_read_b128 v[116:119], v28 offset:6144
  v_mfma_f32_16x16x32_bf16 v[100:103], v[164:167], v[132:135], v[100:103]
  v_mfma_f32_16x16x32_bf16 v[96:99], v[160:163], v[132:135], v[96:99]
  v_mfma_f32_16x16x32_bf16 v[92:95], v[156:159], v[132:135], v[92:95]
  s_add_u32 m0, s34, 45760
  s_nop 0
  buffer_load_dwordx4 v17, s[16:19], s35 offen offset:1024 lds
  s_add_u32 s35, s35, 14336
  v_mfma_f32_16x16x32_bf16 v[88:91], v[152:155], v[132:135], v[88:91]
  s_cmp_lg_u32 s3, 0
  s_cbranch_scc1 ow_60
  s_waitcnt vmcnt(8)
  v_cmp_ne_u32 vcc, 0, v12
  s_nop 0
  s_cmp_eq_u64 vcc, -1
  s_cbranch_scc1 pok_61
  s_mov_b32 s75, 400000
psp_62:
  buffer_load_dword v12, v13, s[8:11], 0 offen sc1
  s_waitcnt vmcnt(0)
  v_cmp_ne_u32 vcc, 0, v12
  s_nop 0
  s_cmp_eq_u64 vcc, -1
  s_cbranch_scc1 pok_61
  s_sub_u32 s75, s75, 1
  s_cmp_lg_u32 s75, 0
  s_cbranch_scc1 psp_62
pok_61:
ow_60:
  s_waitcnt vmcnt(8) lgkmcnt(0)
  s_barrier
  v_mfma_f32_16x16x32_bf16 v[40:43], v[136:139], v[104:107], v[40:43]
  ds_read_b128 v[120:123], v28 offset:16384
  v_mfma_f32_16x16x32_bf16 v[44:47], v[140:143], v[104:107], v[44:47]
  ds_read_b64_tr_b16 v[152:153], v29 offset:15232
  v_mfma_f32_16x16x32_bf16 v[48:51], v[144:147], v[104:107], v[48:51]
  ds_read_b64_tr_b16 v[154:155], v29 offset:15296
  s_add_u32 m0, s32, 0
  s_nop 0
  buffer_load_dwordx4 v18, s[20:23], s92 offen lds
  v_mfma_f32_16x16x32_bf16 v[52:55], v[148:151], v[104:107], v[52:55]
  ds_read_b64_tr_b16 v[156:157], v29 offset:17408
  v_mfma_f32_16x16x32_bf16 v[68:71], v[148:151], v[108:111], v[68:71]
  ds_read_b64_tr_b16 v[158:159], v29 offset:17472
  v_mfma_f32_16x16x32_bf16 v[64:67], v[144:147], v[108:111], v[64:67]
  ds_read_b64_tr_b16 v[160:161], v29 offset:19584
  v_mfma_f32_16x16x32_bf16 v[60:63], v[140:143], v[108:111], v[60:63]
  ds_read_b64_tr_b16 v[162:163], v29 offset:19648
  v_mfma_f32_16x16x32_bf16 v[56:59], v[136:139], v[108:111], v[56:59]
  ds_read_b64_tr_b16 v[164:165], v29 offset:21760
  v_mfma_f32_16x16x32_bf16 v[72:75], v[136:139], v[112:115], v[72:75]
  ds_read_b64_tr_b16 v[166:167], v29 offset:21824
  buffer_load_dwordx4 v18, s[20:23], s92 offen offset:1024 lds
  s_add_u32 s92, s92, 16384
  v_mfma_f32_16x16x32_bf16 v[76:79], v[140:143], v[112:115], v[76:79]
  ds_read_b128 v[124:127], v28 offset:18432
  v_mfma_f32_16x16x32_bf16 v[80:83], v[144:147], v[112:115], v[80:83]
  ds_read_b128 v[128:131], v28 offset:20480
  v_mfma_f32_16x16x32_bf16 v[84:87], v[148:151], v[112:115], v[84:87]
  ds_read_b128 v[132:135], v28 offset:22528
  v_mfma_f32_16x16x32_bf16 v[100:103], v[148:151], v[116:119], v[100:103]
  v_mfma_f32_16x16x32_bf16 v[96:99], v[144:147], v[116:119], v[96:99]
  s_add_u32 m0, s36, 0
  s_nop 0
  buffer_load_dwordx4 v19, s[24:27], s37 offen lds
  s_add_u32 s37, s37, 131072
  v_mfma_f32_16x16x32_bf16 v[92:95], v[140:143], v[116:119], v[92:95]
  v_mfma_f32_16x16x32_bf16 v[88:91], v[136:139], v[116:119], v[88:91]
  s_waitcnt vmcnt(7) lgkmcnt(0)
  s_barrier
  v_mfma_f32_16x16x32_bf16 v[40:43], v[152:155], v[120:123], v[40:43]
  ds_read_b128 v[104:107], v28 offset:32768
  s_mul_i32 s4, s43, 14
  v_mfma_f32_16x16x32_bf16 v[44:47], v[156:159], v[120:123], v[44:47]
  ds_read_b64_tr_b16 v[136:137], v29 offset:30464
  s_lshl_b32 s5, s83, 3
  v_mfma_f32_16x16x32_bf16 v[48:51], v[160:163], v[120:123], v[48:51]
  ds_read_b64_tr_b16 v[138:139], v29 offset:30528
  s_add_u32 m0, s32, 16384
  s_nop 0
  buffer_load_dwordx4 v18, s[20:23], s92 offen lds
  v_mfma_f32_16x16x32_bf16 v[52:55], v[164:167], v[120:123], v[52:55]
  ds_read_b64_tr_b16 v[140:141], v29 offset:32640
  s_add_u32 s4, s4, s5
  v_mfma_f32_16x16x32_bf16 v[68:71], v[164:167], v[124:127], v[68:71]
  ds_read_b64_tr_b16 v[142:143], v29 offset:32704
  v_mfma_f32_16x16x32_bf16 v[64:67], v[160:163], v[124:127], v[64:67]
  ds_read_b64_tr_b16 v[144:145], v29 offset:34816
  s_add_u32 s4, s4, 128
  v_mfma_f32_16x16x32_bf16 v[60:63], v[156:159], v[124:127], v[60:63]
  ds_read_b64_tr_b16 v[146:147], v29 offset:34880
  v_mfma_f32_16x16x32_bf16 v[56:59], v[152:155], v[124:127], v[56:59]
  ds_read_b64_tr_b16 v[148:149], v29 offset:36992
  v_bfe_u32 v3, v1, 4, 1
  v_mfma_f32_16x16x32_bf16 v[72:75], v[152:155], v[128:131], v[72:75]
  ds_read_b64_tr_b16 v[150:151], v29 offset:37056
  buffer_load_dwordx4 v18, s[20:23], s92 offen offset:1024 lds
  s_add_u32 s92, s92, 16384
  v_lshrrev_b32 v2, 5, v1
  v_mfma_f32_16x16x32_bf16 v[76:79], v[156:159], v[128:131], v[76:79]
  ds_read_b128 v[108:111], v28 offset:34816
  v_mfma_f32_16x16x32_bf16 v[80:83], v[160:163], v[128:131], v[80:83]
  ds_read_b128 v[112:115], v28 offset:36864
  v_lshl_add_u32 v2, v3, 1, v2
  v_mfma_f32_16x16x32_bf16 v[84:87], v[164:167], v[128:131], v[84:87]
  ds_read_b128 v[116:119], v28 offset:38912
  v_mfma_f32_16x16x32_bf16 v[100:103], v[164:167], v[132:135], v[100:103]
  v_add_u32 v2, s4, v2
  v_mfma_f32_16x16x32_bf16 v[96:99], v[160:163], v[132:135], v[96:99]
  s_add_u32 m0, s36, 8192
  s_nop 0
  buffer_load_dwordx4 v19, s[24:27], s37 offen lds
  s_add_u32 s37, s37, 131072
  v_mfma_f32_16x16x32_bf16 v[92:95], v[156:159], v[132:135], v[92:95]
  v_and_b32 v4, 127, v20
  v_mfma_f32_16x16x32_bf16 v[88:91], v[152:155], v[132:135], v[88:91]
  s_waitcnt vmcnt(6) lgkmcnt(0)
  s_barrier
  v_mfma_f32_16x16x32_bf16 v[40:43], v[136:139], v[104:107], v[40:43]
  ds_read_b128 v[120:123], v28 offset:49152
  v_lshlrev_b32 v4, 4, v4
  v_mfma_f32_16x16x32_bf16 v[44:47], v[140:143], v[104:107], v[44:47]
  ds_read_b64_tr_b16 v[152:153], v29 offset:45696
  v_lshl_add_u32 v184, v2, 11, v4
  v_mfma_f32_16x16x32_bf16 v[48:51], v[144:147], v[104:107], v[48:51]
  ds_read_b64_tr_b16 v[154:155], v29 offset:45760
  s_add_u32 m0, s32, 32768
  s_nop 0
  buffer_load_dwordx4 v18, s[20:23], s92 offen lds
  v_mfma_f32_16x16x32_bf16 v[52:55], v[148:151], v[104:107], v[52:55]
  ds_read_b64_tr_b16 v[156:157], v29 offset:47872
  s_mul_i32 s4, s42, 720896
  v_mfma_f32_16x16x32_bf16 v[68:71], v[148:151], v[108:111], v[68:71]
  ds_read_b64_tr_b16 v[158:159], v29 offset:47936
  v_mfma_f32_16x16x32_bf16 v[64:67], v[144:147], v[108:111], v[64:67]
  ds_read_b64_tr_b16 v[160:161], v29 offset:50048
  s_add_u32 s4, s4, 16777216
  v_mfma_f32_16x16x32_bf16 v[60:63], v[140:143], v[108:111], v[60:63]
  ds_read_b64_tr_b16 v[162:163], v29 offset:50112
  v_mfma_f32_16x16x32_bf16 v[56:59], v[136:139], v[108:111], v[56:59]
  ds_read_b64_tr_b16 v[164:165], v29 offset:52224
  v_add_u32 v184, s4, v184
  v_mfma_f32_16x16x32_bf16 v[72:75], v[136:139], v[112:115], v[72:75]
  ds_read_b64_tr_b16 v[166:167], v29 offset:52288
  buffer_load_dwordx4 v18, s[20:23], s92 offen offset:1024 lds
  s_add_u32 s92, s92, 16384
  v_add_u32 v185, 8192, v184
  v_mfma_f32_16x16x32_bf16 v[76:79], v[140:143], v[112:115], v[76:79]
  ds_read_b128 v[124:127], v28 offset:51200
  v_mfma_f32_16x16x32_bf16 v[80:83], v[144:147], v[112:115], v[80:83]
  ds_read_b128 v[128:131], v28 offset:53248
  v_mul_lo_u32 v3, v3, s83
  v_mfma_f32_16x16x32_bf16 v[84:87], v[148:151], v[112:115], v[84:87]
  ds_read_b128 v[132:135], v28 offset:55296
  v_mfma_f32_16x16x32_bf16 v[100:103], v[148:151], v[116:119], v[100:103]
  v_mov_b32 v4, 2146435072
  v_mfma_f32_16x16x32_bf16 v[96:99], v[144:147], v[116:119], v[96:99]
  s_add_u32 m0, s36, 16384
  s_nop 0
  buffer_load_dwordx4 v19, s[24:27], s37 offen lds
  s_add_u32 s37, s37, 131072
  v_mfma_f32_16x16x32_bf16 v[92:95], v[140:143], v[116:119], v[92:95]
  v_cmp_eq_u32 vcc, 1, v3
  s_nop 1
  v_cndmask_b32 v185, v185, v4, vcc
  v_mfma_f32_16x16x32_bf16 v[88:91], v[136:139], v[116:119], v[88:91]
  s_waitcnt lgkmcnt(0)
  v_mfma_f32_16x16x32_bf16 v[40:43], v[152:155], v[120:123], v[40:43]
  v_add_u32 v186, 256, v184
  v_mfma_f32_16x16x32_bf16 v[44:47], v[156:159], v[120:123], v[44:47]
  v_mfma_f32_16x16x32_bf16 v[48:51], v[160:163], v[120:123], v[48:51]
  v_add_u32 v187, 256, v185
  v_mfma_f32_16x16x32_bf16 v[52:55], v[164:167], v[120:123], v[52:55]
  v_mfma_f32_16x16x32_bf16 v[68:71], v[164:167], v[124:127], v[68:71]
  s_lshl_b32 s4, s42, 6
  v_mfma_f32_16x16x32_bf16 v[64:67], v[160:163], v[124:127], v[64:67]
  v_mfma_f32_16x16x32_bf16 v[60:63], v[156:159], v[124:127], v[60:63]
  s_add_u32 s4, s4, 15731968
  v_mfma_f32_16x16x32_bf16 v[56:59], v[152:155], v[124:127], v[56:59]
  v_mfma_f32_16x16x32_bf16 v[72:75], v[152:155], v[128:131], v[72:75]
  v_and_b32 v2, 15, v1
  v_mfma_f32_16x16x32_bf16 v[76:79], v[156:159], v[128:131], v[76:79]
  v_mfma_f32_16x16x32_bf16 v[80:83], v[160:163], v[128:131], v[80:83]
  v_lshl_add_u32 v13, v2, 2, s4
  v_mfma_f32_16x16x32_bf16 v[84:87], v[164:167], v[128:131], v[84:87]
  v_mfma_f32_16x16x32_bf16 v[100:103], v[164:167], v[132:135], v[100:103]
  s_lshl_b32 s76, s43, 2
  v_mfma_f32_16x16x32_bf16 v[96:99], v[160:163], v[132:135], v[96:99]
  v_mfma_f32_16x16x32_bf16 v[92:95], v[156:159], v[132:135], v[92:95]
  s_add_u32 s76, s76, s4
  v_mfma_f32_16x16x32_bf16 v[88:91], v[152:155], v[132:135], v[88:91]
  s_branch L_t4j
L_t4b:
  s_waitcnt vmcnt(13)
  s_barrier
  ds_read_b128 v[104:107], v28 offset:0
  ds_read_b64_tr_b16 v[136:137], v29 offset:0
  ds_read_b64_tr_b16 v[138:139], v29 offset:64
  ds_read_b64_tr_b16 v[140:141], v29 offset:2176
  ds_read_b64_tr_b16 v[142:143], v29 offset:2240
  ds_read_b64_tr_b16 v[144:145], v29 offset:4352
  ds_read_b64_tr_b16 v[146:147], v29 offset:4416
  ds_read_b128 v[108:111], v28 offset:2048
  ds_read_b128 v[112:115], v28 offset:4096
  ds_read_b128 v[116:119], v28 offset:6144
  s_waitcnt vmcnt(9) lgkmcnt(0)
  s_barrier
  s_cmp_lg_u32 s3, 0
  s_cbranch_scc1 ow_63
  v_lshlrev_b32 v12, 4, v1
  v_add_u32 v11, 147456, v12
  ds_read_b128 v[2:5], v11 offset:0
  ds_read_b128 v[6:9], v11 offset:1024
  ds_read_b128 v[248:251], v11 offset:2048
  ds_read_b128 v[252:255], v11 offset:3072
  s_waitcnt lgkmcnt(0)
  v_pk_add_f32 v[2:3], v[2:3], v[6:7]
  v_pk_add_f32 v[4:5], v[4:5], v[8:9]
  v_pk_add_f32 v[2:3], v[2:3], v[248:249]
  v_pk_add_f32 v[4:5], v[4:5], v[250:251]
  v_pk_add_f32 v[2:3], v[2:3], v[252:253]
  v_pk_add_f32 v[4:5], v[4:5], v[254:255]
  ds_read_b128 v[6:9], v11 offset:4096
  ds_read_b128 v[248:251], v11 offset:5120
  ds_read_b128 v[252:255], v11 offset:6144
  s_waitcnt lgkmcnt(0)
  v_pk_add_f32 v[2:3], v[2:3], v[6:7]
  v_pk_add_f32 v[4:5], v[4:5], v[8:9]
  v_pk_add_f32 v[2:3], v[2:3], v[248:249]
  v_pk_add_f32 v[4:5], v[4:5], v[250:251]
  v_pk_add_f32 v[2:3], v[2:3], v[252:253]
  v_pk_add_f32 v[4:5], v[4:5], v[254:255]
  ds_read_b128 v[6:9], v11 offset:7168
  s_waitcnt lgkmcnt(0)
  v_pk_add_f32 v[2:3], v[2:3], v[6:7]
  v_pk_add_f32 v[4:5], v[4:5], v[8:9]
  v_cvt_pk_bf16_f32 v2, v2, v3
  v_cvt_pk_bf16_f32 v3, v4, v5
  s_and_b32 s6, s2, 7
  s_lshr_b32 s4, s6, 2
  s_lshl_b32 s4, s4, 1
  s_and_b32 s5, s6, 1
  s_add_u32 s4, s4, s5
  s_lshl_b32 s4, s4, 10
  s_bfe_u32 s5, s6, 0x10001
  s_lshl_b32 s5, s5, 3
  s_add_u32 s4, s4, s5
  s_lshr_b32 s5, s2, 3
  s_lshl_b32 s5, s5, 12
  s_add_u32 s4, s4, s5
  s_add_u32 s4, s4, 14680064
  buffer_store_dwordx2 v[2:3], v12, s[8:11], s4 offen sc1
ow_63:
  s_cmp_lg_u32 s3, 1
  s_cbranch_scc1 ow_64
  s_and_b32 s4, s2, 7
  s_cmp_lg_u32 s4, 0
  s_cbranch_scc1 nz_65
  v_lshlrev_b32 v12, 2, v1
  v_add_u32 v12, 159744, v12
  ds_read_b32 v2, v12 offset:0
  ds_read_b32 v3, v12 offset:256
  ds_read_b32 v4, v12 offset:512
  ds_read_b32 v5, v12 offset:768
  ds_read_b32 v6, v12 offset:1024
  ds_read_b32 v7, v12 offset:1280
  ds_read_b32 v8, v12 offset:1536
  ds_read_b32 v9, v12 offset:1792
  s_waitcnt lgkmcnt(0)
  v_add_f32 v2, v2, v3
  v_add_f32 v2, v2, v4
  v_add_f32 v2, v2, v5
  v_add_f32 v2, v2, v6
  v_add_f32 v2, v2, v7
  v_add_f32 v2, v2, v8
  v_add_f32 v2, v2, v9
  v_cvt_pk_bf16_f32 v2, v2, v2
  v_lshrrev_b32 v3, 5, v1
  v_lshlrev_b32 v3, 6, v3
  v_bfe_u32 v4, v1, 2, 2
  v_lshl_add_u32 v3, v4, 4, v3
  v_bfe_u32 v4, v1, 4, 1
  v_lshl_add_u32 v3, v4, 3, v3
  v_and_b32 v4, 3, v1
  v_lshl_add_u32 v3, v4, 1, v3
  s_lshr_b32 s4, s2, 3
  s_lshl_b32 s4, s4, 7
  s_add_u32 s4, s4, 14811136
  buffer_store_short v2, v3, s[8:11], s4 offen sc1
nz_65:
ow_64:
  v_mfma_f32_16x16x32_bf16 v[40:43], v[136:139], v[104:107], 0
  ds_read_b128 v[120:123], v28 offset:16384
  v_mfma_f32_16x16x32_bf16 v[44:47], v[140:143], v[104:107], 0
  ds_read_b64_tr_b16 v[152:153], v29 offset:15232
  s_add_u32 m0, s32, 0
  s_nop 0
  buffer_load_dwordx4 v14, s[12:15], s33 offen lds
  v_mfma_f32_16x16x32_bf16 v[48:51], v[144:147], v[104:107], 0
  ds_read_b64_tr_b16 v[154:155], v29 offset:15296
  v_mfma_f32_16x16x32_bf16 v[64:67], v[144:147], v[108:111], 0
  ds_read_b64_tr_b16 v[156:157], v29 offset:17408
  v_mfma_f32_16x16x32_bf16 v[60:63], v[140:143], v[108:111], 0
  ds_read_b64_tr_b16 v[158:159], v29 offset:17472
  buffer_load_dwordx4 v15, s[12:15], s33 offen offset:1024 lds
  s_add_u32 s33, s33, 128
  v_mfma_f32_16x16x32_bf16 v[56:59], v[136:139], v[108:111], 0
  v_mfma_f32_16x16x32_bf16 v[72:75], v[136:139], v[112:115], 0
  ds_read_b64_tr_b16 v[160:161], v29 offset:19584
  v_mfma_f32_16x16x32_bf16 v[76:79], v[140:143], v[112:115], 0
  ds_read_b64_tr_b16 v[162:163], v29 offset:19648
  s_add_u32 m0, s34, 0
  s_nop 0
  buffer_load_dwordx4 v16, s[16:19], s35 offen lds
  v_mfma_f32_16x16x32_bf16 v[80:83], v[144:147], v[112:115], 0
  ds_read_b128 v[124:127], v28 offset:18432
  v_mfma_f32_16x16x32_bf16 v[96:99], v[144:147], v[116:119], 0
  ds_read_b128 v[128:131], v28 offset:20480
  v_mfma_f32_16x16x32_bf16 v[92:95], v[140:143], v[116:119], 0
  ds_read_b128 v[132:135], v28 offset:22528
  s_add_u32 m0, s34, 64
  s_nop 0
  buffer_load_dwordx4 v17, s[16:19], s35 offen offset:1024 lds
  s_add_u32 s35, s35, 14336
  v_mfma_f32_16x16x32_bf16 v[88:91], v[136:139], v[116:119], 0
  s_waitcnt vmcnt(9) lgkmcnt(0)
  s_barrier
  v_mfma_f32_16x16x32_bf16 v[40:43], v[152:155], v[120:123], v[40:43]
  ds_read_b128 v[104:107], v28 offset:32768
  v_mfma_f32_16x16x32_bf16 v[44:47], v[156:159], v[120:123], v[44:47]
  ds_read_b64_tr_b16 v[136:137], v29 offset:30464
  s_add_u32 m0, s32, 16384
  s_nop 0
  buffer_load_dwordx4 v14, s[12:15], s33 offen lds
  v_mfma_f32_16x16x32_bf16 v[48:51], v[160:163], v[120:123], v[48:51]
  ds_read_b64_tr_b16 v[138:139], v29 offset:30528
  v_mfma_f32_16x16x32_bf16 v[64:67], v[160:163], v[124:127], v[64:67]
  ds_read_b64_tr_b16 v[140:141], v29 offset:32640
  v_mfma_f32_16x16x32_bf16 v[60:63], v[156:159], v[124:127], v[60:63]
  ds_read_b64_tr_b16 v[142:143], v29 offset:32704
  buffer_load_dwordx4 v15, s[12:15], s33 offen offset:1024 lds
  s_add_u32 s33, s33, 128
  v_mfma_f32_16x16x32_bf16 v[56:59], v[152:155], v[124:127], v[56:59]
  v_mfma_f32_16x16x32_bf16 v[72:75], v[152:155], v[128:131], v[72:75]
  ds_read_b64_tr_b16 v[144:145], v29 offset:34816
  v_mfma_f32_16x16x32_bf16 v[76:79], v[156:159], v[128:131], v[76:79]
  ds_read_b64_tr_b16 v[146:147], v29 offset:34880
  s_add_u32 m0, s34, 15232
  s_nop 0
  buffer_load_dwordx4 v16, s[16:19], s35 offen lds
  v_mfma_f32_16x16x32_bf16 v[80:83], v[160:163], v[128:131], v[80:83]
  ds_read_b128 v[108:111], v28 offset:34816
  v_mfma_f32_16x16x32_bf16 v[96:99], v[160:163], v[132:135], v[96:99]
  ds_read_b128 v[112:115], v28 offset:36864
  v_mfma_f32_16x16x32_bf16 v[92:95], v[156:159], v[132:135], v[92:95]
  ds_read_b128 v[116:119], v28 offset:38912
  s_add_u32 m0, s34, 15296
  s_nop 0
  buffer_load_dwordx4 v17, s[16:19], s35 offen offset:1024 lds
  s_add_u32 s35, s35, 14336
  v_mfma_f32_16x16x32_bf16 v[88:91], v[152:155], v[132:135], v[88:91]
  s_waitcnt vmcnt(9) lgkmcnt(0)
  s_barrier
  v_mfma_f32_16x16x32_bf16 v[40:43], v[136:139], v[104:107], v[40:43]
  ds_read_b128 v[120:123], v28 offset:49152
  v_mfma_f32_16x16x32_bf16 v[44:47], v[140:143], v[104:107], v[44:47]
  ds_read_b64_tr_b16 v[152:153], v29 offset:45696
  s_add_u32 m0, s32, 32768
  s_nop 0
  buffer_load_dwordx4 v14, s[12:15], s33 offen lds
  v_mfma_f32_16x16x32_bf16 v[48:51], v[144:147], v[104:107], v[48:51]
  ds_read_b64_tr_b16 v[154:155], v29 offset:45760
  v_mfma_f32_16x16x32_bf16 v[64:67], v[144:147], v[108:111], v[64:67]
  ds_read_b64_tr_b16 v[156:157], v29 offset:47872
  v_mfma_f32_16x16x32_bf16 v[60:63], v[140:143], v[108:111], v[60:63]
  ds_read_b64_tr_b16 v[158:159], v29 offset:47936
  buffer_load_dwordx4 v15, s[12:15], s33 offen offset:1024 lds
  s_add_u32 s33, s33, 128
  v_mfma_f32_16x16x32_bf16 v[56:59], v[136:139], v[108:111], v[56:59]
  v_mfma_f32_16x16x32_bf16 v[72:75], v[136:139], v[112:115], v[72:75]
  ds_read_b64_tr_b16 v[160:161], v29 offset:50048
  v_mfma_f32_16x16x32_bf16 v[76:79], v[140:143], v[112:115], v[76:79]
  ds_read_b64_tr_b16 v[162:163], v29 offset:50112
  s_add_u32 m0, s34, 30464
  s_nop 0
  buffer_load_dwordx4 v16, s[16:19], s35 offen lds
  v_mfma_f32_16x16x32_bf16 v[80:83], v[144:147], v[112:115], v[80:83]
  ds_read_b128 v[124:127], v28 offset:51200
  v_mfma_f32_16x16x32_bf16 v[96:99], v[144:147], v[116:119], v[96:99]
  ds_read_b128 v[128:131], v28 offset:53248
  v_mfma_f32_16x16x32_bf16 v[92:95], v[140:143], v[116:119], v[92:95]
  ds_read_b128 v[132:135], v28 offset:55296
  s_add_u32 m0, s34, 30528
  s_nop 0
  buffer_load_dwordx4 v17, s[16:19], s35 offen offset:1024 lds
  s_add_u32 s35, s35, 14336
  v_mfma_f32_16x16x32_bf16 v[88:91], v[136:139], v[116:119], v[88:91]
  s_waitcnt vmcnt(8) lgkmcnt(0)
  s_barrier
  v_mfma_f32_16x16x32_bf16 v[40:43], v[152:155], v[120:123], v[40:43]
  ds_read_b128 v[104:107], v28 offset:0
  v_mfma_f32_16x16x32_bf16 v[44:47], v[156:159], v[120:123], v[44:47]
  ds_read_b64_tr_b16 v[136:137], v29 offset:0
  s_add_u32 m0, s32, 49152
  s_nop 0
  buffer_load_dwordx4 v14, s[12:15], s33 offen lds
  v_mfma_f32_16x16x32_bf16 v[48:51], v[160:163], v[120:123], v[48:51]
  ds_read_b64_tr_b16 v[138:139], v29 offset:64
  v_mfma_f32_16x16x32_bf16 v[64:67], v[160:163], v[124:127], v[64:67]
  ds_read_b64_tr_b16 v[140:141], v29 offset:2176
  v_mfma_f32_16x16x32_bf16 v[60:63], v[156:159], v[124:127], v[60:63]
  ds_read_b64_tr_b16 v[142:143], v29 offset:2240
  buffer_load_dwordx4 v15, s[12:15], s33 offen offset:1024 lds
  s_add_u32 s33, s33, 128
  v_mfma_f32_16x16x32_bf16 v[56:59], v[152:155], v[124:127], v[56:59]
  v_mfma_f32_16x16x32_bf16 v[72:75], v[152:155], v[128:131], v[72:75]
  ds_read_b64_tr_b16 v[144:145], v29 offset:4352
  v_mfma_f32_16x16x32_bf16 v[76:79], v[156:159], v[128:131], v[76:79]
  ds_read_b64_tr_b16 v[146:147], v29 offset:4416
  s_add_u32 m0, s34, 45696
  s_nop 0
  buffer_load_dwordx4 v16, s[16:19], s35 offen lds
  v_mfma_f32_16x16x32_bf16 v[80:83], v[160:163], v[128:131], v[80:83]
  ds_read_b128 v[108:111], v28 offset:2048
  v_mfma_f32_16x16x32_bf16 v[96:99], v[160:163], v[132:135], v[96:99]
  ds_read_b128 v[112:115], v28 offset:4096
  v_mfma_f32_16x16x32_bf16 v[92:95], v[156:159], v[132:135], v[92:95]
  ds_read_b128 v[116:119], v28 offset:6144
  s_add_u32 m0, s34, 45760
  s_nop 0
  buffer_load_dwordx4 v17, s[16:19], s35 offen offset:1024 lds
  s_add_u32 s35, s35, 14336
  v_mfma_f32_16x16x32_bf16 v[88:91], v[152:155], v[132:135], v[88:91]
  s_waitcnt vmcnt(8) lgkmcnt(0)
  s_barrier
  s_cmp_lg_u32 s3, 0
  s_cbranch_scc1 ow_66
  v_mov_b32 v8, 1
  v_mov_b32 v9, 0
  s_mov_b64 exec, 1
  buffer_store_dword v8, v9, s[8:11], s76 offen sc1
  s_mov_b64 exec, -1
ow_66:
  v_mfma_f32_16x16x32_bf16 v[40:43], v[136:139], v[104:107], v[40:43]
  ds_read_b128 v[120:123], v28 offset:16384
  v_mfma_f32_16x16x32_bf16 v[44:47], v[140:143], v[104:107], v[44:47]
  ds_read_b64_tr_b16 v[152:153], v29 offset:15232
  s_add_u32 m0, s32, 0
  s_nop 0
  buffer_load_dwordx4 v14, s[12:15], s33 offen lds
  v_mfma_f32_16x16x32_bf16 v[48:51], v[144:147], v[104:107], v[48:51]
  ds_read_b64_tr_b16 v[154:155], v29 offset:15296
  v_mfma_f32_16x16x32_bf16 v[64:67], v[144:147], v[108:111], v[64:67]
  ds_read_b64_tr_b16 v[156:157], v29 offset:17408
  v_mfma_f32_16x16x32_bf16 v[60:63], v[140:143], v[108:111], v[60:63]
  ds_read_b64_tr_b16 v[158:159], v29 offset:17472
  buffer_load_dwordx4 v15, s[12:15], s33 offen offset:1024 lds
  s_add_u32 s33, s33, 128
  v_mfma_f32_16x16x32_bf16 v[56:59], v[136:139], v[108:111], v[56:59]
  v_mfma_f32_16x16x32_bf16 v[72:75], v[136:139], v[112:115], v[72:75]
  ds_read_b64_tr_b16 v[160:161], v29 offset:19584
  v_mfma_f32_16x16x32_bf16 v[76:79], v[140:143], v[112:115], v[76:79]
  ds_read_b64_tr_b16 v[162:163], v29 offset:19648
  s_add_u32 m0, s34, 0
  s_nop 0
  buffer_load_dwordx4 v16, s[16:19], s35 offen lds
  v_mfma_f32_16x16x32_bf16 v[80:83], v[144:147], v[112:115], v[80:83]
  ds_read_b128 v[124:127], v28 offset:18432
  v_mfma_f32_16x16x32_bf16 v[96:99], v[144:147], v[116:119], v[96:99]
  ds_read_b128 v[128:131], v28 offset:20480
  v_mfma_f32_16x16x32_bf16 v[92:95], v[140:143], v[116:119], v[92:95]
  ds_read_b128 v[132:135], v28 offset:22528
  s_add_u32 m0, s34, 64
  s_nop 0
  buffer_load_dwordx4 v17, s[16:19], s35 offen offset:1024 lds
  s_add_u32 s35, s35, 14336
  v_mfma_f32_16x16x32_bf16 v[88:91], v[136:139], v[116:119], v[88:91]
  s_waitcnt vmcnt(8) lgkmcnt(0)
  s_barrier
  v_mfma_f32_16x16x32_bf16 v[40:43], v[152:155], v[120:123], v[40:43]
  ds_read_b128 v[104:107], v28 offset:32768
  v_mfma_f32_16x16x32_bf16 v[44:47], v[156:159], v[120:123], v[44:47]
  ds_read_b64_tr_b16 v[136:137], v29 offset:30464
  s_add_u32 m0, s32, 16384
  s_nop 0
  buffer_load_dwordx4 v14, s[12:15], s33 offen lds
  v_mfma_f32_16x16x32_bf16 v[48:51], v[160:163], v[120:123], v[48:51]
  ds_read_b64_tr_b16 v[138:139], v29 offset:30528
  v_mfma_f32_16x16x32_bf16 v[64:67], v[160:163], v[124:127], v[64:67]
  ds_read_b64_tr_b16 v[140:141], v29 offset:32640
  v_mfma_f32_16x16x32_bf16 v[60:63], v[156:159], v[124:127], v[60:63]
  ds_read_b64_tr_b16 v[142:143], v29 offset:32704
  buffer_load_dwordx4 v15, s[12:15], s33 offen offset:1024 lds
  s_add_u32 s33, s33, 128
  v_mfma_f32_16x16x32_bf16 v[56:59], v[152:155], v[124:127], v[56:59]
  v_mfma_f32_16x16x32_bf16 v[72:75], v[152:155], v[128:131], v[72:75]
  ds_read_b64_tr_b16 v[144:145], v29 offset:34816
  v_mfma_f32_16x16x32_bf16 v[76:79], v[156:159], v[128:131], v[76:79]
  ds_read_b64_tr_b16 v[146:147], v29 offset:34880
  s_add_u32 m0, s34, 15232
  s_nop 0
  buffer_load_dwordx4 v16, s[16:19], s35 offen lds
  v_mfma_f32_16x16x32_bf16 v[80:83], v[160:163], v[128:131], v[80:83]
  ds_read_b128 v[108:111], v28 offset:34816
  v_mfma_f32_16x16x32_bf16 v[96:99], v[160:163], v[132:135], v[96:99]
  ds_read_b128 v[112:115], v28 offset:36864
  v_mfma_f32_16x16x32_bf16 v[92:95], v[156:159], v[132:135], v[92:95]
  ds_read_b128 v[116:119], v28 offset:38912
  s_add_u32 m0, s34, 15296
  s_nop 0
  buffer_load_dwordx4 v17, s[16:19], s35 offen offset:1024 lds
  s_add_u32 s35, s35, 14336
  v_mfma_f32_16x16x32_bf16 v[88:91], v[152:155], v[132:135], v[88:91]
  s_waitcnt vmcnt(8) lgkmcnt(0)
  s_barrier
  v_mfma_f32_16x16x32_bf16 v[40:43], v[136:139], v[104:107], v[40:43]
  ds_read_b128 v[120:123], v28 offset:49152
  v_mfma_f32_16x16x32_bf16 v[44:47], v[140:143], v[104:107], v[44:47]
  ds_read_b64_tr_b16 v[152:153], v29 offset:45696
  s_add_u32 m0, s32, 32768
  s_nop 0
  buffer_load_dwordx4 v14, s[12:15], s33 offen lds
  v_mfma_f32_16x16x32_bf16 v[48:51], v[144:147], v[104:107], v[48:51]
  ds_read_b64_tr_b16 v[154:155], v29 offset:45760
  v_mfma_f32_16x16x32_bf16 v[64:67], v[144:147], v[108:111], v[64:67]
  ds_read_b64_tr_b16 v[156:157], v29 offset:47872
  v_mfma_f32_16x16x32_bf16 v[60:63], v[140:143], v[108:111], v[60:63]
  ds_read_b64_tr_b16 v[158:159], v29 offset:47936
  buffer_load_dwordx4 v15, s[12:15], s33 offen offset:1024 lds
  s_add_u32 s33, s33, 128
  v_mfma_f32_16x16x32_bf16 v[56:59], v[136:139], v[108:111], v[56:59]
  v_mfma_f32_16x16x32_bf16 v[72:75], v[136:139], v[112:115], v[72:75]
  ds_read_b64_tr_b16 v[160:161], v29 offset:50048
  v_mfma_f32_16x16x32_bf16 v[76:79], v[140:143], v[112:115], v[76:79]
  ds_read_b64_tr_b16 v[162:163], v29 offset:50112
  s_add_u32 m0, s34, 30464
  s_nop 0
  buffer_load_dwordx4 v16, s[16:19], s35 offen lds
  v_mfma_f32_16x16x32_bf16 v[80:83], v[144:147], v[112:115], v[80:83]
  ds_read_b128 v[124:127], v28 offset:51200
  v_mfma_f32_16x16x32_bf16 v[96:99], v[144:147], v[116:119], v[96:99]
  ds_read_b128 v[128:131], v28 offset:53248
  v_mfma_f32_16x16x32_bf16 v[92:95], v[140:143], v[116:119], v[92:95]
  ds_read_b128 v[132:135], v28 offset:55296
  s_add_u32 m0, s34, 30528
  s_nop 0
  buffer_load_dwordx4 v17, s[16:19], s35 offen offset:1024 lds
  s_add_u32 s35, s35, 14336
  v_mfma_f32_16x16x32_bf16 v[88:91], v[136:139], v[116:119], v[88:91]
  s_waitcnt vmcnt(8) lgkmcnt(0)
  s_barrier
  v_mfma_f32_16x16x32_bf16 v[40:43], v[152:155], v[120:123], v[40:43]
  ds_read_b128 v[104:107], v28 offset:0
  v_mfma_f32_16x16x32_bf16 v[44:47], v[156:159], v[120:123], v[44:47]
  ds_read_b64_tr_b16 v[136:137], v29 offset:0
  s_add_u32 m0, s32, 49152
  s_nop 0
  buffer_load_dwordx4 v14, s[12:15], s33 offen lds
  v_mfma_f32_16x16x32_bf16 v[48:51], v[160:163], v[120:123], v[48:51]
  ds_read_b64_tr_b16 v[138:139], v29 offset:64
  v_mfma_f32_16x16x32_bf16 v[64:67], v[160:163], v[124:127], v[64:67]
  ds_read_b64_tr_b16 v[140:141], v29 offset:2176
  v_mfma_f32_16x16x32_bf16 v[60:63], v[156:159], v[124:127], v[60:63]
  ds_read_b64_tr_b16 v[142:143], v29 offset:2240
  buffer_load_dwordx4 v15, s[12:15], s33 offen offset:1024 lds
  s_add_u32 s33, s33, 128
  v_mfma_f32_16x16x32_bf16 v[56:59], v[152:155], v[124:127], v[56:59]
  v_mfma_f32_16x16x32_bf16 v[72:75], v[152:155], v[128:131], v[72:75]
  ds_read_b64_tr_b16 v[144:145], v29 offset:4352
  v_mfma_f32_16x16x32_bf16 v[76:79], v[156:159], v[128:131], v[76:79]
  ds_read_b64_tr_b16 v[146:147], v29 offset:4416
  s_add_u32 m0, s34, 45696
  s_nop 0
  buffer_load_dwordx4 v16, s[16:19], s35 offen lds
  v_mfma_f32_16x16x32_bf16 v[80:83], v[160:163], v[128:131], v[80:83]
  ds_read_b128 v[108:111], v28 offset:2048
  v_mfma_f32_16x16x32_bf16 v[96:99], v[160:163], v[132:135], v[96:99]
  ds_read_b128 v[112:115], v28 offset:4096
  v_mfma_f32_16x16x32_bf16 v[92:95], v[156:159], v[132:135], v[92:95]
  ds_read_b128 v[116:119], v28 offset:6144
  s_add_u32 m0, s34, 45760
  s_nop 0
  buffer_load_dwordx4 v17, s[16:19], s35 offen offset:1024 lds
  s_add_u32 s35, s35, 14336
  v_mfma_f32_16x16x32_bf16 v[88:91], v[152:155], v[132:135], v[88:91]
  s_waitcnt vmcnt(8) lgkmcnt(0)
  s_barrier
  v_mfma_f32_16x16x32_bf16 v[40:43], v[136:139], v[104:107], v[40:43]
  ds_read_b128 v[120:123], v28 offset:16384
  v_mfma_f32_16x16x32_bf16 v[44:47], v[140:143], v[104:107], v[44:47]
  ds_read_b64_tr_b16 v[152:153], v29 offset:15232
  s_add_u32 m0, s32, 0
  s_nop 0
  buffer_load_dwordx4 v14, s[12:15], s33 offen lds
  v_mfma_f32_16x16x32_bf16 v[48:51], v[144:147], v[104:107], v[48:51]
  ds_read_b64_tr_b16 v[154:155], v29 offset:15296
  v_mfma_f32_16x16x32_bf16 v[64:67], v[144:147], v[108:111], v[64:67]
  ds_read_b64_tr_b16 v[156:157], v29 offset:17408
  v_mfma_f32_16x16x32_bf16 v[60:63], v[140:143], v[108:111], v[60:63]
  ds_read_b64_tr_b16 v[158:159], v29 offset:17472
  buffer_load_dwordx4 v15, s[12:15], s33 offen offset:1024 lds
  s_add_u32 s33, s33, 128
  v_mfma_f32_16x16x32_bf16 v[56:59], v[136:139], v[108:111], v[56:59]
  v_mfma_f32_16x16x32_bf16 v[72:75], v[136:139], v[112:115], v[72:75]
  ds_read_b64_tr_b16 v[160:161], v29 offset:19584
  v_mfma_f32_16x16x32_bf16 v[76:79], v[140:143], v[112:115], v[76:79]
  ds_read_b64_tr_b16 v[162:163], v29 offset:19648
  s_add_u32 m0, s34, 0
  s_nop 0
  buffer_load_dwordx4 v16, s[16:19], s35 offen lds
  v_mfma_f32_16x16x32_bf16 v[80:83], v[144:147], v[112:115], v[80:83]
  ds_read_b128 v[124:127], v28 offset:18432
  v_mfma_f32_16x16x32_bf16 v[96:99], v[144:147], v[116:119], v[96:99]
  ds_read_b128 v[128:131], v28 offset:20480
  v_mfma_f32_16x16x32_bf16 v[92:95], v[140:143], v[116:119], v[92:95]
  ds_read_b128 v[132:135], v28 offset:22528
  s_add_u32 m0, s34, 64
  s_nop 0
  buffer_load_dwordx4 v17, s[16:19], s35 offen offset:1024 lds
  s_add_u32 s35, s35, 14336
  v_mfma_f32_16x16x32_bf16 v[88:91], v[136:139], v[116:119], v[88:91]
  s_waitcnt vmcnt(8) lgkmcnt(0)
  s_barrier
  v_mfma_f32_16x16x32_bf16 v[40:43], v[152:155], v[120:123], v[40:43]
  ds_read_b128 v[104:107], v28 offset:32768
  v_mfma_f32_16x16x32_bf16 v[44:47], v[156:159], v[120:123], v[44:47]
  ds_read_b64_tr_b16 v[136:137], v29 offset:30464
  s_add_u32 m0, s32, 16384
  s_nop 0
  buffer_load_dwordx4 v14, s[12:15], s33 offen lds
  v_mfma_f32_16x16x32_bf16 v[48:51], v[160:163], v[120:123], v[48:51]
  ds_read_b64_tr_b16 v[138:139], v29 offset:30528
  v_mfma_f32_16x16x32_bf16 v[64:67], v[160:163], v[124:127], v[64:67]
  ds_read_b64_tr_b16 v[140:141], v29 offset:32640
  v_mfma_f32_16x16x32_bf16 v[60:63], v[156:159], v[124:127], v[60:63]
  ds_read_b64_tr_b16 v[142:143], v29 offset:32704
  buffer_load_dwordx4 v15, s[12:15], s33 offen offset:1024 lds
  s_add_u32 s33, s33, 128
  v_mfma_f32_16x16x32_bf16 v[56:59], v[152:155], v[124:127], v[56:59]
  v_mfma_f32_16x16x32_bf16 v[72:75], v[152:155], v[128:131], v[72:75]
  ds_read_b64_tr_b16 v[144:145], v29 offset:34816
  v_mfma_f32_16x16x32_bf16 v[76:79], v[156:159], v[128:131], v[76:79]
  ds_read_b64_tr_b16 v[146:147], v29 offset:34880
  s_add_u32 m0, s34, 15232
  s_nop 0
  buffer_load_dwordx4 v16, s[16:19], s35 offen lds
  v_mfma_f32_16x16x32_bf16 v[80:83], v[160:163], v[128:131], v[80:83]
  ds_read_b128 v[108:111], v28 offset:34816
  v_mfma_f32_16x16x32_bf16 v[96:99], v[160:163], v[132:135], v[96:99]
  ds_read_b128 v[112:115], v28 offset:36864
  v_mfma_f32_16x16x32_bf16 v[92:95], v[156:159], v[132:135], v[92:95]
  ds_read_b128 v[116:119], v28 offset:38912
  s_add_u32 m0, s34, 15296
  s_nop 0
  buffer_load_dwordx4 v17, s[16:19], s35 offen offset:1024 lds
  s_add_u32 s35, s35, 14336
  v_mfma_f32_16x16x32_bf16 v[88:91], v[152:155], v[132:135], v[88:91]
  s_waitcnt vmcnt(8) lgkmcnt(0)
  s_barrier
  v_mfma_f32_16x16x32_bf16 v[40:43], v[136:139], v[104:107], v[40:43]
  ds_read_b128 v[120:123], v28 offset:49152
  v_mfma_f32_16x16x32_bf16 v[44:47], v[140:143], v[104:107], v[44:47]
  ds_read_b64_tr_b16 v[152:153], v29 offset:45696
  s_add_u32 m0, s32, 32768
  s_nop 0
  buffer_load_dwordx4 v14, s[12:15], s33 offen lds
  v_mfma_f32_16x16x32_bf16 v[48:51], v[144:147], v[104:107], v[48:51]
  ds_read_b64_tr_b16 v[154:155], v29 offset:45760
  v_mfma_f32_16x16x32_bf16 v[64:67], v[144:147], v[108:111], v[64:67]
  ds_read_b64_tr_b16 v[156:157], v29 offset:47872
  v_mfma_f32_16x16x32_bf16 v[60:63], v[140:143], v[108:111], v[60:63]
  ds_read_b64_tr_b16 v[158:159], v29 offset:47936
  buffer_load_dwordx4 v15, s[12:15], s33 offen offset:1024 lds
  s_add_u32 s33, s33, 128
  v_mfma_f32_16x16x32_bf16 v[56:59], v[136:139], v[108:111], v[56:59]
  v_mfma_f32_16x16x32_bf16 v[72:75], v[136:139], v[112:115], v[72:75]
  ds_read_b64_tr_b16 v[160:161], v29 offset:50048
  v_mfma_f32_16x16x32_bf16 v[76:79], v[140:143], v[112:115], v[76:79]
  ds_read_b64_tr_b16 v[162:163], v29 offset:50112
  s_add_u32 m0, s34, 30464
  s_nop 0
  buffer_load_dwordx4 v16, s[16:19], s35 offen lds
  v_mfma_f32_16x16x32_bf16 v[80:83], v[144:147], v[112:115], v[80:83]
  ds_read_b128 v[124:127], v28 offset:51200
  v_mfma_f32_16x16x32_bf16 v[96:99], v[144:147], v[116:119], v[96:99]
  ds_read_b128 v[128:131], v28 offset:53248
  v_mfma_f32_16x16x32_bf16 v[92:95], v[140:143], v[116:119], v[92:95]
  ds_read_b128 v[132:135], v28 offset:55296
  s_add_u32 m0, s34, 30528
  s_nop 0
  buffer_load_dwordx4 v17, s[16:19], s35 offen offset:1024 lds
  s_add_u32 s35, s35, 14336
  v_mfma_f32_16x16x32_bf16 v[88:91], v[136:139], v[116:119], v[88:91]
  s_waitcnt vmcnt(8) lgkmcnt(0)
  s_barrier
  v_mfma_f32_16x16x32_bf16 v[40:43], v[152:155], v[120:123], v[40:43]
  ds_read_b128 v[104:107], v28 offset:0
  v_mfma_f32_16x16x32_bf16 v[44:47], v[156:159], v[120:123], v[44:47]
  ds_read_b64_tr_b16 v[136:137], v29 offset:0
  s_add_u32 m0, s32, 49152
  s_nop 0
  buffer_load_dwordx4 v14, s[12:15], s33 offen lds
  v_mfma_f32_16x16x32_bf16 v[48:51], v[160:163], v[120:123], v[48:51]
  ds_read_b64_tr_b16 v[138:139], v29 offset:64
  v_mfma_f32_16x16x32_bf16 v[64:67], v[160:163], v[124:127], v[64:67]
  ds_read_b64_tr_b16 v[140:141], v29 offset:2176
  v_mfma_f32_16x16x32_bf16 v[60:63], v[156:159], v[124:127], v[60:63]
  ds_read_b64_tr_b16 v[142:143], v29 offset:2240
  buffer_load_dwordx4 v15, s[12:15], s33 offen offset:1024 lds
  s_add_u32 s33, s33, 128
  v_mfma_f32_16x16x32_bf16 v[56:59], v[152:155], v[124:127], v[56:59]
  v_mfma_f32_16x16x32_bf16 v[72:75], v[152:155], v[128:131], v[72:75]
  ds_read_b64_tr_b16 v[144:145], v29 offset:4352
  v_mfma_f32_16x16x32_bf16 v[76:79], v[156:159], v[128:131], v[76:79]
  ds_read_b64_tr_b16 v[146:147], v29 offset:4416
  s_add_u32 m0, s34, 45696
  s_nop 0
  buffer_load_dwordx4 v16, s[16:19], s35 offen lds
  v_mfma_f32_16x16x32_bf16 v[80:83], v[160:163], v[128:131], v[80:83]
  ds_read_b128 v[108:111], v28 offset:2048
  v_mfma_f32_16x16x32_bf16 v[96:99], v[160:163], v[132:135], v[96:99]
  ds_read_b128 v[112:115], v28 offset:4096
  v_mfma_f32_16x16x32_bf16 v[92:95], v[156:159], v[132:135], v[92:95]
  ds_read_b128 v[116:119], v28 offset:6144
  s_add_u32 m0, s34, 45760
  s_nop 0
  buffer_load_dwordx4 v17, s[16:19], s35 offen offset:1024 lds
  s_add_u32 s35, s35, 14336
  v_mfma_f32_16x16x32_bf16 v[88:91], v[152:155], v[132:135], v[88:91]
  s_waitcnt vmcnt(8) lgkmcnt(0)
  s_barrier
  s_cmp_lg_u32 s3, 0
  s_cbranch_scc1 ow_67
  buffer_load_dword v12, v13, s[8:11], 0 offen sc1
ow_67:
  v_mfma_f32_16x16x32_bf16 v[40:43], v[136:139], v[104:107], v[40:43]
  ds_read_b128 v[120:123], v28 offset:16384
  v_mfma_f32_16x16x32_bf16 v[44:47], v[140:143], v[104:107], v[44:47]
  ds_read_b64_tr_b16 v[152:153], v29 offset:15232
  s_add_u32 m0, s32, 0
  s_nop 0
  buffer_load_dwordx4 v14, s[12:15], s33 offen lds
  v_mfma_f32_16x16x32_bf16 v[48:51], v[144:147], v[104:107], v[48:51]
  ds_read_b64_tr_b16 v[154:155], v29 offset:15296
  v_mfma_f32_16x16x32_bf16 v[64:67], v[144:147], v[108:111], v[64:67]
  ds_read_b64_tr_b16 v[156:157], v29 offset:17408
  v_mfma_f32_16x16x32_bf16 v[60:63], v[140:143], v[108:111], v[60:63]
  ds_read_b64_tr_b16 v[158:159], v29 offset:17472
  buffer_load_dwordx4 v15, s[12:15], s33 offen offset:1024 lds
  s_add_u32 s33, s33, 128
  v_mfma_f32_16x16x32_bf16 v[56:59], v[136:139], v[108:111], v[56:59]
  v_mfma_f32_16x16x32_bf16 v[72:75], v[136:139], v[112:115], v[72:75]
  ds_read_b64_tr_b16 v[160:161], v29 offset:19584
  v_mfma_f32_16x16x32_bf16 v[76:79], v[140:143], v[112:115], v[76:79]
  ds_read_b64_tr_b16 v[162:163], v29 offset:19648
  s_add_u32 m0, s34, 0
  s_nop 0
  buffer_load_dwordx4 v16, s[16:19], s35 offen lds
  v_mfma_f32_16x16x32_bf16 v[80:83], v[144:147], v[112:115], v[80:83]
  ds_read_b128 v[124:127], v28 offset:18432
  v_mfma_f32_16x16x32_bf16 v[96:99], v[144:147], v[116:119], v[96:99]
  ds_read_b128 v[128:131], v28 offset:20480
  v_mfma_f32_16x16x32_bf16 v[92:95], v[140:143], v[116:119], v[92:95]
  ds_read_b128 v[132:135], v28 offset:22528
  s_add_u32 m0, s34, 64
  s_nop 0
  buffer_load_dwordx4 v17, s[16:19], s35 offen offset:1024 lds
  s_add_u32 s35, s35, 14336
  v_mfma_f32_16x16x32_bf16 v[88:91], v[136:139], v[116:119], v[88:91]
  s_waitcnt vmcnt(8) lgkmcnt(0)
  s_barrier
  v_mfma_f32_16x16x32_bf16 v[40:43], v[152:155], v[120:123], v[40:43]
  ds_read_b128 v[104:107], v28 offset:32768
  v_mfma_f32_16x16x32_bf16 v[44:47], v[156:159], v[120:123], v[44:47]
  ds_read_b64_tr_b16 v[136:137], v29 offset:30464
  s_add_u32 m0, s32, 16384
  s_nop 0
  buffer_load_dwordx4 v14, s[12:15], s33 offen lds
  v_mfma_f32_16x16x32_bf16 v[48:51], v[160:163], v[120:123], v[48:51]
  ds_read_b64_tr_b16 v[138:139], v29 offset:30528
  v_mfma_f32_16x16x32_bf16 v[64:67], v[160:163], v[124:127], v[64:67]
  ds_read_b64_tr_b16 v[140:141], v29 offset:32640
  v_mfma_f32_16x16x32_bf16 v[60:63], v[156:159], v[124:127], v[60:63]
  ds_read_b64_tr_b16 v[142:143], v29 offset:32704
  buffer_load_dwordx4 v15, s[12:15], s33 offen offset:1024 lds
  s_add_u32 s33, s33, 128
  v_mfma_f32_16x16x32_bf16 v[56:59], v[152:155], v[124:127], v[56:59]
  v_mfma_f32_16x16x32_bf16 v[72:75], v[152:155], v[128:131], v[72:75]
  ds_read_b64_tr_b16 v[144:145], v29 offset:34816
  v_mfma_f32_16x16x32_bf16 v[76:79], v[156:159], v[128:131], v[76:79]
  ds_read_b64_tr_b16 v[146:147], v29 offset:34880
  s_add_u32 m0, s34, 15232
  s_nop 0
  buffer_load_dwordx4 v16, s[16:19], s35 offen lds
  v_mfma_f32_16x16x32_bf16 v[80:83], v[160:163], v[128:131], v[80:83]
  ds_read_b128 v[108:111], v28 offset:34816
  v_mfma_f32_16x16x32_bf16 v[96:99], v[160:163], v[132:135], v[96:99]
  ds_read_b128 v[112:115], v28 offset:36864
  v_mfma_f32_16x16x32_bf16 v[92:95], v[156:159], v[132:135], v[92:95]
  ds_read_b128 v[116:119], v28 offset:38912
  s_add_u32 m0, s34, 15296
  s_nop 0
  buffer_load_dwordx4 v17, s[16:19], s35 offen offset:1024 lds
  s_add_u32 s35, s35, 14336
  v_mfma_f32_16x16x32_bf16 v[88:91], v[152:155], v[132:135], v[88:91]
  s_cmp_lg_u32 s3, 0
  s_cbranch_scc1 ow_68
  s_waitcnt vmcnt(8)
  v_cmp_ne_u32 vcc, 0, v12
  s_nop 0
  s_cmp_eq_u64 vcc, -1
  s_cbranch_scc1 pok_69
  s_mov_b32 s75, 400000
psp_70:
  buffer_load_dword v12, v13, s[8:11], 0 offen sc1
  s_waitcnt vmcnt(0)
  v_cmp_ne_u32 vcc, 0, v12
  s_nop 0
  s_cmp_eq_u64 vcc, -1
  s_cbranch_scc1 pok_69
  s_sub_u32 s75, s75, 1
  s_cmp_lg_u32 s75, 0
  s_cbranch_scc1 psp_70
pok_69:
ow_68:
  s_waitcnt vmcnt(8) lgkmcnt(0)
  s_barrier
  s_lshl_b32 s5, s43, 1
  s_add_u32 s5, s5, s83
  s_lshl_b32 s4, s5, 12
  s_add_u32 s4, s4, 14680064
  v_lshlrev_b32 v2, 4, v1
  buffer_load_dwordx4 v[168:171], v2, s[8:11], s4 offen offset:0 sc1
  buffer_load_dwordx4 v[172:175], v2, s[8:11], s4 offen offset:1024 sc1
  buffer_load_dwordx4 v[176:179], v2, s[8:11], s4 offen offset:2048 sc1
  buffer_load_dwordx4 v[180:183], v2, s[8:11], s4 offen offset:3072 sc1
  s_lshl_b32 s4, s5, 7
  s_add_u32 s4, s4, 14811136
  v_and_b32 v2, 0x30, v1
  buffer_load_dwordx4 v[184:187], v2, s[8:11], s4 offen offset:0 sc1
  buffer_load_dwordx4 v[188:191], v2, s[8:11], s4 offen offset:64 sc1
  v_mfma_f32_16x16x32_bf16 v[40:43], v[136:139], v[104:107], v[40:43]
  ds_read_b128 v[120:123], v28 offset:49152
  v_mfma_f32_16x16x32_bf16 v[44:47], v[140:143], v[104:107], v[44:47]
  ds_read_b64_tr_b16 v[152:153], v29 offset:45696
  s_add_u32 m0, s32, 32768
  s_nop 0
  buffer_load_dwordx4 v14, s[12:15], s33 offen lds
  v_mfma_f32_16x16x32_bf16 v[48:51], v[144:147], v[104:107], v[48:51]
  ds_read_b64_tr_b16 v[154:155], v29 offset:45760
  v_mfma_f32_16x16x32_bf16 v[64:67], v[144:147], v[108:111], v[64:67]
  ds_read_b64_tr_b16 v[156:157], v29 offset:47872
  v_mfma_f32_16x16x32_bf16 v[60:63], v[140:143], v[108:111], v[60:63]
  ds_read_b64_tr_b16 v[158:159], v29 offset:47936
  buffer_load_dwordx4 v15, s[12:15], s33 offen offset:1024 lds
  s_add_u32 s33, s33, 128
  v_mfma_f32_16x16x32_bf16 v[56:59], v[136:139], v[108:111], v[56:59]
  v_mfma_f32_16x16x32_bf16 v[72:75], v[136:139], v[112:115], v[72:75]
  ds_read_b64_tr_b16 v[160:161], v29 offset:50048
  v_mfma_f32_16x16x32_bf16 v[76:79], v[140:143], v[112:115], v[76:79]
  ds_read_b64_tr_b16 v[162:163], v29 offset:50112
  s_add_u32 m0, s34, 30464
  s_nop 0
  buffer_load_dwordx4 v16, s[16:19], s35 offen lds
  v_mfma_f32_16x16x32_bf16 v[80:83], v[144:147], v[112:115], v[80:83]
  ds_read_b128 v[124:127], v28 offset:51200
  v_mfma_f32_16x16x32_bf16 v[96:99], v[144:147], v[116:119], v[96:99]
  ds_read_b128 v[128:131], v28 offset:53248
  v_mfma_f32_16x16x32_bf16 v[92:95], v[140:143], v[116:119], v[92:95]
  ds_read_b128 v[132:135], v28 offset:55296
  s_add_u32 m0, s34, 30528
  s_nop 0
  buffer_load_dwordx4 v17, s[16:19], s35 offen offset:1024 lds
  s_add_u32 s35, s35, 14336
  v_mfma_f32_16x16x32_bf16 v[88:91], v[136:139], v[116:119], v[88:91]
  s_waitcnt vmcnt(14) lgkmcnt(0)
  s_barrier
  v_mfma_f32_16x16x32_bf16 v[40:43], v[152:155], v[120:123], v[40:43]
  ds_read_b128 v[104:107], v28 offset:0
  v_mfma_f32_16x16x32_bf16 v[44:47], v[156:159], v[120:123], v[44:47]
  ds_read_b64_tr_b16 v[136:137], v29 offset:0
  s_add_u32 m0, s32, 49152
  s_nop 0
  buffer_load_dwordx4 v14, s[12:15], s33 offen lds
  v_mfma_f32_16x16x32_bf16 v[48:51], v[160:163], v[120:123], v[48:51]
  ds_read_b64_tr_b16 v[138:139], v29 offset:64
  v_mfma_f32_16x16x32_bf16 v[64:67], v[160:163], v[124:127], v[64:67]
  ds_read_b64_tr_b16 v[140:141], v29 offset:2176
  v_mfma_f32_16x16x32_bf16 v[60:63], v[156:159], v[124:127], v[60:63]
  ds_read_b64_tr_b16 v[142:143], v29 offset:2240
  buffer_load_dwordx4 v15, s[12:15], s33 offen offset:1024 lds
  s_add_u32 s33, s33, 128
  v_mfma_f32_16x16x32_bf16 v[56:59], v[152:155], v[124:127], v[56:59]
  v_mfma_f32_16x16x32_bf16 v[72:75], v[152:155], v[128:131], v[72:75]
  ds_read_b64_tr_b16 v[144:145], v29 offset:4352
  v_mfma_f32_16x16x32_bf16 v[76:79], v[156:159], v[128:131], v[76:79]
  ds_read_b64_tr_b16 v[146:147], v29 offset:4416
  s_add_u32 m0, s34, 45696
  s_nop 0
  buffer_load_dwordx4 v16, s[16:19], s35 offen lds
  v_mfma_f32_16x16x32_bf16 v[80:83], v[160:163], v[128:131], v[80:83]
  ds_read_b128 v[108:111], v28 offset:2048
  v_mfma_f32_16x16x32_bf16 v[96:99], v[160:163], v[132:135], v[96:99]
  ds_read_b128 v[112:115], v28 offset:4096
  v_mfma_f32_16x16x32_bf16 v[92:95], v[156:159], v[132:135], v[92:95]
  ds_read_b128 v[116:119], v28 offset:6144
  s_add_u32 m0, s34, 45760
  s_nop 0
  buffer_load_dwordx4 v17, s[16:19], s35 offen offset:1024 lds
  s_add_u32 s35, s35, 14336
  v_mfma_f32_16x16x32_bf16 v[88:91], v[152:155], v[132:135], v[88:91]
  s_waitcnt vmcnt(14) lgkmcnt(0)
  s_barrier
  v_mfma_f32_16x16x32_bf16 v[40:43], v[136:139], v[104:107], v[40:43]
  ds_read_b128 v[120:123], v28 offset:16384
  v_mfma_f32_16x16x32_bf16 v[44:47], v[140:143], v[104:107], v[44:47]
  ds_read_b64_tr_b16 v[152:153], v29 offset:15232
  s_add_u32 m0, s32, 0
  s_nop 0
  buffer_load_dwordx4 v14, s[12:15], s33 offen lds
  v_mfma_f32_16x16x32_bf16 v[48:51], v[144:147], v[104:107], v[48:51]
  ds_read_b64_tr_b16 v[154:155], v29 offset:15296
  v_mfma_f32_16x16x32_bf16 v[64:67], v[144:147], v[108:111], v[64:67]
  ds_read_b64_tr_b16 v[156:157], v29 offset:17408
  v_mfma_f32_16x16x32_bf16 v[60:63], v[140:143], v[108:111], v[60:63]
  ds_read_b64_tr_b16 v[158:159], v29 offset:17472
  buffer_load_dwordx4 v15, s[12:15], s33 offen offset:1024 lds
  s_add_u32 s33, s33, 128
  v_mfma_f32_16x16x32_bf16 v[56:59], v[136:139], v[108:111], v[56:59]
  v_mfma_f32_16x16x32_bf16 v[72:75], v[136:139], v[112:115], v[72:75]
  ds_read_b64_tr_b16 v[160:161], v29 offset:19584
  v_mfma_f32_16x16x32_bf16 v[76:79], v[140:143], v[112:115], v[76:79]
  ds_read_b64_tr_b16 v[162:163], v29 offset:19648
  s_add_u32 m0, s34, 0
  s_nop 0
  buffer_load_dwordx4 v16, s[16:19], s35 offen lds
  v_mfma_f32_16x16x32_bf16 v[80:83], v[144:147], v[112:115], v[80:83]
  ds_read_b128 v[124:127], v28 offset:18432
  v_mfma_f32_16x16x32_bf16 v[96:99], v[144:147], v[116:119], v[96:99]
  ds_read_b128 v[128:131], v28 offset:20480
  v_mfma_f32_16x16x32_bf16 v[92:95], v[140:143], v[116:119], v[92:95]
  ds_read_b128 v[132:135], v28 offset:22528
  s_add_u32 m0, s34, 64
  s_nop 0
  buffer_load_dwordx4 v17, s[16:19], s35 offen offset:1024 lds
  s_add_u32 s35, s35, 14336
  v_mfma_f32_16x16x32_bf16 v[88:91], v[136:139], v[116:119], v[88:91]
  s_waitcnt vmcnt(8) lgkmcnt(0)
  s_barrier
  v_mfma_f32_16x16x32_bf16 v[40:43], v[152:155], v[120:123], v[40:43]
  ds_read_b128 v[104:107], v28 offset:32768
  v_mfma_f32_16x16x32_bf16 v[44:47], v[156:159], v[120:123], v[44:47]
  ds_read_b64_tr_b16 v[136:137], v29 offset:30464
  s_add_u32 m0, s32, 16384
  s_nop 0
  buffer_load_dwordx4 v14, s[12:15], s33 offen lds
  v_mfma_f32_16x16x32_bf16 v[48:51], v[160:163], v[120:123], v[48:51]
  ds_read_b64_tr_b16 v[138:139], v29 offset:30528
  v_mfma_f32_16x16x32_bf16 v[64:67], v[160:163], v[124:127], v[64:67]
  ds_read_b64_tr_b16 v[140:141], v29 offset:32640
  v_mfma_f32_16x16x32_bf16 v[60:63], v[156:159], v[124:127], v[60:63]
  ds_read_b64_tr_b16 v[142:143], v29 offset:32704
  buffer_load_dwordx4 v15, s[12:15], s33 offen offset:1024 lds
  s_add_u32 s33, s33, 128
  v_mfma_f32_16x16x32_bf16 v[56:59], v[152:155], v[124:127], v[56:59]
  v_mfma_f32_16x16x32_bf16 v[72:75], v[152:155], v[128:131], v[72:75]
  ds_read_b64_tr_b16 v[144:145], v29 offset:34816
  v_mfma_f32_16x16x32_bf16 v[76:79], v[156:159], v[128:131], v[76:79]
  ds_read_b64_tr_b16 v[146:147], v29 offset:34880
  s_add_u32 m0, s34, 15232
  s_nop 0
  buffer_load_dwordx4 v16, s[16:19], s35 offen lds
  v_mfma_f32_16x16x32_bf16 v[80:83], v[160:163], v[128:131], v[80:83]
  ds_read_b128 v[108:111], v28 offset:34816
  v_mfma_f32_16x16x32_bf16 v[96:99], v[160:163], v[132:135], v[96:99]
  ds_read_b128 v[112:115], v28 offset:36864
  v_mfma_f32_16x16x32_bf16 v[92:95], v[156:159], v[132:135], v[92:95]
  ds_read_b128 v[116:119], v28 offset:38912
  s_add_u32 m0, s34, 15296
  s_nop 0
  buffer_load_dwordx4 v17, s[16:19], s35 offen offset:1024 lds
  s_add_u32 s35, s35, 14336
  v_mfma_f32_16x16x32_bf16 v[88:91], v[152:155], v[132:135], v[88:91]
  s_waitcnt vmcnt(16)
  s_lshl_b32 s5, s43, 1
  s_add_u32 s5, s5, s83
  s_lshl_b32 s5, s5, 2
  v_bfe_u32 v2, v1, 4, 1
  v_lshrrev_b32 v3, 5, v1
  v_lshl_add_u32 v2, v2, 1, v3
  v_add_u32 v2, s5, v2
  v_and_b32 v3, 127, v20
  v_lshlrev_b32 v3, 4, v3
  v_lshl_add_u32 v25, v2, 11, v3
  s_mul_i32 s4, s42, 720896
  v_add_u32 v25, s4, v25
  v_mfma_f32_16x16x32_bf16 v[192:195], v[168:171], v[232:235], 0
  v_mfma_f32_16x16x32_bf16 v[196:199], v[172:175], v[232:235], 0
  v_mfma_f32_16x16x32_bf16 v[200:203], v[184:187], v[232:235], 0
  v_mfma_f32_16x16x32_bf16 v[192:195], v[176:179], v[236:239], v[192:195]
  v_mfma_f32_16x16x32_bf16 v[196:199], v[180:183], v[236:239], v[196:199]
  v_mfma_f32_16x16x32_bf16 v[200:203], v[188:191], v[236:239], v[200:203]
  s_nop 7
  v_add_f32 v212, 0x358637bd, v200
  v_rcp_f32 v212, v212
  s_nop 0
  v_mul_f32 v212, v212, v21
  v_pk_mul_f32 v[192:193], v[192:193], v[212:213] op_sel_hi:[1,0]
  v_pk_mul_f32 v[194:195], v[194:195], v[212:213] op_sel_hi:[1,0]
  v_pk_mul_f32 v[196:197], v[196:197], v[212:213] op_sel_hi:[1,0]
  v_pk_mul_f32 v[198:199], v[198:199], v[212:213] op_sel_hi:[1,0]
  v_cvt_pk_bf16_f32 v204, v192, v193
  v_cvt_pk_bf16_f32 v205, v194, v195
  v_cvt_pk_bf16_f32 v206, v196, v197
  v_cvt_pk_bf16_f32 v207, v198, v199
  s_nop 0
  v_permlane16_swap_b32 v204, v206
  v_permlane16_swap_b32 v205, v207
  s_mov_b32 s4, 16777216
  buffer_store_dwordx4 v[204:207], v25, s[8:11], s4 offen sc1
  v_mfma_f32_16x16x32_bf16 v[192:195], v[168:171], v[240:243], 0
  v_mfma_f32_16x16x32_bf16 v[196:199], v[172:175], v[240:243], 0
  v_mfma_f32_16x16x32_bf16 v[200:203], v[184:187], v[240:243], 0
  v_mfma_f32_16x16x32_bf16 v[192:195], v[176:179], v[244:247], v[192:195]
  v_mfma_f32_16x16x32_bf16 v[196:199], v[180:183], v[244:247], v[196:199]
  v_mfma_f32_16x16x32_bf16 v[200:203], v[188:191], v[244:247], v[200:203]
  s_nop 7
  v_add_f32 v212, 0x358637bd, v200
  v_rcp_f32 v212, v212
  s_nop 0
  v_mul_f32 v212, v212, v22
  v_pk_mul_f32 v[192:193], v[192:193], v[212:213] op_sel_hi:[1,0]
  v_pk_mul_f32 v[194:195], v[194:195], v[212:213] op_sel_hi:[1,0]
  v_pk_mul_f32 v[196:197], v[196:197], v[212:213] op_sel_hi:[1,0]
  v_pk_mul_f32 v[198:199], v[198:199], v[212:213] op_sel_hi:[1,0]
  v_cvt_pk_bf16_f32 v208, v192, v193
  v_cvt_pk_bf16_f32 v209, v194, v195
  v_cvt_pk_bf16_f32 v210, v196, v197
  v_cvt_pk_bf16_f32 v211, v198, v199
  s_nop 0
  v_permlane16_swap_b32 v208, v210
  v_permlane16_swap_b32 v209, v211
  s_mov_b32 s4, 16777472
  buffer_store_dwordx4 v[208:211], v25, s[8:11], s4 offen sc1
  s_lshl_b32 s4, s42, 6
  s_add_u32 s4, s4, 15730944
  v_and_b32 v2, 15, v1
  v_lshl_add_u32 v13, v2, 2, s4
  s_lshl_b32 s76, s43, 2
  s_add_u32 s76, s76, s4
  s_waitcnt vmcnt(10) lgkmcnt(0)
  s_barrier
  v_mfma_f32_16x16x32_bf16 v[40:43], v[136:139], v[104:107], v[40:43]
  ds_read_b128 v[120:123], v28 offset:49152
  v_mfma_f32_16x16x32_bf16 v[44:47], v[140:143], v[104:107], v[44:47]
  ds_read_b64_tr_b16 v[152:153], v29 offset:45696
  s_add_u32 m0, s32, 32768
  s_nop 0
  buffer_load_dwordx4 v14, s[12:15], s33 offen lds
  v_mfma_f32_16x16x32_bf16 v[48:51], v[144:147], v[104:107], v[48:51]
  ds_read_b64_tr_b16 v[154:155], v29 offset:45760
  v_mfma_f32_16x16x32_bf16 v[64:67], v[144:147], v[108:111], v[64:67]
  ds_read_b64_tr_b16 v[156:157], v29 offset:47872
  v_mfma_f32_16x16x32_bf16 v[60:63], v[140:143], v[108:111], v[60:63]
  ds_read_b64_tr_b16 v[158:159], v29 offset:47936
  buffer_load_dwordx4 v15, s[12:15], s33 offen offset:1024 lds
  s_add_u32 s33, s33, 128
  v_mfma_f32_16x16x32_bf16 v[56:59], v[136:139], v[108:111], v[56:59]
  v_mfma_f32_16x16x32_bf16 v[72:75], v[136:139], v[112:115], v[72:75]
  ds_read_b64_tr_b16 v[160:161], v29 offset:50048
  v_mfma_f32_16x16x32_bf16 v[76:79], v[140:143], v[112:115], v[76:79]
  ds_read_b64_tr_b16 v[162:163], v29 offset:50112
  s_add_u32 m0, s34, 30464
  s_nop 0
  buffer_load_dwordx4 v16, s[16:19], s35 offen lds
  v_mfma_f32_16x16x32_bf16 v[80:83], v[144:147], v[112:115], v[80:83]
  ds_read_b128 v[124:127], v28 offset:51200
  v_mfma_f32_16x16x32_bf16 v[96:99], v[144:147], v[116:119], v[96:99]
  ds_read_b128 v[128:131], v28 offset:53248
  v_mfma_f32_16x16x32_bf16 v[92:95], v[140:143], v[116:119], v[92:95]
  ds_read_b128 v[132:135], v28 offset:55296
  s_add_u32 m0, s34, 30528
  s_nop 0
  buffer_load_dwordx4 v17, s[16:19], s35 offen offset:1024 lds
  s_add_u32 s35, s35, 14336
  v_mfma_f32_16x16x32_bf16 v[88:91], v[136:139], v[116:119], v[88:91]
  s_waitcnt vmcnt(10) lgkmcnt(0)
  s_barrier
  v_mfma_f32_16x16x32_bf16 v[40:43], v[152:155], v[120:123], v[40:43]
  ds_read_b128 v[104:107], v28 offset:0
  v_mfma_f32_16x16x32_bf16 v[44:47], v[156:159], v[120:123], v[44:47]
  ds_read_b64_tr_b16 v[136:137], v29 offset:0
  s_add_u32 m0, s32, 49152
  s_nop 0
  buffer_load_dwordx4 v14, s[12:15], s33 offen lds
  v_mfma_f32_16x16x32_bf16 v[48:51], v[160:163], v[120:123], v[48:51]
  ds_read_b64_tr_b16 v[138:139], v29 offset:64
  v_mfma_f32_16x16x32_bf16 v[64:67], v[160:163], v[124:127], v[64:67]
  ds_read_b64_tr_b16 v[140:141], v29 offset:2176
  v_mfma_f32_16x16x32_bf16 v[60:63], v[156:159], v[124:127], v[60:63]
  ds_read_b64_tr_b16 v[142:143], v29 offset:2240
  buffer_load_dwordx4 v15, s[12:15], s33 offen offset:1024 lds
  s_add_u32 s33, s33, 128
  v_mfma_f32_16x16x32_bf16 v[56:59], v[152:155], v[124:127], v[56:59]
  v_mfma_f32_16x16x32_bf16 v[72:75], v[152:155], v[128:131], v[72:75]
  ds_read_b64_tr_b16 v[144:145], v29 offset:4352
  v_mfma_f32_16x16x32_bf16 v[76:79], v[156:159], v[128:131], v[76:79]
  ds_read_b64_tr_b16 v[146:147], v29 offset:4416
  s_add_u32 m0, s34, 45696
  s_nop 0
  buffer_load_dwordx4 v16, s[16:19], s35 offen lds
  v_mfma_f32_16x16x32_bf16 v[80:83], v[160:163], v[128:131], v[80:83]
  ds_read_b128 v[108:111], v28 offset:2048
  v_mfma_f32_16x16x32_bf16 v[96:99], v[160:163], v[132:135], v[96:99]
  ds_read_b128 v[112:115], v28 offset:4096
  v_mfma_f32_16x16x32_bf16 v[92:95], v[156:159], v[132:135], v[92:95]
  ds_read_b128 v[116:119], v28 offset:6144
  s_add_u32 m0, s34, 45760
  s_nop 0
  buffer_load_dwordx4 v17, s[16:19], s35 offen offset:1024 lds
  s_add_u32 s35, s35, 14336
  v_mfma_f32_16x16x32_bf16 v[88:91], v[152:155], v[132:135], v[88:91]
  s_waitcnt vmcnt(10) lgkmcnt(0)
  s_barrier
  v_mfma_f32_16x16x32_bf16 v[40:43], v[136:139], v[104:107], v[40:43]
  ds_read_b128 v[120:123], v28 offset:16384
  v_mfma_f32_16x16x32_bf16 v[44:47], v[140:143], v[104:107], v[44:47]
  ds_read_b64_tr_b16 v[152:153], v29 offset:15232
  s_add_u32 m0, s32, 0
  s_nop 0
  buffer_load_dwordx4 v14, s[12:15], s33 offen lds
  v_mfma_f32_16x16x32_bf16 v[48:51], v[144:147], v[104:107], v[48:51]
  ds_read_b64_tr_b16 v[154:155], v29 offset:15296
  v_mfma_f32_16x16x32_bf16 v[64:67], v[144:147], v[108:111], v[64:67]
  ds_read_b64_tr_b16 v[156:157], v29 offset:17408
  v_mfma_f32_16x16x32_bf16 v[60:63], v[140:143], v[108:111], v[60:63]
  ds_read_b64_tr_b16 v[158:159], v29 offset:17472
  buffer_load_dwordx4 v15, s[12:15], s33 offen offset:1024 lds
  s_add_u32 s33, s33, 128
  v_mfma_f32_16x16x32_bf16 v[56:59], v[136:139], v[108:111], v[56:59]
  v_mfma_f32_16x16x32_bf16 v[72:75], v[136:139], v[112:115], v[72:75]
  ds_read_b64_tr_b16 v[160:161], v29 offset:19584
  v_mfma_f32_16x16x32_bf16 v[76:79], v[140:143], v[112:115], v[76:79]
  ds_read_b64_tr_b16 v[162:163], v29 offset:19648
  s_add_u32 m0, s34, 0
  s_nop 0
  buffer_load_dwordx4 v16, s[16:19], s35 offen lds
  v_mfma_f32_16x16x32_bf16 v[80:83], v[144:147], v[112:115], v[80:83]
  ds_read_b128 v[124:127], v28 offset:18432
  v_mfma_f32_16x16x32_bf16 v[96:99], v[144:147], v[116:119], v[96:99]
  ds_read_b128 v[128:131], v28 offset:20480
  v_mfma_f32_16x16x32_bf16 v[92:95], v[140:143], v[116:119], v[92:95]
  ds_read_b128 v[132:135], v28 offset:22528
  s_add_u32 m0, s34, 64
  s_nop 0
  buffer_load_dwordx4 v17, s[16:19], s35 offen offset:1024 lds
  s_add_u32 s35, s35, 14336
  v_mfma_f32_16x16x32_bf16 v[88:91], v[136:139], v[116:119], v[88:91]
  s_waitcnt vmcnt(8) lgkmcnt(0)
  s_barrier
  s_cmp_lg_u32 s3, 0
  s_cbranch_scc1 ow_71
  v_mov_b32 v8, 1
  v_mov_b32 v9, 0
  s_mov_b64 exec, 1
  buffer_store_dword v8, v9, s[8:11], s76 offen sc1
  s_mov_b64 exec, -1
ow_71:
  v_mfma_f32_16x16x32_bf16 v[40:43], v[152:155], v[120:123], v[40:43]
  ds_read_b128 v[104:107], v28 offset:32768
  v_mfma_f32_16x16x32_bf16 v[44:47], v[156:159], v[120:123], v[44:47]
  ds_read_b64_tr_b16 v[136:137], v29 offset:30464
  s_add_u32 m0, s32, 16384
  s_nop 0
  buffer_load_dwordx4 v14, s[12:15], s33 offen lds
  v_mfma_f32_16x16x32_bf16 v[48:51], v[160:163], v[120:123], v[48:51]
  ds_read_b64_tr_b16 v[138:139], v29 offset:30528
  v_mfma_f32_16x16x32_bf16 v[64:67], v[160:163], v[124:127], v[64:67]
  ds_read_b64_tr_b16 v[140:141], v29 offset:32640
  v_mfma_f32_16x16x32_bf16 v[60:63], v[156:159], v[124:127], v[60:63]
  ds_read_b64_tr_b16 v[142:143], v29 offset:32704
  buffer_load_dwordx4 v15, s[12:15], s33 offen offset:1024 lds
  s_add_u32 s33, s33, 128
  v_mfma_f32_16x16x32_bf16 v[56:59], v[152:155], v[124:127], v[56:59]
  v_mfma_f32_16x16x32_bf16 v[72:75], v[152:155], v[128:131], v[72:75]
  ds_read_b64_tr_b16 v[144:145], v29 offset:34816
  v_mfma_f32_16x16x32_bf16 v[76:79], v[156:159], v[128:131], v[76:79]
  ds_read_b64_tr_b16 v[146:147], v29 offset:34880
  s_add_u32 m0, s34, 15232
  s_nop 0
  buffer_load_dwordx4 v16, s[16:19], s35 offen lds
  v_mfma_f32_16x16x32_bf16 v[80:83], v[160:163], v[128:131], v[80:83]
  ds_read_b128 v[108:111], v28 offset:34816
  v_mfma_f32_16x16x32_bf16 v[96:99], v[160:163], v[132:135], v[96:99]
  ds_read_b128 v[112:115], v28 offset:36864
  v_mfma_f32_16x16x32_bf16 v[92:95], v[156:159], v[132:135], v[92:95]
  ds_read_b128 v[116:119], v28 offset:38912
  s_add_u32 m0, s34, 15296
  s_nop 0
  buffer_load_dwordx4 v17, s[16:19], s35 offen offset:1024 lds
  s_add_u32 s35, s35, 14336
  v_mfma_f32_16x16x32_bf16 v[88:91], v[152:155], v[132:135], v[88:91]
  s_waitcnt vmcnt(8) lgkmcnt(0)
  s_barrier
  v_mfma_f32_16x16x32_bf16 v[40:43], v[136:139], v[104:107], v[40:43]
  ds_read_b128 v[120:123], v28 offset:49152
  s_add_u32 s20, s72, 16777216
  s_addc_u32 s21, s73, 0
  v_mfma_f32_16x16x32_bf16 v[44:47], v[140:143], v[104:107], v[44:47]
  ds_read_b64_tr_b16 v[152:153], v29 offset:45696
  s_add_u32 m0, s32, 32768
  s_nop 0
  buffer_load_dwordx4 v14, s[12:15], s33 offen lds
  s_and_b32 s21, s21, 0xffff
  v_mfma_f32_16x16x32_bf16 v[48:51], v[144:147], v[104:107], v[48:51]
  ds_read_b64_tr_b16 v[154:155], v29 offset:45760
  s_mov_b32 s22, 11534336
  v_mfma_f32_16x16x32_bf16 v[64:67], v[144:147], v[108:111], v[64:67]
  ds_read_b64_tr_b16 v[156:157], v29 offset:47872
  s_mov_b32 s23, 0x20000
  v_mfma_f32_16x16x32_bf16 v[60:63], v[140:143], v[108:111], v[60:63]
  ds_read_b64_tr_b16 v[158:159], v29 offset:47936
  buffer_load_dwordx4 v15, s[12:15], s33 offen offset:1024 lds
  s_add_u32 s33, s33, 128
  s_mov_b32 s24, s54
  v_mfma_f32_16x16x32_bf16 v[56:59], v[136:139], v[108:111], v[56:59]
  s_and_b32 s25, s55, 0xffff
  v_mfma_f32_16x16x32_bf16 v[72:75], v[136:139], v[112:115], v[72:75]
  ds_read_b64_tr_b16 v[160:161], v29 offset:50048
  s_mov_b32 s26, 2097152
  v_mfma_f32_16x16x32_bf16 v[76:79], v[140:143], v[112:115], v[76:79]
  ds_read_b64_tr_b16 v[162:163], v29 offset:50112
  s_add_u32 m0, s34, 30464
  s_nop 0
  buffer_load_dwordx4 v16, s[16:19], s35 offen lds
  s_mov_b32 s27, 0x20000
  v_mfma_f32_16x16x32_bf16 v[80:83], v[144:147], v[112:115], v[80:83]
  ds_read_b128 v[124:127], v28 offset:51200
  s_lshl_b32 s36, s3, 10
  v_mfma_f32_16x16x32_bf16 v[96:99], v[144:147], v[116:119], v[96:99]
  ds_read_b128 v[128:131], v28 offset:53248
  s_add_u32 s36, s36, 131072
  v_mfma_f32_16x16x32_bf16 v[92:95], v[140:143], v[116:119], v[92:95]
  ds_read_b128 v[132:135], v28 offset:55296
  s_add_u32 m0, s34, 30528
  s_nop 0
  buffer_load_dwordx4 v17, s[16:19], s35 offen offset:1024 lds
  s_add_u32 s35, s35, 14336
  s_mul_i32 s92, s42, 720896
  v_mfma_f32_16x16x32_bf16 v[88:91], v[136:139], v[116:119], v[88:91]
  s_lshl_b32 s4, s3, 11
  s_waitcnt vmcnt(8) lgkmcnt(0)
  s_barrier
  v_mfma_f32_16x16x32_bf16 v[40:43], v[152:155], v[120:123], v[40:43]
  ds_read_b128 v[104:107], v28 offset:0
  s_add_u32 s92, s92, s4
  v_mfma_f32_16x16x32_bf16 v[44:47], v[156:159], v[120:123], v[44:47]
  ds_read_b64_tr_b16 v[136:137], v29 offset:0
  s_add_u32 m0, s32, 49152
  s_nop 0
  buffer_load_dwordx4 v14, s[12:15], s33 offen lds
  v_lshlrev_b32 v18, 4, v1
  v_mfma_f32_16x16x32_bf16 v[48:51], v[160:163], v[120:123], v[48:51]
  ds_read_b64_tr_b16 v[138:139], v29 offset:64
  s_lshl_b32 s78, s43, 7
  v_mfma_f32_16x16x32_bf16 v[64:67], v[160:163], v[124:127], v[64:67]
  ds_read_b64_tr_b16 v[140:141], v29 offset:2176
  s_mov_b32 s5, 2048
  v_mfma_f32_16x16x32_bf16 v[60:63], v[156:159], v[124:127], v[60:63]
  ds_read_b64_tr_b16 v[142:143], v29 offset:2240
  buffer_load_dwordx4 v15, s[12:15], s33 offen offset:1024 lds
  s_add_u32 s33, s33, 128
  s_mul_i32 s37, s3, 16384
  v_mfma_f32_16x16x32_bf16 v[56:59], v[152:155], v[124:127], v[56:59]
  s_add_u32 s37, s37, s78
  v_mfma_f32_16x16x32_bf16 v[72:75], v[152:155], v[128:131], v[72:75]
  ds_read_b64_tr_b16 v[144:145], v29 offset:4352
  s_lshl_b32 s4, s44, 1
  v_mfma_f32_16x16x32_bf16 v[76:79], v[156:159], v[128:131], v[76:79]
  ds_read_b64_tr_b16 v[146:147], v29 offset:4416
  s_add_u32 m0, s34, 45696
  s_nop 0
  buffer_load_dwordx4 v16, s[16:19], s35 offen lds
  v_bfe_u32 v3, v1, 4, 1
  v_mfma_f32_16x16x32_bf16 v[80:83], v[160:163], v[128:131], v[80:83]
  ds_read_b128 v[108:111], v28 offset:2048
  v_or_b32 v3, s4, v3
  v_mfma_f32_16x16x32_bf16 v[96:99], v[160:163], v[132:135], v[96:99]
  ds_read_b128 v[112:115], v28 offset:4096
  v_bfe_u32 v4, v1, 1, 2
  v_mfma_f32_16x16x32_bf16 v[92:95], v[156:159], v[132:135], v[92:95]
  ds_read_b128 v[116:119], v28 offset:6144
  s_add_u32 m0, s34, 45760
  s_nop 0
  buffer_load_dwordx4 v17, s[16:19], s35 offen offset:1024 lds
  s_add_u32 s35, s35, 14336
  v_xor_b32 v3, v3, v4
  v_mfma_f32_16x16x32_bf16 v[88:91], v[152:155], v[132:135], v[88:91]
  v_and_b32 v4, 1, v1
  s_waitcnt vmcnt(8) lgkmcnt(0)
  s_barrier
  v_mfma_f32_16x16x32_bf16 v[40:43], v[136:139], v[104:107], v[40:43]
  ds_read_b128 v[120:123], v28 offset:16384
  v_lshlrev_b32 v4, 4, v4
  v_mfma_f32_16x16x32_bf16 v[44:47], v[140:143], v[104:107], v[44:47]
  ds_read_b64_tr_b16 v[152:153], v29 offset:15232
  s_add_u32 m0, s32, 0
  s_nop 0
  buffer_load_dwordx4 v14, s[12:15], s33 offen lds
  v_lshl_add_u32 v3, v3, 5, v4
  v_mfma_f32_16x16x32_bf16 v[48:51], v[144:147], v[104:107], v[48:51]
  ds_read_b64_tr_b16 v[154:155], v29 offset:15296
  v_mad_u32_u24 v19, v0, s5, v3
  v_mfma_f32_16x16x32_bf16 v[64:67], v[144:147], v[108:111], v[64:67]
  ds_read_b64_tr_b16 v[156:157], v29 offset:17408
  v_lshrrev_b32 v2, 4, v1
  v_mfma_f32_16x16x32_bf16 v[60:63], v[140:143], v[108:111], v[60:63]
  ds_read_b64_tr_b16 v[158:159], v29 offset:17472
  buffer_load_dwordx4 v15, s[12:15], s33 offen offset:1024 lds
  s_add_u32 s33, s33, 128
  v_and_b32 v3, 127, v20
  v_mfma_f32_16x16x32_bf16 v[56:59], v[136:139], v[108:111], v[56:59]
  v_mfma_f32_16x16x32_bf16 v[72:75], v[136:139], v[112:115], v[72:75]
  ds_read_b64_tr_b16 v[160:161], v29 offset:19584
  v_lshlrev_b32 v3, 4, v3
  v_mfma_f32_16x16x32_bf16 v[76:79], v[140:143], v[112:115], v[76:79]
  ds_read_b64_tr_b16 v[162:163], v29 offset:19648
  s_add_u32 m0, s34, 0
  s_nop 0
  buffer_load_dwordx4 v16, s[16:19], s35 offen lds
  v_lshl_add_u32 v30, v2, 11, v3
  v_mfma_f32_16x16x32_bf16 v[80:83], v[144:147], v[112:115], v[80:83]
  ds_read_b128 v[124:127], v28 offset:18432
  v_add_u32 v31, 8192, v30
  v_mfma_f32_16x16x32_bf16 v[96:99], v[144:147], v[116:119], v[96:99]
  ds_read_b128 v[128:131], v28 offset:20480
  v_add_u32 v36, 32768, v36
  v_mfma_f32_16x16x32_bf16 v[92:95], v[140:143], v[116:119], v[92:95]
  ds_read_b128 v[132:135], v28 offset:22528
  s_add_u32 m0, s34, 64
  s_nop 0
  buffer_load_dwordx4 v17, s[16:19], s35 offen offset:1024 lds
  s_add_u32 s35, s35, 14336
  v_add_u32 v37, 32768, v37
  v_mfma_f32_16x16x32_bf16 v[88:91], v[136:139], v[116:119], v[88:91]
  s_waitcnt vmcnt(8) lgkmcnt(0)
  s_barrier
  v_mfma_f32_16x16x32_bf16 v[40:43], v[152:155], v[120:123], v[40:43]
  ds_read_b128 v[104:107], v28 offset:32768
  v_mfma_f32_16x16x32_bf16 v[44:47], v[156:159], v[120:123], v[44:47]
  ds_read_b64_tr_b16 v[136:137], v29 offset:30464
  s_add_u32 m0, s32, 16384
  s_nop 0
  buffer_load_dwordx4 v14, s[12:15], s33 offen lds
  v_mfma_f32_16x16x32_bf16 v[48:51], v[160:163], v[120:123], v[48:51]
  ds_read_b64_tr_b16 v[138:139], v29 offset:30528
  v_mfma_f32_16x16x32_bf16 v[64:67], v[160:163], v[124:127], v[64:67]
  ds_read_b64_tr_b16 v[140:141], v29 offset:32640
  v_mfma_f32_16x16x32_bf16 v[60:63], v[156:159], v[124:127], v[60:63]
  ds_read_b64_tr_b16 v[142:143], v29 offset:32704
  buffer_load_dwordx4 v15, s[12:15], s33 offen offset:1024 lds
  s_add_u32 s33, s33, 128
  v_mfma_f32_16x16x32_bf16 v[56:59], v[152:155], v[124:127], v[56:59]
  v_mfma_f32_16x16x32_bf16 v[72:75], v[152:155], v[128:131], v[72:75]
  ds_read_b64_tr_b16 v[144:145], v29 offset:34816
  v_mfma_f32_16x16x32_bf16 v[76:79], v[156:159], v[128:131], v[76:79]
  ds_read_b64_tr_b16 v[146:147], v29 offset:34880
  s_add_u32 m0, s34, 15232
  s_nop 0
  buffer_load_dwordx4 v16, s[16:19], s35 offen lds
  v_mfma_f32_16x16x32_bf16 v[80:83], v[160:163], v[128:131], v[80:83]
  ds_read_b128 v[108:111], v28 offset:34816
  v_mfma_f32_16x16x32_bf16 v[96:99], v[160:163], v[132:135], v[96:99]
  ds_read_b128 v[112:115], v28 offset:36864
  v_mfma_f32_16x16x32_bf16 v[92:95], v[156:159], v[132:135], v[92:95]
  ds_read_b128 v[116:119], v28 offset:38912
  s_add_u32 m0, s34, 15296
  s_nop 0
  buffer_load_dwordx4 v17, s[16:19], s35 offen offset:1024 lds
  s_add_u32 s35, s35, 14336
  v_mfma_f32_16x16x32_bf16 v[88:91], v[152:155], v[132:135], v[88:91]
  s_waitcnt vmcnt(8) lgkmcnt(0)
  s_barrier
  s_cmp_lg_u32 s3, 0
  s_cbranch_scc1 ow_72
  buffer_load_dword v12, v13, s[8:11], 0 offen sc1
ow_72:
  v_mfma_f32_16x16x32_bf16 v[40:43], v[136:139], v[104:107], v[40:43]
  ds_read_b128 v[120:123], v28 offset:49152
  v_mfma_f32_16x16x32_bf16 v[44:47], v[140:143], v[104:107], v[44:47]
  ds_read_b64_tr_b16 v[152:153], v29 offset:45696
  s_add_u32 m0, s32, 32768
  s_nop 0
  buffer_load_dwordx4 v14, s[12:15], s33 offen lds
  v_mfma_f32_16x16x32_bf16 v[48:51], v[144:147], v[104:107], v[48:51]
  ds_read_b64_tr_b16 v[154:155], v29 offset:45760
  v_mfma_f32_16x16x32_bf16 v[64:67], v[144:147], v[108:111], v[64:67]
  ds_read_b64_tr_b16 v[156:157], v29 offset:47872
  v_mfma_f32_16x16x32_bf16 v[60:63], v[140:143], v[108:111], v[60:63]
  ds_read_b64_tr_b16 v[158:159], v29 offset:47936
  buffer_load_dwordx4 v15, s[12:15], s33 offen offset:1024 lds
  s_add_u32 s33, s33, 128
  v_mfma_f32_16x16x32_bf16 v[56:59], v[136:139], v[108:111], v[56:59]
  v_mfma_f32_16x16x32_bf16 v[72:75], v[136:139], v[112:115], v[72:75]
  ds_read_b64_tr_b16 v[160:161], v29 offset:50048
  v_mfma_f32_16x16x32_bf16 v[76:79], v[140:143], v[112:115], v[76:79]
  ds_read_b64_tr_b16 v[162:163], v29 offset:50112
  s_add_u32 m0, s34, 30464
  s_nop 0
  buffer_load_dwordx4 v16, s[16:19], s35 offen lds
  v_mfma_f32_16x16x32_bf16 v[80:83], v[144:147], v[112:115], v[80:83]
  ds_read_b128 v[124:127], v28 offset:51200
  v_mfma_f32_16x16x32_bf16 v[96:99], v[144:147], v[116:119], v[96:99]
  ds_read_b128 v[128:131], v28 offset:53248
  v_mfma_f32_16x16x32_bf16 v[92:95], v[140:143], v[116:119], v[92:95]
  ds_read_b128 v[132:135], v28 offset:55296
  s_add_u32 m0, s34, 30528
  s_nop 0
  buffer_load_dwordx4 v17, s[16:19], s35 offen offset:1024 lds
  s_add_u32 s35, s35, 14336
  v_mfma_f32_16x16x32_bf16 v[88:91], v[136:139], v[116:119], v[88:91]
  s_waitcnt vmcnt(8) lgkmcnt(0)
  s_barrier
  v_mfma_f32_16x16x32_bf16 v[40:43], v[152:155], v[120:123], v[40:43]
  ds_read_b128 v[104:107], v28 offset:0
  v_mfma_f32_16x16x32_bf16 v[44:47], v[156:159], v[120:123], v[44:47]
  ds_read_b64_tr_b16 v[136:137], v29 offset:0
  s_add_u32 m0, s32, 49152
  s_nop 0
  buffer_load_dwordx4 v14, s[12:15], s33 offen lds
  v_mfma_f32_16x16x32_bf16 v[48:51], v[160:163], v[120:123], v[48:51]
  ds_read_b64_tr_b16 v[138:139], v29 offset:64
  v_mfma_f32_16x16x32_bf16 v[64:67], v[160:163], v[124:127], v[64:67]
  ds_read_b64_tr_b16 v[140:141], v29 offset:2176
  v_mfma_f32_16x16x32_bf16 v[60:63], v[156:159], v[124:127], v[60:63]
  ds_read_b64_tr_b16 v[142:143], v29 offset:2240
  buffer_load_dwordx4 v15, s[12:15], s33 offen offset:1024 lds
  s_add_u32 s33, s33, 128
  v_mfma_f32_16x16x32_bf16 v[56:59], v[152:155], v[124:127], v[56:59]
  v_mfma_f32_16x16x32_bf16 v[72:75], v[152:155], v[128:131], v[72:75]
  ds_read_b64_tr_b16 v[144:145], v29 offset:4352
  v_mfma_f32_16x16x32_bf16 v[76:79], v[156:159], v[128:131], v[76:79]
  ds_read_b64_tr_b16 v[146:147], v29 offset:4416
  s_add_u32 m0, s34, 45696
  s_nop 0
  buffer_load_dwordx4 v16, s[16:19], s35 offen lds
  v_mfma_f32_16x16x32_bf16 v[80:83], v[160:163], v[128:131], v[80:83]
  ds_read_b128 v[108:111], v28 offset:2048
  v_mfma_f32_16x16x32_bf16 v[96:99], v[160:163], v[132:135], v[96:99]
  ds_read_b128 v[112:115], v28 offset:4096
  v_mfma_f32_16x16x32_bf16 v[92:95], v[156:159], v[132:135], v[92:95]
  ds_read_b128 v[116:119], v28 offset:6144
  s_add_u32 m0, s34, 45760
  s_nop 0
  buffer_load_dwordx4 v17, s[16:19], s35 offen offset:1024 lds
  s_add_u32 s35, s35, 14336
  v_mfma_f32_16x16x32_bf16 v[88:91], v[152:155], v[132:135], v[88:91]
  s_cmp_lg_u32 s3, 0
  s_cbranch_scc1 ow_73
  s_waitcnt vmcnt(8)
  v_cmp_ne_u32 vcc, 0, v12
  s_nop 0
  s_cmp_eq_u64 vcc, -1
  s_cbranch_scc1 pok_74
  s_mov_b32 s75, 400000
psp_75:
  buffer_load_dword v12, v13, s[8:11], 0 offen sc1
  s_waitcnt vmcnt(0)
  v_cmp_ne_u32 vcc, 0, v12
  s_nop 0
  s_cmp_eq_u64 vcc, -1
  s_cbranch_scc1 pok_74
  s_sub_u32 s75, s75, 1
  s_cmp_lg_u32 s75, 0
  s_cbranch_scc1 psp_75
pok_74:
ow_73:
  s_waitcnt vmcnt(8) lgkmcnt(0)
  s_barrier
  v_mfma_f32_16x16x32_bf16 v[40:43], v[136:139], v[104:107], v[40:43]
  ds_read_b128 v[120:123], v28 offset:16384
  v_mfma_f32_16x16x32_bf16 v[44:47], v[140:143], v[104:107], v[44:47]
  ds_read_b64_tr_b16 v[152:153], v29 offset:15232
  v_mfma_f32_16x16x32_bf16 v[48:51], v[144:147], v[104:107], v[48:51]
  ds_read_b64_tr_b16 v[154:155], v29 offset:15296
  s_add_u32 m0, s32, 0
  s_nop 0
  buffer_load_dwordx4 v18, s[20:23], s92 offen lds
  v_mfma_f32_16x16x32_bf16 v[64:67], v[144:147], v[108:111], v[64:67]
  ds_read_b64_tr_b16 v[156:157], v29 offset:17408
  v_mfma_f32_16x16x32_bf16 v[60:63], v[140:143], v[108:111], v[60:63]
  ds_read_b64_tr_b16 v[158:159], v29 offset:17472
  v_mfma_f32_16x16x32_bf16 v[56:59], v[136:139], v[108:111], v[56:59]
  v_mfma_f32_16x16x32_bf16 v[72:75], v[136:139], v[112:115], v[72:75]
  ds_read_b64_tr_b16 v[160:161], v29 offset:19584
  buffer_load_dwordx4 v18, s[20:23], s92 offen offset:1024 lds
  s_add_u32 s92, s92, 16384
  v_mfma_f32_16x16x32_bf16 v[76:79], v[140:143], v[112:115], v[76:79]
  ds_read_b64_tr_b16 v[162:163], v29 offset:19648
  v_mfma_f32_16x16x32_bf16 v[80:83], v[144:147], v[112:115], v[80:83]
  ds_read_b128 v[124:127], v28 offset:18432
  v_mfma_f32_16x16x32_bf16 v[96:99], v[144:147], v[116:119], v[96:99]
  ds_read_b128 v[128:131], v28 offset:20480
  v_mfma_f32_16x16x32_bf16 v[92:95], v[140:143], v[116:119], v[92:95]
  ds_read_b128 v[132:135], v28 offset:22528
  s_add_u32 m0, s36, 0
  s_nop 0
  buffer_load_dwordx4 v19, s[24:27], s37 offen lds
  s_add_u32 s37, s37, 131072
  v_mfma_f32_16x16x32_bf16 v[88:91], v[136:139], v[116:119], v[88:91]
  s_waitcnt vmcnt(7) lgkmcnt(0)
  s_barrier
  v_mfma_f32_16x16x32_bf16 v[40:43], v[152:155], v[120:123], v[40:43]
  ds_read_b128 v[104:107], v28 offset:32768
  s_mul_i32 s4, s43, 14
  v_mfma_f32_16x16x32_bf16 v[44:47], v[156:159], v[120:123], v[44:47]
  ds_read_b64_tr_b16 v[136:137], v29 offset:30464
  s_lshl_b32 s5, s83, 3
  v_mfma_f32_16x16x32_bf16 v[48:51], v[160:163], v[120:123], v[48:51]
  ds_read_b64_tr_b16 v[138:139], v29 offset:30528
  s_add_u32 m0, s32, 16384
  s_nop 0
  buffer_load_dwordx4 v18, s[20:23], s92 offen lds
  s_add_u32 s4, s4, s5
  v_mfma_f32_16x16x32_bf16 v[64:67], v[160:163], v[124:127], v[64:67]
  ds_read_b64_tr_b16 v[140:141], v29 offset:32640
  v_mfma_f32_16x16x32_bf16 v[60:63], v[156:159], v[124:127], v[60:63]
  ds_read_b64_tr_b16 v[142:143], v29 offset:32704
  s_add_u32 s4, s4, 128
  v_mfma_f32_16x16x32_bf16 v[56:59], v[152:155], v[124:127], v[56:59]
  v_bfe_u32 v3, v1, 4, 1
  v_mfma_f32_16x16x32_bf16 v[72:75], v[152:155], v[128:131], v[72:75]
  ds_read_b64_tr_b16 v[144:145], v29 offset:34816
  buffer_load_dwordx4 v18, s[20:23], s92 offen offset:1024 lds
  s_add_u32 s92, s92, 16384
  v_lshrrev_b32 v2, 5, v1
  v_mfma_f32_16x16x32_bf16 v[76:79], v[156:159], v[128:131], v[76:79]
  ds_read_b64_tr_b16 v[146:147], v29 offset:34880
  v_mfma_f32_16x16x32_bf16 v[80:83], v[160:163], v[128:131], v[80:83]
  ds_read_b128 v[108:111], v28 offset:34816
  v_lshl_add_u32 v2, v3, 1, v2
  v_mfma_f32_16x16x32_bf16 v[96:99], v[160:163], v[132:135], v[96:99]
  ds_read_b128 v[112:115], v28 offset:36864
  v_add_u32 v2, s4, v2
  v_mfma_f32_16x16x32_bf16 v[92:95], v[156:159], v[132:135], v[92:95]
  ds_read_b128 v[116:119], v28 offset:38912
  s_add_u32 m0, s36, 8192
  s_nop 0
  buffer_load_dwordx4 v19, s[24:27], s37 offen lds
  s_add_u32 s37, s37, 131072
  v_and_b32 v4, 127, v20
  v_mfma_f32_16x16x32_bf16 v[88:91], v[152:155], v[132:135], v[88:91]
  s_waitcnt vmcnt(6) lgkmcnt(0)
  s_barrier
  v_mfma_f32_16x16x32_bf16 v[40:43], v[136:139], v[104:107], v[40:43]
  ds_read_b128 v[120:123], v28 offset:49152
  v_lshlrev_b32 v4, 4, v4
  v_mfma_f32_16x16x32_bf16 v[44:47], v[140:143], v[104:107], v[44:47]
  ds_read_b64_tr_b16 v[152:153], v29 offset:45696
  v_lshl_add_u32 v184, v2, 11, v4
  v_mfma_f32_16x16x32_bf16 v[48:51], v[144:147], v[104:107], v[48:51]
  ds_read_b64_tr_b16 v[154:155], v29 offset:45760
  s_add_u32 m0, s32, 32768
  s_nop 0
  buffer_load_dwordx4 v18, s[20:23], s92 offen lds
  s_mul_i32 s4, s42, 720896
  v_mfma_f32_16x16x32_bf16 v[64:67], v[144:147], v[108:111], v[64:67]
  ds_read_b64_tr_b16 v[156:157], v29 offset:47872
  v_mfma_f32_16x16x32_bf16 v[60:63], v[140:143], v[108:111], v[60:63]
  ds_read_b64_tr_b16 v[158:159], v29 offset:47936
  s_add_u32 s4, s4, 16777216
  v_mfma_f32_16x16x32_bf16 v[56:59], v[136:139], v[108:111], v[56:59]
  v_add_u32 v184, s4, v184
  v_mfma_f32_16x16x32_bf16 v[72:75], v[136:139], v[112:115], v[72:75]
  ds_read_b64_tr_b16 v[160:161], v29 offset:50048
  buffer_load_dwordx4 v18, s[20:23], s92 offen offset:1024 lds
  s_add_u32 s92, s92, 16384
  v_add_u32 v185, 8192, v184
  v_mfma_f32_16x16x32_bf16 v[76:79], v[140:143], v[112:115], v[76:79]
  ds_read_b64_tr_b16 v[162:163], v29 offset:50112
  v_mfma_f32_16x16x32_bf16 v[80:83], v[144:147], v[112:115], v[80:83]
  ds_read_b128 v[124:127], v28 offset:51200
  v_mul_lo_u32 v3, v3, s83
  v_mfma_f32_16x16x32_bf16 v[96:99], v[144:147], v[116:119], v[96:99]
  ds_read_b128 v[128:131], v28 offset:53248
  v_mov_b32 v4, 2146435072
  v_mfma_f32_16x16x32_bf16 v[92:95], v[140:143], v[116:119], v[92:95]
  ds_read_b128 v[132:135], v28 offset:55296
  s_add_u32 m0, s36, 16384
  s_nop 0
  buffer_load_dwordx4 v19, s[24:27], s37 offen lds
  s_add_u32 s37, s37, 131072
  v_cmp_eq_u32 vcc, 1, v3
  s_nop 1
  v_cndmask_b32 v185, v185, v4, vcc
  v_mfma_f32_16x16x32_bf16 v[88:91], v[136:139], v[116:119], v[88:91]
  s_waitcnt lgkmcnt(0)
  v_mfma_f32_16x16x32_bf16 v[40:43], v[152:155], v[120:123], v[40:43]
  v_add_u32 v186, 256, v184
  v_mfma_f32_16x16x32_bf16 v[44:47], v[156:159], v[120:123], v[44:47]
  v_add_u32 v187, 256, v185
  v_mfma_f32_16x16x32_bf16 v[48:51], v[160:163], v[120:123], v[48:51]
  v_mfma_f32_16x16x32_bf16 v[64:67], v[160:163], v[124:127], v[64:67]
  s_lshl_b32 s4, s42, 6
  v_mfma_f32_16x16x32_bf16 v[60:63], v[156:159], v[124:127], v[60:63]
  s_add_u32 s4, s4, 15731968
  v_mfma_f32_16x16x32_bf16 v[56:59], v[152:155], v[124:127], v[56:59]
  v_mfma_f32_16x16x32_bf16 v[72:75], v[152:155], v[128:131], v[72:75]
  v_and_b32 v2, 15, v1
  v_mfma_f32_16x16x32_bf16 v[76:79], v[156:159], v[128:131], v[76:79]
  v_lshl_add_u32 v13, v2, 2, s4
  v_mfma_f32_16x16x32_bf16 v[80:83], v[160:163], v[128:131], v[80:83]
  v_mfma_f32_16x16x32_bf16 v[96:99], v[160:163], v[132:135], v[96:99]
  s_lshl_b32 s76, s43, 2
  v_mfma_f32_16x16x32_bf16 v[92:95], v[156:159], v[132:135], v[92:95]
  s_add_u32 s76, s76, s4
  v_mfma_f32_16x16x32_bf16 v[88:91], v[152:155], v[132:135], v[88:91]
  v_mov_b64 v[52:53], 0
  v_mov_b64 v[54:55], 0
  v_mov_b64 v[68:69], 0
  v_mov_b64 v[70:71], 0
  v_mov_b64 v[84:85], 0
  v_mov_b64 v[86:87], 0
  v_mov_b64 v[100:101], 0
  v_mov_b64 v[102:103], 0
L_t4j:
  s_barrier
  s_add_u32 m0, s32, 49152
  s_nop 0
  buffer_load_dwordx4 v18, s[20:23], s92 offen lds
  buffer_load_dwordx4 v18, s[20:23], s92 offen offset:1024 lds
  s_add_u32 s92, s92, 16384
  s_add_u32 m0, s36, 24576
  s_nop 0
  buffer_load_dwordx4 v19, s[24:27], s37 offen lds
  s_add_u32 s37, s37, 131072
  s_xor_b32 s5, s3, 2
  s_lshl_b32 s4, s5, 13
  s_add_u32 s4, s4, 65536
  v_lshl_add_u32 v2, v1, 4, s4
  s_cmp_eq_u32 s82, 0
  s_cbranch_scc0 x4_s_76
  ds_write_b128 v2, v[72:75] offset:0
  ds_write_b128 v2, v[76:79] offset:1024
  ds_write_b128 v2, v[80:83] offset:2048
  ds_write_b128 v2, v[84:87] offset:3072
  ds_write_b128 v2, v[88:91] offset:4096
  ds_write_b128 v2, v[92:95] offset:5120
  ds_write_b128 v2, v[96:99] offset:6144
  ds_write_b128 v2, v[100:103] offset:7168
  s_branch x4_d_77
x4_s_76:
  ds_write_b128 v2, v[40:43] offset:0
  ds_write_b128 v2, v[44:47] offset:1024
  ds_write_b128 v2, v[48:51] offset:2048
  ds_write_b128 v2, v[52:55] offset:3072
  ds_write_b128 v2, v[56:59] offset:4096
  ds_write_b128 v2, v[60:63] offset:5120
  ds_write_b128 v2, v[64:67] offset:6144
  ds_write_b128 v2, v[68:71] offset:7168
  v_mov_b64 v[40:41], v[72:73]
  v_mov_b64 v[42:43], v[74:75]
  v_mov_b64 v[44:45], v[76:77]
  v_mov_b64 v[46:47], v[78:79]
  v_mov_b64 v[48:49], v[80:81]
  v_mov_b64 v[50:51], v[82:83]
  v_mov_b64 v[52:53], v[84:85]
  v_mov_b64 v[54:55], v[86:87]
  v_mov_b64 v[56:57], v[88:89]
  v_mov_b64 v[58:59], v[90:91]
  v_mov_b64 v[60:61], v[92:93]
  v_mov_b64 v[62:63], v[94:95]
  v_mov_b64 v[64:65], v[96:97]
  v_mov_b64 v[66:67], v[98:99]
  v_mov_b64 v[68:69], v[100:101]
  v_mov_b64 v[70:71], v[102:103]
x4_d_77:
  s_lshl_b32 s4, s3, 13
  s_add_u32 s4, s4, 65536
  v_lshl_add_u32 v2, v1, 4, s4
  s_waitcnt lgkmcnt(0)
  s_barrier
  ds_read_b128 v[72:75], v2 offset:0
  ds_read_b128 v[76:79], v2 offset:1024
  ds_read_b128 v[80:83], v2 offset:2048
  ds_read_b128 v[84:87], v2 offset:3072
  ds_read_b128 v[88:91], v2 offset:4096
  ds_read_b128 v[92:95], v2 offset:5120
  ds_read_b128 v[96:99], v2 offset:6144
  ds_read_b128 v[100:103], v2 offset:7168
  s_waitcnt lgkmcnt(0)
  v_pk_add_f32 v[40:41], v[40:41], v[72:73]
  v_pk_add_f32 v[42:43], v[42:43], v[74:75]
  v_pk_add_f32 v[44:45], v[44:45], v[76:77]
  v_pk_add_f32 v[46:47], v[46:47], v[78:79]
  v_pk_add_f32 v[48:49], v[48:49], v[80:81]
  v_pk_add_f32 v[50:51], v[50:51], v[82:83]
  v_pk_add_f32 v[52:53], v[52:53], v[84:85]
  v_pk_add_f32 v[54:55], v[54:55], v[86:87]
  v_pk_add_f32 v[56:57], v[56:57], v[88:89]
  v_pk_add_f32 v[58:59], v[58:59], v[90:91]
  v_pk_add_f32 v[60:61], v[60:61], v[92:93]
  v_pk_add_f32 v[62:63], v[62:63], v[94:95]
  v_pk_add_f32 v[64:65], v[64:65], v[96:97]
  v_pk_add_f32 v[66:67], v[66:67], v[98:99]
  v_pk_add_f32 v[68:69], v[68:69], v[100:101]
  v_pk_add_f32 v[70:71], v[70:71], v[102:103]
  v_lshlrev_b32 v198, 16, v23
  v_sub_f32 v196, 1.0, v21
  v_lshlrev_b32 v192, 16, v216
  v_and_b32 v193, 0xffff0000, v216
  v_lshlrev_b32 v194, 16, v217
  v_and_b32 v195, 0xffff0000, v217
  v_pk_add_f32 v[40:41], v[40:41], v[198:199] op_sel_hi:[1,0]
  v_pk_add_f32 v[42:43], v[42:43], v[198:199] op_sel_hi:[1,0]
  v_pk_mul_f32 v[192:193], v[192:193], v[196:197] op_sel_hi:[1,0]
  v_pk_mul_f32 v[194:195], v[194:195], v[196:197] op_sel_hi:[1,0]
  v_pk_mul_f32 v[40:41], v[40:41], v[192:193]
  v_pk_mul_f32 v[42:43], v[42:43], v[194:195]
  v_lshlrev_b32 v192, 16, v218
  v_and_b32 v193, 0xffff0000, v218
  v_lshlrev_b32 v194, 16, v219
  v_and_b32 v195, 0xffff0000, v219
  v_pk_add_f32 v[44:45], v[44:45], v[198:199] op_sel_hi:[1,0]
  v_pk_add_f32 v[46:47], v[46:47], v[198:199] op_sel_hi:[1,0]
  v_pk_mul_f32 v[192:193], v[192:193], v[196:197] op_sel_hi:[1,0]
  v_pk_mul_f32 v[194:195], v[194:195], v[196:197] op_sel_hi:[1,0]
  v_pk_mul_f32 v[44:45], v[44:45], v[192:193]
  v_pk_mul_f32 v[46:47], v[46:47], v[194:195]
  v_lshlrev_b32 v192, 16, v220
  v_and_b32 v193, 0xffff0000, v220
  v_lshlrev_b32 v194, 16, v221
  v_and_b32 v195, 0xffff0000, v221
  v_pk_add_f32 v[48:49], v[48:49], v[198:199] op_sel_hi:[1,0]
  v_pk_add_f32 v[50:51], v[50:51], v[198:199] op_sel_hi:[1,0]
  v_pk_mul_f32 v[192:193], v[192:193], v[196:197] op_sel_hi:[1,0]
  v_pk_mul_f32 v[194:195], v[194:195], v[196:197] op_sel_hi:[1,0]
  v_pk_mul_f32 v[48:49], v[48:49], v[192:193]
  v_pk_mul_f32 v[50:51], v[50:51], v[194:195]
  v_lshlrev_b32 v192, 16, v222
  v_and_b32 v193, 0xffff0000, v222
  v_lshlrev_b32 v194, 16, v223
  v_and_b32 v195, 0xffff0000, v223
  v_pk_add_f32 v[52:53], v[52:53], v[198:199] op_sel_hi:[1,0]
  v_pk_add_f32 v[54:55], v[54:55], v[198:199] op_sel_hi:[1,0]
  v_pk_mul_f32 v[192:193], v[192:193], v[196:197] op_sel_hi:[1,0]
  v_pk_mul_f32 v[194:195], v[194:195], v[196:197] op_sel_hi:[1,0]
  v_pk_mul_f32 v[52:53], v[52:53], v[192:193]
  v_pk_mul_f32 v[54:55], v[54:55], v[194:195]
  v_cvt_pk_bf16_f32 v168, v40, v41
  v_cvt_pk_bf16_f32 v169, v42, v43
  v_cvt_pk_bf16_f32 v170, v44, v45
  v_cvt_pk_bf16_f32 v171, v46, v47
  v_cvt_pk_bf16_f32 v172, v48, v49
  v_cvt_pk_bf16_f32 v173, v50, v51
  v_cvt_pk_bf16_f32 v174, v52, v53
  v_cvt_pk_bf16_f32 v175, v54, v55
  v_permlane16_swap_b32 v168, v170
  v_permlane16_swap_b32 v169, v171
  v_permlane16_swap_b32 v172, v174
  v_permlane16_swap_b32 v173, v175
  v_lshlrev_b32 v198, 16, v24
  v_sub_f32 v196, 1.0, v22
  v_lshlrev_b32 v192, 16, v224
  v_and_b32 v193, 0xffff0000, v224
  v_lshlrev_b32 v194, 16, v225
  v_and_b32 v195, 0xffff0000, v225
  v_pk_add_f32 v[56:57], v[56:57], v[198:199] op_sel_hi:[1,0]
  v_pk_add_f32 v[58:59], v[58:59], v[198:199] op_sel_hi:[1,0]
  v_pk_mul_f32 v[192:193], v[192:193], v[196:197] op_sel_hi:[1,0]
  v_pk_mul_f32 v[194:195], v[194:195], v[196:197] op_sel_hi:[1,0]
  v_pk_mul_f32 v[56:57], v[56:57], v[192:193]
  v_pk_mul_f32 v[58:59], v[58:59], v[194:195]
  v_lshlrev_b32 v192, 16, v226
  v_and_b32 v193, 0xffff0000, v226
  v_lshlrev_b32 v194, 16, v227
  v_and_b32 v195, 0xffff0000, v227
  v_pk_add_f32 v[60:61], v[60:61], v[198:199] op_sel_hi:[1,0]
  v_pk_add_f32 v[62:63], v[62:63], v[198:199] op_sel_hi:[1,0]
  v_pk_mul_f32 v[192:193], v[192:193], v[196:197] op_sel_hi:[1,0]
  v_pk_mul_f32 v[194:195], v[194:195], v[196:197] op_sel_hi:[1,0]
  v_pk_mul_f32 v[60:61], v[60:61], v[192:193]
  v_pk_mul_f32 v[62:63], v[62:63], v[194:195]
  v_lshlrev_b32 v192, 16, v228
  v_and_b32 v193, 0xffff0000, v228
  v_lshlrev_b32 v194, 16, v229
  v_and_b32 v195, 0xffff0000, v229
  v_pk_add_f32 v[64:65], v[64:65], v[198:199] op_sel_hi:[1,0]
  v_pk_add_f32 v[66:67], v[66:67], v[198:199] op_sel_hi:[1,0]
  v_pk_mul_f32 v[192:193], v[192:193], v[196:197] op_sel_hi:[1,0]
  v_pk_mul_f32 v[194:195], v[194:195], v[196:197] op_sel_hi:[1,0]
  v_pk_mul_f32 v[64:65], v[64:65], v[192:193]
  v_pk_mul_f32 v[66:67], v[66:67], v[194:195]
  v_lshlrev_b32 v192, 16, v230
  v_and_b32 v193, 0xffff0000, v230
  v_lshlrev_b32 v194, 16, v231
  v_and_b32 v195, 0xffff0000, v231
  v_pk_add_f32 v[68:69], v[68:69], v[198:199] op_sel_hi:[1,0]
  v_pk_add_f32 v[70:71], v[70:71], v[198:199] op_sel_hi:[1,0]
  v_pk_mul_f32 v[192:193], v[192:193], v[196:197] op_sel_hi:[1,0]
  v_pk_mul_f32 v[194:195], v[194:195], v[196:197] op_sel_hi:[1,0]
  v_pk_mul_f32 v[68:69], v[68:69], v[192:193]
  v_pk_mul_f32 v[70:71], v[70:71], v[194:195]
  v_cvt_pk_bf16_f32 v176, v56, v57
  v_cvt_pk_bf16_f32 v177, v58, v59
  v_cvt_pk_bf16_f32 v178, v60, v61
  v_cvt_pk_bf16_f32 v179, v62, v63
  v_cvt_pk_bf16_f32 v180, v64, v65
  v_cvt_pk_bf16_f32 v181, v66, v67
  v_cvt_pk_bf16_f32 v182, v68, v69
  v_cvt_pk_bf16_f32 v183, v70, v71
  v_permlane16_swap_b32 v176, v178
  v_permlane16_swap_b32 v177, v179
  v_permlane16_swap_b32 v180, v182
  v_permlane16_swap_b32 v181, v183
  buffer_store_dwordx4 v[168:171], v184, s[8:11], 0 offen sc1
  buffer_store_dwordx4 v[172:175], v185, s[8:11], 0 offen sc1
  buffer_store_dwordx4 v[176:179], v186, s[8:11], 0 offen sc1
  buffer_store_dwordx4 v[180:183], v187, s[8:11], 0 offen sc1
  s_waitcnt vmcnt(13)
  s_barrier
  ds_read_b128 v[120:123], v30 offset:0
  ds_read_b64_tr_b16 v[136:137], v36 offset:0
  ds_read_b64_tr_b16 v[138:139], v36 offset:512
  ds_read_b64_tr_b16 v[140:141], v37 offset:0
  ds_read_b64_tr_b16 v[142:143], v37 offset:512
  ds_read_b128 v[124:127], v30 offset:256
  s_waitcnt lgkmcnt(0)
  v_mfma_f32_16x16x32_bf16 v[104:107], v[136:139], v[120:123], 0
  ds_read_b128 v[128:131], v31 offset:0
  ds_read_b64_tr_b16 v[144:145], v36 offset:4096
  v_mfma_f32_16x16x32_bf16 v[108:111], v[140:143], v[120:123], 0
  ds_read_b64_tr_b16 v[146:147], v36 offset:4608
  v_mfma_f32_16x16x32_bf16 v[116:119], v[140:143], v[124:127], 0
  ds_read_b64_tr_b16 v[148:149], v37 offset:4096
  ds_read_b64_tr_b16 v[150:151], v37 offset:4608
  v_mfma_f32_16x16x32_bf16 v[112:115], v[136:139], v[124:127], 0
  ds_read_b128 v[132:135], v31 offset:256
  s_waitcnt vmcnt(10) lgkmcnt(0)
  s_barrier
  v_mfma_f32_16x16x32_bf16 v[104:107], v[144:147], v[128:131], v[104:107]
  ds_read_b128 v[120:123], v30 offset:16384
  ds_read_b64_tr_b16 v[136:137], v36 offset:8192
  v_mfma_f32_16x16x32_bf16 v[108:111], v[148:151], v[128:131], v[108:111]
  ds_read_b64_tr_b16 v[138:139], v36 offset:8704
  s_add_u32 m0, s32, 0
  s_nop 0
  buffer_load_dwordx4 v18, s[20:23], s92 offen lds
  v_mfma_f32_16x16x32_bf16 v[116:119], v[148:151], v[132:135], v[116:119]
  ds_read_b64_tr_b16 v[140:141], v37 offset:8192
  ds_read_b64_tr_b16 v[142:143], v37 offset:8704
  v_mfma_f32_16x16x32_bf16 v[112:115], v[144:147], v[132:135], v[112:115]
  ds_read_b128 v[124:127], v30 offset:16640
  buffer_load_dwordx4 v18, s[20:23], s92 offen offset:1024 lds
  s_add_u32 s92, s92, 16384
  s_waitcnt lgkmcnt(0)
  v_mfma_f32_16x16x32_bf16 v[104:107], v[136:139], v[120:123], v[104:107]
  ds_read_b128 v[128:131], v31 offset:16384
  ds_read_b64_tr_b16 v[144:145], v36 offset:12288
  v_mfma_f32_16x16x32_bf16 v[108:111], v[140:143], v[120:123], v[108:111]
  ds_read_b64_tr_b16 v[146:147], v36 offset:12800
  v_mfma_f32_16x16x32_bf16 v[116:119], v[140:143], v[124:127], v[116:119]
  ds_read_b64_tr_b16 v[148:149], v37 offset:12288
  ds_read_b64_tr_b16 v[150:151], v37 offset:12800
  s_add_u32 m0, s36, 0
  s_nop 0
  buffer_load_dwordx4 v19, s[24:27], s37 offen lds
  s_add_u32 s37, s37, 131072
  v_mfma_f32_16x16x32_bf16 v[112:115], v[136:139], v[124:127], v[112:115]
  ds_read_b128 v[132:135], v31 offset:16640
  s_waitcnt vmcnt(10) lgkmcnt(0)
  s_barrier
  v_mfma_f32_16x16x32_bf16 v[104:107], v[144:147], v[128:131], v[104:107]
  ds_read_b128 v[120:123], v30 offset:32768
  ds_read_b64_tr_b16 v[136:137], v36 offset:16384
  v_mfma_f32_16x16x32_bf16 v[108:111], v[148:151], v[128:131], v[108:111]
  ds_read_b64_tr_b16 v[138:139], v36 offset:16896
  s_add_u32 m0, s32, 16384
  s_nop 0
  buffer_load_dwordx4 v18, s[20:23], s92 offen lds
  v_mfma_f32_16x16x32_bf16 v[116:119], v[148:151], v[132:135], v[116:119]
  ds_read_b64_tr_b16 v[140:141], v37 offset:16384
  ds_read_b64_tr_b16 v[142:143], v37 offset:16896
  v_mfma_f32_16x16x32_bf16 v[112:115], v[144:147], v[132:135], v[112:115]
  ds_read_b128 v[124:127], v30 offset:33024
  buffer_load_dwordx4 v18, s[20:23], s92 offen offset:1024 lds
  s_add_u32 s92, s92, 16384
  s_waitcnt lgkmcnt(0)
  v_mfma_f32_16x16x32_bf16 v[104:107], v[136:139], v[120:123], v[104:107]
  ds_read_b128 v[128:131], v31 offset:32768
  ds_read_b64_tr_b16 v[144:145], v36 offset:20480
  v_mfma_f32_16x16x32_bf16 v[108:111], v[140:143], v[120:123], v[108:111]
  ds_read_b64_tr_b16 v[146:147], v36 offset:20992
  v_mfma_f32_16x16x32_bf16 v[116:119], v[140:143], v[124:127], v[116:119]
  ds_read_b64_tr_b16 v[148:149], v37 offset:20480
  ds_read_b64_tr_b16 v[150:151], v37 offset:20992
  s_add_u32 m0, s36, 8192
  s_nop 0
  buffer_load_dwordx4 v19, s[24:27], s37 offen lds
  s_add_u32 s37, s37, 131072
  v_mfma_f32_16x16x32_bf16 v[112:115], v[136:139], v[124:127], v[112:115]
  ds_read_b128 v[132:135], v31 offset:33024
  s_waitcnt vmcnt(6)
  s_waitcnt vmcnt(10) lgkmcnt(0)
  s_barrier
  s_cmp_lg_u32 s3, 0
  s_cbranch_scc1 ow_78
  v_mov_b32 v8, 1
  v_mov_b32 v9, 0
  s_mov_b64 exec, 1
  buffer_store_dword v8, v9, s[8:11], s76 offen sc1
  s_mov_b64 exec, -1
ow_78:
  v_mfma_f32_16x16x32_bf16 v[104:107], v[144:147], v[128:131], v[104:107]
  ds_read_b128 v[120:123], v30 offset:49152
  ds_read_b64_tr_b16 v[136:137], v36 offset:24576
  v_mfma_f32_16x16x32_bf16 v[108:111], v[148:151], v[128:131], v[108:111]
  ds_read_b64_tr_b16 v[138:139], v36 offset:25088
  s_add_u32 m0, s32, 32768
  s_nop 0
  buffer_load_dwordx4 v18, s[20:23], s92 offen lds
  v_mfma_f32_16x16x32_bf16 v[116:119], v[148:151], v[132:135], v[116:119]
  ds_read_b64_tr_b16 v[140:141], v37 offset:24576
  ds_read_b64_tr_b16 v[142:143], v37 offset:25088
  v_mfma_f32_16x16x32_bf16 v[112:115], v[144:147], v[132:135], v[112:115]
  ds_read_b128 v[124:127], v30 offset:49408
  buffer_load_dwordx4 v18, s[20:23], s92 offen offset:1024 lds
  s_add_u32 s92, s92, 16384
  s_waitcnt lgkmcnt(0)
  v_mfma_f32_16x16x32_bf16 v[104:107], v[136:139], v[120:123], v[104:107]
  ds_read_b128 v[128:131], v31 offset:49152
  ds_read_b64_tr_b16 v[144:145], v36 offset:28672
  v_mfma_f32_16x16x32_bf16 v[108:111], v[140:143], v[120:123], v[108:111]
  ds_read_b64_tr_b16 v[146:147], v36 offset:29184
  v_mfma_f32_16x16x32_bf16 v[116:119], v[140:143], v[124:127], v[116:119]
  ds_read_b64_tr_b16 v[148:149], v37 offset:28672
  ds_read_b64_tr_b16 v[150:151], v37 offset:29184
  s_add_u32 m0, s36, 16384
  s_nop 0
  buffer_load_dwordx4 v19, s[24:27], s37 offen lds
  s_add_u32 s37, s37, 131072
  v_mfma_f32_16x16x32_bf16 v[112:115], v[136:139], v[124:127], v[112:115]
  ds_read_b128 v[132:135], v31 offset:49408
  s_waitcnt vmcnt(6) lgkmcnt(0)
  s_barrier
  v_mfma_f32_16x16x32_bf16 v[104:107], v[144:147], v[128:131], v[104:107]
  ds_read_b128 v[120:123], v30 offset:0
  ds_read_b64_tr_b16 v[136:137], v36 offset:0
  v_mfma_f32_16x16x32_bf16 v[108:111], v[148:151], v[128:131], v[108:111]
  ds_read_b64_tr_b16 v[138:139], v36 offset:512
  s_add_u32 m0, s32, 49152
  s_nop 0
  buffer_load_dwordx4 v18, s[20:23], s92 offen lds
  v_mfma_f32_16x16x32_bf16 v[116:119], v[148:151], v[132:135], v[116:119]
  ds_read_b64_tr_b16 v[140:141], v37 offset:0
  ds_read_b64_tr_b16 v[142:143], v37 offset:512
  v_mfma_f32_16x16x32_bf16 v[112:115], v[144:147], v[132:135], v[112:115]
  ds_read_b128 v[124:127], v30 offset:256
  buffer_load_dwordx4 v18, s[20:23], s92 offen offset:1024 lds
  s_add_u32 s92, s92, 16384
  s_waitcnt lgkmcnt(0)
  v_mfma_f32_16x16x32_bf16 v[104:107], v[136:139], v[120:123], v[104:107]
  ds_read_b128 v[128:131], v31 offset:0
  ds_read_b64_tr_b16 v[144:145], v36 offset:4096
  v_mfma_f32_16x16x32_bf16 v[108:111], v[140:143], v[120:123], v[108:111]
  ds_read_b64_tr_b16 v[146:147], v36 offset:4608
  v_mfma_f32_16x16x32_bf16 v[116:119], v[140:143], v[124:127], v[116:119]
  ds_read_b64_tr_b16 v[148:149], v37 offset:4096
  ds_read_b64_tr_b16 v[150:151], v37 offset:4608
  s_add_u32 m0, s36, 24576
  s_nop 0
  buffer_load_dwordx4 v19, s[24:27], s37 offen lds
  s_add_u32 s37, s37, 131072
  v_mfma_f32_16x16x32_bf16 v[112:115], v[136:139], v[124:127], v[112:115]
  ds_read_b128 v[132:135], v31 offset:256
  s_waitcnt vmcnt(6) lgkmcnt(0)
  s_barrier
  v_mfma_f32_16x16x32_bf16 v[104:107], v[144:147], v[128:131], v[104:107]
  ds_read_b128 v[120:123], v30 offset:16384
  ds_read_b64_tr_b16 v[136:137], v36 offset:8192
  v_mfma_f32_16x16x32_bf16 v[108:111], v[148:151], v[128:131], v[108:111]
  ds_read_b64_tr_b16 v[138:139], v36 offset:8704
  s_add_u32 m0, s32, 0
  s_nop 0
  buffer_load_dwordx4 v18, s[20:23], s92 offen lds
  v_mfma_f32_16x16x32_bf16 v[116:119], v[148:151], v[132:135], v[116:119]
  ds_read_b64_tr_b16 v[140:141], v37 offset:8192
  ds_read_b64_tr_b16 v[142:143], v37 offset:8704
  v_mfma_f32_16x16x32_bf16 v[112:115], v[144:147], v[132:135], v[112:115]
  ds_read_b128 v[124:127], v30 offset:16640
  buffer_load_dwordx4 v18, s[20:23], s92 offen offset:1024 lds
  s_add_u32 s92, s92, 16384
  s_waitcnt lgkmcnt(0)
  v_mfma_f32_16x16x32_bf16 v[104:107], v[136:139], v[120:123], v[104:107]
  ds_read_b128 v[128:131], v31 offset:16384
  ds_read_b64_tr_b16 v[144:145], v36 offset:12288
  v_mfma_f32_16x16x32_bf16 v[108:111], v[140:143], v[120:123], v[108:111]
  ds_read_b64_tr_b16 v[146:147], v36 offset:12800
  v_mfma_f32_16x16x32_bf16 v[116:119], v[140:143], v[124:127], v[116:119]
  ds_read_b64_tr_b16 v[148:149], v37 offset:12288
  ds_read_b64_tr_b16 v[150:151], v37 offset:12800
  s_add_u32 m0, s36, 0
  s_nop 0
  buffer_load_dwordx4 v19, s[24:27], s37 offen lds
  s_add_u32 s37, s37, 131072
  v_mfma_f32_16x16x32_bf16 v[112:115], v[136:139], v[124:127], v[112:115]
  ds_read_b128 v[132:135], v31 offset:16640
  s_waitcnt vmcnt(6) lgkmcnt(0)
  s_barrier
  v_mfma_f32_16x16x32_bf16 v[104:107], v[144:147], v[128:131], v[104:107]
  ds_read_b128 v[120:123], v30 offset:32768
  ds_read_b64_tr_b16 v[136:137], v36 offset:16384
  v_mfma_f32_16x16x32_bf16 v[108:111], v[148:151], v[128:131], v[108:111]
  ds_read_b64_tr_b16 v[138:139], v36 offset:16896
  s_add_u32 m0, s32, 16384
  s_nop 0
  buffer_load_dwordx4 v18, s[20:23], s92 offen lds
  v_mfma_f32_16x16x32_bf16 v[116:119], v[148:151], v[132:135], v[116:119]
  ds_read_b64_tr_b16 v[140:141], v37 offset:16384
  ds_read_b64_tr_b16 v[142:143], v37 offset:16896
  v_mfma_f32_16x16x32_bf16 v[112:115], v[144:147], v[132:135], v[112:115]
  ds_read_b128 v[124:127], v30 offset:33024
  buffer_load_dwordx4 v18, s[20:23], s92 offen offset:1024 lds
  s_add_u32 s92, s92, 16384
  s_waitcnt lgkmcnt(0)
  v_mfma_f32_16x16x32_bf16 v[104:107], v[136:139], v[120:123], v[104:107]
  ds_read_b128 v[128:131], v31 offset:32768
  ds_read_b64_tr_b16 v[144:145], v36 offset:20480
  v_mfma_f32_16x16x32_bf16 v[108:111], v[140:143], v[120:123], v[108:111]
  ds_read_b64_tr_b16 v[146:147], v36 offset:20992
  v_mfma_f32_16x16x32_bf16 v[116:119], v[140:143], v[124:127], v[116:119]
  ds_read_b64_tr_b16 v[148:149], v37 offset:20480
  ds_read_b64_tr_b16 v[150:151], v37 offset:20992
  s_add_u32 m0, s36, 8192
  s_nop 0
  buffer_load_dwordx4 v19, s[24:27], s37 offen lds
  s_add_u32 s37, s37, 131072
  v_mfma_f32_16x16x32_bf16 v[112:115], v[136:139], v[124:127], v[112:115]
  ds_read_b128 v[132:135], v31 offset:33024
  s_waitcnt vmcnt(6) lgkmcnt(0)
  s_barrier
  v_mfma_f32_16x16x32_bf16 v[104:107], v[144:147], v[128:131], v[104:107]
  ds_read_b128 v[120:123], v30 offset:49152
  ds_read_b64_tr_b16 v[136:137], v36 offset:24576
  v_mfma_f32_16x16x32_bf16 v[108:111], v[148:151], v[128:131], v[108:111]
  ds_read_b64_tr_b16 v[138:139], v36 offset:25088
  s_add_u32 m0, s32, 32768
  s_nop 0
  buffer_load_dwordx4 v18, s[20:23], s92 offen lds
  v_mfma_f32_16x16x32_bf16 v[116:119], v[148:151], v[132:135], v[116:119]
  ds_read_b64_tr_b16 v[140:141], v37 offset:24576
  ds_read_b64_tr_b16 v[142:143], v37 offset:25088
  v_mfma_f32_16x16x32_bf16 v[112:115], v[144:147], v[132:135], v[112:115]
  ds_read_b128 v[124:127], v30 offset:49408
  buffer_load_dwordx4 v18, s[20:23], s92 offen offset:1024 lds
  s_add_u32 s92, s92, 16384
  s_waitcnt lgkmcnt(0)
  v_mfma_f32_16x16x32_bf16 v[104:107], v[136:139], v[120:123], v[104:107]
  ds_read_b128 v[128:131], v31 offset:49152
  ds_read_b64_tr_b16 v[144:145], v36 offset:28672
  v_mfma_f32_16x16x32_bf16 v[108:111], v[140:143], v[120:123], v[108:111]
  ds_read_b64_tr_b16 v[146:147], v36 offset:29184
  v_mfma_f32_16x16x32_bf16 v[116:119], v[140:143], v[124:127], v[116:119]
  ds_read_b64_tr_b16 v[148:149], v37 offset:28672
  ds_read_b64_tr_b16 v[150:151], v37 offset:29184
  s_add_u32 m0, s36, 16384
  s_nop 0
  buffer_load_dwordx4 v19, s[24:27], s37 offen lds
  s_add_u32 s37, s37, 131072
  v_mfma_f32_16x16x32_bf16 v[112:115], v[136:139], v[124:127], v[112:115]
  ds_read_b128 v[132:135], v31 offset:49408
  s_waitcnt vmcnt(6) lgkmcnt(0)
  s_barrier
  v_mfma_f32_16x16x32_bf16 v[104:107], v[144:147], v[128:131], v[104:107]
  ds_read_b128 v[120:123], v30 offset:0
  ds_read_b64_tr_b16 v[136:137], v36 offset:0
  v_mfma_f32_16x16x32_bf16 v[108:111], v[148:151], v[128:131], v[108:111]
  ds_read_b64_tr_b16 v[138:139], v36 offset:512
  s_add_u32 m0, s32, 49152
  s_nop 0
  buffer_load_dwordx4 v18, s[20:23], s92 offen lds
  v_mfma_f32_16x16x32_bf16 v[116:119], v[148:151], v[132:135], v[116:119]
  ds_read_b64_tr_b16 v[140:141], v37 offset:0
  ds_read_b64_tr_b16 v[142:143], v37 offset:512
  v_mfma_f32_16x16x32_bf16 v[112:115], v[144:147], v[132:135], v[112:115]
  ds_read_b128 v[124:127], v30 offset:256
  buffer_load_dwordx4 v18, s[20:23], s92 offen offset:1024 lds
  s_add_u32 s92, s92, 16384
  s_waitcnt lgkmcnt(0)
  v_mfma_f32_16x16x32_bf16 v[104:107], v[136:139], v[120:123], v[104:107]
  ds_read_b128 v[128:131], v31 offset:0
  ds_read_b64_tr_b16 v[144:145], v36 offset:4096
  v_mfma_f32_16x16x32_bf16 v[108:111], v[140:143], v[120:123], v[108:111]
  ds_read_b64_tr_b16 v[146:147], v36 offset:4608
  v_mfma_f32_16x16x32_bf16 v[116:119], v[140:143], v[124:127], v[116:119]
  ds_read_b64_tr_b16 v[148:149], v37 offset:4096
  ds_read_b64_tr_b16 v[150:151], v37 offset:4608
  s_add_u32 m0, s36, 24576
  s_nop 0
  buffer_load_dwordx4 v19, s[24:27], s37 offen lds
  s_add_u32 s37, s37, 131072
  v_mfma_f32_16x16x32_bf16 v[112:115], v[136:139], v[124:127], v[112:115]
  ds_read_b128 v[132:135], v31 offset:256
  s_waitcnt vmcnt(6) lgkmcnt(0)
  s_barrier
  v_mfma_f32_16x16x32_bf16 v[104:107], v[144:147], v[128:131], v[104:107]
  ds_read_b128 v[120:123], v30 offset:16384
  ds_read_b64_tr_b16 v[136:137], v36 offset:8192
  v_mfma_f32_16x16x32_bf16 v[108:111], v[148:151], v[128:131], v[108:111]
  ds_read_b64_tr_b16 v[138:139], v36 offset:8704
  s_add_u32 m0, s32, 0
  s_nop 0
  buffer_load_dwordx4 v18, s[20:23], s92 offen lds
  v_mfma_f32_16x16x32_bf16 v[116:119], v[148:151], v[132:135], v[116:119]
  ds_read_b64_tr_b16 v[140:141], v37 offset:8192
  ds_read_b64_tr_b16 v[142:143], v37 offset:8704
  v_mfma_f32_16x16x32_bf16 v[112:115], v[144:147], v[132:135], v[112:115]
  ds_read_b128 v[124:127], v30 offset:16640
  buffer_load_dwordx4 v18, s[20:23], s92 offen offset:1024 lds
  s_add_u32 s92, s92, 16384
  s_waitcnt lgkmcnt(0)
  v_mfma_f32_16x16x32_bf16 v[104:107], v[136:139], v[120:123], v[104:107]
  ds_read_b128 v[128:131], v31 offset:16384
  ds_read_b64_tr_b16 v[144:145], v36 offset:12288
  v_mfma_f32_16x16x32_bf16 v[108:111], v[140:143], v[120:123], v[108:111]
  ds_read_b64_tr_b16 v[146:147], v36 offset:12800
  v_mfma_f32_16x16x32_bf16 v[116:119], v[140:143], v[124:127], v[116:119]
  ds_read_b64_tr_b16 v[148:149], v37 offset:12288
  ds_read_b64_tr_b16 v[150:151], v37 offset:12800
  s_add_u32 m0, s36, 0
  s_nop 0
  buffer_load_dwordx4 v19, s[24:27], s37 offen lds
  s_add_u32 s37, s37, 131072
  v_mfma_f32_16x16x32_bf16 v[112:115], v[136:139], v[124:127], v[112:115]
  ds_read_b128 v[132:135], v31 offset:16640
  s_waitcnt vmcnt(6) lgkmcnt(0)
  s_barrier
  v_mfma_f32_16x16x32_bf16 v[104:107], v[144:147], v[128:131], v[104:107]
  ds_read_b128 v[120:123], v30 offset:32768
  ds_read_b64_tr_b16 v[136:137], v36 offset:16384
  v_mfma_f32_16x16x32_bf16 v[108:111], v[148:151], v[128:131], v[108:111]
  ds_read_b64_tr_b16 v[138:139], v36 offset:16896
  s_add_u32 m0, s32, 16384
  s_nop 0
  buffer_load_dwordx4 v18, s[20:23], s92 offen lds
  v_mfma_f32_16x16x32_bf16 v[116:119], v[148:151], v[132:135], v[116:119]
  ds_read_b64_tr_b16 v[140:141], v37 offset:16384
  ds_read_b64_tr_b16 v[142:143], v37 offset:16896
  v_mfma_f32_16x16x32_bf16 v[112:115], v[144:147], v[132:135], v[112:115]
  ds_read_b128 v[124:127], v30 offset:33024
  buffer_load_dwordx4 v18, s[20:23], s92 offen offset:1024 lds
  s_add_u32 s92, s92, 16384
  s_waitcnt lgkmcnt(0)
  v_mfma_f32_16x16x32_bf16 v[104:107], v[136:139], v[120:123], v[104:107]
  ds_read_b128 v[128:131], v31 offset:32768
  ds_read_b64_tr_b16 v[144:145], v36 offset:20480
  v_mfma_f32_16x16x32_bf16 v[108:111], v[140:143], v[120:123], v[108:111]
  ds_read_b64_tr_b16 v[146:147], v36 offset:20992
  v_mfma_f32_16x16x32_bf16 v[116:119], v[140:143], v[124:127], v[116:119]
  ds_read_b64_tr_b16 v[148:149], v37 offset:20480
  ds_read_b64_tr_b16 v[150:151], v37 offset:20992
  s_add_u32 m0, s36, 8192
  s_nop 0
  buffer_load_dwordx4 v19, s[24:27], s37 offen lds
  s_add_u32 s37, s37, 131072
  v_mfma_f32_16x16x32_bf16 v[112:115], v[136:139], v[124:127], v[112:115]
  ds_read_b128 v[132:135], v31 offset:33024
  s_waitcnt vmcnt(6) lgkmcnt(0)
  s_barrier
  s_cmp_lg_u32 s3, 0
  s_cbranch_scc1 ow_79
  buffer_load_dword v12, v13, s[8:11], 0 offen sc1
ow_79:
  v_mfma_f32_16x16x32_bf16 v[104:107], v[144:147], v[128:131], v[104:107]
  ds_read_b128 v[120:123], v30 offset:49152
  ds_read_b64_tr_b16 v[136:137], v36 offset:24576
  v_mfma_f32_16x16x32_bf16 v[108:111], v[148:151], v[128:131], v[108:111]
  ds_read_b64_tr_b16 v[138:139], v36 offset:25088
  s_add_u32 m0, s32, 32768
  s_nop 0
  buffer_load_dwordx4 v18, s[20:23], s92 offen lds
  v_mfma_f32_16x16x32_bf16 v[116:119], v[148:151], v[132:135], v[116:119]
  ds_read_b64_tr_b16 v[140:141], v37 offset:24576
  ds_read_b64_tr_b16 v[142:143], v37 offset:25088
  v_mfma_f32_16x16x32_bf16 v[112:115], v[144:147], v[132:135], v[112:115]
  ds_read_b128 v[124:127], v30 offset:49408
  buffer_load_dwordx4 v18, s[20:23], s92 offen offset:1024 lds
  s_add_u32 s92, s92, 16384
  s_waitcnt lgkmcnt(0)
  v_mfma_f32_16x16x32_bf16 v[104:107], v[136:139], v[120:123], v[104:107]
  ds_read_b128 v[128:131], v31 offset:49152
  ds_read_b64_tr_b16 v[144:145], v36 offset:28672
  v_mfma_f32_16x16x32_bf16 v[108:111], v[140:143], v[120:123], v[108:111]
  ds_read_b64_tr_b16 v[146:147], v36 offset:29184
  v_mfma_f32_16x16x32_bf16 v[116:119], v[140:143], v[124:127], v[116:119]
  ds_read_b64_tr_b16 v[148:149], v37 offset:28672
  ds_read_b64_tr_b16 v[150:151], v37 offset:29184
  s_add_u32 m0, s36, 16384
  s_nop 0
  buffer_load_dwordx4 v19, s[24:27], s37 offen lds
  s_add_u32 s37, s37, 131072
  v_mfma_f32_16x16x32_bf16 v[112:115], v[136:139], v[124:127], v[112:115]
  ds_read_b128 v[132:135], v31 offset:49408
  s_waitcnt vmcnt(6) lgkmcnt(0)
  s_barrier
  v_mfma_f32_16x16x32_bf16 v[104:107], v[144:147], v[128:131], v[104:107]
  ds_read_b128 v[120:123], v30 offset:0
  ds_read_b64_tr_b16 v[136:137], v36 offset:0
  v_mfma_f32_16x16x32_bf16 v[108:111], v[148:151], v[128:131], v[108:111]
  ds_read_b64_tr_b16 v[138:139], v36 offset:512
  s_add_u32 m0, s32, 49152
  s_nop 0
  buffer_load_dwordx4 v18, s[20:23], s92 offen lds
  v_mfma_f32_16x16x32_bf16 v[116:119], v[148:151], v[132:135], v[116:119]
  ds_read_b64_tr_b16 v[140:141], v37 offset:0
  ds_read_b64_tr_b16 v[142:143], v37 offset:512
  v_mfma_f32_16x16x32_bf16 v[112:115], v[144:147], v[132:135], v[112:115]
  ds_read_b128 v[124:127], v30 offset:256
  buffer_load_dwordx4 v18, s[20:23], s92 offen offset:1024 lds
  s_add_u32 s92, s92, 16384
  s_waitcnt lgkmcnt(0)
  v_mfma_f32_16x16x32_bf16 v[104:107], v[136:139], v[120:123], v[104:107]
  ds_read_b128 v[128:131], v31 offset:0
  ds_read_b64_tr_b16 v[144:145], v36 offset:4096
  v_mfma_f32_16x16x32_bf16 v[108:111], v[140:143], v[120:123], v[108:111]
  ds_read_b64_tr_b16 v[146:147], v36 offset:4608
  v_mfma_f32_16x16x32_bf16 v[116:119], v[140:143], v[124:127], v[116:119]
  ds_read_b64_tr_b16 v[148:149], v37 offset:4096
  ds_read_b64_tr_b16 v[150:151], v37 offset:4608
  s_add_u32 m0, s36, 24576
  s_nop 0
  buffer_load_dwordx4 v19, s[24:27], s37 offen lds
  s_add_u32 s37, s37, 131072
  v_mfma_f32_16x16x32_bf16 v[112:115], v[136:139], v[124:127], v[112:115]
  ds_read_b128 v[132:135], v31 offset:256
  s_cmp_lg_u32 s3, 0
  s_cbranch_scc1 ow_80
  s_waitcnt vmcnt(6)
  v_cmp_ne_u32 vcc, 0, v12
  s_nop 0
  s_cmp_eq_u64 vcc, -1
  s_cbranch_scc1 pok_81
  s_mov_b32 s75, 400000
psp_82:
  buffer_load_dword v12, v13, s[8:11], 0 offen sc1
  s_waitcnt vmcnt(0)
  v_cmp_ne_u32 vcc, 0, v12
  s_nop 0
  s_cmp_eq_u64 vcc, -1
  s_cbranch_scc1 pok_81
  s_sub_u32 s75, s75, 1
  s_cmp_lg_u32 s75, 0
  s_cbranch_scc1 psp_82
pok_81:
ow_80:
  s_waitcnt vmcnt(6) lgkmcnt(0)
  s_barrier
  s_mov_b32 s24, s64
  s_and_b32 s25, s65, 0xffff
  s_mov_b32 s26, 3670016
  s_mov_b32 s27, 0x20000
  s_mul_i32 s37, s3, 16384
  s_add_u32 s37, s37, s78
  v_mfma_f32_16x16x32_bf16 v[104:107], v[144:147], v[128:131], v[104:107]
  ds_read_b128 v[120:123], v30 offset:16384
  ds_read_b64_tr_b16 v[136:137], v36 offset:8192
  v_mfma_f32_16x16x32_bf16 v[108:111], v[148:151], v[128:131], v[108:111]
  ds_read_b64_tr_b16 v[138:139], v36 offset:8704
  s_add_u32 m0, s32, 0
  s_nop 0
  buffer_load_dwordx4 v18, s[20:23], s92 offen lds
  v_mfma_f32_16x16x32_bf16 v[116:119], v[148:151], v[132:135], v[116:119]
  ds_read_b64_tr_b16 v[140:141], v37 offset:8192
  ds_read_b64_tr_b16 v[142:143], v37 offset:8704
  v_mfma_f32_16x16x32_bf16 v[112:115], v[144:147], v[132:135], v[112:115]
  ds_read_b128 v[124:127], v30 offset:16640
  buffer_load_dwordx4 v18, s[20:23], s92 offen offset:1024 lds
  s_add_u32 s92, s92, 16384
  s_mov_b32 s7, 6
  .p2align 3
t5_loop_83:
  s_waitcnt lgkmcnt(0)
  v_mfma_f32_16x16x32_bf16 v[104:107], v[136:139], v[120:123], v[104:107]
  ds_read_b128 v[128:131], v31 offset:16384
  ds_read_b64_tr_b16 v[144:145], v36 offset:12288
  v_mfma_f32_16x16x32_bf16 v[108:111], v[140:143], v[120:123], v[108:111]
  ds_read_b64_tr_b16 v[146:147], v36 offset:12800
  v_mfma_f32_16x16x32_bf16 v[116:119], v[140:143], v[124:127], v[116:119]
  ds_read_b64_tr_b16 v[148:149], v37 offset:12288
  ds_read_b64_tr_b16 v[150:151], v37 offset:12800
  s_add_u32 m0, s36, 0
  s_nop 0
  buffer_load_dwordx4 v19, s[24:27], s37 offen lds
  s_add_u32 s37, s37, 131072
  v_mfma_f32_16x16x32_bf16 v[112:115], v[136:139], v[124:127], v[112:115]
  ds_read_b128 v[132:135], v31 offset:16640
  s_waitcnt vmcnt(6) lgkmcnt(0)
  s_barrier
  v_mfma_f32_16x16x32_bf16 v[104:107], v[144:147], v[128:131], v[104:107]
  ds_read_b128 v[120:123], v30 offset:32768
  ds_read_b64_tr_b16 v[136:137], v36 offset:16384
  v_mfma_f32_16x16x32_bf16 v[108:111], v[148:151], v[128:131], v[108:111]
  ds_read_b64_tr_b16 v[138:139], v36 offset:16896
  s_add_u32 m0, s32, 16384
  s_nop 0
  buffer_load_dwordx4 v18, s[20:23], s92 offen lds
  v_mfma_f32_16x16x32_bf16 v[116:119], v[148:151], v[132:135], v[116:119]
  ds_read_b64_tr_b16 v[140:141], v37 offset:16384
  ds_read_b64_tr_b16 v[142:143], v37 offset:16896
  v_mfma_f32_16x16x32_bf16 v[112:115], v[144:147], v[132:135], v[112:115]
  ds_read_b128 v[124:127], v30 offset:33024
  buffer_load_dwordx4 v18, s[20:23], s92 offen offset:1024 lds
  s_add_u32 s92, s92, 16384
  s_waitcnt lgkmcnt(0)
  v_mfma_f32_16x16x32_bf16 v[104:107], v[136:139], v[120:123], v[104:107]
  ds_read_b128 v[128:131], v31 offset:32768
  ds_read_b64_tr_b16 v[144:145], v36 offset:20480
  v_mfma_f32_16x16x32_bf16 v[108:111], v[140:143], v[120:123], v[108:111]
  ds_read_b64_tr_b16 v[146:147], v36 offset:20992
  v_mfma_f32_16x16x32_bf16 v[116:119], v[140:143], v[124:127], v[116:119]
  ds_read_b64_tr_b16 v[148:149], v37 offset:20480
  ds_read_b64_tr_b16 v[150:151], v37 offset:20992
  s_add_u32 m0, s36, 8192
  s_nop 0
  buffer_load_dwordx4 v19, s[24:27], s37 offen lds
  s_add_u32 s37, s37, 131072
  v_mfma_f32_16x16x32_bf16 v[112:115], v[136:139], v[124:127], v[112:115]
  ds_read_b128 v[132:135], v31 offset:33024
  s_waitcnt vmcnt(6) lgkmcnt(0)
  s_barrier
  v_mfma_f32_16x16x32_bf16 v[104:107], v[144:147], v[128:131], v[104:107]
  ds_read_b128 v[120:123], v30 offset:49152
  ds_read_b64_tr_b16 v[136:137], v36 offset:24576
  v_mfma_f32_16x16x32_bf16 v[108:111], v[148:151], v[128:131], v[108:111]
  ds_read_b64_tr_b16 v[138:139], v36 offset:25088
  s_add_u32 m0, s32, 32768
  s_nop 0
  buffer_load_dwordx4 v18, s[20:23], s92 offen lds
  v_mfma_f32_16x16x32_bf16 v[116:119], v[148:151], v[132:135], v[116:119]
  ds_read_b64_tr_b16 v[140:141], v37 offset:24576
  ds_read_b64_tr_b16 v[142:143], v37 offset:25088
  v_mfma_f32_16x16x32_bf16 v[112:115], v[144:147], v[132:135], v[112:115]
  ds_read_b128 v[124:127], v30 offset:49408
  buffer_load_dwordx4 v18, s[20:23], s92 offen offset:1024 lds
  s_add_u32 s92, s92, 16384
  s_waitcnt lgkmcnt(0)
  v_mfma_f32_16x16x32_bf16 v[104:107], v[136:139], v[120:123], v[104:107]
  ds_read_b128 v[128:131], v31 offset:49152
  ds_read_b64_tr_b16 v[144:145], v36 offset:28672
  v_mfma_f32_16x16x32_bf16 v[108:111], v[140:143], v[120:123], v[108:111]
  ds_read_b64_tr_b16 v[146:147], v36 offset:29184
  v_mfma_f32_16x16x32_bf16 v[116:119], v[140:143], v[124:127], v[116:119]
  ds_read_b64_tr_b16 v[148:149], v37 offset:28672
  ds_read_b64_tr_b16 v[150:151], v37 offset:29184
  s_add_u32 m0, s36, 16384
  s_nop 0
  buffer_load_dwordx4 v19, s[24:27], s37 offen lds
  s_add_u32 s37, s37, 131072
  v_mfma_f32_16x16x32_bf16 v[112:115], v[136:139], v[124:127], v[112:115]
  ds_read_b128 v[132:135], v31 offset:49408
  s_waitcnt vmcnt(6) lgkmcnt(0)
  s_barrier
  v_mfma_f32_16x16x32_bf16 v[104:107], v[144:147], v[128:131], v[104:107]
  ds_read_b128 v[120:123], v30 offset:0
  ds_read_b64_tr_b16 v[136:137], v36 offset:0
  v_mfma_f32_16x16x32_bf16 v[108:111], v[148:151], v[128:131], v[108:111]
  ds_read_b64_tr_b16 v[138:139], v36 offset:512
  s_add_u32 m0, s32, 49152
  s_nop 0
  buffer_load_dwordx4 v18, s[20:23], s92 offen lds
  v_mfma_f32_16x16x32_bf16 v[116:119], v[148:151], v[132:135], v[116:119]
  ds_read_b64_tr_b16 v[140:141], v37 offset:0
  ds_read_b64_tr_b16 v[142:143], v37 offset:512
  v_mfma_f32_16x16x32_bf16 v[112:115], v[144:147], v[132:135], v[112:115]
  ds_read_b128 v[124:127], v30 offset:256
  buffer_load_dwordx4 v18, s[20:23], s92 offen offset:1024 lds
  s_add_u32 s92, s92, 16384
  s_waitcnt lgkmcnt(0)
  v_mfma_f32_16x16x32_bf16 v[104:107], v[136:139], v[120:123], v[104:107]
  ds_read_b128 v[128:131], v31 offset:0
  ds_read_b64_tr_b16 v[144:145], v36 offset:4096
  v_mfma_f32_16x16x32_bf16 v[108:111], v[140:143], v[120:123], v[108:111]
  ds_read_b64_tr_b16 v[146:147], v36 offset:4608
  v_mfma_f32_16x16x32_bf16 v[116:119], v[140:143], v[124:127], v[116:119]
  ds_read_b64_tr_b16 v[148:149], v37 offset:4096
  ds_read_b64_tr_b16 v[150:151], v37 offset:4608
  s_add_u32 m0, s36, 24576
  s_nop 0
  buffer_load_dwordx4 v19, s[24:27], s37 offen lds
  s_add_u32 s37, s37, 131072
  v_mfma_f32_16x16x32_bf16 v[112:115], v[136:139], v[124:127], v[112:115]
  ds_read_b128 v[132:135], v31 offset:256
  s_waitcnt vmcnt(6) lgkmcnt(0)
  s_barrier
  v_mfma_f32_16x16x32_bf16 v[104:107], v[144:147], v[128:131], v[104:107]
  ds_read_b128 v[120:123], v30 offset:16384
  ds_read_b64_tr_b16 v[136:137], v36 offset:8192
  v_mfma_f32_16x16x32_bf16 v[108:111], v[148:151], v[128:131], v[108:111]
  ds_read_b64_tr_b16 v[138:139], v36 offset:8704
  s_add_u32 m0, s32, 0
  s_nop 0
  buffer_load_dwordx4 v18, s[20:23], s92 offen lds
  v_mfma_f32_16x16x32_bf16 v[116:119], v[148:151], v[132:135], v[116:119]
  ds_read_b64_tr_b16 v[140:141], v37 offset:8192
  ds_read_b64_tr_b16 v[142:143], v37 offset:8704
  v_mfma_f32_16x16x32_bf16 v[112:115], v[144:147], v[132:135], v[112:115]
  ds_read_b128 v[124:127], v30 offset:16640
  buffer_load_dwordx4 v18, s[20:23], s92 offen offset:1024 lds
  s_add_u32 s92, s92, 16384
  s_sub_u32 s7, s7, 1
  s_cmp_lg_u32 s7, 0
  s_cbranch_scc1 t5_loop_83
  s_waitcnt lgkmcnt(0)
  v_mfma_f32_16x16x32_bf16 v[104:107], v[136:139], v[120:123], v[104:107]
  ds_read_b128 v[128:131], v31 offset:16384
  ds_read_b64_tr_b16 v[144:145], v36 offset:12288
  v_mfma_f32_16x16x32_bf16 v[108:111], v[140:143], v[120:123], v[108:111]
  ds_read_b64_tr_b16 v[146:147], v36 offset:12800
  v_mfma_f32_16x16x32_bf16 v[116:119], v[140:143], v[124:127], v[116:119]
  ds_read_b64_tr_b16 v[148:149], v37 offset:12288
  ds_read_b64_tr_b16 v[150:151], v37 offset:12800
  s_add_u32 m0, s36, 0
  s_nop 0
  buffer_load_dwordx4 v19, s[24:27], s37 offen lds
  s_add_u32 s37, s37, 131072
  v_mfma_f32_16x16x32_bf16 v[112:115], v[136:139], v[124:127], v[112:115]
  ds_read_b128 v[132:135], v31 offset:16640
  s_waitcnt vmcnt(6) lgkmcnt(0)
  s_barrier
  v_mfma_f32_16x16x32_bf16 v[104:107], v[144:147], v[128:131], v[104:107]
  ds_read_b128 v[120:123], v30 offset:32768
  ds_read_b64_tr_b16 v[136:137], v36 offset:16384
  v_mfma_f32_16x16x32_bf16 v[108:111], v[148:151], v[128:131], v[108:111]
  ds_read_b64_tr_b16 v[138:139], v36 offset:16896
  s_add_u32 m0, s32, 16384
  s_nop 0
  buffer_load_dwordx4 v18, s[20:23], s92 offen lds
  v_mfma_f32_16x16x32_bf16 v[116:119], v[148:151], v[132:135], v[116:119]
  ds_read_b64_tr_b16 v[140:141], v37 offset:16384
  ds_read_b64_tr_b16 v[142:143], v37 offset:16896
  v_mfma_f32_16x16x32_bf16 v[112:115], v[144:147], v[132:135], v[112:115]
  ds_read_b128 v[124:127], v30 offset:33024
  buffer_load_dwordx4 v18, s[20:23], s92 offen offset:1024 lds
  s_add_u32 s92, s92, 16384
  s_waitcnt lgkmcnt(0)
  v_mfma_f32_16x16x32_bf16 v[104:107], v[136:139], v[120:123], v[104:107]
  ds_read_b128 v[128:131], v31 offset:32768
  ds_read_b64_tr_b16 v[144:145], v36 offset:20480
  v_mfma_f32_16x16x32_bf16 v[108:111], v[140:143], v[120:123], v[108:111]
  ds_read_b64_tr_b16 v[146:147], v36 offset:20992
  v_mfma_f32_16x16x32_bf16 v[116:119], v[140:143], v[124:127], v[116:119]
  ds_read_b64_tr_b16 v[148:149], v37 offset:20480
  ds_read_b64_tr_b16 v[150:151], v37 offset:20992
  s_add_u32 m0, s36, 8192
  s_nop 0
  buffer_load_dwordx4 v19, s[24:27], s37 offen lds
  s_add_u32 s37, s37, 131072
  v_mfma_f32_16x16x32_bf16 v[112:115], v[136:139], v[124:127], v[112:115]
  ds_read_b128 v[132:135], v31 offset:33024
  s_waitcnt vmcnt(6) lgkmcnt(0)
  s_barrier
  v_mfma_f32_16x16x32_bf16 v[104:107], v[144:147], v[128:131], v[104:107]
  ds_read_b128 v[120:123], v30 offset:49152
  ds_read_b64_tr_b16 v[136:137], v36 offset:24576
  v_mfma_f32_16x16x32_bf16 v[108:111], v[148:151], v[128:131], v[108:111]
  ds_read_b64_tr_b16 v[138:139], v36 offset:25088
  s_add_u32 m0, s32, 32768
  s_nop 0
  buffer_load_dwordx4 v18, s[20:23], s92 offen lds
  v_mfma_f32_16x16x32_bf16 v[116:119], v[148:151], v[132:135], v[116:119]
  ds_read_b64_tr_b16 v[140:141], v37 offset:24576
  ds_read_b64_tr_b16 v[142:143], v37 offset:25088
  v_mfma_f32_16x16x32_bf16 v[112:115], v[144:147], v[132:135], v[112:115]
  ds_read_b128 v[124:127], v30 offset:49408
  buffer_load_dwordx4 v18, s[20:23], s92 offen offset:1024 lds
  s_add_u32 s92, s92, 16384
  s_waitcnt lgkmcnt(0)
  v_mfma_f32_16x16x32_bf16 v[104:107], v[136:139], v[120:123], v[104:107]
  ds_read_b128 v[128:131], v31 offset:49152
  ds_read_b64_tr_b16 v[144:145], v36 offset:28672
  v_mfma_f32_16x16x32_bf16 v[108:111], v[140:143], v[120:123], v[108:111]
  ds_read_b64_tr_b16 v[146:147], v36 offset:29184
  v_mfma_f32_16x16x32_bf16 v[116:119], v[140:143], v[124:127], v[116:119]
  ds_read_b64_tr_b16 v[148:149], v37 offset:28672
  ds_read_b64_tr_b16 v[150:151], v37 offset:29184
  s_add_u32 m0, s36, 16384
  s_nop 0
  buffer_load_dwordx4 v19, s[24:27], s37 offen lds
  s_add_u32 s37, s37, 131072
  v_mfma_f32_16x16x32_bf16 v[112:115], v[136:139], v[124:127], v[112:115]
  ds_read_b128 v[132:135], v31 offset:49408
  s_waitcnt vmcnt(6) lgkmcnt(0)
  s_barrier
  v_mfma_f32_16x16x32_bf16 v[104:107], v[144:147], v[128:131], v[104:107]
  ds_read_b128 v[120:123], v30 offset:0
  ds_read_b64_tr_b16 v[136:137], v36 offset:0
  v_mfma_f32_16x16x32_bf16 v[108:111], v[148:151], v[128:131], v[108:111]
  ds_read_b64_tr_b16 v[138:139], v36 offset:512
  s_add_u32 m0, s32, 49152
  s_nop 0
  buffer_load_dwordx4 v18, s[20:23], s92 offen lds
  v_mfma_f32_16x16x32_bf16 v[116:119], v[148:151], v[132:135], v[116:119]
  ds_read_b64_tr_b16 v[140:141], v37 offset:0
  ds_read_b64_tr_b16 v[142:143], v37 offset:512
  v_mfma_f32_16x16x32_bf16 v[112:115], v[144:147], v[132:135], v[112:115]
  ds_read_b128 v[124:127], v30 offset:256
  buffer_load_dwordx4 v18, s[20:23], s92 offen offset:1024 lds
  s_add_u32 s92, s92, 16384
  s_waitcnt lgkmcnt(0)
  v_mfma_f32_16x16x32_bf16 v[104:107], v[136:139], v[120:123], v[104:107]
  ds_read_b128 v[128:131], v31 offset:0
  ds_read_b64_tr_b16 v[144:145], v36 offset:4096
  v_mfma_f32_16x16x32_bf16 v[108:111], v[140:143], v[120:123], v[108:111]
  ds_read_b64_tr_b16 v[146:147], v36 offset:4608
  v_mfma_f32_16x16x32_bf16 v[116:119], v[140:143], v[124:127], v[116:119]
  ds_read_b64_tr_b16 v[148:149], v37 offset:4096
  ds_read_b64_tr_b16 v[150:151], v37 offset:4608
  s_add_u32 m0, s36, 24576
  s_nop 0
  buffer_load_dwordx4 v19, s[24:27], s37 offen lds
  s_add_u32 s37, s37, 131072
  v_mfma_f32_16x16x32_bf16 v[112:115], v[136:139], v[124:127], v[112:115]
  ds_read_b128 v[132:135], v31 offset:256
  s_waitcnt vmcnt(6) lgkmcnt(0)
  s_barrier
  v_mfma_f32_16x16x32_bf16 v[104:107], v[144:147], v[128:131], v[104:107]
  ds_read_b128 v[120:123], v30 offset:16384
  ds_read_b64_tr_b16 v[136:137], v36 offset:8192
  v_mfma_f32_16x16x32_bf16 v[108:111], v[148:151], v[128:131], v[108:111]
  ds_read_b64_tr_b16 v[138:139], v36 offset:8704
  v_mfma_f32_16x16x32_bf16 v[116:119], v[148:151], v[132:135], v[116:119]
  ds_read_b64_tr_b16 v[140:141], v37 offset:8192
  ds_read_b64_tr_b16 v[142:143], v37 offset:8704
  v_mfma_f32_16x16x32_bf16 v[112:115], v[144:147], v[132:135], v[112:115]
  ds_read_b128 v[124:127], v30 offset:16640
  s_waitcnt lgkmcnt(0)
  v_mfma_f32_16x16x32_bf16 v[104:107], v[136:139], v[120:123], v[104:107]
  ds_read_b128 v[128:131], v31 offset:16384
  ds_read_b64_tr_b16 v[144:145], v36 offset:12288
  v_mfma_f32_16x16x32_bf16 v[108:111], v[140:143], v[120:123], v[108:111]
  ds_read_b64_tr_b16 v[146:147], v36 offset:12800
  v_mfma_f32_16x16x32_bf16 v[116:119], v[140:143], v[124:127], v[116:119]
  ds_read_b64_tr_b16 v[148:149], v37 offset:12288
  ds_read_b64_tr_b16 v[150:151], v37 offset:12800
  v_mfma_f32_16x16x32_bf16 v[112:115], v[136:139], v[124:127], v[112:115]
  ds_read_b128 v[132:135], v31 offset:16640
  s_waitcnt vmcnt(3) lgkmcnt(0)
  s_barrier
  v_mfma_f32_16x16x32_bf16 v[104:107], v[144:147], v[128:131], v[104:107]
  ds_read_b128 v[120:123], v30 offset:32768
  ds_read_b64_tr_b16 v[136:137], v36 offset:16384
  v_mfma_f32_16x16x32_bf16 v[108:111], v[148:151], v[128:131], v[108:111]
  ds_read_b64_tr_b16 v[138:139], v36 offset:16896
  v_mfma_f32_16x16x32_bf16 v[116:119], v[148:151], v[132:135], v[116:119]
  ds_read_b64_tr_b16 v[140:141], v37 offset:16384
  ds_read_b64_tr_b16 v[142:143], v37 offset:16896
  v_mfma_f32_16x16x32_bf16 v[112:115], v[144:147], v[132:135], v[112:115]
  ds_read_b128 v[124:127], v30 offset:33024
  s_waitcnt lgkmcnt(0)
  v_mfma_f32_16x16x32_bf16 v[104:107], v[136:139], v[120:123], v[104:107]
  ds_read_b128 v[128:131], v31 offset:32768
  ds_read_b64_tr_b16 v[144:145], v36 offset:20480
  v_mfma_f32_16x16x32_bf16 v[108:111], v[140:143], v[120:123], v[108:111]
  ds_read_b64_tr_b16 v[146:147], v36 offset:20992
  v_mfma_f32_16x16x32_bf16 v[116:119], v[140:143], v[124:127], v[116:119]
  ds_read_b64_tr_b16 v[148:149], v37 offset:20480
  ds_read_b64_tr_b16 v[150:151], v37 offset:20992
  v_mfma_f32_16x16x32_bf16 v[112:115], v[136:139], v[124:127], v[112:115]
  ds_read_b128 v[132:135], v31 offset:33024
  s_waitcnt vmcnt(0) lgkmcnt(0)
  s_barrier
  v_mfma_f32_16x16x32_bf16 v[104:107], v[144:147], v[128:131], v[104:107]
  ds_read_b128 v[120:123], v30 offset:49152
  ds_read_b64_tr_b16 v[136:137], v36 offset:24576
  v_mfma_f32_16x16x32_bf16 v[108:111], v[148:151], v[128:131], v[108:111]
  ds_read_b64_tr_b16 v[138:139], v36 offset:25088
  v_mfma_f32_16x16x32_bf16 v[116:119], v[148:151], v[132:135], v[116:119]
  ds_read_b64_tr_b16 v[140:141], v37 offset:24576
  ds_read_b64_tr_b16 v[142:143], v37 offset:25088
  v_mfma_f32_16x16x32_bf16 v[112:115], v[144:147], v[132:135], v[112:115]
  ds_read_b128 v[124:127], v30 offset:49408
  s_waitcnt lgkmcnt(0)
  v_mfma_f32_16x16x32_bf16 v[104:107], v[136:139], v[120:123], v[104:107]
  ds_read_b128 v[128:131], v31 offset:49152
  ds_read_b64_tr_b16 v[144:145], v36 offset:28672
  v_mfma_f32_16x16x32_bf16 v[108:111], v[140:143], v[120:123], v[108:111]
  ds_read_b64_tr_b16 v[146:147], v36 offset:29184
  v_mfma_f32_16x16x32_bf16 v[116:119], v[140:143], v[124:127], v[116:119]
  ds_read_b64_tr_b16 v[148:149], v37 offset:28672
  ds_read_b64_tr_b16 v[150:151], v37 offset:29184
  v_mfma_f32_16x16x32_bf16 v[112:115], v[136:139], v[124:127], v[112:115]
  ds_read_b128 v[132:135], v31 offset:49408
  s_waitcnt lgkmcnt(0)
  v_mfma_f32_16x16x32_bf16 v[104:107], v[144:147], v[128:131], v[104:107]
  v_mfma_f32_16x16x32_bf16 v[108:111], v[148:151], v[128:131], v[108:111]
  v_mfma_f32_16x16x32_bf16 v[116:119], v[148:151], v[132:135], v[116:119]
  v_mfma_f32_16x16x32_bf16 v[112:115], v[144:147], v[132:135], v[112:115]
  s_mov_b32 s28, s68
  s_and_b32 s29, s69, 0xffff
  s_mov_b32 s30, 4194304
  s_mov_b32 s31, 0x20000
  v_lshlrev_b32 v6, 11, v20
  s_lshl_b32 s4, s83, 6
  s_add_u32 s4, s4, s78
  v_add_u32 v6, s4, v6
  v_bfe_u32 v3, v1, 4, 1
  v_lshl_add_u32 v6, v3, 5, v6
  v_lshrrev_b32 v3, 5, v1
  v_lshl_add_u32 v6, v3, 4, v6
  v_cvt_pk_bf16_f32 v120, v104, v105
  v_cvt_pk_bf16_f32 v121, v106, v107
  v_cvt_pk_bf16_f32 v122, v108, v109
  v_cvt_pk_bf16_f32 v123, v110, v111
  s_nop 0
  v_permlane16_swap_b32 v120, v122
  v_permlane16_swap_b32 v121, v123
  s_mov_b32 s4, 0
  buffer_store_dwordx4 v[120:123], v6, s[28:31], s4 offen
  v_cvt_pk_bf16_f32 v124, v112, v113
  v_cvt_pk_bf16_f32 v125, v114, v115
  v_cvt_pk_bf16_f32 v126, v116, v117
  v_cvt_pk_bf16_f32 v127, v118, v119
  s_nop 0
  v_permlane16_swap_b32 v124, v126
  v_permlane16_swap_b32 v125, v127
  s_mov_b32 s4, 32768
  buffer_store_dwordx4 v[124:127], v6, s[28:31], s4 offen
L_end:
  s_endpgm
.section .rodata,"a"
.p2align 6
.amdhsa_kernel gated_mix__linear_kernel_hedgehog__mixer_gmlp__prompt_kernel
  .amdhsa_next_free_vgpr 256
  .amdhsa_next_free_sgpr 96
  .amdhsa_accum_offset 256
  .amdhsa_group_segment_fixed_size 0
  .amdhsa_kernarg_size 104
  .amdhsa_user_sgpr_count 2
  .amdhsa_user_sgpr_kernarg_segment_ptr 1
  .amdhsa_system_sgpr_workgroup_id_x 1
  .amdhsa_float_denorm_mode_32 3
.end_amdhsa_kernel
.text
```
